```python
import torch

def _softmax(x, axis=-1):
    return torch.softmax(x, dim=axis)
def _gelu(x):
    return torch.nn.functional.gelu(x, approximate="tanh")
def _silu(x):
    return torch.nn.functional.silu(x)
def _sigmoid(x):
    return torch.sigmoid(x)
def _layernorm(x, axis=-1, eps=1e-5):
    m = x.mean(dim=axis, keepdim=True)
    v = x.var(dim=axis, keepdim=True, unbiased=False)
    return (x - m) / torch.sqrt(v + eps)
def _scatter_add(tgt, idx, src, axis=0):
    return tgt.clone().index_add_(axis, idx, src)
def _segment_sum(src, seg, n):
    out = torch.zeros((n,) + src.shape[1:], dtype=src.dtype)
    return out.index_add_(0, seg, src)
def _pad(x, pw):
    flat = tuple(v for pair in reversed(pw) for v in pair)
    return torch.nn.functional.pad(x, flat)

kernel_name = 'gated_mix__linear_attn_block__dense_activation_relu__prompt'

def setup_inputs():

    _w = (lambda a: (lambda t: t.to(torch.bfloat16) if t.is_floating_point() else t)(torch.as_tensor(a)))
    def _A_setup():
        B, S, D = 1, 2048, 1024
        return {
            "x": _w((lambda *s: torch.randn(*s, dtype=torch.bfloat16) * 0.05)(B, S, D)),
            "wqkv": _w((lambda *s: torch.randn(*s, dtype=torch.bfloat16) * 0.8)(D, 3 * D)),
            "wo": _w((lambda *s: torch.randn(*s, dtype=torch.bfloat16) * 0.2)(D, D)),
        }
    _A_in = _A_setup()

    def _B_setup():
        B, S, D, Dff = 1, 2048, 1024, 3584
        return {
            "x": _w((lambda *s: torch.randn(*s, dtype=torch.bfloat16) * 0.05)(B, S, D)),
            "w1": _w((lambda *s: torch.randn(*s, dtype=torch.bfloat16) * 0.05)(D, Dff)),
            "w2": _w((lambda *s: torch.randn(*s, dtype=torch.bfloat16) * 0.05)(Dff, D)),
        }
    _B_in = _B_setup()

    return {
        "A_x": _A_in["x"],
        "A_wqkv": _A_in["wqkv"],
        "A_wo": _A_in["wo"],
        "B_x": _B_in["x"],
        "B_w1": _B_in["w1"],
        "B_w2": _B_in["w2"],
        "gate_w": _w((lambda *s: torch.randn(*s, dtype=torch.bfloat16) * 0.05)(1024) * 16.0),
    }

def reference(A_x, A_wqkv, A_wo, B_x, B_w1, B_w2, gate_w):
    def _A_ref(x, wqkv, wo):
        B, S, D = x.shape
        H = 32; Dh = D // H
        qkv = (lambda x, *d: x.permute(*d))((x @ wqkv).reshape(B, S, 3, H, Dh), 2, 0, 3, 1, 4)
        q, k, v = qkv[0], qkv[1], qkv[2]
        phi = lambda t: torch.where(t > 0, t + 1, torch.exp(t)) + 1e-6
        pq, pk = phi(q), phi(k)
        kv = torch.einsum("bhsd,bhse->bhde", pk, v)
        z = torch.einsum("bhsd->bhd", pk)
        num = torch.einsum("bhqd,bhde->bhqe", pq, kv)
        den = torch.einsum("bhqd,bhd->bhq", pq, z)[..., None] + 1e-6
        o = num / den
        return (lambda x, *d: x.permute(*d))(o, 0, 2, 1, 3).reshape(B, S, D) @ wo

    def _B_ref(x, w1, w2):
        h = torch.einsum("bsd,df->bsf", x, w1)
        zero = torch.zeros_like(h)
        h = torch.maximum(h, zero)
        return torch.einsum("bsf,fd->bsd", h, w2)

    x = A_x
    g = _sigmoid((x * gate_w).sum(-1, keepdims=True))
    a = _A_ref(x, A_wqkv, A_wo)
    b = _B_ref(x, B_w1, B_w2)
    return g * a + (1 - g) * b
```

```asm
; @launch grid=(256,1,1) block=(256,1,1) lds=163840
.amdgcn_target "amdgcn-amd-amdhsa--gfx950"
.text
.globl gated_mix__linear_attn_block__dense_activation_relu__prompt_kernel
.p2align 8
.type gated_mix__linear_attn_block__dense_activation_relu__prompt_kernel,@function
gated_mix__linear_attn_block__dense_activation_relu__prompt_kernel:
  s_cmp_ge_u32 s2, 256
  s_cbranch_scc1 L_end
  s_load_dwordx4 s[40:43], s[0:1], 0
  s_load_dwordx4 s[44:47], s[0:1], 32
  s_load_dwordx2 s[48:49], s[0:1], 72
  s_load_dwordx2 s[64:65], s[0:1], 48
  s_load_dwordx2 s[96:97], s[0:1], 16
  s_load_dwordx2 s[60:61], s[0:1], 56
  s_load_dwordx2 s[56:57], s[0:1], 64
  s_mov_b32 s86, s2
  v_lshrrev_b32 v3, 6, v0
  v_and_b32 v1, 63, v0
  v_readfirstlane_b32 s24, v3
  s_nop 0
  s_cmp_eq_u32 s24, 2
  s_cbranch_scc0 L1_ecp
  s_getpc_b64 s[4:5]
L1_ecpa:
  s_mov_b32 s6, gm_text_end-L1_ecpa
  s_mov_b32 s7, 0x20000
  s_lshr_b32 s3, s86, 3
  s_lshl_b32 s3, s3, 7
  v_lshlrev_b32 v34, 12, v1
  s_mov_b64 exec, 4194303
  buffer_load_dword a255, v34, s[4:7], s3 offen
  s_mov_b64 exec, -1
L1_ecp:
  v_lshrrev_b32 v24, 3, v1
  v_lshrrev_b32 v25, 4, v1
  v_and_b32 v26, 7, v1
  v_xor_b32 v27, v26, v25
  v_lshlrev_b32 v28, 11, v24
  v_lshl_add_u32 v4, v27, 4, v28
  v_xor_b32 v5, 64, v4
  v_add_u32 v6, 30720, v4
  v_add_u32 v5, 15360, v5
  v_add_u32 v7, 30720, v5
  s_and_b32 s5, s2, 1
  s_lshl_b32 s5, s5, 2
  s_bfe_u32 s6, s2, 0x20003
  s_add_u32 s25, s5, s6
  s_lshr_b32 s29, s2, 5
  s_and_b32 s29, s29, 2
  s_lshr_b32 s38, s24, 1
  s_and_b32 s39, s24, 1
  s_lshl_b32 s36, s24, 12
  s_xor_b32 s4, s39, s29
  s_lshl_b32 s4, s4, 5
  s_lshl_b32 s5, s25, 8
  s_lshl_b32 s6, s38, 7
  s_add_u32 s5, s5, s6
  s_add_u32 s6, s5, s4
  s_lshl_b32 s30, s6, 11
  s_xor_b32 s31, s30, 131072
  s_mov_b32 s10, 4194304
  s_mov_b32 s11, 0x20000
  s_waitcnt lgkmcnt(0)
  s_mov_b32 s8, s40
  s_mov_b32 s9, s41
  s_add_u32 m0, s36, 131072
  s_nop 0
  buffer_load_dwordx4 v4, s[8:11], s30 offen offset:0 lds
  buffer_load_dwordx4 v5, s[8:11], s30 offen offset:1024 lds
  buffer_load_dwordx4 v6, s[8:11], s30 offen offset:2048 lds
  buffer_load_dwordx4 v7, s[8:11], s30 offen offset:3072 lds
  s_add_u32 s30, s30, 128
  s_bfe_u32 s99, s86, 0x20003
  s_mov_b32 s91, 0x20000
  v_lshlrev_b32 v3, 7, v1
  v_mov_b32 v30, 0x40000000
  s_lshr_b32 s6, s2, 6
  s_lshl_b32 s6, s6, 5
  s_and_b32 s3, s2, 31
  s_add_u32 s6, s6, s3
  s_cmp_eq_u32 s38, 0
  s_cbranch_scc1 L1_pfa
  s_xor_b32 s99, s99, 0
  s_cmp_eq_u32 s39, 0
  s_cselect_b32 s88, s46, s96
  s_cselect_b32 s89, s47, s97
  s_mov_b32 s93, 8192
  s_cmov_b32 s93, 7168
  s_mov_b32 s5, 16384
  s_cmov_b32 s5, 57344
  s_mov_b32 s98, 73760
  s_cmov_b32 s98, 269854
  s_lshl_b32 s90, s5, 7
  s_mul_i32 s92, s5, s6
  s_lshr_b32 s5, s98, 16
  s_mul_i32 s5, s5, s93
  s_bitcmp0_b32 s2, 5
  s_cselect_b32 s5, s5, 0
  s_cselect_b32 s3, 0, 8
  s_add_u32 s92, s92, s5
  s_lshr_b32 s98, s98, s3
  s_and_b32 s98, s98, 0xff
  v_cmp_le_u32 vcc, s93, v3
  s_branch L1_pfd
L1_pfa:
  s_mov_b32 s98, 31
  s_cmp_eq_u32 s39, 0
  s_cbranch_scc0 L1_pfx
  s_bitcmp0_b32 s2, 5
  s_cselect_b32 s88, s42, s44
  s_cselect_b32 s89, s43, s45
  s_mov_b32 s5, 7168
  s_cmov_b32 s5, 6144
  s_lshl_b32 s90, s5, 10
  s_lshl_b32 s93, s5, 7
  s_mul_i32 s92, s6, s5
  v_cmp_le_u32 vcc, s5, v3
  s_branch L1_pfd
L1_pfx:
  s_mov_b32 s88, s40
  s_mov_b32 s89, s41
  s_mov_b32 s90, 4194304
  s_mov_b32 s93, 256
  s_lshl_b32 s92, s2, 14
  s_add_u32 s92, s92, 128
  v_lshrrev_b32 v3, 1, v1
  v_lshlrev_b32 v3, 11, v3
  v_and_b32 v29, 1, v1
  v_cmp_lt_u32 vcc, 15, v1
  v_lshl_add_u32 v3, v29, 7, v3
L1_pfd:
  s_nop 1
  v_cndmask_b32 v3, v3, v30, vcc
  s_cmp_eq_u32 s38, 0
  s_cbranch_scc0 L1_tp0
  buffer_load_dword a255, v3, s[88:91], s92 offen
  s_add_u32 s92, s92, s93
L1_tp0:
  s_add_u32 m0, s36, 0
  s_nop 0
  buffer_load_dwordx4 v4, s[8:11], s31 offen offset:0 lds
  buffer_load_dwordx4 v5, s[8:11], s31 offen offset:1024 lds
  buffer_load_dwordx4 v6, s[8:11], s31 offen offset:2048 lds
  buffer_load_dwordx4 v7, s[8:11], s31 offen offset:3072 lds
  s_add_u32 s31, s31, 128
  s_bfe_u32 s3, s2, 0x20001
  s_bfe_u32 s26, s2, 0x10005
  s_lshr_b32 s5, s2, 6
  s_lshl_b32 s6, s3, 2
  s_add_u32 s27, s5, s6
  s_lshr_b32 s50, s27, 1
  s_mul_i32 s50, s50, 7
  s_and_b32 s51, s27, 1
  s_mul_i32 s51, s51, 3
  s_add_u32 s51, s51, s50
  s_add_u32 s50, s50, 6
  v_and_b32 v27, 1, v25
  v_lshlrev_b32 v27, 1, v27
  v_xor_b32 v27, v27, v26
  v_lshlrev_b32 v27, 4, v27
  v_xor_b32 v28, 64, v27
  s_add_u32 s4, s27, 16
  s_cmp_eq_u32 s26, 0
  s_cselect_b32 s4, s4, s51
  s_cselect_b32 s16, s42, s44
  s_cselect_b32 s17, s43, s45
  s_mov_b32 s54, 7168
  s_cmov_b32 s54, 6144
  s_cmp_eq_u32 s38, 0
  s_cselect_b32 s4, s50, s4
  s_cselect_b32 s55, 7168, s54
  s_cselect_b32 s12, s44, s16
  s_cselect_b32 s13, s45, s17
  s_lshl_b32 s14, s55, 10
  s_cmp_gt_u32 s26, s38
  s_cselect_b32 s14, 0, s14
  s_mov_b32 s15, 0x20000
  s_lshl_b32 s7, s39, 5
  s_lshl_b32 s4, s4, 7
  s_mul_i32 s6, s7, s55
  s_add_u32 s32, s4, s6
  s_lshl_b32 s34, s55, 6
  s_lshl_b32 s4, s55, 3
  s_sub_u32 s4, s4, 1024
  s_lshl_b32 s5, s4, 1
  v_mul_lo_u32 v29, v24, s55
  v_add_u32 v8, v29, v27
  v_add3_u32 v9, v29, v28, s4
  v_add_u32 v10, s5, v8
  v_add_u32 v11, s5, v9
  s_add_u32 m0, s36, 16384
  s_nop 0
  buffer_load_dwordx4 v8, s[12:15], s32 offen offset:0 lds
  buffer_load_dwordx4 v9, s[12:15], s32 offen offset:1024 lds
  buffer_load_dwordx4 v10, s[12:15], s32 offen offset:2048 lds
  buffer_load_dwordx4 v11, s[12:15], s32 offen offset:3072 lds
  s_add_u32 s32, s32, s34
  s_add_u32 s4, s27, 32
  s_xor_b32 s5, s27, 1
  s_cmp_eq_u32 s38, 0
  s_cselect_b32 s4, s4, s5
  s_add_u32 s5, s51, 1
  s_add_u32 s5, s5, s38
  s_cmp_eq_u32 s26, 0
  s_cselect_b32 s4, s4, s5
  s_lshl_b32 s4, s4, 7
  s_mul_i32 s6, s7, s54
  s_add_u32 s33, s4, s6
  s_lshl_b32 s35, s54, 6
  s_lshl_b32 s18, s54, 10
  s_mov_b32 s19, 0x20000
  s_lshl_b32 s4, s54, 3
  s_sub_u32 s4, s4, 1024
  s_lshl_b32 s5, s4, 1
  v_mul_lo_u32 v29, v24, s54
  v_add_u32 v12, v29, v27
  v_add3_u32 v13, v29, v28, s4
  v_add_u32 v14, s5, v12
  v_add_u32 v15, s5, v13
  s_add_u32 m0, s36, 49152
  v_lshlrev_b32 v2, 4, v1
  v_and_b32 v24, 15, v1
  v_lshrrev_b32 v27, 1, v24
  v_xor_b32 v27, v27, v25
  v_lshlrev_b32 v27, 4, v27
  buffer_load_dwordx4 v12, s[16:19], s33 offen offset:0 lds
  v_lshl_add_u32 v27, v24, 7, v27
  s_lshl_b32 s4, s38, 13
  v_add_u32 v16, s4, v27
  v_xor_b32 v17, 64, v16
  v_add_u32 v18, 0x10000, v16
  v_add_u32 v19, 0x10000, v17
  buffer_load_dwordx4 v13, s[16:19], s33 offen offset:1024 lds
  v_bfe_u32 v24, v1, 2, 2
  v_lshl_add_u32 v27, v25, 3, v24
  v_lshlrev_b32 v27, 7, v27
  v_bfe_u32 v28, v1, 3, 2
  s_lshl_b32 s4, s39, 1
  buffer_load_dwordx4 v14, s[16:19], s33 offen offset:2048 lds
  v_xor_b32 v28, s4, v28
  v_lshl_add_u32 v27, v28, 5, v27
  v_and_b32 v28, 3, v1
  v_lshl_add_u32 v27, v28, 3, v27
  v_add_u32 v20, 16384, v27
  v_xor_b32 v21, 32, v20
  buffer_load_dwordx4 v15, s[16:19], s33 offen offset:3072 lds
  v_add_u32 v22, 0x10000, v20
  v_add_u32 v23, 0x10000, v21
  v_add_u32 v24, 0x20000, v16
  v_add_u32 v25, 0x20000, v17
  s_mov_b32 s20, s48
  s_add_u32 s33, s33, s35
  s_mov_b32 s21, s49
  s_mov_b32 s22, 75497472
  s_mov_b32 s23, 0x20000
  s_mov_b32 s58, 256
  s_mov_b32 s59, 0x20000
  s_mov_b32 s66, 2048
  s_add_u32 m0, s36, 32768
  s_mov_b32 s67, 0x20000
  s_bfe_u32 s3, s2, 0x20001
  s_lshl_b32 s52, s25, 2
  s_add_u32 s52, s52, s3
  s_lshl_b32 s52, s52, 3
  s_lshr_b32 s4, s2, 5
  buffer_load_dwordx4 v4, s[8:11], s30 offen offset:0 lds
  s_add_u32 s52, s52, s4
  s_and_b32 s4, s2, 1
  s_lshl_b32 s4, s4, 2
  s_or_b32 s3, s3, s4
  s_and_b32 s4, s2, 0xf8
  buffer_load_dwordx4 v5, s[8:11], s30 offen offset:1024 lds
  s_or_b32 s1, s3, s4
  s_getreg_b32 s53, hwreg(HW_REG_XCC_ID, 0, 4)
  s_or_b32 s53, s53, 0x80
  s_lshr_b32 s3, s52, 3
  s_lshl_b32 s3, s3, 7
  s_add_u32 s69, s3, 40058880
  buffer_load_dwordx4 v6, s[8:11], s30 offen offset:2048 lds
  s_and_b32 s4, s52, 7
  s_lshl_b32 s4, s4, 2
  s_add_u32 s3, s3, s4
  s_add_u32 s55, s3, 40075264
  s_lshr_b32 s3, s52, 3
  buffer_load_dwordx4 v7, s[8:11], s30 offen offset:3072 lds
  s_lshl_b32 s3, s3, 7
  s_and_b32 s4, s52, 7
  s_lshl_b32 s4, s4, 2
  s_add_u32 s3, s3, s4
  s_add_u32 s48, s3, 40042496
  v_mov_b32 v44, s53
  s_add_u32 s30, s30, 128
  v_and_b32 v46, 7, v1
  v_lshlrev_b32 v46, 2, v46
  v_and_b32 v43, 31, v1
  v_lshlrev_b32 v43, 3, v43
  v_lshlrev_b32 v34, 7, v1
  s_mov_b32 s37, 1
  s_lshl_b32 s3, s26, 2
  s_add_u32 s3, s3, s24
  s_getpc_b64 s[4:5]
L1_hopa:
  s_add_u32 s4, s4, L1_hopb-L1_hopa
  s_addc_u32 s5, s5, 0
  s_cmp_eq_u32 s3, 0
  s_cbranch_scc1 L_stubQ0
  s_cmp_eq_u32 s3, 4
  s_cbranch_scc1 L_stubH0
L1_hopb:
  s_waitcnt vmcnt(8)
  s_barrier
  ds_read_b64_tr_b16 a[176:177], v20 offset:0
  ds_read_b64_tr_b16 a[178:179], v20 offset:512
  ds_read_b64_tr_b16 a[180:181], v20 offset:4096
  ds_read_b64_tr_b16 a[182:183], v20 offset:4608
  ds_read_b64_tr_b16 a[184:185], v21 offset:0
  ds_read_b64_tr_b16 a[186:187], v21 offset:512
  ds_read_b64_tr_b16 a[188:189], v21 offset:4096
  ds_read_b64_tr_b16 a[190:191], v21 offset:4608
  ds_read_b64_tr_b16 a[128:129], v20 offset:8192
  ds_read_b64_tr_b16 a[130:131], v20 offset:8704
  ds_read_b64_tr_b16 a[132:133], v20 offset:12288
  ds_read_b64_tr_b16 a[134:135], v20 offset:12800
  ds_read_b64_tr_b16 a[136:137], v21 offset:8192
  ds_read_b64_tr_b16 a[138:139], v21 offset:8704
  ds_read_b64_tr_b16 a[140:141], v21 offset:12288
  ds_read_b64_tr_b16 a[142:143], v21 offset:12800
  ds_read_b128 a[0:3], v24 offset:0
  ds_read_b128 a[4:7], v25 offset:0
  ds_read_b128 a[8:11], v24 offset:2048
  ds_read_b128 a[12:15], v25 offset:2048
  s_add_u32 m0, s36, 81920
  ds_read_b128 a[16:19], v24 offset:4096
  ds_read_b128 a[20:23], v25 offset:4096
  buffer_load_dwordx4 v8, s[12:15], s32 offen offset:0 lds
  ds_read_b128 a[24:27], v24 offset:6144
  ds_read_b128 a[28:31], v25 offset:6144
  buffer_load_dwordx4 v9, s[12:15], s32 offen offset:1024 lds
  ds_read_b128 a[32:35], v16 offset:0
  ds_read_b128 a[36:39], v17 offset:0
  buffer_load_dwordx4 v10, s[12:15], s32 offen offset:2048 lds
  ds_read_b128 a[40:43], v16 offset:2048
  ds_read_b128 a[44:47], v17 offset:2048
  buffer_load_dwordx4 v11, s[12:15], s32 offen offset:3072 lds
  ds_read_b128 a[48:51], v16 offset:4096
  ds_read_b128 a[52:55], v17 offset:4096
  s_add_u32 s32, s32, s34
  ds_read_b128 a[56:59], v16 offset:6144
  ds_read_b128 a[60:63], v17 offset:6144
  s_mov_b32 s28, 0
  s_waitcnt lgkmcnt(0)
  s_cmp_eq_u32 s26, 0
  s_cbranch_scc0 L1_firstH
  s_branch L1_firstQ
  .p2align 12
L_stubQ0:
  s_setpc_b64 s[4:5]
  s_nop 0
L1_firstQ:
  v_mfma_f32_16x16x32_bf16 v[240:243], a[176:179], a[0:3], 0
  v_mfma_f32_16x16x32_bf16 v[240:243], a[180:183], a[4:7], v[240:243]
  s_add_u32 m0, s36, 65536
  v_mfma_f32_16x16x32_bf16 v[244:247], a[180:183], a[12:15], 0
  buffer_load_dwordx4 v4, s[8:11], s31 offen offset:0 lds
  v_mfma_f32_16x16x32_bf16 v[244:247], a[176:179], a[8:11], v[244:247]
  v_mfma_f32_16x16x32_bf16 a[232:235], a[176:179], a[16:19], 0
  v_mfma_f32_16x16x32_bf16 a[232:235], a[180:183], a[20:23], a[232:235]
  v_mfma_f32_16x16x32_bf16 a[240:243], a[180:183], a[28:31], 0
  buffer_load_dwordx4 v5, s[8:11], s31 offen offset:1024 lds
  v_mfma_f32_16x16x32_bf16 a[240:243], a[176:179], a[24:27], a[240:243]
  v_mfma_f32_16x16x32_bf16 v[248:251], a[184:187], a[0:3], 0
  v_mfma_f32_16x16x32_bf16 v[248:251], a[188:191], a[4:7], v[248:251]
  v_mfma_f32_16x16x32_bf16 v[252:255], a[188:191], a[12:15], 0
  v_mfma_f32_16x16x32_bf16 v[252:255], a[184:187], a[8:11], v[252:255]
  buffer_load_dwordx4 v6, s[8:11], s31 offen offset:2048 lds
  v_mfma_f32_16x16x32_bf16 a[236:239], a[184:187], a[16:19], 0
  v_mfma_f32_16x16x32_bf16 a[236:239], a[188:191], a[20:23], a[236:239]
  v_mfma_f32_16x16x32_bf16 a[244:247], a[188:191], a[28:31], 0
  v_mfma_f32_16x16x32_bf16 a[244:247], a[184:187], a[24:27], a[244:247]
  v_mfma_f32_16x16x32_bf16 v[48:51], a[0:3], a[128:131], 0
  buffer_load_dwordx4 v7, s[8:11], s31 offen offset:3072 lds
  v_mfma_f32_16x16x32_bf16 v[48:51], a[4:7], a[132:135], v[48:51]
  v_mfma_f32_16x16x32_bf16 v[52:55], a[12:15], a[132:135], 0
  v_mfma_f32_16x16x32_bf16 v[52:55], a[8:11], a[128:131], v[52:55]
  v_mfma_f32_16x16x32_bf16 v[56:59], a[16:19], a[128:131], 0
  s_add_u32 s31, s31, 128
  s_add_u32 m0, s36, 114688
  v_mfma_f32_16x16x32_bf16 v[56:59], a[20:23], a[132:135], v[56:59]
  buffer_load_dwordx4 v12, s[16:19], s33 offen offset:0 lds
  v_mfma_f32_16x16x32_bf16 v[60:63], a[28:31], a[132:135], 0
  v_mfma_f32_16x16x32_bf16 v[60:63], a[24:27], a[128:131], v[60:63]
  s_waitcnt vmcnt(9)
  s_barrier
  s_cmp_eq_u32 s38, 0
  s_cbranch_scc0 L1_loopQf_t1
  buffer_load_dword a255, v3, s[88:91], s92 offen
  s_add_u32 s92, s92, s93
L1_loopQf_t1:
  v_mfma_f32_16x16x32_bf16 v[64:67], a[32:35], a[128:131], 0
  ds_read_b64_tr_b16 a[144:145], v20 offset:32768
  ds_read_b64_tr_b16 a[146:147], v20 offset:33280
  v_mfma_f32_16x16x32_bf16 v[64:67], a[36:39], a[132:135], v[64:67]
  ds_read_b64_tr_b16 a[148:149], v20 offset:36864
  ds_read_b64_tr_b16 a[150:151], v20 offset:37376
  v_mfma_f32_16x16x32_bf16 v[68:71], a[44:47], a[132:135], 0
  buffer_load_dwordx4 v13, s[16:19], s33 offen offset:1024 lds
  ds_read_b128 a[64:67], v16 offset:32768
  v_mfma_f32_16x16x32_bf16 v[68:71], a[40:43], a[128:131], v[68:71]
  ds_read_b64_tr_b16 a[152:153], v21 offset:32768
  v_mfma_f32_16x16x32_bf16 v[72:75], a[48:51], a[128:131], 0
  ds_read_b128 a[68:71], v17 offset:32768
  v_mfma_f32_16x16x32_bf16 v[72:75], a[52:55], a[132:135], v[72:75]
  ds_read_b64_tr_b16 a[154:155], v21 offset:33280
  v_mfma_f32_16x16x32_bf16 v[76:79], a[60:63], a[132:135], 0
  buffer_load_dwordx4 v14, s[16:19], s33 offen offset:2048 lds
  v_mfma_f32_16x16x32_bf16 v[76:79], a[56:59], a[128:131], v[76:79]
  ds_read_b64_tr_b16 a[156:157], v21 offset:36864
  v_mfma_f32_16x16x32_bf16 v[80:83], a[0:3], a[136:139], 0
  ds_read_b128 a[72:75], v16 offset:34816
  v_mfma_f32_16x16x32_bf16 v[80:83], a[4:7], a[140:143], v[80:83]
  ds_read_b64_tr_b16 a[158:159], v21 offset:37376
  v_mfma_f32_16x16x32_bf16 v[84:87], a[12:15], a[140:143], 0
  v_mfma_f32_16x16x32_bf16 v[84:87], a[8:11], a[136:139], v[84:87]
  buffer_load_dwordx4 v15, s[16:19], s33 offen offset:3072 lds
  ds_read_b128 a[76:79], v17 offset:34816
  v_mfma_f32_16x16x32_bf16 v[88:91], a[16:19], a[136:139], 0
  ds_read_b64_tr_b16 a[160:161], v20 offset:40960
  v_mfma_f32_16x16x32_bf16 v[88:91], a[20:23], a[140:143], v[88:91]
  ds_read_b64_tr_b16 a[162:163], v20 offset:41472
  v_mfma_f32_16x16x32_bf16 v[92:95], a[28:31], a[140:143], 0
  v_mfma_f32_16x16x32_bf16 v[92:95], a[24:27], a[136:139], v[92:95]
  s_add_u32 s33, s33, s35
  s_add_u32 m0, s36, 98304
  ds_read_b128 a[80:83], v16 offset:36864
  v_mfma_f32_16x16x32_bf16 v[96:99], a[32:35], a[136:139], 0
  buffer_load_dwordx4 v4, s[8:11], s30 offen offset:0 lds
  ds_read_b64_tr_b16 a[164:165], v20 offset:45056
  v_mfma_f32_16x16x32_bf16 v[96:99], a[36:39], a[140:143], v[96:99]
  ds_read_b128 a[84:87], v17 offset:36864
  v_mfma_f32_16x16x32_bf16 v[100:103], a[44:47], a[140:143], 0
  ds_read_b64_tr_b16 a[166:167], v20 offset:45568
  v_mfma_f32_16x16x32_bf16 v[100:103], a[40:43], a[136:139], v[100:103]
  v_mfma_f32_16x16x32_bf16 v[104:107], a[48:51], a[136:139], 0
  ds_read_b64_tr_b16 a[168:169], v21 offset:40960
  v_mfma_f32_16x16x32_bf16 v[104:107], a[52:55], a[140:143], v[104:107]
  buffer_load_dwordx4 v5, s[8:11], s30 offen offset:1024 lds
  ds_read_b128 a[88:91], v16 offset:38912
  v_mfma_f32_16x16x32_bf16 v[108:111], a[60:63], a[140:143], 0
  ds_read_b64_tr_b16 a[170:171], v21 offset:41472
  v_mfma_f32_16x16x32_bf16 v[108:111], a[56:59], a[136:139], v[108:111]
  s_waitcnt lgkmcnt(15)
  v_mfma_f32_16x16x32_bf16 v[112:115], a[0:3], a[144:147], 0
  ds_read_b128 a[92:95], v17 offset:38912
  v_mfma_f32_16x16x32_bf16 v[112:115], a[4:7], a[148:151], v[112:115]
  ds_read_b64_tr_b16 a[172:173], v21 offset:45056
  v_mfma_f32_16x16x32_bf16 v[116:119], a[12:15], a[148:151], 0
  ds_read_b64_tr_b16 a[174:175], v21 offset:45568
  v_mfma_f32_16x16x32_bf16 v[116:119], a[8:11], a[144:147], v[116:119]
  v_mfma_f32_16x16x32_bf16 v[120:123], a[16:19], a[144:147], 0
  v_mfma_f32_16x16x32_bf16 v[120:123], a[20:23], a[148:151], v[120:123]
  v_mfma_f32_16x16x32_bf16 v[124:127], a[28:31], a[148:151], 0
  v_mfma_f32_16x16x32_bf16 v[124:127], a[24:27], a[144:147], v[124:127]
  s_waitcnt vmcnt(6) lgkmcnt(0)
  s_barrier
  v_mfma_f32_16x16x32_bf16 v[128:131], a[32:35], a[144:147], 0
  ds_read_b64_tr_b16 a[176:177], v22 offset:0
  v_mfma_f32_16x16x32_bf16 v[128:131], a[36:39], a[148:151], v[128:131]
  v_mfma_f32_16x16x32_bf16 v[132:135], a[44:47], a[148:151], 0
  buffer_load_dwordx4 v6, s[8:11], s30 offen offset:2048 lds
  v_mfma_f32_16x16x32_bf16 v[132:135], a[40:43], a[144:147], v[132:135]
  ds_read_b64_tr_b16 a[178:179], v22 offset:512
  v_mfma_f32_16x16x32_bf16 v[136:139], a[48:51], a[144:147], 0
  ds_read_b64_tr_b16 a[180:181], v22 offset:4096
  v_mfma_f32_16x16x32_bf16 v[136:139], a[52:55], a[148:151], v[136:139]
  v_mfma_f32_16x16x32_bf16 v[140:143], a[60:63], a[148:151], 0
  buffer_load_dwordx4 v7, s[8:11], s30 offen offset:3072 lds
  v_mfma_f32_16x16x32_bf16 v[140:143], a[56:59], a[144:147], v[140:143]
  ds_read_b64_tr_b16 a[182:183], v22 offset:4608
  v_mfma_f32_16x16x32_bf16 v[144:147], a[0:3], a[152:155], 0
  ds_read_b128 a[96:99], v18 offset:0
  v_mfma_f32_16x16x32_bf16 v[144:147], a[4:7], a[156:159], v[144:147]
  v_mfma_f32_16x16x32_bf16 v[148:151], a[12:15], a[156:159], 0
  s_add_u32 s30, s30, 128
  s_add_u32 m0, s36, 16384
  v_mfma_f32_16x16x32_bf16 v[148:151], a[8:11], a[152:155], v[148:151]
  buffer_load_dwordx4 v8, s[12:15], s32 offen offset:0 lds
  v_mfma_f32_16x16x32_bf16 v[152:155], a[16:19], a[152:155], 0
  ds_read_b64_tr_b16 a[184:185], v23 offset:0
  v_mfma_f32_16x16x32_bf16 v[152:155], a[20:23], a[156:159], v[152:155]
  ds_read_b128 a[100:103], v19 offset:0
  v_mfma_f32_16x16x32_bf16 v[156:159], a[28:31], a[156:159], 0
  ds_read_b64_tr_b16 a[186:187], v23 offset:512
  v_mfma_f32_16x16x32_bf16 v[156:159], a[24:27], a[152:155], v[156:159]
  v_mfma_f32_16x16x32_bf16 v[160:163], a[32:35], a[152:155], 0
  buffer_load_dwordx4 v9, s[12:15], s32 offen offset:1024 lds
  v_mfma_f32_16x16x32_bf16 v[160:163], a[36:39], a[156:159], v[160:163]
  ds_read_b64_tr_b16 a[188:189], v23 offset:4096
  v_mfma_f32_16x16x32_bf16 v[164:167], a[44:47], a[156:159], 0
  ds_read_b128 a[104:107], v18 offset:2048
  v_mfma_f32_16x16x32_bf16 v[164:167], a[40:43], a[152:155], v[164:167]
  v_mfma_f32_16x16x32_bf16 v[168:171], a[48:51], a[152:155], 0
  ds_read_b64_tr_b16 a[190:191], v23 offset:4608
  v_mfma_f32_16x16x32_bf16 v[168:171], a[52:55], a[156:159], v[168:171]
  buffer_load_dwordx4 v10, s[12:15], s32 offen offset:2048 lds
  v_mfma_f32_16x16x32_bf16 v[172:175], a[60:63], a[156:159], 0
  ds_read_b128 a[108:111], v19 offset:2048
  v_mfma_f32_16x16x32_bf16 v[172:175], a[56:59], a[152:155], v[172:175]
  v_mfma_f32_16x16x32_bf16 v[176:179], a[160:163], a[0:3], 0
  ds_read_b64_tr_b16 a[128:129], v22 offset:8192
  v_mfma_f32_16x16x32_bf16 v[176:179], a[164:167], a[4:7], v[176:179]
  s_getpc_b64 s[4:5]
L1_loopQf_h10a:
  s_add_u32 s4, s4, L1_loopQf_h10b-L1_loopQf_h10a
  s_addc_u32 s5, s5, 0
  s_cmp_eq_u32 s24, 1
  s_cbranch_scc1 L_stubQ1
L1_loopQf_h10b:
  v_mfma_f32_16x16x32_bf16 v[180:183], a[164:167], a[12:15], 0
  buffer_load_dwordx4 v11, s[12:15], s32 offen offset:3072 lds
  v_mfma_f32_16x16x32_bf16 v[180:183], a[160:163], a[8:11], v[180:183]
  ds_read_b64_tr_b16 a[130:131], v22 offset:8704
  v_mfma_f32_16x16x32_bf16 v[184:187], a[160:163], a[16:19], 0
  ds_read_b128 a[112:115], v18 offset:4096
  v_mfma_f32_16x16x32_bf16 v[184:187], a[164:167], a[20:23], v[184:187]
  s_add_u32 s32, s32, s34
  s_add_u32 m0, s36, 0
  v_mfma_f32_16x16x32_bf16 v[188:191], a[164:167], a[28:31], 0
  buffer_load_dwordx4 v4, s[8:11], s31 offen offset:0 lds
  v_mfma_f32_16x16x32_bf16 v[188:191], a[160:163], a[24:27], v[188:191]
  ds_read_b64_tr_b16 a[132:133], v22 offset:12288
  v_mfma_f32_16x16x32_bf16 v[192:195], a[160:163], a[32:35], 0
  ds_read_b128 a[116:119], v19 offset:4096
  v_mfma_f32_16x16x32_bf16 v[192:195], a[164:167], a[36:39], v[192:195]
  v_mfma_f32_16x16x32_bf16 v[196:199], a[164:167], a[44:47], 0
  ds_read_b64_tr_b16 a[134:135], v22 offset:12800
  v_mfma_f32_16x16x32_bf16 v[196:199], a[160:163], a[40:43], v[196:199]
  buffer_load_dwordx4 v5, s[8:11], s31 offen offset:1024 lds
  v_mfma_f32_16x16x32_bf16 v[200:203], a[160:163], a[48:51], 0
  ds_read_b64_tr_b16 a[136:137], v23 offset:8192
  v_mfma_f32_16x16x32_bf16 v[200:203], a[164:167], a[52:55], v[200:203]
  v_mfma_f32_16x16x32_bf16 v[204:207], a[164:167], a[60:63], 0
  ds_read_b128 a[120:123], v18 offset:6144
  v_mfma_f32_16x16x32_bf16 v[204:207], a[160:163], a[56:59], v[204:207]
  v_mfma_f32_16x16x32_bf16 v[208:211], a[168:171], a[0:3], 0
  buffer_load_dwordx4 v6, s[8:11], s31 offen offset:2048 lds
  v_mfma_f32_16x16x32_bf16 v[208:211], a[172:175], a[4:7], v[208:211]
  ds_read_b64_tr_b16 a[138:139], v23 offset:8704
  v_mfma_f32_16x16x32_bf16 v[212:215], a[172:175], a[12:15], 0
  ds_read_b128 a[124:127], v19 offset:6144
  v_mfma_f32_16x16x32_bf16 v[212:215], a[168:171], a[8:11], v[212:215]
  v_mfma_f32_16x16x32_bf16 v[216:219], a[168:171], a[16:19], 0
  ds_read_b64_tr_b16 a[140:141], v23 offset:12288
  v_mfma_f32_16x16x32_bf16 v[216:219], a[172:175], a[20:23], v[216:219]
  buffer_load_dwordx4 v7, s[8:11], s31 offen offset:3072 lds
  v_mfma_f32_16x16x32_bf16 v[220:223], a[172:175], a[28:31], 0
  s_add_u32 s31, s31, 128
  v_mfma_f32_16x16x32_bf16 v[220:223], a[168:171], a[24:27], v[220:223]
  ds_read_b64_tr_b16 a[142:143], v23 offset:12800
  v_mfma_f32_16x16x32_bf16 v[224:227], a[168:171], a[32:35], 0
  v_mfma_f32_16x16x32_bf16 v[224:227], a[172:175], a[36:39], v[224:227]
  v_mfma_f32_16x16x32_bf16 v[228:231], a[172:175], a[44:47], 0
  v_mfma_f32_16x16x32_bf16 v[228:231], a[168:171], a[40:43], v[228:231]
  v_mfma_f32_16x16x32_bf16 v[232:235], a[168:171], a[48:51], 0
  v_mfma_f32_16x16x32_bf16 v[232:235], a[172:175], a[52:55], v[232:235]
  v_mfma_f32_16x16x32_bf16 v[236:239], a[172:175], a[60:63], 0
  v_mfma_f32_16x16x32_bf16 v[236:239], a[168:171], a[56:59], v[236:239]
  s_waitcnt vmcnt(8) lgkmcnt(0)
  s_barrier
  v_mfma_f32_16x16x32_bf16 v[240:243], a[176:179], a[64:67], v[240:243]
  ds_read_b64_tr_b16 a[144:145], v22 offset:32768
  v_mfma_f32_16x16x32_bf16 v[240:243], a[180:183], a[68:71], v[240:243]
  s_add_u32 m0, s36, 49152
  v_mfma_f32_16x16x32_bf16 v[244:247], a[180:183], a[76:79], v[244:247]
  buffer_load_dwordx4 v12, s[16:19], s33 offen offset:0 lds
  v_mfma_f32_16x16x32_bf16 v[244:247], a[176:179], a[72:75], v[244:247]
  ds_read_b64_tr_b16 a[146:147], v22 offset:33280
  v_mfma_f32_16x16x32_bf16 a[232:235], a[176:179], a[80:83], a[232:235]
  ds_read_b64_tr_b16 a[148:149], v22 offset:36864
  v_mfma_f32_16x16x32_bf16 a[232:235], a[180:183], a[84:87], a[232:235]
  v_mfma_f32_16x16x32_bf16 a[240:243], a[180:183], a[92:95], a[240:243]
  buffer_load_dwordx4 v13, s[16:19], s33 offen offset:1024 lds
  v_mfma_f32_16x16x32_bf16 a[240:243], a[176:179], a[88:91], a[240:243]
  ds_read_b64_tr_b16 a[150:151], v22 offset:37376
  v_mfma_f32_16x16x32_bf16 v[248:251], a[184:187], a[64:67], v[248:251]
  ds_read_b128 a[0:3], v18 offset:32768
  v_mfma_f32_16x16x32_bf16 v[248:251], a[188:191], a[68:71], v[248:251]
  v_mfma_f32_16x16x32_bf16 v[252:255], a[188:191], a[76:79], v[252:255]
  ds_read_b64_tr_b16 a[152:153], v23 offset:32768
  v_mfma_f32_16x16x32_bf16 v[252:255], a[184:187], a[72:75], v[252:255]
  buffer_load_dwordx4 v14, s[16:19], s33 offen offset:2048 lds
  v_mfma_f32_16x16x32_bf16 a[236:239], a[184:187], a[80:83], a[236:239]
  ds_read_b128 a[4:7], v19 offset:32768
  v_mfma_f32_16x16x32_bf16 a[236:239], a[188:191], a[84:87], a[236:239]
  v_mfma_f32_16x16x32_bf16 a[244:247], a[188:191], a[92:95], a[244:247]
  ds_read_b64_tr_b16 a[154:155], v23 offset:33280
  v_mfma_f32_16x16x32_bf16 a[244:247], a[184:187], a[88:91], a[244:247]
  v_mfma_f32_16x16x32_bf16 v[48:51], a[64:67], a[128:131], v[48:51]
  buffer_load_dwordx4 v15, s[16:19], s33 offen offset:3072 lds
  v_mfma_f32_16x16x32_bf16 v[48:51], a[68:71], a[132:135], v[48:51]
  ds_read_b64_tr_b16 a[156:157], v23 offset:36864
  v_mfma_f32_16x16x32_bf16 v[52:55], a[76:79], a[132:135], v[52:55]
  ds_read_b128 a[8:11], v18 offset:34816
  v_mfma_f32_16x16x32_bf16 v[52:55], a[72:75], a[128:131], v[52:55]
  v_mfma_f32_16x16x32_bf16 v[56:59], a[80:83], a[128:131], v[56:59]
  s_add_u32 s33, s33, s35
  s_add_u32 m0, s36, 32768
  v_mfma_f32_16x16x32_bf16 v[56:59], a[84:87], a[132:135], v[56:59]
  buffer_load_dwordx4 v4, s[8:11], s30 offen offset:0 lds
  v_mfma_f32_16x16x32_bf16 v[60:63], a[92:95], a[132:135], v[60:63]
  ds_read_b64_tr_b16 a[158:159], v23 offset:37376
  v_mfma_f32_16x16x32_bf16 v[60:63], a[88:91], a[128:131], v[60:63]
  ds_read_b128 a[12:15], v19 offset:34816
  v_mfma_f32_16x16x32_bf16 v[64:67], a[96:99], a[128:131], v[64:67]
  ds_read_b64_tr_b16 a[160:161], v22 offset:40960
  v_mfma_f32_16x16x32_bf16 v[64:67], a[100:103], a[132:135], v[64:67]
  s_getpc_b64 s[4:5]
L1_loopQf_h20a:
  s_add_u32 s4, s4, L1_loopQf_h20b-L1_loopQf_h20a
  s_addc_u32 s5, s5, 0
  s_cmp_eq_u32 s24, 2
  s_cbranch_scc1 L_stubQ2
  s_cmp_eq_u32 s24, 3
  s_cbranch_scc1 L_stubQ3
  s_cmp_eq_u32 s24, 0
  s_cbranch_scc1 L_stubQ4
  s_cmp_eq_u32 s24, 1
  s_cbranch_scc1 L_stubQ5
L1_loopQf_h20b:
  v_mfma_f32_16x16x32_bf16 v[68:71], a[108:111], a[132:135], v[68:71]
  buffer_load_dwordx4 v5, s[8:11], s30 offen offset:1024 lds
  v_mfma_f32_16x16x32_bf16 v[68:71], a[104:107], a[128:131], v[68:71]
  ds_read_b64_tr_b16 a[162:163], v22 offset:41472
  v_mfma_f32_16x16x32_bf16 v[72:75], a[112:115], a[128:131], v[72:75]
  ds_read_b128 a[16:19], v18 offset:36864
  v_mfma_f32_16x16x32_bf16 v[72:75], a[116:119], a[132:135], v[72:75]
  v_mfma_f32_16x16x32_bf16 v[76:79], a[124:127], a[132:135], v[76:79]
  buffer_load_dwordx4 v6, s[8:11], s30 offen offset:2048 lds
  v_mfma_f32_16x16x32_bf16 v[76:79], a[120:123], a[128:131], v[76:79]
  ds_read_b64_tr_b16 a[164:165], v22 offset:45056
  v_mfma_f32_16x16x32_bf16 v[80:83], a[64:67], a[136:139], v[80:83]
  ds_read_b128 a[20:23], v19 offset:36864
  v_mfma_f32_16x16x32_bf16 v[80:83], a[68:71], a[140:143], v[80:83]
  v_mfma_f32_16x16x32_bf16 v[84:87], a[76:79], a[140:143], v[84:87]
  ds_read_b64_tr_b16 a[166:167], v22 offset:45568
  v_mfma_f32_16x16x32_bf16 v[84:87], a[72:75], a[136:139], v[84:87]
  buffer_load_dwordx4 v7, s[8:11], s30 offen offset:3072 lds
  v_mfma_f32_16x16x32_bf16 v[88:91], a[80:83], a[136:139], v[88:91]
  ds_read_b64_tr_b16 a[168:169], v23 offset:40960
  v_mfma_f32_16x16x32_bf16 v[88:91], a[84:87], a[140:143], v[88:91]
  v_mfma_f32_16x16x32_bf16 v[92:95], a[92:95], a[140:143], v[92:95]
  ds_read_b128 a[24:27], v18 offset:38912
  v_mfma_f32_16x16x32_bf16 v[92:95], a[88:91], a[136:139], v[92:95]
  s_add_u32 s30, s30, 128
  s_add_u32 m0, s36, 81920
  v_mfma_f32_16x16x32_bf16 v[96:99], a[96:99], a[136:139], v[96:99]
  buffer_load_dwordx4 v8, s[12:15], s32 offen offset:0 lds
  v_mfma_f32_16x16x32_bf16 v[96:99], a[100:103], a[140:143], v[96:99]
  ds_read_b64_tr_b16 a[170:171], v23 offset:41472
  v_mfma_f32_16x16x32_bf16 v[100:103], a[108:111], a[140:143], v[100:103]
  ds_read_b128 a[28:31], v19 offset:38912
  v_mfma_f32_16x16x32_bf16 v[100:103], a[104:107], a[136:139], v[100:103]
  v_mfma_f32_16x16x32_bf16 v[104:107], a[112:115], a[136:139], v[104:107]
  ds_read_b64_tr_b16 a[172:173], v23 offset:45056
  v_mfma_f32_16x16x32_bf16 v[104:107], a[116:119], a[140:143], v[104:107]
  buffer_load_dwordx4 v9, s[12:15], s32 offen offset:1024 lds
  v_mfma_f32_16x16x32_bf16 v[108:111], a[124:127], a[140:143], v[108:111]
  ds_read_b64_tr_b16 a[174:175], v23 offset:45568
  v_mfma_f32_16x16x32_bf16 v[108:111], a[120:123], a[136:139], v[108:111]
  s_waitcnt lgkmcnt(15)
  v_mfma_f32_16x16x32_bf16 v[112:115], a[64:67], a[144:147], v[112:115]
  v_mfma_f32_16x16x32_bf16 v[112:115], a[68:71], a[148:151], v[112:115]
  v_mfma_f32_16x16x32_bf16 v[116:119], a[76:79], a[148:151], v[116:119]
  v_mfma_f32_16x16x32_bf16 v[116:119], a[72:75], a[144:147], v[116:119]
  s_cmp_eq_u32 s38, 0
  s_cbranch_scc0 L1_loopQf_x2
  buffer_load_dword a255, v3, s[88:91], s92 offen
  s_add_u32 s92, s92, s93
  s_branch L1_loopQf_x4
L1_loopQf_x2:
  s_cmp_eq_u32 s39, 0
  s_cbranch_scc0 L1_loopQf_x3
  buffer_load_dword a255, v34, s[64:67], 0 offen
  s_branch L1_loopQf_x4
L1_loopQf_x3:
  s_lshr_b32 s3, s86, 3
  s_lshr_b32 s4, s86, 5
  s_add_u32 s3, s3, s4
  s_and_b32 s99, s3, 3
  s_and_b32 s3, s52, 7
  s_mov_b32 s28, 0x18
  s_cbranch_scc1 L1_loopQf_x5
  v_mov_b64 v[36:37], 0
  v_mov_b64 v[38:39], 0
  v_lshrrev_b32 v32, 3, v1
  v_and_b32 v33, 0x70, v2
  v_lshl_add_u32 v32, v32, 14, v33
  s_lshl_b32 s3, s52, 7
  s_add_u32 s3, s3, 39976960
  s_lshl_b32 s4, s52, 4
  s_add_u32 s4, s4, 40042496
  buffer_store_dwordx4 v[36:39], v2, s[20:23], s3 offen sc1
  s_add_u32 s3, s3, -131072
  buffer_store_dwordx4 v[36:39], v2, s[20:23], s3 offen sc1
  s_mov_b32 exec_hi, 0xff
  buffer_store_dwordx4 v[36:39], v32, s[20:23], s4 offen sc1
  s_lshl_b32 s3, s52, 6
  s_add_u32 s3, s3, 40124416
  s_mov_b32 exec_hi, 0
  buffer_store_dwordx4 v[36:39], v2, s[20:23], s3 offen sc1
  s_lshl_b32 s3, s52, 5
  s_add_u32 s3, s3, 39911424
  s_mov_b64 exec, 0xffff
  buffer_store_dwordx4 v[36:39], v2, s[20:23], s3 offen sc1
  s_mov_b64 exec, -1
L1_loopQf_x5:
  s_or_b32 s98, s98, s28
L1_loopQf_x4:
  s_add_u32 s55, s55, s24
  v_mfma_f32_16x16x32_bf16 v[120:123], a[80:83], a[144:147], v[120:123]
  v_mfma_f32_16x16x32_bf16 v[120:123], a[84:87], a[148:151], v[120:123]
  v_mfma_f32_16x16x32_bf16 v[124:127], a[92:95], a[148:151], v[124:127]
  v_mfma_f32_16x16x32_bf16 v[124:127], a[88:91], a[144:147], v[124:127]
  s_waitcnt vmcnt(10) lgkmcnt(0)
  s_barrier
  v_mfma_f32_16x16x32_bf16 v[128:131], a[96:99], a[144:147], v[128:131]
  ds_read_b64_tr_b16 a[176:177], v20 offset:0
  v_mfma_f32_16x16x32_bf16 v[128:131], a[100:103], a[148:151], v[128:131]
  v_mfma_f32_16x16x32_bf16 v[132:135], a[108:111], a[148:151], v[132:135]
  buffer_load_dwordx4 v10, s[12:15], s32 offen offset:2048 lds
  v_mfma_f32_16x16x32_bf16 v[132:135], a[104:107], a[144:147], v[132:135]
  ds_read_b64_tr_b16 a[178:179], v20 offset:512
  v_mfma_f32_16x16x32_bf16 v[136:139], a[112:115], a[144:147], v[136:139]
  ds_read_b64_tr_b16 a[180:181], v20 offset:4096
  v_mfma_f32_16x16x32_bf16 v[136:139], a[116:119], a[148:151], v[136:139]
  v_mfma_f32_16x16x32_bf16 v[140:143], a[124:127], a[148:151], v[140:143]
  buffer_load_dwordx4 v11, s[12:15], s32 offen offset:3072 lds
  v_mfma_f32_16x16x32_bf16 v[140:143], a[120:123], a[144:147], v[140:143]
  ds_read_b64_tr_b16 a[182:183], v20 offset:4608
  v_mfma_f32_16x16x32_bf16 v[144:147], a[64:67], a[152:155], v[144:147]
  ds_read_b128 a[32:35], v16 offset:0
  v_mfma_f32_16x16x32_bf16 v[144:147], a[68:71], a[156:159], v[144:147]
  v_mfma_f32_16x16x32_bf16 v[148:151], a[76:79], a[156:159], v[148:151]
  s_add_u32 s32, s32, s34
  s_add_u32 m0, s36, 65536
  v_mfma_f32_16x16x32_bf16 v[148:151], a[72:75], a[152:155], v[148:151]
  buffer_load_dwordx4 v4, s[8:11], s31 offen offset:0 lds
  v_mfma_f32_16x16x32_bf16 v[152:155], a[80:83], a[152:155], v[152:155]
  ds_read_b64_tr_b16 a[184:185], v21 offset:0
  v_mfma_f32_16x16x32_bf16 v[152:155], a[84:87], a[156:159], v[152:155]
  ds_read_b128 a[36:39], v17 offset:0
  v_mfma_f32_16x16x32_bf16 v[156:159], a[92:95], a[156:159], v[156:159]
  ds_read_b64_tr_b16 a[186:187], v21 offset:512
  v_mfma_f32_16x16x32_bf16 v[156:159], a[88:91], a[152:155], v[156:159]
  v_mfma_f32_16x16x32_bf16 v[160:163], a[96:99], a[152:155], v[160:163]
  buffer_load_dwordx4 v5, s[8:11], s31 offen offset:1024 lds
  v_mfma_f32_16x16x32_bf16 v[160:163], a[100:103], a[156:159], v[160:163]
  ds_read_b64_tr_b16 a[188:189], v21 offset:4096
  v_mfma_f32_16x16x32_bf16 v[164:167], a[108:111], a[156:159], v[164:167]
  ds_read_b128 a[40:43], v16 offset:2048
  v_mfma_f32_16x16x32_bf16 v[164:167], a[104:107], a[152:155], v[164:167]
  v_mfma_f32_16x16x32_bf16 v[168:171], a[112:115], a[152:155], v[168:171]
  ds_read_b64_tr_b16 a[190:191], v21 offset:4608
  v_mfma_f32_16x16x32_bf16 v[168:171], a[116:119], a[156:159], v[168:171]
  buffer_load_dwordx4 v6, s[8:11], s31 offen offset:2048 lds
  v_mfma_f32_16x16x32_bf16 v[172:175], a[124:127], a[156:159], v[172:175]
  ds_read_b128 a[44:47], v17 offset:2048
  v_mfma_f32_16x16x32_bf16 v[172:175], a[120:123], a[152:155], v[172:175]
  v_mfma_f32_16x16x32_bf16 v[176:179], a[160:163], a[64:67], v[176:179]
  ds_read_b64_tr_b16 a[128:129], v20 offset:8192
  v_mfma_f32_16x16x32_bf16 v[176:179], a[164:167], a[68:71], v[176:179]
  s_getpc_b64 s[4:5]
L1_loopQf_h30a:
  s_add_u32 s4, s4, L1_loopQf_h30b-L1_loopQf_h30a
  s_addc_u32 s5, s5, 0
  s_cmp_eq_u32 s24, 2
  s_cbranch_scc1 L_stubQ6
  s_cmp_eq_u32 s24, 3
  s_cbranch_scc1 L_stubQ7
  s_cmp_eq_u32 s24, 0
  s_cbranch_scc1 L_stubQ8
  s_cmp_eq_u32 s24, 1
  s_cbranch_scc1 L_stubQ9
L1_loopQf_h30b:
  v_mfma_f32_16x16x32_bf16 v[180:183], a[164:167], a[76:79], v[180:183]
  buffer_load_dwordx4 v7, s[8:11], s31 offen offset:3072 lds
  v_mfma_f32_16x16x32_bf16 v[180:183], a[160:163], a[72:75], v[180:183]
  ds_read_b64_tr_b16 a[130:131], v20 offset:8704
  v_mfma_f32_16x16x32_bf16 v[184:187], a[160:163], a[80:83], v[184:187]
  ds_read_b128 a[48:51], v16 offset:4096
  v_mfma_f32_16x16x32_bf16 v[184:187], a[164:167], a[84:87], v[184:187]
  s_add_u32 s31, s31, 128
  s_add_u32 m0, s36, 114688
  v_mfma_f32_16x16x32_bf16 v[188:191], a[164:167], a[92:95], v[188:191]
  buffer_load_dwordx4 v12, s[16:19], s33 offen offset:0 lds
  v_mfma_f32_16x16x32_bf16 v[188:191], a[160:163], a[88:91], v[188:191]
  ds_read_b64_tr_b16 a[132:133], v20 offset:12288
  v_mfma_f32_16x16x32_bf16 v[192:195], a[160:163], a[96:99], v[192:195]
  ds_read_b128 a[52:55], v17 offset:4096
  v_mfma_f32_16x16x32_bf16 v[192:195], a[164:167], a[100:103], v[192:195]
  v_mfma_f32_16x16x32_bf16 v[196:199], a[164:167], a[108:111], v[196:199]
  ds_read_b64_tr_b16 a[134:135], v20 offset:12800
  v_mfma_f32_16x16x32_bf16 v[196:199], a[160:163], a[104:107], v[196:199]
  buffer_load_dwordx4 v13, s[16:19], s33 offen offset:1024 lds
  v_mfma_f32_16x16x32_bf16 v[200:203], a[160:163], a[112:115], v[200:203]
  ds_read_b64_tr_b16 a[136:137], v21 offset:8192
  v_mfma_f32_16x16x32_bf16 v[200:203], a[164:167], a[116:119], v[200:203]
  v_mfma_f32_16x16x32_bf16 v[204:207], a[164:167], a[124:127], v[204:207]
  ds_read_b128 a[56:59], v16 offset:6144
  v_mfma_f32_16x16x32_bf16 v[204:207], a[160:163], a[120:123], v[204:207]
  v_mfma_f32_16x16x32_bf16 v[208:211], a[168:171], a[64:67], v[208:211]
  buffer_load_dwordx4 v14, s[16:19], s33 offen offset:2048 lds
  v_mfma_f32_16x16x32_bf16 v[208:211], a[172:175], a[68:71], v[208:211]
  ds_read_b64_tr_b16 a[138:139], v21 offset:8704
  v_mfma_f32_16x16x32_bf16 v[212:215], a[172:175], a[76:79], v[212:215]
  ds_read_b128 a[60:63], v17 offset:6144
  v_mfma_f32_16x16x32_bf16 v[212:215], a[168:171], a[72:75], v[212:215]
  v_mfma_f32_16x16x32_bf16 v[216:219], a[168:171], a[80:83], v[216:219]
  ds_read_b64_tr_b16 a[140:141], v21 offset:12288
  v_mfma_f32_16x16x32_bf16 v[216:219], a[172:175], a[84:87], v[216:219]
  buffer_load_dwordx4 v15, s[16:19], s33 offen offset:3072 lds
  v_mfma_f32_16x16x32_bf16 v[220:223], a[172:175], a[92:95], v[220:223]
  s_add_u32 s33, s33, s35
  v_mfma_f32_16x16x32_bf16 v[220:223], a[168:171], a[88:91], v[220:223]
  ds_read_b64_tr_b16 a[142:143], v21 offset:12800
  v_mfma_f32_16x16x32_bf16 v[224:227], a[168:171], a[96:99], v[224:227]
  v_mfma_f32_16x16x32_bf16 v[224:227], a[172:175], a[100:103], v[224:227]
  v_mfma_f32_16x16x32_bf16 v[228:231], a[172:175], a[108:111], v[228:231]
  v_mfma_f32_16x16x32_bf16 v[228:231], a[168:171], a[104:107], v[228:231]
  s_cmp_eq_u32 s38, 0
  v_mfma_f32_16x16x32_bf16 v[232:235], a[168:171], a[112:115], v[232:235]
  s_cbranch_scc1 L1_loopQf_nt3_o
L1_loopQf_nt3:
  v_mfma_f32_16x16x32_bf16 v[232:235], a[172:175], a[116:119], v[232:235]
  s_and_b32 s3, s52, 7
  s_lshl_b32 s3, s3, 2
  s_add_u32 s3, s3, s24
  s_cmp_eq_u32 s3, 3
  s_cbranch_scc1 L1_loopQf_an_o
L1_loopQf_an:
  v_mfma_f32_16x16x32_bf16 v[236:239], a[172:175], a[124:127], v[236:239]
  v_mfma_f32_16x16x32_bf16 v[236:239], a[168:171], a[120:123], v[236:239]
  s_waitcnt vmcnt(12) lgkmcnt(0)
  s_barrier
  s_branch L1_loopQ
L1_loopQf_nt3_o:
  buffer_load_dword a255, v3, s[88:91], s92 offen
  s_add_u32 s92, s92, s93
  s_branch L1_loopQf_nt3
L1_loopQf_an_o:
  s_waitcnt vmcnt(10)
  s_mov_b64 exec, 1
  buffer_store_dword v44, off, s[56:59], s52 sc1
  s_mov_b64 exec, -1
  s_branch L1_loopQf_an
L1_loopQ_nt0_o:
  s_bitcmp1_b32 s28, s37
  s_cbranch_scc1 L1_loopQ_w3
  buffer_load_dword a255, v3, s[88:91], s92 offen
  s_add_u32 s92, s92, s93
  s_branch L1_loopQ_nt0
L1_loopQ_nt1_o:
  s_bitcmp1_b32 s28, s37
  s_cbranch_scc1 L1_loopQ_w3
  buffer_load_dword a255, v3, s[88:91], s92 offen
  s_add_u32 s92, s92, s93
  s_branch L1_loopQ_nt1
L1_loopQ_nt2_o:
  s_bitcmp1_b32 s28, s37
  s_cbranch_scc1 L1_loopQ_w3
  buffer_load_dword a255, v3, s[88:91], s92 offen
  s_add_u32 s92, s92, s93
  s_branch L1_loopQ_nt2
L1_loopQ_nd_o:
  buffer_load_dword v47, v46, s[20:23], s69 offen sc1
  s_branch L1_loopQ_nd
L1_loopQ_nt3_o:
  s_bitcmp1_b32 s28, s37
  s_cbranch_scc1 L1_loopQ_w3
  buffer_load_dword a255, v3, s[88:91], s92 offen
  s_add_u32 s92, s92, s93
  s_branch L1_loopQ_nt3
L1_loopQ_w3:
  s_cmp_eq_u32 s37, 4
  s_cbranch_scc1 L1_loopQ_w3c
  buffer_load_dword v47, v43, s[56:59], 0 offen
  s_branch L1_loopQ_w3r
L1_loopQ_w3c:
  s_mov_b32 s3, 0
L1_loopQ_w3d:
  v_cmp_eq_u32 vcc, 0, v47
  s_add_u32 s3, s3, 1
  s_cmp_eq_u64 vcc, 0
  s_cbranch_scc1 L1_loopQ_w3e
  s_cmp_gt_u32 s3, 262144
  s_cbranch_scc1 L1_loopQ_w3e
  s_sleep 8
  buffer_load_dword v47, v43, s[56:59], 0 offen sc1
  s_waitcnt vmcnt(0)
  s_branch L1_loopQ_w3d
L1_loopQ_w3e:
  s_and_b32 s3, s52, 7
  s_lshl_b32 s3, s3, 2
  s_add_u32 s3, s3, s69
  s_mov_b64 exec, 1
  buffer_store_dword v44, off, s[20:23], s3 sc1
  s_mov_b64 exec, -1
L1_loopQ_w3r:
  s_cmp_eq_u32 s87, 0
  s_cbranch_scc1 L1_loopQ_nt0
  s_cmp_eq_u32 s87, 1
  s_cbranch_scc1 L1_loopQ_nt1
  s_cmp_eq_u32 s87, 2
  s_cbranch_scc1 L1_loopQ_nt2
  s_branch L1_loopQ_nt3
  .p2align 12
L_stubQ1:
  s_setpc_b64 s[4:5]
  s_nop 0
L1_loopQ:
  v_mfma_f32_16x16x32_bf16 v[240:243], a[176:179], a[0:3], v[240:243]
  ds_read_b64_tr_b16 a[144:145], v20 offset:32768
  v_mfma_f32_16x16x32_bf16 v[240:243], a[180:183], a[4:7], v[240:243]
  s_bitcmp1_b32 s98, s37
  s_cselect_b32 s87, s99, 7
  v_mfma_f32_16x16x32_bf16 v[244:247], a[180:183], a[12:15], v[244:247]
  s_add_u32 m0, s36, 98304
  v_mfma_f32_16x16x32_bf16 v[244:247], a[176:179], a[8:11], v[244:247]
  buffer_load_dwordx4 v4, s[8:11], s30 offen offset:0 lds
  v_mfma_f32_16x16x32_bf16 a[232:235], a[176:179], a[16:19], a[232:235]
  ds_read_b64_tr_b16 a[146:147], v20 offset:33280
  v_mfma_f32_16x16x32_bf16 a[232:235], a[180:183], a[20:23], a[232:235]
  ds_read_b64_tr_b16 a[148:149], v20 offset:36864
  v_mfma_f32_16x16x32_bf16 a[240:243], a[180:183], a[28:31], a[240:243]
  ds_read_b64_tr_b16 a[150:151], v20 offset:37376
  v_mfma_f32_16x16x32_bf16 a[240:243], a[176:179], a[24:27], a[240:243]
  v_mfma_f32_16x16x32_bf16 v[248:251], a[184:187], a[0:3], v[248:251]
  buffer_load_dwordx4 v5, s[8:11], s30 offen offset:1024 lds
  v_mfma_f32_16x16x32_bf16 v[248:251], a[188:191], a[4:7], v[248:251]
  ds_read_b128 a[64:67], v16 offset:32768
  v_mfma_f32_16x16x32_bf16 v[252:255], a[188:191], a[12:15], v[252:255]
  ds_read_b64_tr_b16 a[152:153], v21 offset:32768
  v_mfma_f32_16x16x32_bf16 v[252:255], a[184:187], a[8:11], v[252:255]
  v_mfma_f32_16x16x32_bf16 a[236:239], a[184:187], a[16:19], a[236:239]
  ds_read_b128 a[68:71], v17 offset:32768
  v_mfma_f32_16x16x32_bf16 a[236:239], a[188:191], a[20:23], a[236:239]
  v_mfma_f32_16x16x32_bf16 a[244:247], a[188:191], a[28:31], a[244:247]
  buffer_load_dwordx4 v6, s[8:11], s30 offen offset:2048 lds
  v_mfma_f32_16x16x32_bf16 a[244:247], a[184:187], a[24:27], a[244:247]
  ds_read_b64_tr_b16 a[154:155], v21 offset:33280
  v_mfma_f32_16x16x32_bf16 v[48:51], a[0:3], a[128:131], v[48:51]
  ds_read_b64_tr_b16 a[156:157], v21 offset:36864
  v_mfma_f32_16x16x32_bf16 v[48:51], a[4:7], a[132:135], v[48:51]
  v_mfma_f32_16x16x32_bf16 v[52:55], a[12:15], a[132:135], v[52:55]
  ds_read_b128 a[72:75], v16 offset:34816
  v_mfma_f32_16x16x32_bf16 v[52:55], a[8:11], a[128:131], v[52:55]
  v_mfma_f32_16x16x32_bf16 v[56:59], a[16:19], a[128:131], v[56:59]
  buffer_load_dwordx4 v7, s[8:11], s30 offen offset:3072 lds
  v_mfma_f32_16x16x32_bf16 v[56:59], a[20:23], a[132:135], v[56:59]
  ds_read_b64_tr_b16 a[158:159], v21 offset:37376
  v_mfma_f32_16x16x32_bf16 v[60:63], a[28:31], a[132:135], v[60:63]
  ds_read_b128 a[76:79], v17 offset:34816
  v_mfma_f32_16x16x32_bf16 v[60:63], a[24:27], a[128:131], v[60:63]
  v_mfma_f32_16x16x32_bf16 v[64:67], a[32:35], a[128:131], v[64:67]
  ds_read_b64_tr_b16 a[160:161], v20 offset:40960
  v_mfma_f32_16x16x32_bf16 v[64:67], a[36:39], a[132:135], v[64:67]
  s_add_u32 s30, s30, 128
  s_add_u32 m0, s36, 16384
  v_mfma_f32_16x16x32_bf16 v[68:71], a[44:47], a[132:135], v[68:71]
  buffer_load_dwordx4 v8, s[12:15], s32 offen offset:0 lds
  v_mfma_f32_16x16x32_bf16 v[68:71], a[40:43], a[128:131], v[68:71]
  ds_read_b64_tr_b16 a[162:163], v20 offset:41472
  v_mfma_f32_16x16x32_bf16 v[72:75], a[48:51], a[128:131], v[72:75]
  ds_read_b128 a[80:83], v16 offset:36864
  v_mfma_f32_16x16x32_bf16 v[72:75], a[52:55], a[132:135], v[72:75]
  v_mfma_f32_16x16x32_bf16 v[76:79], a[60:63], a[132:135], v[76:79]
  ds_read_b64_tr_b16 a[164:165], v20 offset:45056
  v_mfma_f32_16x16x32_bf16 v[76:79], a[56:59], a[128:131], v[76:79]
  buffer_load_dwordx4 v9, s[12:15], s32 offen offset:1024 lds
  v_mfma_f32_16x16x32_bf16 v[80:83], a[0:3], a[136:139], v[80:83]
  ds_read_b128 a[84:87], v17 offset:36864
  v_mfma_f32_16x16x32_bf16 v[80:83], a[4:7], a[140:143], v[80:83]
  v_mfma_f32_16x16x32_bf16 v[84:87], a[12:15], a[140:143], v[84:87]
  ds_read_b64_tr_b16 a[166:167], v20 offset:45568
  v_mfma_f32_16x16x32_bf16 v[84:87], a[8:11], a[136:139], v[84:87]
  v_mfma_f32_16x16x32_bf16 v[88:91], a[16:19], a[136:139], v[88:91]
  ds_read_b64_tr_b16 a[168:169], v21 offset:40960
  v_mfma_f32_16x16x32_bf16 v[88:91], a[20:23], a[140:143], v[88:91]
  buffer_load_dwordx4 v10, s[12:15], s32 offen offset:2048 lds
  v_mfma_f32_16x16x32_bf16 v[92:95], a[28:31], a[140:143], v[92:95]
  ds_read_b128 a[88:91], v16 offset:38912
  v_mfma_f32_16x16x32_bf16 v[92:95], a[24:27], a[136:139], v[92:95]
  v_mfma_f32_16x16x32_bf16 v[96:99], a[32:35], a[136:139], v[96:99]
  ds_read_b64_tr_b16 a[170:171], v21 offset:41472
  v_mfma_f32_16x16x32_bf16 v[96:99], a[36:39], a[140:143], v[96:99]
  v_mfma_f32_16x16x32_bf16 v[100:103], a[44:47], a[140:143], v[100:103]
  ds_read_b128 a[92:95], v17 offset:38912
  v_mfma_f32_16x16x32_bf16 v[100:103], a[40:43], a[136:139], v[100:103]
  buffer_load_dwordx4 v11, s[12:15], s32 offen offset:3072 lds
  v_mfma_f32_16x16x32_bf16 v[104:107], a[48:51], a[136:139], v[104:107]
  s_add_u32 s32, s32, s34
  v_mfma_f32_16x16x32_bf16 v[104:107], a[52:55], a[140:143], v[104:107]
  ds_read_b64_tr_b16 a[172:173], v21 offset:45056
  v_mfma_f32_16x16x32_bf16 v[108:111], a[60:63], a[140:143], v[108:111]
  ds_read_b64_tr_b16 a[174:175], v21 offset:45568
  v_mfma_f32_16x16x32_bf16 v[108:111], a[56:59], a[136:139], v[108:111]
  s_waitcnt lgkmcnt(15)
  v_mfma_f32_16x16x32_bf16 v[112:115], a[0:3], a[144:147], v[112:115]
  v_mfma_f32_16x16x32_bf16 v[112:115], a[4:7], a[148:151], v[112:115]
  v_mfma_f32_16x16x32_bf16 v[116:119], a[12:15], a[148:151], v[116:119]
  v_mfma_f32_16x16x32_bf16 v[116:119], a[8:11], a[144:147], v[116:119]
  s_cmp_eq_u32 s87, 0
  v_mfma_f32_16x16x32_bf16 v[120:123], a[16:19], a[144:147], v[120:123]
  s_cbranch_scc1 L1_loopQ_nt0_o
L1_loopQ_nt0:
  v_mfma_f32_16x16x32_bf16 v[120:123], a[20:23], a[148:151], v[120:123]
  v_mfma_f32_16x16x32_bf16 v[124:127], a[28:31], a[148:151], v[124:127]
  v_mfma_f32_16x16x32_bf16 v[124:127], a[24:27], a[144:147], v[124:127]
  s_waitcnt vmcnt(12) lgkmcnt(0)
  s_barrier
  v_mfma_f32_16x16x32_bf16 v[128:131], a[32:35], a[144:147], v[128:131]
  ds_read_b64_tr_b16 a[176:177], v22 offset:0
  v_mfma_f32_16x16x32_bf16 v[128:131], a[36:39], a[148:151], v[128:131]
  v_mfma_f32_16x16x32_bf16 v[132:135], a[44:47], a[148:151], v[132:135]
  s_add_u32 m0, s36, 0
  v_mfma_f32_16x16x32_bf16 v[132:135], a[40:43], a[144:147], v[132:135]
  buffer_load_dwordx4 v4, s[8:11], s31 offen offset:0 lds
  v_mfma_f32_16x16x32_bf16 v[136:139], a[48:51], a[144:147], v[136:139]
  ds_read_b64_tr_b16 a[178:179], v22 offset:512
  v_mfma_f32_16x16x32_bf16 v[136:139], a[52:55], a[148:151], v[136:139]
  ds_read_b64_tr_b16 a[180:181], v22 offset:4096
  v_mfma_f32_16x16x32_bf16 v[140:143], a[60:63], a[148:151], v[140:143]
  ds_read_b64_tr_b16 a[182:183], v22 offset:4608
  v_mfma_f32_16x16x32_bf16 v[140:143], a[56:59], a[144:147], v[140:143]
  v_mfma_f32_16x16x32_bf16 v[144:147], a[0:3], a[152:155], v[144:147]
  buffer_load_dwordx4 v5, s[8:11], s31 offen offset:1024 lds
  v_mfma_f32_16x16x32_bf16 v[144:147], a[4:7], a[156:159], v[144:147]
  ds_read_b128 a[96:99], v18 offset:0
  v_mfma_f32_16x16x32_bf16 v[148:151], a[12:15], a[156:159], v[148:151]
  ds_read_b64_tr_b16 a[184:185], v23 offset:0
  v_mfma_f32_16x16x32_bf16 v[148:151], a[8:11], a[152:155], v[148:151]
  v_mfma_f32_16x16x32_bf16 v[152:155], a[16:19], a[152:155], v[152:155]
  ds_read_b128 a[100:103], v19 offset:0
  v_mfma_f32_16x16x32_bf16 v[152:155], a[20:23], a[156:159], v[152:155]
  v_mfma_f32_16x16x32_bf16 v[156:159], a[28:31], a[156:159], v[156:159]
  buffer_load_dwordx4 v6, s[8:11], s31 offen offset:2048 lds
  v_mfma_f32_16x16x32_bf16 v[156:159], a[24:27], a[152:155], v[156:159]
  ds_read_b64_tr_b16 a[186:187], v23 offset:512
  v_mfma_f32_16x16x32_bf16 v[160:163], a[32:35], a[152:155], v[160:163]
  ds_read_b64_tr_b16 a[188:189], v23 offset:4096
  v_mfma_f32_16x16x32_bf16 v[160:163], a[36:39], a[156:159], v[160:163]
  v_mfma_f32_16x16x32_bf16 v[164:167], a[44:47], a[156:159], v[164:167]
  ds_read_b128 a[104:107], v18 offset:2048
  v_mfma_f32_16x16x32_bf16 v[164:167], a[40:43], a[152:155], v[164:167]
  v_mfma_f32_16x16x32_bf16 v[168:171], a[48:51], a[152:155], v[168:171]
  buffer_load_dwordx4 v7, s[8:11], s31 offen offset:3072 lds
  v_mfma_f32_16x16x32_bf16 v[168:171], a[52:55], a[156:159], v[168:171]
  ds_read_b64_tr_b16 a[190:191], v23 offset:4608
  v_mfma_f32_16x16x32_bf16 v[172:175], a[60:63], a[156:159], v[172:175]
  ds_read_b128 a[108:111], v19 offset:2048
  v_mfma_f32_16x16x32_bf16 v[172:175], a[56:59], a[152:155], v[172:175]
  v_mfma_f32_16x16x32_bf16 v[176:179], a[160:163], a[0:3], v[176:179]
  ds_read_b64_tr_b16 a[128:129], v22 offset:8192
  v_mfma_f32_16x16x32_bf16 v[176:179], a[164:167], a[4:7], v[176:179]
  s_add_u32 s31, s31, 128
  s_add_u32 m0, s36, 49152
  v_mfma_f32_16x16x32_bf16 v[180:183], a[164:167], a[12:15], v[180:183]
  buffer_load_dwordx4 v12, s[16:19], s33 offen offset:0 lds
  v_mfma_f32_16x16x32_bf16 v[180:183], a[160:163], a[8:11], v[180:183]
  ds_read_b64_tr_b16 a[130:131], v22 offset:8704
  v_mfma_f32_16x16x32_bf16 v[184:187], a[160:163], a[16:19], v[184:187]
  ds_read_b128 a[112:115], v18 offset:4096
  v_mfma_f32_16x16x32_bf16 v[184:187], a[164:167], a[20:23], v[184:187]
  v_mfma_f32_16x16x32_bf16 v[188:191], a[164:167], a[28:31], v[188:191]
  ds_read_b64_tr_b16 a[132:133], v22 offset:12288
  v_mfma_f32_16x16x32_bf16 v[188:191], a[160:163], a[24:27], v[188:191]
  buffer_load_dwordx4 v13, s[16:19], s33 offen offset:1024 lds
  v_mfma_f32_16x16x32_bf16 v[192:195], a[160:163], a[32:35], v[192:195]
  ds_read_b128 a[116:119], v19 offset:4096
  v_mfma_f32_16x16x32_bf16 v[192:195], a[164:167], a[36:39], v[192:195]
  v_mfma_f32_16x16x32_bf16 v[196:199], a[164:167], a[44:47], v[196:199]
  ds_read_b64_tr_b16 a[134:135], v22 offset:12800
  v_mfma_f32_16x16x32_bf16 v[196:199], a[160:163], a[40:43], v[196:199]
  v_mfma_f32_16x16x32_bf16 v[200:203], a[160:163], a[48:51], v[200:203]
  ds_read_b64_tr_b16 a[136:137], v23 offset:8192
  v_mfma_f32_16x16x32_bf16 v[200:203], a[164:167], a[52:55], v[200:203]
  buffer_load_dwordx4 v14, s[16:19], s33 offen offset:2048 lds
  v_mfma_f32_16x16x32_bf16 v[204:207], a[164:167], a[60:63], v[204:207]
  ds_read_b128 a[120:123], v18 offset:6144
  v_mfma_f32_16x16x32_bf16 v[204:207], a[160:163], a[56:59], v[204:207]
  v_mfma_f32_16x16x32_bf16 v[208:211], a[168:171], a[0:3], v[208:211]
  ds_read_b64_tr_b16 a[138:139], v23 offset:8704
  v_mfma_f32_16x16x32_bf16 v[208:211], a[172:175], a[4:7], v[208:211]
  v_mfma_f32_16x16x32_bf16 v[212:215], a[172:175], a[12:15], v[212:215]
  ds_read_b128 a[124:127], v19 offset:6144
  v_mfma_f32_16x16x32_bf16 v[212:215], a[168:171], a[8:11], v[212:215]
  buffer_load_dwordx4 v15, s[16:19], s33 offen offset:3072 lds
  v_mfma_f32_16x16x32_bf16 v[216:219], a[168:171], a[16:19], v[216:219]
  s_add_u32 s33, s33, s35
  v_mfma_f32_16x16x32_bf16 v[216:219], a[172:175], a[20:23], v[216:219]
  ds_read_b64_tr_b16 a[140:141], v23 offset:12288
  v_mfma_f32_16x16x32_bf16 v[220:223], a[172:175], a[28:31], v[220:223]
  ds_read_b64_tr_b16 a[142:143], v23 offset:12800
  v_mfma_f32_16x16x32_bf16 v[220:223], a[168:171], a[24:27], v[220:223]
  v_mfma_f32_16x16x32_bf16 v[224:227], a[168:171], a[32:35], v[224:227]
  v_mfma_f32_16x16x32_bf16 v[224:227], a[172:175], a[36:39], v[224:227]
  v_mfma_f32_16x16x32_bf16 v[228:231], a[172:175], a[44:47], v[228:231]
  v_mfma_f32_16x16x32_bf16 v[228:231], a[168:171], a[40:43], v[228:231]
  s_cmp_eq_u32 s87, 1
  v_mfma_f32_16x16x32_bf16 v[232:235], a[168:171], a[48:51], v[232:235]
  s_cbranch_scc1 L1_loopQ_nt1_o
L1_loopQ_nt1:
  v_mfma_f32_16x16x32_bf16 v[232:235], a[172:175], a[52:55], v[232:235]
  v_mfma_f32_16x16x32_bf16 v[236:239], a[172:175], a[60:63], v[236:239]
  v_mfma_f32_16x16x32_bf16 v[236:239], a[168:171], a[56:59], v[236:239]
  s_waitcnt vmcnt(12) lgkmcnt(0)
  s_barrier
  v_mfma_f32_16x16x32_bf16 v[240:243], a[176:179], a[64:67], v[240:243]
  ds_read_b64_tr_b16 a[144:145], v22 offset:32768
  v_mfma_f32_16x16x32_bf16 v[240:243], a[180:183], a[68:71], v[240:243]
  v_mfma_f32_16x16x32_bf16 v[244:247], a[180:183], a[76:79], v[244:247]
  s_add_u32 m0, s36, 32768
  v_mfma_f32_16x16x32_bf16 v[244:247], a[176:179], a[72:75], v[244:247]
  buffer_load_dwordx4 v4, s[8:11], s30 offen offset:0 lds
  v_mfma_f32_16x16x32_bf16 a[232:235], a[176:179], a[80:83], a[232:235]
  ds_read_b64_tr_b16 a[146:147], v22 offset:33280
  v_mfma_f32_16x16x32_bf16 a[232:235], a[180:183], a[84:87], a[232:235]
  ds_read_b64_tr_b16 a[148:149], v22 offset:36864
  v_mfma_f32_16x16x32_bf16 a[240:243], a[180:183], a[92:95], a[240:243]
  ds_read_b64_tr_b16 a[150:151], v22 offset:37376
  v_mfma_f32_16x16x32_bf16 a[240:243], a[176:179], a[88:91], a[240:243]
  v_mfma_f32_16x16x32_bf16 v[248:251], a[184:187], a[64:67], v[248:251]
  buffer_load_dwordx4 v5, s[8:11], s30 offen offset:1024 lds
  v_mfma_f32_16x16x32_bf16 v[248:251], a[188:191], a[68:71], v[248:251]
  ds_read_b128 a[0:3], v18 offset:32768
  v_mfma_f32_16x16x32_bf16 v[252:255], a[188:191], a[76:79], v[252:255]
  ds_read_b64_tr_b16 a[152:153], v23 offset:32768
  v_mfma_f32_16x16x32_bf16 v[252:255], a[184:187], a[72:75], v[252:255]
  v_mfma_f32_16x16x32_bf16 a[236:239], a[184:187], a[80:83], a[236:239]
  ds_read_b128 a[4:7], v19 offset:32768
  v_mfma_f32_16x16x32_bf16 a[236:239], a[188:191], a[84:87], a[236:239]
  v_mfma_f32_16x16x32_bf16 a[244:247], a[188:191], a[92:95], a[244:247]
  buffer_load_dwordx4 v6, s[8:11], s30 offen offset:2048 lds
  v_mfma_f32_16x16x32_bf16 a[244:247], a[184:187], a[88:91], a[244:247]
  ds_read_b64_tr_b16 a[154:155], v23 offset:33280
  v_mfma_f32_16x16x32_bf16 v[48:51], a[64:67], a[128:131], v[48:51]
  ds_read_b64_tr_b16 a[156:157], v23 offset:36864
  v_mfma_f32_16x16x32_bf16 v[48:51], a[68:71], a[132:135], v[48:51]
  v_mfma_f32_16x16x32_bf16 v[52:55], a[76:79], a[132:135], v[52:55]
  ds_read_b128 a[8:11], v18 offset:34816
  v_mfma_f32_16x16x32_bf16 v[52:55], a[72:75], a[128:131], v[52:55]
  v_mfma_f32_16x16x32_bf16 v[56:59], a[80:83], a[128:131], v[56:59]
  buffer_load_dwordx4 v7, s[8:11], s30 offen offset:3072 lds
  v_mfma_f32_16x16x32_bf16 v[56:59], a[84:87], a[132:135], v[56:59]
  ds_read_b64_tr_b16 a[158:159], v23 offset:37376
  v_mfma_f32_16x16x32_bf16 v[60:63], a[92:95], a[132:135], v[60:63]
  ds_read_b128 a[12:15], v19 offset:34816
  v_mfma_f32_16x16x32_bf16 v[60:63], a[88:91], a[128:131], v[60:63]
  v_mfma_f32_16x16x32_bf16 v[64:67], a[96:99], a[128:131], v[64:67]
  ds_read_b64_tr_b16 a[160:161], v22 offset:40960
  v_mfma_f32_16x16x32_bf16 v[64:67], a[100:103], a[132:135], v[64:67]
  s_add_u32 s30, s30, 128
  s_add_u32 m0, s36, 81920
  v_mfma_f32_16x16x32_bf16 v[68:71], a[108:111], a[132:135], v[68:71]
  buffer_load_dwordx4 v8, s[12:15], s32 offen offset:0 lds
  v_mfma_f32_16x16x32_bf16 v[68:71], a[104:107], a[128:131], v[68:71]
  ds_read_b64_tr_b16 a[162:163], v22 offset:41472
  v_mfma_f32_16x16x32_bf16 v[72:75], a[112:115], a[128:131], v[72:75]
  ds_read_b128 a[16:19], v18 offset:36864
  v_mfma_f32_16x16x32_bf16 v[72:75], a[116:119], a[132:135], v[72:75]
  v_mfma_f32_16x16x32_bf16 v[76:79], a[124:127], a[132:135], v[76:79]
  ds_read_b64_tr_b16 a[164:165], v22 offset:45056
  v_mfma_f32_16x16x32_bf16 v[76:79], a[120:123], a[128:131], v[76:79]
  buffer_load_dwordx4 v9, s[12:15], s32 offen offset:1024 lds
  v_mfma_f32_16x16x32_bf16 v[80:83], a[64:67], a[136:139], v[80:83]
  ds_read_b128 a[20:23], v19 offset:36864
  v_mfma_f32_16x16x32_bf16 v[80:83], a[68:71], a[140:143], v[80:83]
  v_mfma_f32_16x16x32_bf16 v[84:87], a[76:79], a[140:143], v[84:87]
  ds_read_b64_tr_b16 a[166:167], v22 offset:45568
  v_mfma_f32_16x16x32_bf16 v[84:87], a[72:75], a[136:139], v[84:87]
  v_mfma_f32_16x16x32_bf16 v[88:91], a[80:83], a[136:139], v[88:91]
  ds_read_b64_tr_b16 a[168:169], v23 offset:40960
  v_mfma_f32_16x16x32_bf16 v[88:91], a[84:87], a[140:143], v[88:91]
  buffer_load_dwordx4 v10, s[12:15], s32 offen offset:2048 lds
  v_mfma_f32_16x16x32_bf16 v[92:95], a[92:95], a[140:143], v[92:95]
  ds_read_b128 a[24:27], v18 offset:38912
  v_mfma_f32_16x16x32_bf16 v[92:95], a[88:91], a[136:139], v[92:95]
  v_mfma_f32_16x16x32_bf16 v[96:99], a[96:99], a[136:139], v[96:99]
  ds_read_b64_tr_b16 a[170:171], v23 offset:41472
  v_mfma_f32_16x16x32_bf16 v[96:99], a[100:103], a[140:143], v[96:99]
  v_mfma_f32_16x16x32_bf16 v[100:103], a[108:111], a[140:143], v[100:103]
  ds_read_b128 a[28:31], v19 offset:38912
  v_mfma_f32_16x16x32_bf16 v[100:103], a[104:107], a[136:139], v[100:103]
  buffer_load_dwordx4 v11, s[12:15], s32 offen offset:3072 lds
  v_mfma_f32_16x16x32_bf16 v[104:107], a[112:115], a[136:139], v[104:107]
  s_add_u32 s32, s32, s34
  v_mfma_f32_16x16x32_bf16 v[104:107], a[116:119], a[140:143], v[104:107]
  ds_read_b64_tr_b16 a[172:173], v23 offset:45056
  v_mfma_f32_16x16x32_bf16 v[108:111], a[124:127], a[140:143], v[108:111]
  ds_read_b64_tr_b16 a[174:175], v23 offset:45568
  v_mfma_f32_16x16x32_bf16 v[108:111], a[120:123], a[136:139], v[108:111]
  s_waitcnt lgkmcnt(15)
  v_mfma_f32_16x16x32_bf16 v[112:115], a[64:67], a[144:147], v[112:115]
  v_mfma_f32_16x16x32_bf16 v[112:115], a[68:71], a[148:151], v[112:115]
  s_cmp_eq_u32 s37, 6
  v_mfma_f32_16x16x32_bf16 v[116:119], a[76:79], a[148:151], v[116:119]
  s_cbranch_scc1 L1_loopQ_nd_o
L1_loopQ_nd:
  v_mfma_f32_16x16x32_bf16 v[116:119], a[72:75], a[144:147], v[116:119]
  s_cmp_eq_u32 s87, 2
  v_mfma_f32_16x16x32_bf16 v[120:123], a[80:83], a[144:147], v[120:123]
  s_cbranch_scc1 L1_loopQ_nt2_o
L1_loopQ_nt2:
  v_mfma_f32_16x16x32_bf16 v[120:123], a[84:87], a[148:151], v[120:123]
  v_mfma_f32_16x16x32_bf16 v[124:127], a[92:95], a[148:151], v[124:127]
  v_mfma_f32_16x16x32_bf16 v[124:127], a[88:91], a[144:147], v[124:127]
  s_waitcnt vmcnt(12) lgkmcnt(0)
  s_barrier
  v_mfma_f32_16x16x32_bf16 v[128:131], a[96:99], a[144:147], v[128:131]
  ds_read_b64_tr_b16 a[176:177], v20 offset:0
  v_mfma_f32_16x16x32_bf16 v[128:131], a[100:103], a[148:151], v[128:131]
  v_mfma_f32_16x16x32_bf16 v[132:135], a[108:111], a[148:151], v[132:135]
  s_add_u32 m0, s36, 65536
  v_mfma_f32_16x16x32_bf16 v[132:135], a[104:107], a[144:147], v[132:135]
  buffer_load_dwordx4 v4, s[8:11], s31 offen offset:0 lds
  v_mfma_f32_16x16x32_bf16 v[136:139], a[112:115], a[144:147], v[136:139]
  ds_read_b64_tr_b16 a[178:179], v20 offset:512
  v_mfma_f32_16x16x32_bf16 v[136:139], a[116:119], a[148:151], v[136:139]
  ds_read_b64_tr_b16 a[180:181], v20 offset:4096
  v_mfma_f32_16x16x32_bf16 v[140:143], a[124:127], a[148:151], v[140:143]
  ds_read_b64_tr_b16 a[182:183], v20 offset:4608
  v_mfma_f32_16x16x32_bf16 v[140:143], a[120:123], a[144:147], v[140:143]
  v_mfma_f32_16x16x32_bf16 v[144:147], a[64:67], a[152:155], v[144:147]
  buffer_load_dwordx4 v5, s[8:11], s31 offen offset:1024 lds
  v_mfma_f32_16x16x32_bf16 v[144:147], a[68:71], a[156:159], v[144:147]
  ds_read_b128 a[32:35], v16 offset:0
  v_mfma_f32_16x16x32_bf16 v[148:151], a[76:79], a[156:159], v[148:151]
  ds_read_b64_tr_b16 a[184:185], v21 offset:0
  v_mfma_f32_16x16x32_bf16 v[148:151], a[72:75], a[152:155], v[148:151]
  v_mfma_f32_16x16x32_bf16 v[152:155], a[80:83], a[152:155], v[152:155]
  ds_read_b128 a[36:39], v17 offset:0
  v_mfma_f32_16x16x32_bf16 v[152:155], a[84:87], a[156:159], v[152:155]
  v_mfma_f32_16x16x32_bf16 v[156:159], a[92:95], a[156:159], v[156:159]
  buffer_load_dwordx4 v6, s[8:11], s31 offen offset:2048 lds
  v_mfma_f32_16x16x32_bf16 v[156:159], a[88:91], a[152:155], v[156:159]
  ds_read_b64_tr_b16 a[186:187], v21 offset:512
  v_mfma_f32_16x16x32_bf16 v[160:163], a[96:99], a[152:155], v[160:163]
  ds_read_b64_tr_b16 a[188:189], v21 offset:4096
  v_mfma_f32_16x16x32_bf16 v[160:163], a[100:103], a[156:159], v[160:163]
  v_mfma_f32_16x16x32_bf16 v[164:167], a[108:111], a[156:159], v[164:167]
  ds_read_b128 a[40:43], v16 offset:2048
  v_mfma_f32_16x16x32_bf16 v[164:167], a[104:107], a[152:155], v[164:167]
  v_mfma_f32_16x16x32_bf16 v[168:171], a[112:115], a[152:155], v[168:171]
  buffer_load_dwordx4 v7, s[8:11], s31 offen offset:3072 lds
  v_mfma_f32_16x16x32_bf16 v[168:171], a[116:119], a[156:159], v[168:171]
  ds_read_b64_tr_b16 a[190:191], v21 offset:4608
  v_mfma_f32_16x16x32_bf16 v[172:175], a[124:127], a[156:159], v[172:175]
  ds_read_b128 a[44:47], v17 offset:2048
  v_mfma_f32_16x16x32_bf16 v[172:175], a[120:123], a[152:155], v[172:175]
  v_mfma_f32_16x16x32_bf16 v[176:179], a[160:163], a[64:67], v[176:179]
  ds_read_b64_tr_b16 a[128:129], v20 offset:8192
  v_mfma_f32_16x16x32_bf16 v[176:179], a[164:167], a[68:71], v[176:179]
  s_add_u32 s31, s31, 128
  s_add_u32 m0, s36, 114688
  v_mfma_f32_16x16x32_bf16 v[180:183], a[164:167], a[76:79], v[180:183]
  buffer_load_dwordx4 v12, s[16:19], s33 offen offset:0 lds
  v_mfma_f32_16x16x32_bf16 v[180:183], a[160:163], a[72:75], v[180:183]
  ds_read_b64_tr_b16 a[130:131], v20 offset:8704
  v_mfma_f32_16x16x32_bf16 v[184:187], a[160:163], a[80:83], v[184:187]
  ds_read_b128 a[48:51], v16 offset:4096
  v_mfma_f32_16x16x32_bf16 v[184:187], a[164:167], a[84:87], v[184:187]
  v_mfma_f32_16x16x32_bf16 v[188:191], a[164:167], a[92:95], v[188:191]
  ds_read_b64_tr_b16 a[132:133], v20 offset:12288
  v_mfma_f32_16x16x32_bf16 v[188:191], a[160:163], a[88:91], v[188:191]
  buffer_load_dwordx4 v13, s[16:19], s33 offen offset:1024 lds
  v_mfma_f32_16x16x32_bf16 v[192:195], a[160:163], a[96:99], v[192:195]
  ds_read_b128 a[52:55], v17 offset:4096
  v_mfma_f32_16x16x32_bf16 v[192:195], a[164:167], a[100:103], v[192:195]
  v_mfma_f32_16x16x32_bf16 v[196:199], a[164:167], a[108:111], v[196:199]
  ds_read_b64_tr_b16 a[134:135], v20 offset:12800
  v_mfma_f32_16x16x32_bf16 v[196:199], a[160:163], a[104:107], v[196:199]
  v_mfma_f32_16x16x32_bf16 v[200:203], a[160:163], a[112:115], v[200:203]
  ds_read_b64_tr_b16 a[136:137], v21 offset:8192
  v_mfma_f32_16x16x32_bf16 v[200:203], a[164:167], a[116:119], v[200:203]
  buffer_load_dwordx4 v14, s[16:19], s33 offen offset:2048 lds
  v_mfma_f32_16x16x32_bf16 v[204:207], a[164:167], a[124:127], v[204:207]
  ds_read_b128 a[56:59], v16 offset:6144
  v_mfma_f32_16x16x32_bf16 v[204:207], a[160:163], a[120:123], v[204:207]
  v_mfma_f32_16x16x32_bf16 v[208:211], a[168:171], a[64:67], v[208:211]
  ds_read_b64_tr_b16 a[138:139], v21 offset:8704
  v_mfma_f32_16x16x32_bf16 v[208:211], a[172:175], a[68:71], v[208:211]
  v_mfma_f32_16x16x32_bf16 v[212:215], a[172:175], a[76:79], v[212:215]
  ds_read_b128 a[60:63], v17 offset:6144
  v_mfma_f32_16x16x32_bf16 v[212:215], a[168:171], a[72:75], v[212:215]
  buffer_load_dwordx4 v15, s[16:19], s33 offen offset:3072 lds
  v_mfma_f32_16x16x32_bf16 v[216:219], a[168:171], a[80:83], v[216:219]
  s_add_u32 s33, s33, s35
  v_mfma_f32_16x16x32_bf16 v[216:219], a[172:175], a[84:87], v[216:219]
  ds_read_b64_tr_b16 a[140:141], v21 offset:12288
  v_mfma_f32_16x16x32_bf16 v[220:223], a[172:175], a[92:95], v[220:223]
  ds_read_b64_tr_b16 a[142:143], v21 offset:12800
  v_mfma_f32_16x16x32_bf16 v[220:223], a[168:171], a[88:91], v[220:223]
  v_mfma_f32_16x16x32_bf16 v[224:227], a[168:171], a[96:99], v[224:227]
  v_mfma_f32_16x16x32_bf16 v[224:227], a[172:175], a[100:103], v[224:227]
  v_mfma_f32_16x16x32_bf16 v[228:231], a[172:175], a[108:111], v[228:231]
  v_mfma_f32_16x16x32_bf16 v[228:231], a[168:171], a[104:107], v[228:231]
  s_cmp_eq_u32 s87, 3
  v_mfma_f32_16x16x32_bf16 v[232:235], a[168:171], a[112:115], v[232:235]
  s_cbranch_scc1 L1_loopQ_nt3_o
L1_loopQ_nt3:
  v_mfma_f32_16x16x32_bf16 v[232:235], a[172:175], a[116:119], v[232:235]
  s_add_u32 s37, s37, 1
  v_mfma_f32_16x16x32_bf16 v[236:239], a[172:175], a[124:127], v[236:239]
  s_cmp_lt_u32 s37, 7
  v_mfma_f32_16x16x32_bf16 v[236:239], a[168:171], a[120:123], v[236:239]
  s_waitcnt vmcnt(12) lgkmcnt(0)
  s_barrier
  s_cbranch_scc1 L1_loopQ
  v_mfma_f32_16x16x32_bf16 v[240:243], a[176:179], a[0:3], v[240:243]
  s_getpc_b64 s[88:89]
L1_loopQ_cp:
  s_add_u32 s88, s88, L2_entryQ-L1_loopQ_cp
  s_addc_u32 s89, s89, 0
  v_mfma_f32_16x16x32_bf16 v[240:243], a[180:183], a[4:7], v[240:243]
  s_mov_b32 s90, L2_endQ-L2_entryQ
  s_bfe_u32 s6, s86, 0x20003
  s_lshr_b32 s3, s86, 6
  v_mfma_f32_16x16x32_bf16 v[244:247], a[180:183], a[12:15], v[244:247]
  s_lshl_b32 s3, s3, 2
  ds_read_b64_tr_b16 a[144:145], v20 offset:32768
  ds_read_b64_tr_b16 a[146:147], v20 offset:33280
  v_mfma_f32_16x16x32_bf16 v[244:247], a[176:179], a[8:11], v[244:247]
  s_add_u32 s6, s6, s3
  s_lshl_b32 s3, s6, 2
  ds_read_b64_tr_b16 a[148:149], v20 offset:36864
  v_mfma_f32_16x16x32_bf16 a[232:235], a[176:179], a[16:19], a[232:235]
  s_add_u32 s3, s3, s24
  s_lshl_b32 s92, s3, 9
  v_mfma_f32_16x16x32_bf16 a[232:235], a[180:183], a[20:23], a[232:235]
  v_lshlrev_b32 v3, 7, v1
  ds_read_b64_tr_b16 a[150:151], v20 offset:37376
  v_mfma_f32_16x16x32_bf16 a[240:243], a[180:183], a[28:31], a[240:243]
  s_mov_b64 exec, 15
  buffer_load_dword a255, v3, s[88:91], s92 offen
  s_mov_b64 exec, -1
  v_mfma_f32_16x16x32_bf16 a[240:243], a[176:179], a[24:27], a[240:243]
  ds_read_b128 a[64:67], v16 offset:32768
  s_mov_b32 s12, s46
  v_mfma_f32_16x16x32_bf16 v[248:251], a[184:187], a[0:3], v[248:251]
  ds_read_b64_tr_b16 a[152:153], v21 offset:32768
  s_mov_b32 s13, s47
  v_mfma_f32_16x16x32_bf16 v[248:251], a[188:191], a[4:7], v[248:251]
  s_mov_b32 s14, 7340032
  v_mfma_f32_16x16x32_bf16 v[252:255], a[188:191], a[12:15], v[252:255]
  ds_read_b128 a[68:71], v17 offset:32768
  s_and_b32 s41, s1, 3
  v_mfma_f32_16x16x32_bf16 v[252:255], a[184:187], a[8:11], v[252:255]
  ds_read_b64_tr_b16 a[154:155], v21 offset:33280
  s_lshr_b32 s40, s1, 5
  v_mfma_f32_16x16x32_bf16 a[236:239], a[184:187], a[16:19], a[236:239]
  s_lshl_b32 s42, s24, 11
  v_mfma_f32_16x16x32_bf16 a[236:239], a[188:191], a[20:23], a[236:239]
  ds_read_b64_tr_b16 a[156:157], v21 offset:36864
  s_lshl_b32 s3, s40, 1
  v_mfma_f32_16x16x32_bf16 a[244:247], a[188:191], a[28:31], a[244:247]
  s_and_b32 s4, s41, 1
  v_mfma_f32_16x16x32_bf16 a[244:247], a[184:187], a[24:27], a[244:247]
  ds_read_b128 a[72:75], v16 offset:34816
  s_add_u32 s3, s3, s4
  v_mfma_f32_16x16x32_bf16 v[48:51], a[0:3], a[128:131], v[48:51]
  v_mfma_f32_16x16x32_bf16 v[48:51], a[4:7], a[132:135], v[48:51]
  ds_read_b64_tr_b16 a[158:159], v21 offset:37376
  s_lshl_b32 s43, s3, 7
  v_mfma_f32_16x16x32_bf16 v[52:55], a[12:15], a[132:135], v[52:55]
  ds_read_b128 a[76:79], v17 offset:34816
  s_lshl_b32 s3, s24, 15
  v_mfma_f32_16x16x32_bf16 v[52:55], a[8:11], a[128:131], v[52:55]
  s_add_u32 s35, s3, s43
  v_mfma_f32_16x16x32_bf16 v[56:59], a[16:19], a[128:131], v[56:59]
  ds_read_b64_tr_b16 a[160:161], v20 offset:40960
  s_mul_i32 s7, s41, 14
  v_mfma_f32_16x16x32_bf16 v[56:59], a[20:23], a[132:135], v[56:59]
  s_add_u32 s7, s7, 0
  v_mfma_f32_16x16x32_bf16 v[60:63], a[28:31], a[132:135], v[60:63]
  ds_read_b64_tr_b16 a[162:163], v20 offset:41472
  s_lshl_b32 s5, s7, 17
  v_mfma_f32_16x16x32_bf16 v[60:63], a[24:27], a[128:131], v[60:63]
  ds_read_b128 a[80:83], v16 offset:36864
  s_add_u32 s34, s35, s5
  v_mfma_f32_16x16x32_bf16 v[64:67], a[32:35], a[128:131], v[64:67]
  s_xor_b32 s33, s34, 128
  v_mfma_f32_16x16x32_bf16 v[64:67], a[36:39], a[132:135], v[64:67]
  ds_read_b64_tr_b16 a[164:165], v20 offset:45056
  v_mfma_f32_16x16x32_bf16 v[68:71], a[44:47], a[132:135], v[68:71]
  v_lshrrev_b32 v6, 3, v1
  v_mfma_f32_16x16x32_bf16 v[68:71], a[40:43], a[128:131], v[68:71]
  ds_read_b128 a[84:87], v17 offset:36864
  v_lshrrev_b32 v7, 4, v1
  v_mfma_f32_16x16x32_bf16 v[72:75], a[48:51], a[128:131], v[72:75]
  v_and_b32 v8, 7, v1
  v_mfma_f32_16x16x32_bf16 v[72:75], a[52:55], a[132:135], v[72:75]
  ds_read_b64_tr_b16 a[166:167], v20 offset:45568
  v_lshlrev_b32 v7, 1, v7
  v_mfma_f32_16x16x32_bf16 v[76:79], a[60:63], a[132:135], v[76:79]
  ds_read_b64_tr_b16 a[168:169], v21 offset:40960
  v_xor_b32 v7, v7, v8
  v_mfma_f32_16x16x32_bf16 v[76:79], a[56:59], a[128:131], v[76:79]
  v_lshlrev_b32 v7, 4, v7
  v_mfma_f32_16x16x32_bf16 v[80:83], a[0:3], a[136:139], v[80:83]
  ds_read_b128 a[88:91], v16 offset:38912
  v_lshl_add_u32 v4, v6, 11, v7
  v_mfma_f32_16x16x32_bf16 v[80:83], a[4:7], a[140:143], v[80:83]
  v_add_u32 v5, 15360, v4
  v_mfma_f32_16x16x32_bf16 v[84:87], a[12:15], a[140:143], v[84:87]
  ds_read_b64_tr_b16 a[170:171], v21 offset:41472
  v_mov_b32 v15, 1
  v_mfma_f32_16x16x32_bf16 v[84:87], a[8:11], a[136:139], v[84:87]
  ds_read_b128 a[92:95], v17 offset:38912
  v_mfma_f32_16x16x32_bf16 v[88:91], a[16:19], a[136:139], v[88:91]
  v_add_u32 v6, 40, v1
  v_mfma_f32_16x16x32_bf16 v[88:91], a[20:23], a[140:143], v[88:91]
  ds_read_b64_tr_b16 a[172:173], v21 offset:45056
  v_lshrrev_b32 v6, 6, v6
  v_mfma_f32_16x16x32_bf16 v[92:95], a[28:31], a[140:143], v[92:95]
  v_lshl_add_u32 v3, v6, 7, v2
  v_mfma_f32_16x16x32_bf16 v[92:95], a[24:27], a[136:139], v[92:95]
  ds_read_b64_tr_b16 a[174:175], v21 offset:45568
  s_lshl_b32 s3, s25, 4
  v_mfma_f32_16x16x32_bf16 v[96:99], a[32:35], a[136:139], v[96:99]
  s_lshl_b32 s5, s24, 1
  v_mfma_f32_16x16x32_bf16 v[96:99], a[36:39], a[140:143], v[96:99]
  s_add_u32 s3, s3, s5
  v_mfma_f32_16x16x32_bf16 v[100:103], a[44:47], a[140:143], v[100:103]
  s_lshl_b32 s5, s41, 2
  v_mfma_f32_16x16x32_bf16 v[100:103], a[40:43], a[136:139], v[100:103]
  s_and_b32 s5, s5, 8
  v_mfma_f32_16x16x32_bf16 v[104:107], a[48:51], a[136:139], v[104:107]
  v_mfma_f32_16x16x32_bf16 v[104:107], a[52:55], a[140:143], v[104:107]
  s_add_u32 s5, s3, s5
  v_mfma_f32_16x16x32_bf16 v[108:111], a[60:63], a[140:143], v[108:111]
  s_xor_b32 s6, s5, 8
  s_waitcnt vmcnt(5) lgkmcnt(0)
  s_barrier
  v_mfma_f32_16x16x32_bf16 v[108:111], a[56:59], a[136:139], v[108:111]
  ds_read_b64_tr_b16 a[176:177], v22 offset:0
  s_mul_i32 s5, s5, 294912
  v_mfma_f32_16x16x32_bf16 v[112:115], a[0:3], a[144:147], v[112:115]
  ds_read_b64_tr_b16 a[178:179], v22 offset:512
  s_mul_i32 s6, s6, 294912
  v_mfma_f32_16x16x32_bf16 v[112:115], a[4:7], a[148:151], v[112:115]
  ds_read_b64_tr_b16 a[180:181], v22 offset:4096
  s_lshl_b32 s7, s7, 12
  v_mfma_f32_16x16x32_bf16 v[116:119], a[12:15], a[148:151], v[116:119]
  ds_read_b64_tr_b16 a[182:183], v22 offset:4608
  s_add_u32 s32, s5, 229376
  v_mfma_f32_16x16x32_bf16 v[116:119], a[8:11], a[144:147], v[116:119]
  ds_read_b64_tr_b16 a[184:185], v23 offset:0
  s_add_u32 s30, s5, s7
  v_mfma_f32_16x16x32_bf16 v[120:123], a[16:19], a[144:147], v[120:123]
  ds_read_b64_tr_b16 a[186:187], v23 offset:512
  s_add_u32 s31, s6, s7
  v_mfma_f32_16x16x32_bf16 v[120:123], a[20:23], a[148:151], v[120:123]
  ds_read_b64_tr_b16 a[188:189], v23 offset:4096
  v_mfma_f32_16x16x32_bf16 v[124:127], a[28:31], a[148:151], v[124:127]
  ds_read_b64_tr_b16 a[190:191], v23 offset:4608
  v_mfma_f32_16x16x32_bf16 v[124:127], a[24:27], a[144:147], v[124:127]
  v_cmp_eq_u32 vcc, 0, v47
  v_cmp_ne_u32 s[6:7], s53, v47
  v_mfma_f32_16x16x32_bf16 v[128:131], a[32:35], a[144:147], v[128:131]
  ds_read_b128 a[96:99], v18 offset:0
  s_nop 0
  v_mfma_f32_16x16x32_bf16 v[128:131], a[36:39], a[148:151], v[128:131]
  ds_read_b64_tr_b16 a[128:129], v22 offset:8192
  s_cmp_lg_u64 vcc, 0
  s_cbranch_scc1 L1_loopQ_is
L1_loopQ_ir:
  v_mfma_f32_16x16x32_bf16 v[132:135], a[44:47], a[148:151], v[132:135]
  ds_read_b128 a[100:103], v19 offset:0
  s_branch L_stubQs2
L_stubQ2:
  s_setpc_b64 s[4:5]
L_stubQs2:
  s_cmp_lg_u64 s[6:7], 0
  s_cselect_b32 s0, 0, 1
  v_mfma_f32_16x16x32_bf16 v[132:135], a[40:43], a[144:147], v[132:135]
  ds_read_b64_tr_b16 a[130:131], v22 offset:8704
  v_mfma_f32_16x16x32_bf16 v[136:139], a[48:51], a[144:147], v[136:139]
  ds_read_b128 a[104:107], v18 offset:2048
  s_lshl_b32 s4, s29, 1
  s_lshl_b32 s5, s25, 4
  v_mfma_f32_16x16x32_bf16 v[136:139], a[52:55], a[148:151], v[136:139]
  ds_read_b64_tr_b16 a[132:133], v22 offset:12288
  s_lshl_b32 s6, s38, 3
  v_mfma_f32_16x16x32_bf16 v[140:143], a[60:63], a[148:151], v[140:143]
  ds_read_b128 a[108:111], v19 offset:2048
  s_add_u32 s5, s5, s6
  v_mfma_f32_16x16x32_bf16 v[140:143], a[56:59], a[144:147], v[140:143]
  ds_read_b64_tr_b16 a[134:135], v22 offset:12800
  s_add_u32 s5, s5, s4
  v_mfma_f32_16x16x32_bf16 v[144:147], a[0:3], a[152:155], v[144:147]
  s_xor_b32 s88, s5, 0
  v_mfma_f32_16x16x32_bf16 v[144:147], a[4:7], a[156:159], v[144:147]
  ds_read_b128 a[112:115], v18 offset:4096
  s_mul_i32 s88, s88, 294912
  v_mfma_f32_16x16x32_bf16 v[148:151], a[12:15], a[156:159], v[148:151]
  ds_read_b64_tr_b16 a[136:137], v23 offset:8192
  s_xor_b32 s89, s5, 1
  s_mul_i32 s89, s89, 294912
  v_mfma_f32_16x16x32_bf16 v[148:151], a[8:11], a[152:155], v[148:151]
  ds_read_b128 a[116:119], v19 offset:4096
  s_xor_b32 s90, s5, 2
  v_mfma_f32_16x16x32_bf16 v[152:155], a[16:19], a[152:155], v[152:155]
  s_mov_b32 s8, s96
  s_mov_b32 s9, s97
  s_add_u32 m0, s42, 40960
  v_mfma_f32_16x16x32_bf16 v[152:155], a[20:23], a[156:159], v[152:155]
  s_mov_b32 s10, 2097152
  buffer_load_dwordx4 v4, s[12:15], s33 offen offset:0 lds
  v_mfma_f32_16x16x32_bf16 v[156:159], a[28:31], a[156:159], v[156:159]
  ds_read_b64_tr_b16 a[138:139], v23 offset:8704
  ds_read_b128 a[120:123], v18 offset:6144
  ds_read_b64_tr_b16 a[140:141], v23 offset:12288
  v_mfma_f32_16x16x32_bf16 v[156:159], a[24:27], a[152:155], v[156:159]
  ds_read_b128 a[124:127], v19 offset:6144
  s_mul_i32 s90, s90, 294912
  s_xor_b32 s91, s5, 3
  v_mfma_f32_16x16x32_bf16 v[160:163], a[32:35], a[152:155], v[160:163]
  ds_read_b64_tr_b16 a[142:143], v23 offset:12800
  s_mul_i32 s91, s91, 294912
  s_xor_b32 s92, s5, 4
  v_mfma_f32_16x16x32_bf16 v[160:163], a[36:39], a[156:159], v[160:163]
  s_mul_i32 s92, s92, 294912
  s_xor_b32 s93, s5, 5
  s_mul_i32 s93, s93, 294912
  v_mfma_f32_16x16x32_bf16 v[164:167], a[44:47], a[156:159], v[164:167]
  buffer_load_dwordx4 v5, s[12:15], s33 offen offset:1024 lds
  s_xor_b32 s98, s5, 6
  v_mfma_f32_16x16x32_bf16 v[164:167], a[40:43], a[152:155], v[164:167]
  s_add_u32 s33, s33, 393216
  s_mul_i32 s98, s98, 294912
  v_mfma_f32_16x16x32_bf16 v[168:171], a[48:51], a[152:155], v[168:171]
  s_xor_b32 s99, s5, 7
  v_mfma_f32_16x16x32_bf16 v[168:171], a[52:55], a[156:159], v[168:171]
  s_mul_i32 s99, s99, 294912
  v_mfma_f32_16x16x32_bf16 v[172:175], a[60:63], a[156:159], v[172:175]
  v_mfma_f32_16x16x32_bf16 v[172:175], a[56:59], a[152:155], v[172:175]
  s_waitcnt vmcnt(3) lgkmcnt(0)
  s_barrier
  v_mfma_f32_16x16x32_bf16 v[240:243], a[176:179], a[64:67], v[240:243]
  s_add_u32 m0, s42, 65536
  ds_read_b64_tr_b16 a[144:145], v22 offset:32768
  s_lshl_b32 s4, s50, 1
  s_add_u32 s4, s4, s39
  v_mfma_f32_16x16x32_bf16 v[240:243], a[180:183], a[68:71], v[240:243]
  buffer_load_dwordx4 v4, s[12:15], s34 offen offset:0 lds
  s_lshl_b32 s4, s4, 11
  v_mfma_f32_16x16x32_bf16 v[248:251], a[188:191], a[68:71], v[248:251]
  ds_read_b64_tr_b16 a[146:147], v22 offset:33280
  v_add_u32 v19, s4, v3
  s_lshl_b32 s67, s27, 1
  v_mfma_f32_16x16x32_bf16 v[248:251], a[184:187], a[64:67], v[248:251]
  s_add_u32 s67, s67, s39
  v_mfma_f32_16x16x32_bf16 v[244:247], a[176:179], a[72:75], v[244:247]
  buffer_load_dwordx4 v5, s[12:15], s34 offen offset:1024 lds
  ds_read_b64_tr_b16 a[148:149], v22 offset:36864
  s_xor_b32 s4, s67, 2
  v_mfma_f32_16x16x32_bf16 v[244:247], a[180:183], a[76:79], v[244:247]
  s_add_u32 s4, s4, 112
  s_lshl_b32 s50, s4, 11
  v_mfma_f32_16x16x32_bf16 v[252:255], a[188:191], a[76:79], v[252:255]
  ds_read_b64_tr_b16 a[150:151], v22 offset:37376
  s_mov_b32 s64, 1069066811
  s_mov_b32 s65, 1069066811
  v_mfma_f32_16x16x32_bf16 v[252:255], a[184:187], a[72:75], v[252:255]
  s_add_u32 s34, s34, 393216
  s_add_u32 m0, s42, 90112
  s_mov_b32 s66, 897988541
  v_mfma_f32_16x16x32_bf16 a[232:235], a[176:179], a[80:83], a[232:235]
  buffer_load_dwordx4 v4, s[12:15], s33 offen offset:0 lds
  ds_read_b64_tr_b16 a[152:153], v23 offset:32768
  v_mfma_f32_16x16x32_bf16 a[232:235], a[180:183], a[84:87], a[232:235]
  v_mfma_f32_16x16x32_bf16 a[236:239], a[188:191], a[84:87], a[236:239]
  ds_read_b64_tr_b16 a[154:155], v23 offset:33280
  v_mfma_f32_16x16x32_bf16 a[236:239], a[184:187], a[80:83], a[236:239]
  v_mfma_f32_16x16x32_bf16 a[240:243], a[176:179], a[88:91], a[240:243]
  buffer_load_dwordx4 v5, s[12:15], s33 offen offset:1024 lds
  ds_read_b64_tr_b16 a[156:157], v23 offset:36864
  v_mfma_f32_16x16x32_bf16 a[240:243], a[180:183], a[92:95], a[240:243]
  s_add_u32 s33, s33, 524288
  v_mfma_f32_16x16x32_bf16 a[244:247], a[188:191], a[92:95], a[244:247]
  ds_read_b64_tr_b16 a[158:159], v23 offset:37376
  v_mfma_f32_16x16x32_bf16 a[244:247], a[184:187], a[88:91], a[244:247]
  v_mfma_f32_16x16x32_bf16 v[48:51], a[64:67], a[128:131], v[48:51]
  ds_read_b64_tr_b16 a[176:177], v22 offset:40960
  v_mfma_f32_16x16x32_bf16 v[48:51], a[68:71], a[132:135], v[48:51]
  v_mfma_f32_16x16x32_bf16 v[80:83], a[68:71], a[140:143], v[80:83]
  ds_read_b64_tr_b16 a[178:179], v22 offset:41472
  v_mfma_f32_16x16x32_bf16 v[80:83], a[64:67], a[136:139], v[80:83]
  v_mfma_f32_16x16x32_bf16 v[52:55], a[72:75], a[128:131], v[52:55]
  ds_read_b64_tr_b16 a[180:181], v22 offset:45056
  v_mfma_f32_16x16x32_bf16 v[52:55], a[76:79], a[132:135], v[52:55]
  v_mfma_f32_16x16x32_bf16 v[84:87], a[76:79], a[140:143], v[84:87]
  v_mfma_f32_16x16x32_bf16 v[84:87], a[72:75], a[136:139], v[84:87]
  ds_read_b64_tr_b16 a[182:183], v22 offset:45568
  v_mfma_f32_16x16x32_bf16 v[56:59], a[80:83], a[128:131], v[56:59]
  v_mfma_f32_16x16x32_bf16 v[56:59], a[84:87], a[132:135], v[56:59]
  ds_read_b64_tr_b16 a[184:185], v23 offset:40960
  v_mfma_f32_16x16x32_bf16 v[88:91], a[84:87], a[140:143], v[88:91]
  v_mfma_f32_16x16x32_bf16 v[88:91], a[80:83], a[136:139], v[88:91]
  ds_read_b64_tr_b16 a[186:187], v23 offset:41472
  v_mfma_f32_16x16x32_bf16 v[60:63], a[88:91], a[128:131], v[60:63]
  v_mfma_f32_16x16x32_bf16 v[60:63], a[92:95], a[132:135], v[60:63]
  v_mul_f32 v40, s64, v48
  v_mul_f32 v41, s65, v49
  v_mul_f32 v42, s64, v50
  v_mfma_f32_16x16x32_bf16 v[92:95], a[92:95], a[140:143], v[92:95]
  ds_read_b64_tr_b16 a[188:189], v23 offset:45056
  v_mul_f32 v43, s65, v51
  v_mfma_f32_16x16x32_bf16 v[92:95], a[88:91], a[136:139], v[92:95]
  v_exp_f32_e64 v40, v40 clamp
  v_max_f32 v48, s66, v48
  v_mfma_f32_16x16x32_bf16 v[64:67], a[96:99], a[128:131], v[64:67]
  ds_read_b64_tr_b16 a[190:191], v23 offset:45568
  v_exp_f32_e64 v41, v41 clamp
  v_mfma_f32_16x16x32_bf16 v[64:67], a[100:103], a[132:135], v[64:67]
  v_max_f32 v49, s66, v49
  v_exp_f32_e64 v42, v42 clamp
  v_mfma_f32_16x16x32_bf16 v[96:99], a[100:103], a[140:143], v[96:99]
  v_max_f32 v50, s66, v50
  v_exp_f32_e64 v43, v43 clamp
  v_mfma_f32_16x16x32_bf16 v[96:99], a[96:99], a[136:139], v[96:99]
  v_max_f32 v51, s66, v51
  v_add_f32 v48, v48, v40
  v_add_f32 v49, v49, v41
  v_mfma_f32_16x16x32_bf16 v[68:71], a[104:107], a[128:131], v[68:71]
  v_add_f32 v50, v50, v42
  v_add_f32 v51, v51, v43
  v_mul_f32 v44, s64, v52
  v_mfma_f32_16x16x32_bf16 v[68:71], a[108:111], a[132:135], v[68:71]
  v_mul_f32 v45, s65, v53
  v_mul_f32 v46, s64, v54
  v_mul_f32 v47, s65, v55
  v_mfma_f32_16x16x32_bf16 v[100:103], a[108:111], a[140:143], v[100:103]
  v_exp_f32_e64 v44, v44 clamp
  v_max_f32 v52, s66, v52
  v_mfma_f32_16x16x32_bf16 v[100:103], a[104:107], a[136:139], v[100:103]
  v_exp_f32_e64 v45, v45 clamp
  v_max_f32 v53, s66, v53
  v_mfma_f32_16x16x32_bf16 v[72:75], a[112:115], a[128:131], v[72:75]
  v_exp_f32_e64 v46, v46 clamp
  v_max_f32 v54, s66, v54
  s_waitcnt lgkmcnt(0)
  s_barrier
  v_mfma_f32_16x16x32_bf16 v[72:75], a[116:119], a[132:135], v[72:75]
  s_add_u32 m0, s42, 114688
  v_exp_f32_e64 v47, v47 clamp
  v_mfma_f32_16x16x32_bf16 v[104:107], a[116:119], a[140:143], v[104:107]
  buffer_load_dwordx4 v4, s[12:15], s34 offen offset:0 lds
  v_max_f32 v55, s66, v55
  v_mfma_f32_16x16x32_bf16 v[104:107], a[112:115], a[136:139], v[104:107]
  v_add_f32 v52, v52, v44
  v_add_f32 v53, v53, v45
  v_add_f32 v54, v54, v46
  v_mfma_f32_16x16x32_bf16 v[76:79], a[120:123], a[128:131], v[76:79]
  v_add_f32 v55, v55, v47
  v_cvt_pk_bf16_f32 v48, v48, v49
  v_cvt_pk_bf16_f32 v49, v50, v51
  v_mfma_f32_16x16x32_bf16 v[76:79], a[124:127], a[132:135], v[76:79]
  buffer_load_dwordx4 v5, s[12:15], s34 offen offset:1024 lds
  v_cvt_pk_bf16_f32 v50, v52, v53
  v_mfma_f32_16x16x32_bf16 v[108:111], a[124:127], a[140:143], v[108:111]
  v_cvt_pk_bf16_f32 v51, v54, v55
  v_mul_f32 v40, s64, v80
  v_mul_f32 v41, s65, v81
  v_mfma_f32_16x16x32_bf16 v[108:111], a[120:123], a[136:139], v[108:111]
  v_mul_f32 v42, s64, v82
  v_mul_f32 v43, s65, v83
  v_mfma_f32_16x16x32_bf16 v[112:115], a[64:67], a[144:147], v[112:115]
  s_add_u32 s34, s34, 524288
  s_add_u32 m0, s42, 139264
  v_mfma_f32_16x16x32_bf16 v[112:115], a[68:71], a[148:151], v[112:115]
  buffer_load_dwordx4 v4, s[12:15], s33 offen offset:0 lds
  v_mfma_f32_16x16x32_bf16 v[144:147], a[68:71], a[156:159], v[144:147]
  v_exp_f32_e64 v40, v40 clamp
  v_max_f32 v80, s66, v80
  v_mfma_f32_16x16x32_bf16 v[144:147], a[64:67], a[152:155], v[144:147]
  v_exp_f32_e64 v41, v41 clamp
  v_max_f32 v81, s66, v81
  v_mfma_f32_16x16x32_bf16 v[116:119], a[72:75], a[144:147], v[116:119]
  v_exp_f32_e64 v42, v42 clamp
  v_max_f32 v82, s66, v82
  v_mfma_f32_16x16x32_bf16 v[116:119], a[76:79], a[148:151], v[116:119]
  buffer_load_dwordx4 v5, s[12:15], s33 offen offset:1024 lds
  v_mfma_f32_16x16x32_bf16 v[148:151], a[76:79], a[156:159], v[148:151]
  s_add_u32 s33, s33, 393216
  v_exp_f32_e64 v43, v43 clamp
  v_mfma_f32_16x16x32_bf16 v[148:151], a[72:75], a[152:155], v[148:151]
  v_max_f32 v83, s66, v83
  v_add_f32 v80, v80, v40
  v_add_f32 v81, v81, v41
  v_mfma_f32_16x16x32_bf16 v[120:123], a[80:83], a[144:147], v[120:123]
  v_add_f32 v82, v82, v42
  v_add_f32 v83, v83, v43
  v_mul_f32 v44, s64, v84
  v_mfma_f32_16x16x32_bf16 v[120:123], a[84:87], a[148:151], v[120:123]
  v_mul_f32 v45, s65, v85
  v_mul_f32 v46, s64, v86
  v_mul_f32 v47, s65, v87
  v_mfma_f32_16x16x32_bf16 v[152:155], a[84:87], a[156:159], v[152:155]
  v_exp_f32_e64 v44, v44 clamp
  v_max_f32 v84, s66, v84
  v_mfma_f32_16x16x32_bf16 v[152:155], a[80:83], a[152:155], v[152:155]
  v_exp_f32_e64 v45, v45 clamp
  v_max_f32 v85, s66, v85
  v_mfma_f32_16x16x32_bf16 v[124:127], a[88:91], a[144:147], v[124:127]
  v_exp_f32_e64 v46, v46 clamp
  v_max_f32 v86, s66, v86
  v_mfma_f32_16x16x32_bf16 v[124:127], a[92:95], a[148:151], v[124:127]
  v_exp_f32_e64 v47, v47 clamp
  v_max_f32 v87, s66, v87
  v_mfma_f32_16x16x32_bf16 v[156:159], a[92:95], a[156:159], v[156:159]
  v_add_f32 v84, v84, v44
  v_add_f32 v85, v85, v45
  v_add_f32 v86, v86, v46
  v_mfma_f32_16x16x32_bf16 v[156:159], a[88:91], a[152:155], v[156:159]
  v_add_f32 v87, v87, v47
  v_cvt_pk_bf16_f32 v80, v80, v81
  v_cvt_pk_bf16_f32 v81, v82, v83
  v_mfma_f32_16x16x32_bf16 v[128:131], a[96:99], a[144:147], v[128:131]
  v_cvt_pk_bf16_f32 v82, v84, v85
  v_cvt_pk_bf16_f32 v83, v86, v87
  v_mul_f32 v40, s64, v56
  v_mfma_f32_16x16x32_bf16 v[128:131], a[100:103], a[148:151], v[128:131]
  v_mul_f32 v41, s65, v57
  v_mul_f32 v42, s64, v58
  v_mul_f32 v43, s65, v59
  v_mfma_f32_16x16x32_bf16 v[160:163], a[100:103], a[156:159], v[160:163]
  v_exp_f32_e64 v40, v40 clamp
  v_max_f32 v56, s66, v56
  v_mfma_f32_16x16x32_bf16 v[160:163], a[96:99], a[152:155], v[160:163]
  v_exp_f32_e64 v41, v41 clamp
  v_max_f32 v57, s66, v57
  v_mfma_f32_16x16x32_bf16 v[132:135], a[104:107], a[144:147], v[132:135]
  v_exp_f32_e64 v42, v42 clamp
  v_max_f32 v58, s66, v58
  v_mfma_f32_16x16x32_bf16 v[132:135], a[108:111], a[148:151], v[132:135]
  v_exp_f32_e64 v43, v43 clamp
  v_max_f32 v59, s66, v59
  v_mfma_f32_16x16x32_bf16 v[164:167], a[108:111], a[156:159], v[164:167]
  v_add_f32 v56, v56, v40
  v_add_f32 v57, v57, v41
  v_add_f32 v58, v58, v42
  v_mfma_f32_16x16x32_bf16 v[164:167], a[104:107], a[152:155], v[164:167]
  v_add_f32 v59, v59, v43
  v_mul_f32 v44, s64, v60
  v_mul_f32 v45, s65, v61
  v_mfma_f32_16x16x32_bf16 v[136:139], a[112:115], a[144:147], v[136:139]
  v_mul_f32 v46, s64, v62
  v_mul_f32 v47, s65, v63
  v_mfma_f32_16x16x32_bf16 v[136:139], a[116:119], a[148:151], v[136:139]
  v_exp_f32_e64 v44, v44 clamp
  v_max_f32 v60, s66, v60
  v_mfma_f32_16x16x32_bf16 v[168:171], a[116:119], a[156:159], v[168:171]
  v_exp_f32_e64 v45, v45 clamp
  v_max_f32 v61, s66, v61
  v_mfma_f32_16x16x32_bf16 v[168:171], a[112:115], a[152:155], v[168:171]
  v_exp_f32_e64 v46, v46 clamp
  v_max_f32 v62, s66, v62
  v_mfma_f32_16x16x32_bf16 v[140:143], a[120:123], a[144:147], v[140:143]
  v_exp_f32_e64 v47, v47 clamp
  v_max_f32 v63, s66, v63
  v_mfma_f32_16x16x32_bf16 v[140:143], a[124:127], a[148:151], v[140:143]
  v_add_f32 v60, v60, v44
  v_add_f32 v61, v61, v45
  v_add_f32 v62, v62, v46
  v_mfma_f32_16x16x32_bf16 v[172:175], a[124:127], a[156:159], v[172:175]
  v_add_f32 v63, v63, v47
  v_cvt_pk_bf16_f32 v56, v56, v57
  v_cvt_pk_bf16_f32 v57, v58, v59
  v_mfma_f32_16x16x32_bf16 v[172:175], a[120:123], a[152:155], v[172:175]
  v_cvt_pk_bf16_f32 v58, v60, v61
  v_cvt_pk_bf16_f32 v59, v62, v63
  v_mul_f32 v40, s64, v88
  v_mfma_f32_16x16x32_bf16 v[176:179], a[160:163], a[0:3], v[176:179]
  v_mul_f32 v41, s65, v89
  v_mul_f32 v42, s64, v90
  v_mul_f32 v43, s65, v91
  v_mfma_f32_16x16x32_bf16 v[176:179], a[164:167], a[4:7], v[176:179]
  v_exp_f32_e64 v40, v40 clamp
  v_max_f32 v88, s66, v88
  v_mfma_f32_16x16x32_bf16 v[176:179], a[176:179], a[64:67], v[176:179]
  v_exp_f32_e64 v41, v41 clamp
  v_max_f32 v89, s66, v89
  v_mfma_f32_16x16x32_bf16 v[176:179], a[180:183], a[68:71], v[176:179]
  v_exp_f32_e64 v42, v42 clamp
  v_max_f32 v90, s66, v90
  v_mfma_f32_16x16x32_bf16 v[208:211], a[168:171], a[0:3], v[208:211]
  v_exp_f32_e64 v43, v43 clamp
  v_max_f32 v91, s66, v91
  v_mfma_f32_16x16x32_bf16 v[208:211], a[172:175], a[4:7], v[208:211]
  v_add_f32 v88, v88, v40
  v_add_f32 v89, v89, v41
  v_add_f32 v90, v90, v42
  v_mfma_f32_16x16x32_bf16 v[208:211], a[184:187], a[64:67], v[208:211]
  v_add_f32 v91, v91, v43
  v_mul_f32 v44, s64, v92
  v_mul_f32 v45, s65, v93
  v_mfma_f32_16x16x32_bf16 v[208:211], a[188:191], a[68:71], v[208:211]
  v_mul_f32 v46, s64, v94
  v_mul_f32 v47, s65, v95
  v_mfma_f32_16x16x32_bf16 v[180:183], a[160:163], a[8:11], v[180:183]
  v_exp_f32_e64 v44, v44 clamp
  v_max_f32 v92, s66, v92
  v_mfma_f32_16x16x32_bf16 v[180:183], a[164:167], a[12:15], v[180:183]
  v_exp_f32_e64 v45, v45 clamp
  v_max_f32 v93, s66, v93
  v_mfma_f32_16x16x32_bf16 v[180:183], a[176:179], a[72:75], v[180:183]
  v_exp_f32_e64 v46, v46 clamp
  v_max_f32 v94, s66, v94
  v_mfma_f32_16x16x32_bf16 v[180:183], a[180:183], a[76:79], v[180:183]
  v_exp_f32_e64 v47, v47 clamp
  v_max_f32 v95, s66, v95
  v_mfma_f32_16x16x32_bf16 v[212:215], a[168:171], a[8:11], v[212:215]
  v_add_f32 v92, v92, v44
  v_add_f32 v93, v93, v45
  v_add_f32 v94, v94, v46
  v_mfma_f32_16x16x32_bf16 v[212:215], a[172:175], a[12:15], v[212:215]
  v_add_f32 v95, v95, v47
  v_cvt_pk_bf16_f32 v88, v88, v89
  v_cvt_pk_bf16_f32 v89, v90, v91
  v_mfma_f32_16x16x32_bf16 v[212:215], a[184:187], a[72:75], v[212:215]
  v_cvt_pk_bf16_f32 v90, v92, v93
  v_cvt_pk_bf16_f32 v91, v94, v95
  v_cvt_pk_bf16_f32 v24, v240, v241
  v_mfma_f32_16x16x32_bf16 v[212:215], a[188:191], a[76:79], v[212:215]
  v_cvt_pk_bf16_f32 v25, v242, v243
  v_cvt_pk_bf16_f32 v26, v248, v249
  v_cvt_pk_bf16_f32 v27, v250, v251
  v_mfma_f32_16x16x32_bf16 v[184:187], a[160:163], a[16:19], v[184:187]
  v_pk_max_i16 v24, v24, 0
  v_pk_max_i16 v25, v25, 0
  v_pk_max_i16 v26, v26, 0
  v_mfma_f32_16x16x32_bf16 v[184:187], a[164:167], a[20:23], v[184:187]
  v_pk_max_i16 v27, v27, 0
  buffer_store_dwordx4 v[24:27], v19, s[20:23], s88 offen offset:0 sc1
  v_mfma_f32_16x16x32_bf16 v[184:187], a[176:179], a[80:83], v[184:187]
  v_mul_f32 v40, s64, v64
  v_mul_f32 v41, s65, v65
  v_mul_f32 v42, s64, v66
  v_mfma_f32_16x16x32_bf16 v[184:187], a[180:183], a[84:87], v[184:187]
  v_mul_f32 v43, s65, v67
  v_exp_f32_e64 v40, v40 clamp
  v_mfma_f32_16x16x32_bf16 v[216:219], a[168:171], a[16:19], v[216:219]
  v_max_f32 v64, s66, v64
  v_exp_f32_e64 v41, v41 clamp
  v_mfma_f32_16x16x32_bf16 v[216:219], a[172:175], a[20:23], v[216:219]
  v_max_f32 v65, s66, v65
  v_exp_f32_e64 v42, v42 clamp
  v_mfma_f32_16x16x32_bf16 v[216:219], a[184:187], a[80:83], v[216:219]
  v_max_f32 v66, s66, v66
  v_exp_f32_e64 v43, v43 clamp
  v_mfma_f32_16x16x32_bf16 v[216:219], a[188:191], a[84:87], v[216:219]
  v_max_f32 v67, s66, v67
  v_add_f32 v64, v64, v40
  v_add_f32 v65, v65, v41
  v_mfma_f32_16x16x32_bf16 v[188:191], a[160:163], a[24:27], v[188:191]
  v_add_f32 v66, v66, v42
  v_add_f32 v67, v67, v43
  v_mul_f32 v44, s64, v68
  v_mfma_f32_16x16x32_bf16 v[188:191], a[164:167], a[28:31], v[188:191]
  v_mul_f32 v45, s65, v69
  v_mul_f32 v46, s64, v70
  v_mul_f32 v47, s65, v71
  v_mfma_f32_16x16x32_bf16 v[188:191], a[176:179], a[88:91], v[188:191]
  v_exp_f32_e64 v44, v44 clamp
  v_max_f32 v68, s66, v68
  v_mfma_f32_16x16x32_bf16 v[188:191], a[180:183], a[92:95], v[188:191]
  v_exp_f32_e64 v45, v45 clamp
  v_max_f32 v69, s66, v69
  v_mfma_f32_16x16x32_bf16 v[220:223], a[168:171], a[24:27], v[220:223]
  v_exp_f32_e64 v46, v46 clamp
  v_max_f32 v70, s66, v70
  v_mfma_f32_16x16x32_bf16 v[220:223], a[172:175], a[28:31], v[220:223]
  v_exp_f32_e64 v47, v47 clamp
  v_max_f32 v71, s66, v71
  v_mfma_f32_16x16x32_bf16 v[220:223], a[184:187], a[88:91], v[220:223]
  v_add_f32 v68, v68, v44
  v_add_f32 v69, v69, v45
  v_add_f32 v70, v70, v46
  v_mfma_f32_16x16x32_bf16 v[220:223], a[188:191], a[92:95], v[220:223]
  v_add_f32 v71, v71, v47
  v_cvt_pk_bf16_f32 v64, v64, v65
  v_cvt_pk_bf16_f32 v65, v66, v67
  v_mfma_f32_16x16x32_bf16 v[192:195], a[160:163], a[32:35], v[192:195]
  v_cvt_pk_bf16_f32 v66, v68, v69
  v_cvt_pk_bf16_f32 v67, v70, v71
  v_cvt_pk_bf16_f32 v28, v244, v245
  v_mfma_f32_16x16x32_bf16 v[192:195], a[164:167], a[36:39], v[192:195]
  v_cvt_pk_bf16_f32 v29, v246, v247
  v_cvt_pk_bf16_f32 v30, v252, v253
  v_cvt_pk_bf16_f32 v31, v254, v255
  v_mfma_f32_16x16x32_bf16 v[192:195], a[176:179], a[96:99], v[192:195]
  v_pk_max_i16 v28, v28, 0
  v_pk_max_i16 v29, v29, 0
  v_pk_max_i16 v30, v30, 0
  v_mfma_f32_16x16x32_bf16 v[192:195], a[180:183], a[100:103], v[192:195]
  v_pk_max_i16 v31, v31, 0
  buffer_store_dwordx4 v[28:31], v19, s[20:23], s89 offen offset:0 sc1
  v_mfma_f32_16x16x32_bf16 v[224:227], a[168:171], a[32:35], v[224:227]
  v_mul_f32 v40, s64, v96
  v_mul_f32 v41, s65, v97
  v_mul_f32 v42, s64, v98
  v_mfma_f32_16x16x32_bf16 v[224:227], a[172:175], a[36:39], v[224:227]
  v_mul_f32 v43, s65, v99
  v_exp_f32_e64 v40, v40 clamp
  v_mfma_f32_16x16x32_bf16 v[224:227], a[184:187], a[96:99], v[224:227]
  v_max_f32 v96, s66, v96
  v_exp_f32_e64 v41, v41 clamp
  v_mfma_f32_16x16x32_bf16 v[224:227], a[188:191], a[100:103], v[224:227]
  v_max_f32 v97, s66, v97
  v_exp_f32_e64 v42, v42 clamp
  v_mfma_f32_16x16x32_bf16 v[196:199], a[160:163], a[40:43], v[196:199]
  v_max_f32 v98, s66, v98
  v_exp_f32_e64 v43, v43 clamp
  v_mfma_f32_16x16x32_bf16 v[196:199], a[164:167], a[44:47], v[196:199]
  v_max_f32 v99, s66, v99
  v_add_f32 v96, v96, v40
  v_add_f32 v97, v97, v41
  v_mfma_f32_16x16x32_bf16 v[196:199], a[176:179], a[104:107], v[196:199]
  v_add_f32 v98, v98, v42
  v_add_f32 v99, v99, v43
  v_mul_f32 v44, s64, v100
  v_mfma_f32_16x16x32_bf16 v[196:199], a[180:183], a[108:111], v[196:199]
  v_mul_f32 v45, s65, v101
  v_mul_f32 v46, s64, v102
  v_mul_f32 v47, s65, v103
  v_mfma_f32_16x16x32_bf16 v[228:231], a[168:171], a[40:43], v[228:231]
  v_exp_f32_e64 v44, v44 clamp
  v_max_f32 v100, s66, v100
  v_mfma_f32_16x16x32_bf16 v[228:231], a[172:175], a[44:47], v[228:231]
  v_exp_f32_e64 v45, v45 clamp
  v_max_f32 v101, s66, v101
  v_mfma_f32_16x16x32_bf16 v[228:231], a[184:187], a[104:107], v[228:231]
  v_exp_f32_e64 v46, v46 clamp
  v_max_f32 v102, s66, v102
  v_mfma_f32_16x16x32_bf16 v[228:231], a[188:191], a[108:111], v[228:231]
  v_exp_f32_e64 v47, v47 clamp
  v_max_f32 v103, s66, v103
  v_mfma_f32_16x16x32_bf16 v[200:203], a[160:163], a[48:51], v[200:203]
  v_add_f32 v100, v100, v44
  v_add_f32 v101, v101, v45
  v_add_f32 v102, v102, v46
  v_mfma_f32_16x16x32_bf16 v[200:203], a[164:167], a[52:55], v[200:203]
  v_add_f32 v103, v103, v47
  v_cvt_pk_bf16_f32 v96, v96, v97
  v_cvt_pk_bf16_f32 v97, v98, v99
  v_mfma_f32_16x16x32_bf16 v[200:203], a[176:179], a[112:115], v[200:203]
  v_cvt_pk_bf16_f32 v98, v100, v101
  v_cvt_pk_bf16_f32 v99, v102, v103
  v_accvgpr_read_b32 v40, a232
  v_mfma_f32_16x16x32_bf16 v[200:203], a[180:183], a[116:119], v[200:203]
  v_accvgpr_read_b32 v41, a233
  v_accvgpr_read_b32 v42, a234
  v_accvgpr_read_b32 v43, a235
  v_mfma_f32_16x16x32_bf16 v[232:235], a[168:171], a[48:51], v[232:235]
  v_accvgpr_read_b32 v44, a236
  v_accvgpr_read_b32 v45, a237
  v_accvgpr_read_b32 v46, a238
  v_mfma_f32_16x16x32_bf16 v[232:235], a[172:175], a[52:55], v[232:235]
  v_accvgpr_read_b32 v47, a239
  v_cvt_pk_bf16_f32 v32, v40, v41
  v_cvt_pk_bf16_f32 v33, v42, v43
  v_mfma_f32_16x16x32_bf16 v[232:235], a[184:187], a[112:115], v[232:235]
  v_cvt_pk_bf16_f32 v34, v44, v45
  v_cvt_pk_bf16_f32 v35, v46, v47
  v_pk_max_i16 v32, v32, 0
  v_mfma_f32_16x16x32_bf16 v[232:235], a[188:191], a[116:119], v[232:235]
  v_pk_max_i16 v33, v33, 0
  v_pk_max_i16 v34, v34, 0
  v_pk_max_i16 v35, v35, 0
  v_mfma_f32_16x16x32_bf16 v[204:207], a[160:163], a[56:59], v[204:207]
  buffer_store_dwordx4 v[32:35], v19, s[20:23], s90 offen offset:0 sc1
  v_mul_f32 v40, s64, v72
  v_mfma_f32_16x16x32_bf16 v[204:207], a[164:167], a[60:63], v[204:207]
  v_mul_f32 v41, s65, v73
  v_mul_f32 v42, s64, v74
  v_mul_f32 v43, s65, v75
  v_mfma_f32_16x16x32_bf16 v[204:207], a[176:179], a[120:123], v[204:207]
  v_exp_f32_e64 v40, v40 clamp
  v_max_f32 v72, s66, v72
  v_mfma_f32_16x16x32_bf16 v[204:207], a[180:183], a[124:127], v[204:207]
  v_exp_f32_e64 v41, v41 clamp
  v_max_f32 v73, s66, v73
  v_mfma_f32_16x16x32_bf16 v[236:239], a[168:171], a[56:59], v[236:239]
  v_exp_f32_e64 v42, v42 clamp
  v_max_f32 v74, s66, v74
  v_mfma_f32_16x16x32_bf16 v[236:239], a[172:175], a[60:63], v[236:239]
  v_exp_f32_e64 v43, v43 clamp
  v_max_f32 v75, s66, v75
  v_mfma_f32_16x16x32_bf16 v[236:239], a[184:187], a[120:123], v[236:239]
  v_add_f32 v72, v72, v40
  v_add_f32 v73, v73, v41
  v_add_f32 v74, v74, v42
  v_mfma_f32_16x16x32_bf16 v[236:239], a[188:191], a[124:127], v[236:239]
  v_add_f32 v75, v75, v43
  v_mul_f32 v44, s64, v76
  v_mul_f32 v45, s65, v77
  s_nop 7
  v_mul_f32 v46, s64, v78
  v_mul_f32 v47, s65, v79
  v_exp_f32_e64 v44, v44 clamp
  v_max_f32 v76, s66, v76
  v_exp_f32_e64 v45, v45 clamp
  v_max_f32 v77, s66, v77
  v_exp_f32_e64 v46, v46 clamp
  v_max_f32 v78, s66, v78
  v_exp_f32_e64 v47, v47 clamp
  v_max_f32 v79, s66, v79
  v_pk_add_f32 v[76:77], v[76:77], v[44:45]
  v_pk_add_f32 v[78:79], v[78:79], v[46:47]
  v_cvt_pk_bf16_f32 v72, v72, v73
  v_cvt_pk_bf16_f32 v73, v74, v75
  v_cvt_pk_bf16_f32 v74, v76, v77
  v_cvt_pk_bf16_f32 v75, v78, v79
  v_accvgpr_read_b32 v40, a240
  v_accvgpr_read_b32 v41, a241
  v_accvgpr_read_b32 v42, a242
  v_accvgpr_read_b32 v43, a243
  v_accvgpr_read_b32 v44, a244
  v_accvgpr_read_b32 v45, a245
  v_accvgpr_read_b32 v46, a246
  v_accvgpr_read_b32 v47, a247
  v_cvt_pk_bf16_f32 v36, v40, v41
  v_cvt_pk_bf16_f32 v37, v42, v43
  v_cvt_pk_bf16_f32 v38, v44, v45
  v_cvt_pk_bf16_f32 v39, v46, v47
  v_pk_max_i16 v36, v36, 0
  v_pk_max_i16 v37, v37, 0
  v_pk_max_i16 v38, v38, 0
  v_pk_max_i16 v39, v39, 0
  buffer_store_dwordx4 v[36:39], v19, s[20:23], s91 offen offset:0 sc1
  v_pk_mul_f32 v[40:41], v[104:105], s[64:65]
  v_pk_mul_f32 v[42:43], v[106:107], s[64:65]
  v_exp_f32_e64 v40, v40 clamp
  v_max_f32 v104, s66, v104
  v_exp_f32_e64 v41, v41 clamp
  v_max_f32 v105, s66, v105
  v_exp_f32_e64 v42, v42 clamp
  v_max_f32 v106, s66, v106
  v_exp_f32_e64 v43, v43 clamp
  v_max_f32 v107, s66, v107
  v_pk_add_f32 v[104:105], v[104:105], v[40:41]
  v_pk_add_f32 v[106:107], v[106:107], v[42:43]
  v_pk_mul_f32 v[44:45], v[108:109], s[64:65]
  v_pk_mul_f32 v[46:47], v[110:111], s[64:65]
  v_exp_f32_e64 v44, v44 clamp
  v_max_f32 v108, s66, v108
  v_exp_f32_e64 v45, v45 clamp
  v_max_f32 v109, s66, v109
  v_exp_f32_e64 v46, v46 clamp
  v_max_f32 v110, s66, v110
  v_exp_f32_e64 v47, v47 clamp
  v_max_f32 v111, s66, v111
  v_pk_add_f32 v[108:109], v[108:109], v[44:45]
  v_pk_add_f32 v[110:111], v[110:111], v[46:47]
  v_cvt_pk_bf16_f32 v104, v104, v105
  v_cvt_pk_bf16_f32 v105, v106, v107
  v_cvt_pk_bf16_f32 v106, v108, v109
  v_cvt_pk_bf16_f32 v107, v110, v111
  v_and_b32 v22, 3, v1
  v_lshlrev_b32 v22, 3, v22
  s_and_b32 s51, s55, 0xffffff80
  v_add_u32 v20, s50, v3
  v_mov_b32 v76, 0x3f803f80
  v_mov_b32 v77, 0x3f803f80
  v_mov_b32 v78, 0x3f803f80
  v_mov_b32 v79, 0x3f803f80
  v_cvt_pk_bf16_f32 v112, v112, v113
  v_cvt_pk_bf16_f32 v113, v114, v115
  v_cvt_pk_bf16_f32 v114, v116, v117
  v_cvt_pk_bf16_f32 v115, v118, v119
  v_cvt_pk_bf16_f32 v144, v144, v145
  v_cvt_pk_bf16_f32 v145, v146, v147
  v_cvt_pk_bf16_f32 v146, v148, v149
  v_cvt_pk_bf16_f32 v147, v150, v151
  s_nop 1
  v_mfma_f32_16x16x32_bf16 v[52:55], v[48:51], v[112:115], 0
  v_mfma_f32_16x16x32_bf16 v[84:87], v[48:51], v[144:147], 0
  v_mfma_f32_16x16x32_bf16 v[60:63], v[48:51], v[76:79], 0
  v_mfma_f32_16x16x32_bf16 v[92:95], v[80:83], v[112:115], 0
  v_mfma_f32_16x16x32_bf16 v[68:71], v[80:83], v[144:147], 0
  v_mfma_f32_16x16x32_bf16 v[100:103], v[80:83], v[76:79], 0
  v_cvt_pk_bf16_f32 v120, v120, v121
  v_cvt_pk_bf16_f32 v121, v122, v123
  v_cvt_pk_bf16_f32 v122, v124, v125
  v_cvt_pk_bf16_f32 v123, v126, v127
  s_branch L_stubQs3
L_stubQ3:
  s_setpc_b64 s[4:5]
L_stubQs3:
  v_cvt_pk_bf16_f32 v152, v152, v153
  v_cvt_pk_bf16_f32 v153, v154, v155
  v_cvt_pk_bf16_f32 v154, v156, v157
  v_cvt_pk_bf16_f32 v155, v158, v159
  s_nop 1
  v_mfma_f32_16x16x32_bf16 v[52:55], v[56:59], v[120:123], v[52:55]
  v_mfma_f32_16x16x32_bf16 v[84:87], v[56:59], v[152:155], v[84:87]
  v_mfma_f32_16x16x32_bf16 v[60:63], v[56:59], v[76:79], v[60:63]
  v_mfma_f32_16x16x32_bf16 v[92:95], v[88:91], v[120:123], v[92:95]
  v_mfma_f32_16x16x32_bf16 v[68:71], v[88:91], v[152:155], v[68:71]
  v_mfma_f32_16x16x32_bf16 v[100:103], v[88:91], v[76:79], v[100:103]
  v_cvt_pk_bf16_f32 v128, v128, v129
  v_cvt_pk_bf16_f32 v129, v130, v131
  v_cvt_pk_bf16_f32 v130, v132, v133
  v_cvt_pk_bf16_f32 v131, v134, v135
  v_cvt_pk_bf16_f32 v160, v160, v161
  v_cvt_pk_bf16_f32 v161, v162, v163
  v_cvt_pk_bf16_f32 v162, v164, v165
  v_cvt_pk_bf16_f32 v163, v166, v167
  s_nop 1
  v_mfma_f32_16x16x32_bf16 v[52:55], v[64:67], v[128:131], v[52:55]
  v_mfma_f32_16x16x32_bf16 v[84:87], v[64:67], v[160:163], v[84:87]
  v_mfma_f32_16x16x32_bf16 v[60:63], v[64:67], v[76:79], v[60:63]
  v_mfma_f32_16x16x32_bf16 v[92:95], v[96:99], v[128:131], v[92:95]
  v_mfma_f32_16x16x32_bf16 v[68:71], v[96:99], v[160:163], v[68:71]
  v_mfma_f32_16x16x32_bf16 v[100:103], v[96:99], v[76:79], v[100:103]
  v_cvt_pk_bf16_f32 v136, v136, v137
  v_cvt_pk_bf16_f32 v137, v138, v139
  v_cvt_pk_bf16_f32 v138, v140, v141
  v_cvt_pk_bf16_f32 v139, v142, v143
  v_cvt_pk_bf16_f32 v168, v168, v169
  v_cvt_pk_bf16_f32 v169, v170, v171
  v_cvt_pk_bf16_f32 v170, v172, v173
  v_cvt_pk_bf16_f32 v171, v174, v175
  s_nop 1
  v_mfma_f32_16x16x32_bf16 v[52:55], v[72:75], v[136:139], v[52:55]
  v_mfma_f32_16x16x32_bf16 v[84:87], v[72:75], v[168:171], v[84:87]
  v_mfma_f32_16x16x32_bf16 v[60:63], v[72:75], v[76:79], v[60:63]
  v_mfma_f32_16x16x32_bf16 v[92:95], v[104:107], v[136:139], v[92:95]
  v_mfma_f32_16x16x32_bf16 v[68:71], v[104:107], v[168:171], v[68:71]
  v_mfma_f32_16x16x32_bf16 v[100:103], v[104:107], v[76:79], v[100:103]
  s_mul_i32 s4, s39, 6144
  s_mul_i32 s5, s38, 75776
  s_add_u32 s5, s5, s4
  s_add_u32 s5, s5, 73728
  v_add_u32 v108, s5, v2
  s_mul_i32 s5, s38, 3072
  s_add_u32 s4, s4, s5
  s_add_u32 s5, s4, 73728
  v_add_u32 v109, s5, v2
  s_add_u32 s5, s4, 149504
  v_add_u32 v110, s5, v2
  v_and_b32 v111, 48, v1
  ds_write_b128 v108, v[52:55] offset:0
  ds_write_b128 v108, v[84:87] offset:1024
  ds_write_b128 v108, v[60:63] offset:2048
  ds_write_b128 v108, v[92:95] offset:3072
  ds_write_b128 v108, v[68:71] offset:4096
  ds_write_b128 v108, v[100:103] offset:5120
  v_add_u32 v252, 1024, v3
  v_add_u32 v253, 292864, v3
  v_add_u32 v254, 293888, v3
  v_add_u32 v255, 4096, v3
  s_waitcnt lgkmcnt(0)
  s_barrier
  ds_read_b128 v[116:119], v109 offset:0
  ds_read_b128 v[148:151], v109 offset:1024
  ds_read_b128 v[124:127], v109 offset:2048
  ds_read_b128 v[156:159], v110 offset:0
  ds_read_b128 v[132:135], v110 offset:1024
  ds_read_b128 v[164:167], v110 offset:2048
  s_lshl_b32 s4, s67, 3
  s_add_u32 s4, s4, s25
  s_lshl_b32 s4, s4, 1
  s_add_u32 s4, s4, s38
  s_lshl_b32 s4, s4, 12
  s_add_u32 s4, s4, 37748736
  s_lshl_b32 s5, s67, 1
  s_add_u32 s5, s5, s38
  s_lshl_b32 s5, s5, 3
  s_add_u32 s5, s5, s25
  s_lshl_b32 s5, s5, 6
  s_add_u32 s5, s5, 39845888
  s_waitcnt lgkmcnt(0)
  v_pk_add_f32 v[116:117], v[116:117], v[156:157]
  v_pk_add_f32 v[118:119], v[118:119], v[158:159]
  v_pk_add_f32 v[148:149], v[148:149], v[132:133]
  v_pk_add_f32 v[150:151], v[150:151], v[134:135]
  v_pk_add_f32 v[124:125], v[124:125], v[164:165]
  v_pk_add_f32 v[126:127], v[126:127], v[166:167]
  buffer_store_dwordx4 v[116:119], v3, s[20:23], s4 offen offset:0 sc1
  buffer_store_dwordx4 v[148:151], v3, s[20:23], s4 offen offset:2048 sc1
  s_mov_b32 exec_lo, 0x00010001
  s_mov_b32 exec_hi, 0x00010001
  buffer_store_dwordx4 v[124:127], v111, s[20:23], s5 offen sc1
  s_mov_b64 exec, -1
  v_pk_mul_f32 v[40:41], v[176:177], s[64:65]
  v_pk_mul_f32 v[42:43], v[178:179], s[64:65]
  v_exp_f32_e64 v40, v40 clamp
  v_max_f32 v176, s66, v176
  v_exp_f32_e64 v41, v41 clamp
  v_max_f32 v177, s66, v177
  v_exp_f32_e64 v42, v42 clamp
  v_max_f32 v178, s66, v178
  v_exp_f32_e64 v43, v43 clamp
  v_max_f32 v179, s66, v179
  v_pk_add_f32 v[176:177], v[176:177], v[40:41]
  v_pk_add_f32 v[178:179], v[178:179], v[42:43]
  v_pk_mul_f32 v[44:45], v[208:209], s[64:65]
  v_pk_mul_f32 v[46:47], v[210:211], s[64:65]
  v_exp_f32_e64 v44, v44 clamp
  v_max_f32 v208, s66, v208
  v_exp_f32_e64 v45, v45 clamp
  v_max_f32 v209, s66, v209
  v_exp_f32_e64 v46, v46 clamp
  v_max_f32 v210, s66, v210
  v_exp_f32_e64 v47, v47 clamp
  v_max_f32 v211, s66, v211
  v_pk_add_f32 v[208:209], v[208:209], v[44:45]
  v_pk_add_f32 v[210:211], v[210:211], v[46:47]
  v_cvt_pk_bf16_f32 v176, v176, v177
  v_cvt_pk_bf16_f32 v177, v178, v179
  v_cvt_pk_bf16_f32 v178, v208, v209
  v_cvt_pk_bf16_f32 v179, v210, v211
  buffer_store_dwordx4 v[176:179], v20, s[20:23], s88 offen sc1
  v_pk_mul_f32 v[40:41], v[180:181], s[64:65]
  v_pk_mul_f32 v[42:43], v[182:183], s[64:65]
  v_exp_f32_e64 v40, v40 clamp
  v_max_f32 v180, s66, v180
  v_exp_f32_e64 v41, v41 clamp
  v_max_f32 v181, s66, v181
  v_exp_f32_e64 v42, v42 clamp
  v_max_f32 v182, s66, v182
  v_exp_f32_e64 v43, v43 clamp
  v_max_f32 v183, s66, v183
  v_pk_add_f32 v[180:181], v[180:181], v[40:41]
  v_pk_add_f32 v[182:183], v[182:183], v[42:43]
  v_pk_mul_f32 v[44:45], v[212:213], s[64:65]
  v_pk_mul_f32 v[46:47], v[214:215], s[64:65]
  v_exp_f32_e64 v44, v44 clamp
  v_max_f32 v212, s66, v212
  v_exp_f32_e64 v45, v45 clamp
  v_max_f32 v213, s66, v213
  v_exp_f32_e64 v46, v46 clamp
  v_max_f32 v214, s66, v214
  v_exp_f32_e64 v47, v47 clamp
  v_max_f32 v215, s66, v215
  v_pk_add_f32 v[212:213], v[212:213], v[44:45]
  v_pk_add_f32 v[214:215], v[214:215], v[46:47]
  v_cvt_pk_bf16_f32 v180, v180, v181
  v_cvt_pk_bf16_f32 v181, v182, v183
  v_cvt_pk_bf16_f32 v182, v212, v213
  v_cvt_pk_bf16_f32 v183, v214, v215
  buffer_store_dwordx4 v[180:183], v20, s[20:23], s89 offen sc1
  v_pk_mul_f32 v[40:41], v[184:185], s[64:65]
  v_pk_mul_f32 v[42:43], v[186:187], s[64:65]
  v_exp_f32_e64 v40, v40 clamp
  v_max_f32 v184, s66, v184
  v_exp_f32_e64 v41, v41 clamp
  v_max_f32 v185, s66, v185
  v_exp_f32_e64 v42, v42 clamp
  v_max_f32 v186, s66, v186
  v_exp_f32_e64 v43, v43 clamp
  v_max_f32 v187, s66, v187
  v_pk_add_f32 v[184:185], v[184:185], v[40:41]
  v_pk_add_f32 v[186:187], v[186:187], v[42:43]
  v_pk_mul_f32 v[44:45], v[216:217], s[64:65]
  v_pk_mul_f32 v[46:47], v[218:219], s[64:65]
  v_exp_f32_e64 v44, v44 clamp
  v_max_f32 v216, s66, v216
  v_exp_f32_e64 v45, v45 clamp
  v_max_f32 v217, s66, v217
  v_exp_f32_e64 v46, v46 clamp
  v_max_f32 v218, s66, v218
  v_exp_f32_e64 v47, v47 clamp
  v_max_f32 v219, s66, v219
  v_pk_add_f32 v[216:217], v[216:217], v[44:45]
  v_pk_add_f32 v[218:219], v[218:219], v[46:47]
  v_cvt_pk_bf16_f32 v184, v184, v185
  v_cvt_pk_bf16_f32 v185, v186, v187
  v_cvt_pk_bf16_f32 v186, v216, v217
  v_cvt_pk_bf16_f32 v187, v218, v219
  buffer_store_dwordx4 v[184:187], v20, s[20:23], s90 offen sc1
  s_cmp_eq_u32 s0, 1
  s_cbranch_scc0 LE1a
  buffer_load_dword v23, v22, s[20:23], s51 offen offset:68 nt
LE1b:
  v_pk_mul_f32 v[40:41], v[188:189], s[64:65]
  v_pk_mul_f32 v[42:43], v[190:191], s[64:65]
  v_exp_f32_e64 v40, v40 clamp
  v_max_f32 v188, s66, v188
  v_exp_f32_e64 v41, v41 clamp
  v_max_f32 v189, s66, v189
  v_exp_f32_e64 v42, v42 clamp
  v_max_f32 v190, s66, v190
  v_exp_f32_e64 v43, v43 clamp
  v_max_f32 v191, s66, v191
  v_pk_add_f32 v[188:189], v[188:189], v[40:41]
  v_pk_add_f32 v[190:191], v[190:191], v[42:43]
  v_pk_mul_f32 v[44:45], v[220:221], s[64:65]
  v_pk_mul_f32 v[46:47], v[222:223], s[64:65]
  v_exp_f32_e64 v44, v44 clamp
  v_max_f32 v220, s66, v220
  v_exp_f32_e64 v45, v45 clamp
  v_max_f32 v221, s66, v221
  v_exp_f32_e64 v46, v46 clamp
  v_max_f32 v222, s66, v222
  v_exp_f32_e64 v47, v47 clamp
  v_max_f32 v223, s66, v223
  v_pk_add_f32 v[220:221], v[220:221], v[44:45]
  v_pk_add_f32 v[222:223], v[222:223], v[46:47]
  v_cvt_pk_bf16_f32 v188, v188, v189
  v_cvt_pk_bf16_f32 v189, v190, v191
  v_cvt_pk_bf16_f32 v190, v220, v221
  v_cvt_pk_bf16_f32 v191, v222, v223
  buffer_store_dwordx4 v[188:191], v20, s[20:23], s91 offen sc1
  s_lshl_b32 s87, s67, 4
  s_add_u32 s87, s87, s25
  s_lshl_b32 s87, s87, 1
  s_add_u32 s87, s87, s38
  s_lshl_b32 s87, s87, 2
  s_add_u32 s87, s87, 40091648
  s_waitcnt vmcnt(5)
  s_mov_b64 exec, 1
  buffer_store_dword v15, off, s[20:23], s87 sc1
  s_mov_b64 exec, -1
  v_pk_mul_f32 v[40:41], v[192:193], s[64:65]
  v_pk_mul_f32 v[42:43], v[194:195], s[64:65]
  v_exp_f32_e64 v40, v40 clamp
  v_max_f32 v192, s66, v192
  v_exp_f32_e64 v41, v41 clamp
  v_max_f32 v193, s66, v193
  v_exp_f32_e64 v42, v42 clamp
  v_max_f32 v194, s66, v194
  v_exp_f32_e64 v43, v43 clamp
  v_max_f32 v195, s66, v195
  v_pk_add_f32 v[192:193], v[192:193], v[40:41]
  v_pk_add_f32 v[194:195], v[194:195], v[42:43]
  v_pk_mul_f32 v[44:45], v[224:225], s[64:65]
  v_pk_mul_f32 v[46:47], v[226:227], s[64:65]
  v_exp_f32_e64 v44, v44 clamp
  v_max_f32 v224, s66, v224
  v_exp_f32_e64 v45, v45 clamp
  v_max_f32 v225, s66, v225
  v_exp_f32_e64 v46, v46 clamp
  v_max_f32 v226, s66, v226
  v_exp_f32_e64 v47, v47 clamp
  v_max_f32 v227, s66, v227
  v_pk_add_f32 v[224:225], v[224:225], v[44:45]
  v_pk_add_f32 v[226:227], v[226:227], v[46:47]
  v_cvt_pk_bf16_f32 v192, v192, v193
  v_cvt_pk_bf16_f32 v193, v194, v195
  v_cvt_pk_bf16_f32 v194, v224, v225
  v_cvt_pk_bf16_f32 v195, v226, v227
  buffer_store_dwordx4 v[192:195], v20, s[20:23], s92 offen sc1
  v_pk_mul_f32 v[40:41], v[196:197], s[64:65]
  v_pk_mul_f32 v[42:43], v[198:199], s[64:65]
  v_exp_f32_e64 v40, v40 clamp
  v_max_f32 v196, s66, v196
  v_exp_f32_e64 v41, v41 clamp
  v_max_f32 v197, s66, v197
  v_exp_f32_e64 v42, v42 clamp
  v_max_f32 v198, s66, v198
  v_exp_f32_e64 v43, v43 clamp
  v_max_f32 v199, s66, v199
  v_pk_add_f32 v[196:197], v[196:197], v[40:41]
  v_pk_add_f32 v[198:199], v[198:199], v[42:43]
  v_pk_mul_f32 v[44:45], v[228:229], s[64:65]
  v_pk_mul_f32 v[46:47], v[230:231], s[64:65]
  v_exp_f32_e64 v44, v44 clamp
  v_max_f32 v228, s66, v228
  v_exp_f32_e64 v45, v45 clamp
  v_max_f32 v229, s66, v229
  v_exp_f32_e64 v46, v46 clamp
  v_max_f32 v230, s66, v230
  v_exp_f32_e64 v47, v47 clamp
  v_max_f32 v231, s66, v231
  v_pk_add_f32 v[228:229], v[228:229], v[44:45]
  v_pk_add_f32 v[230:231], v[230:231], v[46:47]
  v_cvt_pk_bf16_f32 v196, v196, v197
  v_cvt_pk_bf16_f32 v197, v198, v199
  v_cvt_pk_bf16_f32 v198, v228, v229
  v_cvt_pk_bf16_f32 v199, v230, v231
  buffer_store_dwordx4 v[196:199], v20, s[20:23], s93 offen sc1
  v_pk_mul_f32 v[40:41], v[200:201], s[64:65]
  v_pk_mul_f32 v[42:43], v[202:203], s[64:65]
  v_exp_f32_e64 v40, v40 clamp
  v_max_f32 v200, s66, v200
  v_exp_f32_e64 v41, v41 clamp
  v_max_f32 v201, s66, v201
  v_exp_f32_e64 v42, v42 clamp
  v_max_f32 v202, s66, v202
  v_exp_f32_e64 v43, v43 clamp
  v_max_f32 v203, s66, v203
  v_pk_add_f32 v[200:201], v[200:201], v[40:41]
  v_pk_add_f32 v[202:203], v[202:203], v[42:43]
  v_pk_mul_f32 v[44:45], v[232:233], s[64:65]
  v_pk_mul_f32 v[46:47], v[234:235], s[64:65]
  v_exp_f32_e64 v44, v44 clamp
  v_max_f32 v232, s66, v232
  v_exp_f32_e64 v45, v45 clamp
  v_max_f32 v233, s66, v233
  v_exp_f32_e64 v46, v46 clamp
  v_max_f32 v234, s66, v234
  v_exp_f32_e64 v47, v47 clamp
  v_max_f32 v235, s66, v235
  v_pk_add_f32 v[232:233], v[232:233], v[44:45]
  v_pk_add_f32 v[234:235], v[234:235], v[46:47]
  v_cvt_pk_bf16_f32 v200, v200, v201
  v_cvt_pk_bf16_f32 v201, v202, v203
  v_cvt_pk_bf16_f32 v202, v232, v233
  v_cvt_pk_bf16_f32 v203, v234, v235
  buffer_store_dwordx4 v[200:203], v20, s[20:23], s98 offen sc1
  v_pk_mul_f32 v[40:41], v[204:205], s[64:65]
  v_pk_mul_f32 v[42:43], v[206:207], s[64:65]
  v_exp_f32_e64 v40, v40 clamp
  v_max_f32 v204, s66, v204
  v_exp_f32_e64 v41, v41 clamp
  v_max_f32 v205, s66, v205
  v_exp_f32_e64 v42, v42 clamp
  v_max_f32 v206, s66, v206
  v_exp_f32_e64 v43, v43 clamp
  v_max_f32 v207, s66, v207
  v_pk_add_f32 v[204:205], v[204:205], v[40:41]
  v_pk_add_f32 v[206:207], v[206:207], v[42:43]
  v_pk_mul_f32 v[44:45], v[236:237], s[64:65]
  v_pk_mul_f32 v[46:47], v[238:239], s[64:65]
  v_exp_f32_e64 v44, v44 clamp
  v_max_f32 v236, s66, v236
  v_exp_f32_e64 v45, v45 clamp
  v_max_f32 v237, s66, v237
  v_exp_f32_e64 v46, v46 clamp
  v_max_f32 v238, s66, v238
  v_exp_f32_e64 v47, v47 clamp
  v_max_f32 v239, s66, v239
  v_pk_add_f32 v[236:237], v[236:237], v[44:45]
  v_pk_add_f32 v[238:239], v[238:239], v[46:47]
  v_cvt_pk_bf16_f32 v204, v204, v205
  v_cvt_pk_bf16_f32 v205, v206, v207
  v_cvt_pk_bf16_f32 v206, v236, v237
  v_cvt_pk_bf16_f32 v207, v238, v239
  buffer_store_dwordx4 v[204:207], v20, s[20:23], s99 offen sc1
  s_waitcnt vmcnt(6)
L2_entryQ:
  v_cmp_ne_u32 vcc, 0x01010101, v23
  s_nop 0
  s_cmp_eq_u64 vcc, 0
  s_cbranch_scc0 L2_h_slowQ
L2_h_okQ:
  s_add_u32 m0, s36, 0
  s_nop 0
  buffer_load_dwordx4 v3, s[20:23], s30 offen offset:0 sc1 lds
  buffer_load_dwordx4 v252, s[20:23], s30 offen offset:1024 sc1 lds
  buffer_load_dwordx4 v253, s[20:23], s30 offen offset:2048 sc1 lds
  buffer_load_dwordx4 v254, s[20:23], s30 offen offset:3072 sc1 lds
  s_add_u32 s30, s30, 12288
  s_add_u32 m0, s36, 24576
  s_nop 0
  buffer_load_dwordx4 v3, s[20:23], s31 offen offset:0 sc1 lds
  buffer_load_dwordx4 v252, s[20:23], s31 offen offset:1024 sc1 lds
  buffer_load_dwordx4 v253, s[20:23], s31 offen offset:2048 sc1 lds
  buffer_load_dwordx4 v254, s[20:23], s31 offen offset:3072 sc1 lds
  s_add_u32 s31, s31, 12288
  s_add_u32 m0, s36, 49152
  s_nop 0
  buffer_load_dwordx4 v3, s[20:23], s30 offen offset:0 sc1 lds
  buffer_load_dwordx4 v252, s[20:23], s30 offen offset:1024 sc1 lds
  buffer_load_dwordx4 v253, s[20:23], s30 offen offset:2048 sc1 lds
  buffer_load_dwordx4 v254, s[20:23], s30 offen offset:3072 sc1 lds
  s_add_u32 s30, s30, 16384
  s_mov_b32 s16, s60
  s_mov_b32 s17, s61
  s_mov_b32 s18, 4194304
  v_lshrrev_b32 v25, 4, v1
  v_and_b32 v26, 7, v1
  s_lshl_b32 s4, s38, 13
  v_add_u32 v6, s4, v2
  v_add_u32 v7, 49152, v6
  v_add_u32 v8, 98304, v6
  v_lshlrev_b32 v17, 6, v26
  v_lshl_add_u32 v17, v25, 4, v17
  v_lshrrev_b32 v27, 2, v1
  v_lshlrev_b32 v27, 7, v27
  v_bfe_u32 v28, v1, 3, 2
  s_lshl_b32 s4, s39, 1
  v_xor_b32 v28, s4, v28
  v_lshl_add_u32 v27, v28, 5, v27
  v_and_b32 v28, 3, v1
  v_lshl_add_u32 v27, v28, 3, v27
  v_add_u32 v9, 16384, v27
  v_xor_b32 v10, 32, v9
  v_add_u32 v11, 49152, v9
  v_add_u32 v12, 49152, v10
  v_add_u32 v13, 98304, v9
  v_add_u32 v14, 98304, v10
  v_xor_b32 v16, s1, v28
  v_lshlrev_b32 v16, 7, v16
  v_lshl_add_u32 v16, v28, 2, v16
  v_and_b32 v18, 15, v1
  v_lshlrev_b32 v18, 4, v18
  s_and_b32 s44, s52, 30
  s_and_b32 s5, s25, 1
  s_add_u32 s44, s44, s5
  s_and_b32 s45, s25, 6
  s_lshl_b32 s45, s45, 4
  s_lshl_b32 s5, s24, 3
  s_add_u32 s45, s45, s5
  s_and_b32 s50, s48, 0xfffffc00
  v_bfe_u32 v34, v1, 2, 3
  v_lshlrev_b32 v34, 7, v34
  v_lshl_add_u32 v34, v28, 3, v34
  s_lshl_b32 s54, s44, 7
  s_add_u32 s54, s54, 40091648
  s_lshl_b32 s4, s24, 4
  s_add_u32 s63, s4, 39976960
  s_lshl_b32 s3, s1, 17
  s_lshl_b32 s4, s24, 13
  s_add_u32 s4, s4, 41943040
  s_add_u32 s49, s3, s4
  s_xor_b32 s5, s3, 131072
  s_add_u32 s5, s5, s4
  s_add_u32 s60, s5, 32768
  s_xor_b32 s5, s3, 262144
  s_add_u32 s5, s5, s4
  s_add_u32 s61, s5, 65536
  s_xor_b32 s5, s3, 393216
  s_add_u32 s5, s5, s4
  s_add_u32 s62, s5, 98304
  s_add_u32 s32, s32, 16384
  s_add_u32 s35, s35, 524288
  s_mul_i32 s46, s41, 53248
  s_sub_u32 s46, 176128, s46
  s_mul_i32 s47, s41, 1703936
  s_add_u32 s47, s47, 1703936
  s_waitcnt vmcnt(4)
  s_mov_b64 exec, 1
  s_cmp_eq_u32 s0, 1
  s_cbranch_scc0 LE2a
  buffer_store_byte v15, off, s[20:23], s55 offset:64
LE2b:
  s_mov_b64 exec, -1
  s_xor_b32 s3, s67, 2
  s_lshl_b32 s3, s3, 2
  s_lshr_b32 s4, s25, 1
  s_add_u32 s3, s3, s4
  s_lshl_b32 s3, s3, 7
  s_and_b32 s4, s87, 12
  s_add_u32 s3, s3, s4
  s_add_u32 s3, s3, 40124416
  s_mov_b64 exec, 1
  buffer_store_dword v15, off, s[20:23], s3 sc1
  s_mov_b64 exec, -1
  s_barrier
  ds_read_b64_tr_b16 a[128:129], v9 offset:24576
  ds_read_b128 a[32:35], v6 offset:24576
  ds_read_b64_tr_b16 a[130:131], v9 offset:26624
  ds_read_b128 a[36:39], v6 offset:25600
  ds_read_b64_tr_b16 a[132:133], v9 offset:28672
  ds_read_b128 a[40:43], v6 offset:26624
  ds_read_b64_tr_b16 a[134:135], v9 offset:30720
  ds_read_b128 a[44:47], v6 offset:27648
  ds_read_b64_tr_b16 a[136:137], v10 offset:24576
  ds_read_b128 a[48:51], v6 offset:28672
  s_add_u32 m0, s36, 73728
  ds_read_b64_tr_b16 a[138:139], v10 offset:26624
  ds_read_b128 a[52:55], v6 offset:29696
  buffer_load_dwordx4 v3, s[20:23], s31 offen offset:0 sc1 lds
  ds_read_b64_tr_b16 a[140:141], v10 offset:28672
  ds_read_b128 a[56:59], v6 offset:30720
  buffer_load_dwordx4 v252, s[20:23], s31 offen offset:1024 sc1 lds
  ds_read_b64_tr_b16 a[142:143], v10 offset:30720
  ds_read_b128 a[60:63], v6 offset:31744
  ds_read_b128 a[0:3], v6 offset:0
  buffer_load_dwordx4 v253, s[20:23], s31 offen offset:2048 sc1 lds
  ds_read_b128 a[4:7], v6 offset:1024
  ds_read_b128 a[8:11], v6 offset:2048
  buffer_load_dwordx4 v254, s[20:23], s31 offen offset:3072 sc1 lds
  ds_read_b128 a[12:15], v6 offset:3072
  ds_read_b128 a[16:19], v6 offset:4096
  s_add_u32 s31, s31, 16384
  ds_read_b128 a[20:23], v6 offset:5120
  ds_read_b128 a[24:27], v6 offset:6144
  ds_read_b128 a[28:31], v6 offset:7168
  s_waitcnt vmcnt(6) lgkmcnt(0)
  s_barrier
  v_mfma_f32_16x16x32_bf16 v[48:51], a[128:131], a[0:3], 0
  s_add_u32 m0, s36, 98304
  ds_read_b64_tr_b16 a[144:145], v11 offset:0
  v_mfma_f32_16x16x32_bf16 v[48:51], a[132:135], a[4:7], v[48:51]
  buffer_load_dwordx4 v3, s[20:23], s30 offen offset:0 sc1 lds
  v_mfma_f32_16x16x32_bf16 v[52:55], a[132:135], a[12:15], 0
  ds_read_b128 a[64:67], v7 offset:0
  v_mfma_f32_16x16x32_bf16 v[52:55], a[128:131], a[8:11], v[52:55]
  ds_read_b64_tr_b16 a[146:147], v11 offset:2048
  v_mfma_f32_16x16x32_bf16 v[56:59], a[128:131], a[16:19], 0
  buffer_load_dwordx4 v252, s[20:23], s30 offen offset:1024 sc1 lds
  v_mfma_f32_16x16x32_bf16 v[56:59], a[132:135], a[20:23], v[56:59]
  ds_read_b128 a[68:71], v7 offset:1024
  v_mfma_f32_16x16x32_bf16 v[60:63], a[132:135], a[28:31], 0
  ds_read_b64_tr_b16 a[148:149], v11 offset:4096
  v_mfma_f32_16x16x32_bf16 v[60:63], a[128:131], a[24:27], v[60:63]
  v_mfma_f32_16x16x32_bf16 v[112:115], a[128:131], a[32:35], 0
  buffer_load_dwordx4 v253, s[20:23], s30 offen offset:2048 sc1 lds
  v_mfma_f32_16x16x32_bf16 v[112:115], a[132:135], a[36:39], v[112:115]
  ds_read_b128 a[72:75], v7 offset:2048
  v_mfma_f32_16x16x32_bf16 v[116:119], a[132:135], a[44:47], 0
  ds_read_b64_tr_b16 a[150:151], v11 offset:6144
  v_mfma_f32_16x16x32_bf16 v[116:119], a[128:131], a[40:43], v[116:119]
  ds_read_b128 a[76:79], v7 offset:3072
  v_mfma_f32_16x16x32_bf16 v[120:123], a[128:131], a[48:51], 0
  buffer_load_dwordx4 v254, s[20:23], s30 offen offset:3072 sc1 lds
  v_mfma_f32_16x16x32_bf16 v[120:123], a[132:135], a[52:55], v[120:123]
  ds_read_b64_tr_b16 a[152:153], v12 offset:0
  v_mfma_f32_16x16x32_bf16 v[124:127], a[132:135], a[60:63], 0
  v_mfma_f32_16x16x32_bf16 v[124:127], a[128:131], a[56:59], v[124:127]
  s_add_u32 s30, s30, 12288
  s_add_u32 m0, s36, 122880
  v_mfma_f32_16x16x32_bf16 v[64:67], a[136:139], a[0:3], 0
  buffer_load_dwordx4 v3, s[20:23], s31 offen offset:0 sc1 lds
  v_mfma_f32_16x16x32_bf16 v[64:67], a[140:143], a[4:7], v[64:67]
  ds_read_b128 a[80:83], v7 offset:4096
  ds_read_b64_tr_b16 a[154:155], v12 offset:2048
  v_mfma_f32_16x16x32_bf16 v[68:71], a[140:143], a[12:15], 0
  ds_read_b128 a[84:87], v7 offset:5120
  v_mfma_f32_16x16x32_bf16 v[68:71], a[136:139], a[8:11], v[68:71]
  v_mfma_f32_16x16x32_bf16 v[72:75], a[136:139], a[16:19], 0
  buffer_load_dwordx4 v252, s[20:23], s31 offen offset:1024 sc1 lds
  v_mfma_f32_16x16x32_bf16 v[72:75], a[140:143], a[20:23], v[72:75]
  ds_read_b64_tr_b16 a[156:157], v12 offset:4096
  ds_read_b128 a[88:91], v7 offset:6144
  v_mfma_f32_16x16x32_bf16 v[76:79], a[140:143], a[28:31], 0
  v_mfma_f32_16x16x32_bf16 v[76:79], a[136:139], a[24:27], v[76:79]
  ds_read_b64_tr_b16 a[158:159], v12 offset:6144
  v_mfma_f32_16x16x32_bf16 v[128:131], a[136:139], a[32:35], 0
  buffer_load_dwordx4 v253, s[20:23], s31 offen offset:2048 sc1 lds
  v_mfma_f32_16x16x32_bf16 v[128:131], a[140:143], a[36:39], v[128:131]
  ds_read_b128 a[92:95], v7 offset:7168
  v_mfma_f32_16x16x32_bf16 v[132:135], a[140:143], a[44:47], 0
  v_mfma_f32_16x16x32_bf16 v[132:135], a[136:139], a[40:43], v[132:135]
  v_mfma_f32_16x16x32_bf16 v[136:139], a[136:139], a[48:51], 0
  buffer_load_dwordx4 v254, s[20:23], s31 offen offset:3072 sc1 lds
  v_mfma_f32_16x16x32_bf16 v[136:139], a[140:143], a[52:55], v[136:139]
  s_add_u32 s31, s31, 12288
  v_mfma_f32_16x16x32_bf16 v[140:143], a[140:143], a[60:63], 0
  v_mfma_f32_16x16x32_bf16 v[140:143], a[136:139], a[56:59], v[140:143]
  s_waitcnt vmcnt(8) lgkmcnt(0)
  s_barrier
  v_mfma_f32_16x16x32_bf16 v[80:83], a[144:147], a[0:3], 0
  s_add_u32 m0, s42, 16384
  ds_read_b64_tr_b16 a[128:129], v11 offset:24576
  v_mfma_f32_16x16x32_bf16 v[80:83], a[148:151], a[4:7], v[80:83]
  buffer_load_dwordx4 v4, s[12:15], s34 offen offset:0 lds
  v_mfma_f32_16x16x32_bf16 v[84:87], a[148:151], a[12:15], 0
  ds_read_b128 a[96:99], v7 offset:24576
  v_mfma_f32_16x16x32_bf16 v[84:87], a[144:147], a[8:11], v[84:87]
  ds_read_b64_tr_b16 a[130:131], v11 offset:26624
  v_mfma_f32_16x16x32_bf16 v[88:91], a[144:147], a[16:19], 0
  buffer_load_dwordx4 v5, s[12:15], s34 offen offset:1024 lds
  v_mfma_f32_16x16x32_bf16 v[88:91], a[148:151], a[20:23], v[88:91]
  ds_read_b128 a[100:103], v7 offset:25600
  v_mfma_f32_16x16x32_bf16 v[92:95], a[148:151], a[28:31], 0
  ds_read_b64_tr_b16 a[132:133], v11 offset:28672
  v_mfma_f32_16x16x32_bf16 v[92:95], a[144:147], a[24:27], v[92:95]
  s_add_u32 s34, s34, 393216
  s_add_u32 m0, s36, 0
  v_mfma_f32_16x16x32_bf16 v[144:147], a[144:147], a[32:35], 0
  buffer_load_dwordx4 v3, s[20:23], s30 offen offset:0 sc1 lds
  v_mfma_f32_16x16x32_bf16 v[144:147], a[148:151], a[36:39], v[144:147]
  ds_read_b128 a[104:107], v7 offset:26624
  v_mfma_f32_16x16x32_bf16 v[148:151], a[148:151], a[44:47], 0
  ds_read_b64_tr_b16 a[134:135], v11 offset:30720
  v_mfma_f32_16x16x32_bf16 v[148:151], a[144:147], a[40:43], v[148:151]
  ds_read_b128 a[108:111], v7 offset:27648
  v_mfma_f32_16x16x32_bf16 v[152:155], a[144:147], a[48:51], 0
  buffer_load_dwordx4 v252, s[20:23], s30 offen offset:1024 sc1 lds
  v_mfma_f32_16x16x32_bf16 v[152:155], a[148:151], a[52:55], v[152:155]
  ds_read_b64_tr_b16 a[136:137], v12 offset:24576
  v_mfma_f32_16x16x32_bf16 v[156:159], a[148:151], a[60:63], 0
  v_mfma_f32_16x16x32_bf16 v[156:159], a[144:147], a[56:59], v[156:159]
  ds_read_b128 a[112:115], v7 offset:28672
  v_mfma_f32_16x16x32_bf16 v[96:99], a[152:155], a[0:3], 0
  buffer_load_dwordx4 v253, s[20:23], s30 offen offset:2048 sc1 lds
  v_mfma_f32_16x16x32_bf16 v[96:99], a[156:159], a[4:7], v[96:99]
  ds_read_b64_tr_b16 a[138:139], v12 offset:26624
  v_mfma_f32_16x16x32_bf16 v[100:103], a[156:159], a[12:15], 0
  ds_read_b128 a[116:119], v7 offset:29696
  v_mfma_f32_16x16x32_bf16 v[100:103], a[152:155], a[8:11], v[100:103]
  v_mfma_f32_16x16x32_bf16 v[104:107], a[152:155], a[16:19], 0
  buffer_load_dwordx4 v254, s[20:23], s30 offen offset:3072 sc1 lds
  v_mfma_f32_16x16x32_bf16 v[104:107], a[156:159], a[20:23], v[104:107]
  ds_read_b64_tr_b16 a[140:141], v12 offset:28672
  ds_read_b128 a[120:123], v7 offset:30720
  v_mfma_f32_16x16x32_bf16 v[108:111], a[156:159], a[28:31], 0
  v_mfma_f32_16x16x32_bf16 v[108:111], a[152:155], a[24:27], v[108:111]
  s_branch L_stubQs4
L_stubQ4:
  s_setpc_b64 s[4:5]
L_stubQs4:
  s_sub_u32 s30, s30, 36864
  s_add_u32 m0, s42, 40960
  v_mfma_f32_16x16x32_bf16 v[160:163], a[152:155], a[32:35], 0
  buffer_load_dwordx4 v4, s[12:15], s33 offen offset:0 lds
  v_mfma_f32_16x16x32_bf16 v[160:163], a[156:159], a[36:39], v[160:163]
  ds_read_b64_tr_b16 a[142:143], v12 offset:30720
  ds_read_b128 a[124:127], v7 offset:31744
  v_mfma_f32_16x16x32_bf16 v[164:167], a[156:159], a[44:47], 0
  v_mfma_f32_16x16x32_bf16 v[164:167], a[152:155], a[40:43], v[164:167]
  v_mfma_f32_16x16x32_bf16 v[168:171], a[152:155], a[48:51], 0
  buffer_load_dwordx4 v5, s[12:15], s33 offen offset:1024 lds
  v_mfma_f32_16x16x32_bf16 v[168:171], a[156:159], a[52:55], v[168:171]
  s_sub_u32 s33, s33, 1179648
  v_mfma_f32_16x16x32_bf16 v[172:175], a[156:159], a[60:63], 0
  v_mfma_f32_16x16x32_bf16 v[172:175], a[152:155], a[56:59], v[172:175]
  s_waitcnt vmcnt(12) lgkmcnt(0)
  s_barrier
  v_mfma_f32_16x16x32_bf16 v[48:51], a[128:131], a[64:67], v[48:51]
  s_add_u32 m0, s36, 24576
  ds_read_b64_tr_b16 a[144:145], v13 offset:0
  v_mfma_f32_16x16x32_bf16 v[48:51], a[132:135], a[68:71], v[48:51]
  buffer_load_dwordx4 v3, s[20:23], s31 offen offset:0 sc1 lds
  v_mfma_f32_16x16x32_bf16 v[52:55], a[132:135], a[76:79], v[52:55]
  ds_read_b128 a[0:3], v8 offset:0
  v_mfma_f32_16x16x32_bf16 v[52:55], a[128:131], a[72:75], v[52:55]
  ds_read_b64_tr_b16 a[146:147], v13 offset:2048
  v_mfma_f32_16x16x32_bf16 v[56:59], a[128:131], a[80:83], v[56:59]
  buffer_load_dwordx4 v252, s[20:23], s31 offen offset:1024 sc1 lds
  v_mfma_f32_16x16x32_bf16 v[56:59], a[132:135], a[84:87], v[56:59]
  ds_read_b128 a[4:7], v8 offset:1024
  v_mfma_f32_16x16x32_bf16 v[60:63], a[132:135], a[92:95], v[60:63]
  ds_read_b64_tr_b16 a[148:149], v13 offset:4096
  v_mfma_f32_16x16x32_bf16 v[60:63], a[128:131], a[88:91], v[60:63]
  v_mfma_f32_16x16x32_bf16 v[112:115], a[128:131], a[96:99], v[112:115]
  buffer_load_dwordx4 v253, s[20:23], s31 offen offset:2048 sc1 lds
  v_mfma_f32_16x16x32_bf16 v[112:115], a[132:135], a[100:103], v[112:115]
  ds_read_b128 a[8:11], v8 offset:2048
  v_mfma_f32_16x16x32_bf16 v[116:119], a[132:135], a[108:111], v[116:119]
  ds_read_b64_tr_b16 a[150:151], v13 offset:6144
  v_mfma_f32_16x16x32_bf16 v[116:119], a[128:131], a[104:107], v[116:119]
  ds_read_b128 a[12:15], v8 offset:3072
  v_mfma_f32_16x16x32_bf16 v[120:123], a[128:131], a[112:115], v[120:123]
  buffer_load_dwordx4 v254, s[20:23], s31 offen offset:3072 sc1 lds
  v_mfma_f32_16x16x32_bf16 v[120:123], a[132:135], a[116:119], v[120:123]
  ds_read_b64_tr_b16 a[152:153], v14 offset:0
  v_mfma_f32_16x16x32_bf16 v[124:127], a[132:135], a[124:127], v[124:127]
  v_mfma_f32_16x16x32_bf16 v[124:127], a[128:131], a[120:123], v[124:127]
  s_sub_u32 s31, s31, 36864
  s_add_u32 m0, s42, 65536
  v_mfma_f32_16x16x32_bf16 v[64:67], a[136:139], a[64:67], v[64:67]
  buffer_load_dwordx4 v4, s[12:15], s34 offen offset:0 lds
  v_mfma_f32_16x16x32_bf16 v[64:67], a[140:143], a[68:71], v[64:67]
  ds_read_b128 a[16:19], v8 offset:4096
  ds_read_b64_tr_b16 a[154:155], v14 offset:2048
  v_mfma_f32_16x16x32_bf16 v[68:71], a[140:143], a[76:79], v[68:71]
  ds_read_b128 a[20:23], v8 offset:5120
  v_mfma_f32_16x16x32_bf16 v[68:71], a[136:139], a[72:75], v[68:71]
  v_mfma_f32_16x16x32_bf16 v[72:75], a[136:139], a[80:83], v[72:75]
  buffer_load_dwordx4 v5, s[12:15], s34 offen offset:1024 lds
  v_mfma_f32_16x16x32_bf16 v[72:75], a[140:143], a[84:87], v[72:75]
  ds_read_b64_tr_b16 a[156:157], v14 offset:4096
  ds_read_b128 a[24:27], v8 offset:6144
  v_mfma_f32_16x16x32_bf16 v[76:79], a[140:143], a[92:95], v[76:79]
  v_mfma_f32_16x16x32_bf16 v[76:79], a[136:139], a[88:91], v[76:79]
  s_sub_u32 s34, s34, 1179648
  s_add_u32 m0, s36, 49152
  v_mfma_f32_16x16x32_bf16 v[128:131], a[136:139], a[96:99], v[128:131]
  buffer_load_dwordx4 v3, s[20:23], s30 offen offset:0 sc1 lds
  v_mfma_f32_16x16x32_bf16 v[128:131], a[140:143], a[100:103], v[128:131]
  ds_read_b64_tr_b16 a[158:159], v14 offset:6144
  ds_read_b128 a[28:31], v8 offset:7168
  v_mfma_f32_16x16x32_bf16 v[132:135], a[140:143], a[108:111], v[132:135]
  v_mfma_f32_16x16x32_bf16 v[132:135], a[136:139], a[104:107], v[132:135]
  v_mfma_f32_16x16x32_bf16 v[136:139], a[136:139], a[112:115], v[136:139]
  buffer_load_dwordx4 v252, s[20:23], s30 offen offset:1024 sc1 lds
  v_mfma_f32_16x16x32_bf16 v[136:139], a[140:143], a[116:119], v[136:139]
  v_mfma_f32_16x16x32_bf16 v[140:143], a[140:143], a[124:127], v[140:143]
  v_mfma_f32_16x16x32_bf16 v[140:143], a[136:139], a[120:123], v[140:143]
  s_waitcnt vmcnt(16) lgkmcnt(0)
  s_barrier
  v_mfma_f32_16x16x32_bf16 v[80:83], a[144:147], a[64:67], v[80:83]
  ds_read_b64_tr_b16 a[128:129], v13 offset:24576
  v_mfma_f32_16x16x32_bf16 v[80:83], a[148:151], a[68:71], v[80:83]
  buffer_load_dwordx4 v253, s[20:23], s30 offen offset:2048 sc1 lds
  v_mfma_f32_16x16x32_bf16 v[84:87], a[148:151], a[76:79], v[84:87]
  ds_read_b128 a[32:35], v8 offset:24576
  v_mfma_f32_16x16x32_bf16 v[84:87], a[144:147], a[72:75], v[84:87]
  ds_read_b64_tr_b16 a[130:131], v13 offset:26624
  v_mfma_f32_16x16x32_bf16 v[88:91], a[144:147], a[80:83], v[88:91]
  buffer_load_dwordx4 v254, s[20:23], s30 offen offset:3072 sc1 lds
  v_mfma_f32_16x16x32_bf16 v[88:91], a[148:151], a[84:87], v[88:91]
  ds_read_b128 a[36:39], v8 offset:25600
  v_mfma_f32_16x16x32_bf16 v[92:95], a[148:151], a[92:95], v[92:95]
  ds_read_b64_tr_b16 a[132:133], v13 offset:28672
  v_mfma_f32_16x16x32_bf16 v[92:95], a[144:147], a[88:91], v[92:95]
  s_add_u32 s30, s30, 12288
  s_add_u32 m0, s42, 90112
  v_mfma_f32_16x16x32_bf16 v[144:147], a[144:147], a[96:99], v[144:147]
  buffer_load_dwordx4 v4, s[12:15], s33 offen offset:0 lds
  v_mfma_f32_16x16x32_bf16 v[144:147], a[148:151], a[100:103], v[144:147]
  ds_read_b128 a[40:43], v8 offset:26624
  v_mfma_f32_16x16x32_bf16 v[148:151], a[148:151], a[108:111], v[148:151]
  ds_read_b64_tr_b16 a[134:135], v13 offset:30720
  v_mfma_f32_16x16x32_bf16 v[148:151], a[144:147], a[104:107], v[148:151]
  ds_read_b128 a[44:47], v8 offset:27648
  v_mfma_f32_16x16x32_bf16 v[152:155], a[144:147], a[112:115], v[152:155]
  buffer_load_dwordx4 v5, s[12:15], s33 offen offset:1024 lds
  v_mfma_f32_16x16x32_bf16 v[152:155], a[148:151], a[116:119], v[152:155]
  ds_read_b64_tr_b16 a[136:137], v14 offset:24576
  v_mfma_f32_16x16x32_bf16 v[156:159], a[148:151], a[124:127], v[156:159]
  v_mfma_f32_16x16x32_bf16 v[156:159], a[144:147], a[120:123], v[156:159]
  s_add_u32 s33, s33, 393216
  s_add_u32 m0, s36, 73728
  v_mfma_f32_16x16x32_bf16 v[96:99], a[152:155], a[64:67], v[96:99]
  buffer_load_dwordx4 v3, s[20:23], s31 offen offset:0 sc1 lds
  v_mfma_f32_16x16x32_bf16 v[96:99], a[156:159], a[68:71], v[96:99]
  ds_read_b128 a[48:51], v8 offset:28672
  ds_read_b64_tr_b16 a[138:139], v14 offset:26624
  v_mfma_f32_16x16x32_bf16 v[100:103], a[156:159], a[76:79], v[100:103]
  ds_read_b128 a[52:55], v8 offset:29696
  v_mfma_f32_16x16x32_bf16 v[100:103], a[152:155], a[72:75], v[100:103]
  v_mfma_f32_16x16x32_bf16 v[104:107], a[152:155], a[80:83], v[104:107]
  buffer_load_dwordx4 v252, s[20:23], s31 offen offset:1024 sc1 lds
  v_mfma_f32_16x16x32_bf16 v[104:107], a[156:159], a[84:87], v[104:107]
  ds_read_b64_tr_b16 a[140:141], v14 offset:28672
  ds_read_b128 a[56:59], v8 offset:30720
  v_mfma_f32_16x16x32_bf16 v[108:111], a[156:159], a[92:95], v[108:111]
  v_mfma_f32_16x16x32_bf16 v[108:111], a[152:155], a[88:91], v[108:111]
  ds_read_b64_tr_b16 a[142:143], v14 offset:30720
  v_mfma_f32_16x16x32_bf16 v[160:163], a[152:155], a[96:99], v[160:163]
  buffer_load_dwordx4 v253, s[20:23], s31 offen offset:2048 sc1 lds
  v_mfma_f32_16x16x32_bf16 v[160:163], a[156:159], a[100:103], v[160:163]
  ds_read_b128 a[60:63], v8 offset:31744
  v_mfma_f32_16x16x32_bf16 v[164:167], a[156:159], a[108:111], v[164:167]
  v_mfma_f32_16x16x32_bf16 v[164:167], a[152:155], a[104:107], v[164:167]
  v_mfma_f32_16x16x32_bf16 v[168:171], a[152:155], a[112:115], v[168:171]
  buffer_load_dwordx4 v254, s[20:23], s31 offen offset:3072 sc1 lds
  v_mfma_f32_16x16x32_bf16 v[168:171], a[156:159], a[116:119], v[168:171]
  s_add_u32 s31, s31, 12288
  v_mfma_f32_16x16x32_bf16 v[172:175], a[156:159], a[124:127], v[172:175]
  v_mfma_f32_16x16x32_bf16 v[172:175], a[152:155], a[120:123], v[172:175]
  s_waitcnt vmcnt(18) lgkmcnt(0)
  s_barrier
  v_mfma_f32_16x16x32_bf16 v[48:51], a[128:131], a[0:3], v[48:51]
  s_add_u32 s68, s35, 786432
  s_add_u32 m0, s42, 147456
  v_mfma_f32_16x16x32_bf16 v[48:51], a[132:135], a[4:7], v[48:51]
  buffer_load_dwordx4 v4, s[8:11], s68 offen offset:0 lds
  v_mfma_f32_16x16x32_bf16 v[52:55], a[132:135], a[12:15], v[52:55]
  ds_read_b64_tr_b16 a[144:145], v9 offset:0
  ds_read_b128 a[64:67], v6 offset:0
  v_mfma_f32_16x16x32_bf16 v[52:55], a[128:131], a[8:11], v[52:55]
  ds_read_b64_tr_b16 a[146:147], v9 offset:2048
  v_mfma_f32_16x16x32_bf16 v[56:59], a[128:131], a[16:19], v[56:59]
  buffer_load_dwordx4 v5, s[8:11], s68 offen offset:1024 lds
  v_mfma_f32_16x16x32_bf16 v[56:59], a[132:135], a[20:23], v[56:59]
  ds_read_b128 a[68:71], v6 offset:1024
  v_mfma_f32_16x16x32_bf16 v[60:63], a[132:135], a[28:31], v[60:63]
  ds_read_b64_tr_b16 a[148:149], v9 offset:4096
  v_mfma_f32_16x16x32_bf16 v[60:63], a[128:131], a[24:27], v[60:63]
  s_add_u32 s68, s68, 131072
  s_add_u32 m0, s42, 114688
  v_mfma_f32_16x16x32_bf16 v[112:115], a[128:131], a[32:35], v[112:115]
  buffer_load_dwordx4 v4, s[12:15], s34 offen offset:0 lds
  v_mfma_f32_16x16x32_bf16 v[112:115], a[132:135], a[36:39], v[112:115]
  ds_read_b128 a[72:75], v6 offset:2048
  v_mfma_f32_16x16x32_bf16 v[116:119], a[132:135], a[44:47], v[116:119]
  ds_read_b64_tr_b16 a[150:151], v9 offset:6144
  v_mfma_f32_16x16x32_bf16 v[116:119], a[128:131], a[40:43], v[116:119]
  ds_read_b128 a[76:79], v6 offset:3072
  v_mfma_f32_16x16x32_bf16 v[120:123], a[128:131], a[48:51], v[120:123]
  buffer_load_dwordx4 v5, s[12:15], s34 offen offset:1024 lds
  v_mfma_f32_16x16x32_bf16 v[120:123], a[132:135], a[52:55], v[120:123]
  ds_read_b64_tr_b16 a[152:153], v10 offset:0
  v_mfma_f32_16x16x32_bf16 v[124:127], a[132:135], a[60:63], v[124:127]
  v_mfma_f32_16x16x32_bf16 v[124:127], a[128:131], a[56:59], v[124:127]
  s_add_u32 s34, s34, 393216
  s_add_u32 m0, s36, 98304
  v_mfma_f32_16x16x32_bf16 v[64:67], a[136:139], a[0:3], v[64:67]
  buffer_load_dwordx4 v3, s[20:23], s30 offen offset:0 sc1 lds
  v_mfma_f32_16x16x32_bf16 v[64:67], a[140:143], a[4:7], v[64:67]
  ds_read_b128 a[80:83], v6 offset:4096
  ds_read_b64_tr_b16 a[154:155], v10 offset:2048
  v_mfma_f32_16x16x32_bf16 v[68:71], a[140:143], a[12:15], v[68:71]
  ds_read_b128 a[84:87], v6 offset:5120
  v_mfma_f32_16x16x32_bf16 v[68:71], a[136:139], a[8:11], v[68:71]
  v_mfma_f32_16x16x32_bf16 v[72:75], a[136:139], a[16:19], v[72:75]
  buffer_load_dwordx4 v252, s[20:23], s30 offen offset:1024 sc1 lds
  v_mfma_f32_16x16x32_bf16 v[72:75], a[140:143], a[20:23], v[72:75]
  ds_read_b64_tr_b16 a[156:157], v10 offset:4096
  ds_read_b128 a[88:91], v6 offset:6144
  v_mfma_f32_16x16x32_bf16 v[76:79], a[140:143], a[28:31], v[76:79]
  v_mfma_f32_16x16x32_bf16 v[76:79], a[136:139], a[24:27], v[76:79]
  ds_read_b64_tr_b16 a[158:159], v10 offset:6144
  v_mfma_f32_16x16x32_bf16 v[128:131], a[136:139], a[32:35], v[128:131]
  buffer_load_dwordx4 v253, s[20:23], s30 offen offset:2048 sc1 lds
  v_mfma_f32_16x16x32_bf16 v[128:131], a[140:143], a[36:39], v[128:131]
  ds_read_b128 a[92:95], v6 offset:7168
  v_mfma_f32_16x16x32_bf16 v[132:135], a[140:143], a[44:47], v[132:135]
  v_mfma_f32_16x16x32_bf16 v[132:135], a[136:139], a[40:43], v[132:135]
  v_mfma_f32_16x16x32_bf16 v[136:139], a[136:139], a[48:51], v[136:139]
  buffer_load_dwordx4 v254, s[20:23], s30 offen offset:3072 sc1 lds
  v_mfma_f32_16x16x32_bf16 v[136:139], a[140:143], a[52:55], v[136:139]
  s_add_u32 s30, s30, 16384
  v_mfma_f32_16x16x32_bf16 v[140:143], a[140:143], a[60:63], v[140:143]
  v_mfma_f32_16x16x32_bf16 v[140:143], a[136:139], a[56:59], v[140:143]
  s_waitcnt vmcnt(20) lgkmcnt(0)
  s_barrier
  v_mfma_f32_16x16x32_bf16 v[80:83], a[144:147], a[0:3], v[80:83]
  s_add_u32 m0, s42, 139264
  ds_read_b64_tr_b16 a[128:129], v9 offset:24576
  v_mfma_f32_16x16x32_bf16 v[80:83], a[148:151], a[4:7], v[80:83]
  buffer_load_dwordx4 v4, s[12:15], s33 offen offset:0 lds
  v_mfma_f32_16x16x32_bf16 v[84:87], a[148:151], a[12:15], v[84:87]
  ds_read_b128 a[96:99], v6 offset:24576
  v_mfma_f32_16x16x32_bf16 v[84:87], a[144:147], a[8:11], v[84:87]
  ds_read_b64_tr_b16 a[130:131], v9 offset:26624
  v_mfma_f32_16x16x32_bf16 v[88:91], a[144:147], a[16:19], v[88:91]
  buffer_load_dwordx4 v5, s[12:15], s33 offen offset:1024 lds
  v_mfma_f32_16x16x32_bf16 v[88:91], a[148:151], a[20:23], v[88:91]
  ds_read_b128 a[100:103], v6 offset:25600
  v_mfma_f32_16x16x32_bf16 v[92:95], a[148:151], a[28:31], v[92:95]
  ds_read_b64_tr_b16 a[132:133], v9 offset:28672
  v_mfma_f32_16x16x32_bf16 v[92:95], a[144:147], a[24:27], v[92:95]
  s_add_u32 s33, s33, 524288
  s_add_u32 m0, s36, 122880
  v_mfma_f32_16x16x32_bf16 v[144:147], a[144:147], a[32:35], v[144:147]
  buffer_load_dwordx4 v3, s[20:23], s31 offen offset:0 sc1 lds
  v_mfma_f32_16x16x32_bf16 v[144:147], a[148:151], a[36:39], v[144:147]
  ds_read_b128 a[104:107], v6 offset:26624
  v_mfma_f32_16x16x32_bf16 v[148:151], a[148:151], a[44:47], v[148:151]
  ds_read_b64_tr_b16 a[134:135], v9 offset:30720
  v_mfma_f32_16x16x32_bf16 v[148:151], a[144:147], a[40:43], v[148:151]
  ds_read_b128 a[108:111], v6 offset:27648
  v_mfma_f32_16x16x32_bf16 v[152:155], a[144:147], a[48:51], v[152:155]
  buffer_load_dwordx4 v252, s[20:23], s31 offen offset:1024 sc1 lds
  v_mfma_f32_16x16x32_bf16 v[152:155], a[148:151], a[52:55], v[152:155]
  ds_read_b64_tr_b16 a[136:137], v10 offset:24576
  v_mfma_f32_16x16x32_bf16 v[156:159], a[148:151], a[60:63], v[156:159]
  v_mfma_f32_16x16x32_bf16 v[156:159], a[144:147], a[56:59], v[156:159]
  ds_read_b128 a[112:115], v6 offset:28672
  v_mfma_f32_16x16x32_bf16 v[96:99], a[152:155], a[0:3], v[96:99]
  buffer_load_dwordx4 v253, s[20:23], s31 offen offset:2048 sc1 lds
  v_mfma_f32_16x16x32_bf16 v[96:99], a[156:159], a[4:7], v[96:99]
  ds_read_b64_tr_b16 a[138:139], v10 offset:26624
  v_mfma_f32_16x16x32_bf16 v[100:103], a[156:159], a[12:15], v[100:103]
  ds_read_b128 a[116:119], v6 offset:29696
  v_mfma_f32_16x16x32_bf16 v[100:103], a[152:155], a[8:11], v[100:103]
  v_mfma_f32_16x16x32_bf16 v[104:107], a[152:155], a[16:19], v[104:107]
  buffer_load_dwordx4 v254, s[20:23], s31 offen offset:3072 sc1 lds
  v_mfma_f32_16x16x32_bf16 v[104:107], a[156:159], a[20:23], v[104:107]
  ds_read_b64_tr_b16 a[140:141], v10 offset:28672
  ds_read_b128 a[120:123], v6 offset:30720
  v_mfma_f32_16x16x32_bf16 v[108:111], a[156:159], a[28:31], v[108:111]
  v_mfma_f32_16x16x32_bf16 v[108:111], a[152:155], a[24:27], v[108:111]
  s_add_u32 s31, s31, 16384
  s_add_u32 m0, s42, 16384
  v_mfma_f32_16x16x32_bf16 v[160:163], a[152:155], a[32:35], v[160:163]
  buffer_load_dwordx4 v4, s[12:15], s34 offen offset:0 lds
  v_mfma_f32_16x16x32_bf16 v[160:163], a[156:159], a[36:39], v[160:163]
  ds_read_b64_tr_b16 a[142:143], v10 offset:30720
  ds_read_b128 a[124:127], v6 offset:31744
  v_mfma_f32_16x16x32_bf16 v[164:167], a[156:159], a[44:47], v[164:167]
  v_mfma_f32_16x16x32_bf16 v[164:167], a[152:155], a[40:43], v[164:167]
  v_mfma_f32_16x16x32_bf16 v[168:171], a[152:155], a[48:51], v[168:171]
  buffer_load_dwordx4 v5, s[12:15], s34 offen offset:1024 lds
  v_mfma_f32_16x16x32_bf16 v[168:171], a[156:159], a[52:55], v[168:171]
  s_add_u32 s34, s34, 524288
  v_mfma_f32_16x16x32_bf16 v[172:175], a[156:159], a[60:63], v[172:175]
  v_mfma_f32_16x16x32_bf16 v[172:175], a[152:155], a[56:59], v[172:175]
  s_waitcnt vmcnt(14) lgkmcnt(0)
  s_barrier
  v_mfma_f32_16x16x32_bf16 v[48:51], a[128:131], a[64:67], v[48:51]
  s_add_u32 m0, s42, 155648
  ds_read_b64_tr_b16 a[144:145], v11 offset:0
  v_mfma_f32_16x16x32_bf16 v[48:51], a[132:135], a[68:71], v[48:51]
  buffer_load_dwordx4 v4, s[8:11], s68 offen offset:0 lds
  v_mfma_f32_16x16x32_bf16 v[52:55], a[132:135], a[76:79], v[52:55]
  ds_read_b128 a[0:3], v7 offset:0
  ds_read_b64_tr_b16 a[160:161], v13 offset:32768
  v_mfma_f32_16x16x32_bf16 v[52:55], a[128:131], a[72:75], v[52:55]
  ds_read_b64_tr_b16 a[146:147], v11 offset:2048
  v_mfma_f32_16x16x32_bf16 v[56:59], a[128:131], a[80:83], v[56:59]
  buffer_load_dwordx4 v5, s[8:11], s68 offen offset:1024 lds
  v_mfma_f32_16x16x32_bf16 v[56:59], a[132:135], a[84:87], v[56:59]
  ds_read_b128 a[4:7], v7 offset:1024
  ds_read_b64_tr_b16 a[162:163], v13 offset:34816
  v_mfma_f32_16x16x32_bf16 v[60:63], a[132:135], a[92:95], v[60:63]
  ds_read_b64_tr_b16 a[148:149], v11 offset:4096
  s_mov_b32 s6, 0x00100001
  v_mfma_f32_16x16x32_bf16 v[60:63], a[128:131], a[88:91], v[60:63]
  s_add_u32 s68, s68, 131072
  s_add_u32 m0, s36, 0
  v_mfma_f32_16x16x32_bf16 v[112:115], a[128:131], a[96:99], v[112:115]
  buffer_load_dwordx4 v3, s[20:23], s30 offen offset:0 sc1 lds
  v_mfma_f32_16x16x32_bf16 v[112:115], a[132:135], a[100:103], v[112:115]
  ds_read_b128 a[8:11], v7 offset:2048
  ds_read_b64_tr_b16 a[164:165], v13 offset:36864
  v_mfma_f32_16x16x32_bf16 v[116:119], a[132:135], a[108:111], v[116:119]
  ds_read_b64_tr_b16 a[150:151], v11 offset:6144
  s_mov_b32 s7, 0x10000100
  v_mfma_f32_16x16x32_bf16 v[116:119], a[128:131], a[104:107], v[116:119]
  ds_read_b128 a[12:15], v7 offset:3072
  v_mov_b32 v27, 0x3f80
  v_mfma_f32_16x16x32_bf16 v[120:123], a[128:131], a[112:115], v[120:123]
  buffer_load_dwordx4 v252, s[20:23], s30 offen offset:1024 sc1 lds
  v_mfma_f32_16x16x32_bf16 v[120:123], a[132:135], a[116:119], v[120:123]
  ds_read_b64_tr_b16 a[166:167], v13 offset:38912
  ds_read_b64_tr_b16 a[152:153], v12 offset:0
  v_mfma_f32_16x16x32_bf16 v[124:127], a[132:135], a[124:127], v[124:127]
  ds_read_b128 a[16:19], v7 offset:4096
  v_mov_b32 v244, 0
  v_mfma_f32_16x16x32_bf16 v[124:127], a[128:131], a[120:123], v[124:127]
  ds_read_b64_tr_b16 a[168:169], v14 offset:32768
  v_mov_b32 v245, 0
  v_mfma_f32_16x16x32_bf16 v[64:67], a[136:139], a[64:67], v[64:67]
  buffer_load_dwordx4 v253, s[20:23], s30 offen offset:2048 sc1 lds
  v_mfma_f32_16x16x32_bf16 v[64:67], a[140:143], a[68:71], v[64:67]
  ds_read_b64_tr_b16 a[154:155], v12 offset:2048
  v_mov_b32 v248, 0
  v_mfma_f32_16x16x32_bf16 v[68:71], a[140:143], a[76:79], v[68:71]
  ds_read_b128 a[20:23], v7 offset:5120
  v_mov_b32 v249, 0
  v_mfma_f32_16x16x32_bf16 v[68:71], a[136:139], a[72:75], v[68:71]
  ds_read_b64_tr_b16 a[170:171], v14 offset:34816
  v_cndmask_b32 v246, 0, v27, s[6:7]
  v_mfma_f32_16x16x32_bf16 v[72:75], a[136:139], a[80:83], v[72:75]
  buffer_load_dwordx4 v254, s[20:23], s30 offen offset:3072 sc1 lds
  v_mfma_f32_16x16x32_bf16 v[72:75], a[140:143], a[84:87], v[72:75]
  ds_read_b64_tr_b16 a[156:157], v12 offset:4096
  ds_read_b128 a[24:27], v7 offset:6144
  v_mfma_f32_16x16x32_bf16 v[76:79], a[140:143], a[92:95], v[76:79]
  ds_read_b64_tr_b16 a[172:173], v14 offset:36864
  s_lshl_b64 s[6:7], s[6:7], 1
  v_mfma_f32_16x16x32_bf16 v[76:79], a[136:139], a[88:91], v[76:79]
  s_add_u32 s30, s30, 12288
  s_add_u32 m0, s42, 40960
  v_mfma_f32_16x16x32_bf16 v[128:131], a[136:139], a[96:99], v[128:131]
  buffer_load_dwordx4 v4, s[12:15], s33 offen offset:0 lds
  v_mfma_f32_16x16x32_bf16 v[128:131], a[140:143], a[100:103], v[128:131]
  ds_read_b64_tr_b16 a[158:159], v12 offset:6144
  ds_read_b128 a[28:31], v7 offset:7168
  v_mfma_f32_16x16x32_bf16 v[132:135], a[140:143], a[108:111], v[132:135]
  ds_read_b64_tr_b16 a[174:175], v14 offset:38912
  v_cndmask_b32 v246, v246, 1.0, s[6:7]
  v_mfma_f32_16x16x32_bf16 v[132:135], a[136:139], a[104:107], v[132:135]
  s_lshl_b64 s[6:7], s[6:7], 1
  v_cndmask_b32 v247, 0, v27, s[6:7]
  v_mfma_f32_16x16x32_bf16 v[136:139], a[136:139], a[112:115], v[136:139]
  buffer_load_dwordx4 v5, s[12:15], s33 offen offset:1024 lds
  v_mfma_f32_16x16x32_bf16 v[136:139], a[140:143], a[116:119], v[136:139]
  s_add_u32 s33, s33, 393216
  s_lshl_b64 s[6:7], s[6:7], 1
  v_mfma_f32_16x16x32_bf16 v[140:143], a[140:143], a[124:127], v[140:143]
  v_cndmask_b32 v247, v247, 1.0, s[6:7]
  v_mfma_f32_16x16x32_bf16 v[140:143], a[136:139], a[120:123], v[140:143]
  s_waitcnt vmcnt(22) lgkmcnt(0)
  s_barrier
  v_mfma_f32_16x16x32_bf16 v[80:83], a[144:147], a[64:67], v[80:83]
  s_add_u32 m0, s36, 24576
  ds_read_b64_tr_b16 a[128:129], v11 offset:24576
  v_mfma_f32_16x16x32_bf16 v[80:83], a[148:151], a[68:71], v[80:83]
  buffer_load_dwordx4 v3, s[20:23], s31 offen offset:0 sc1 lds
  v_mfma_f32_16x16x32_bf16 v[84:87], a[148:151], a[76:79], v[84:87]
  ds_read_b128 a[32:35], v7 offset:24576
  v_mfma_f32_16x16x32_bf16 v[84:87], a[144:147], a[72:75], v[84:87]
  ds_read_b64_tr_b16 a[130:131], v11 offset:26624
  v_mfma_f32_16x16x32_bf16 v[88:91], a[144:147], a[80:83], v[88:91]
  buffer_load_dwordx4 v252, s[20:23], s31 offen offset:1024 sc1 lds
  v_mfma_f32_16x16x32_bf16 v[88:91], a[148:151], a[84:87], v[88:91]
  ds_read_b128 a[36:39], v7 offset:25600
  v_mfma_f32_16x16x32_bf16 v[92:95], a[148:151], a[92:95], v[92:95]
  ds_read_b64_tr_b16 a[132:133], v11 offset:28672
  v_mfma_f32_16x16x32_bf16 v[92:95], a[144:147], a[88:91], v[92:95]
  v_mfma_f32_16x16x32_bf16 v[144:147], a[144:147], a[96:99], v[144:147]
  buffer_load_dwordx4 v253, s[20:23], s31 offen offset:2048 sc1 lds
  v_mfma_f32_16x16x32_bf16 v[144:147], a[148:151], a[100:103], v[144:147]
  ds_read_b128 a[40:43], v7 offset:26624
  v_mfma_f32_16x16x32_bf16 v[148:151], a[148:151], a[108:111], v[148:151]
  ds_read_b64_tr_b16 a[134:135], v11 offset:30720
  v_mfma_f32_16x16x32_bf16 v[148:151], a[144:147], a[104:107], v[148:151]
  ds_read_b128 a[44:47], v7 offset:27648
  v_mfma_f32_16x16x32_bf16 v[152:155], a[144:147], a[112:115], v[152:155]
  buffer_load_dwordx4 v254, s[20:23], s31 offen offset:3072 sc1 lds
  v_mfma_f32_16x16x32_bf16 v[152:155], a[148:151], a[116:119], v[152:155]
  ds_read_b64_tr_b16 a[136:137], v12 offset:24576
  v_mfma_f32_16x16x32_bf16 v[156:159], a[148:151], a[124:127], v[156:159]
  v_mfma_f32_16x16x32_bf16 v[156:159], a[144:147], a[120:123], v[156:159]
  s_add_u32 s31, s31, 12288
  s_add_u32 m0, s42, 65536
  v_mfma_f32_16x16x32_bf16 v[96:99], a[152:155], a[64:67], v[96:99]
  buffer_load_dwordx4 v4, s[12:15], s34 offen offset:0 lds
  v_mfma_f32_16x16x32_bf16 v[96:99], a[156:159], a[68:71], v[96:99]
  ds_read_b128 a[48:51], v7 offset:28672
  ds_read_b64_tr_b16 a[138:139], v12 offset:26624
  v_mfma_f32_16x16x32_bf16 v[100:103], a[156:159], a[76:79], v[100:103]
  ds_read_b128 a[52:55], v7 offset:29696
  v_mfma_f32_16x16x32_bf16 v[100:103], a[152:155], a[72:75], v[100:103]
  v_mfma_f32_16x16x32_bf16 v[104:107], a[152:155], a[80:83], v[104:107]
  buffer_load_dwordx4 v5, s[12:15], s34 offen offset:1024 lds
  v_mfma_f32_16x16x32_bf16 v[104:107], a[156:159], a[84:87], v[104:107]
  ds_read_b64_tr_b16 a[140:141], v12 offset:28672
  ds_read_b128 a[56:59], v7 offset:30720
  v_mfma_f32_16x16x32_bf16 v[108:111], a[156:159], a[92:95], v[108:111]
  v_mfma_f32_16x16x32_bf16 v[108:111], a[152:155], a[88:91], v[108:111]
  s_add_u32 s34, s34, 393216
  s_add_u32 m0, s36, 49152
  v_mfma_f32_16x16x32_bf16 v[160:163], a[152:155], a[96:99], v[160:163]
  buffer_load_dwordx4 v3, s[20:23], s30 offen offset:0 sc1 lds
  v_mfma_f32_16x16x32_bf16 v[160:163], a[156:159], a[100:103], v[160:163]
  ds_read_b64_tr_b16 a[142:143], v12 offset:30720
  ds_read_b128 a[60:63], v7 offset:31744
  v_mfma_f32_16x16x32_bf16 v[164:167], a[156:159], a[108:111], v[164:167]
  v_mfma_f32_16x16x32_bf16 v[164:167], a[152:155], a[104:107], v[164:167]
  v_mfma_f32_16x16x32_bf16 v[168:171], a[152:155], a[112:115], v[168:171]
  buffer_load_dwordx4 v252, s[20:23], s30 offen offset:1024 sc1 lds
  v_mfma_f32_16x16x32_bf16 v[168:171], a[156:159], a[116:119], v[168:171]
  v_mfma_f32_16x16x32_bf16 v[172:175], a[156:159], a[124:127], v[172:175]
  v_mfma_f32_16x16x32_bf16 v[172:175], a[152:155], a[120:123], v[172:175]
  s_waitcnt vmcnt(14) lgkmcnt(0)
  s_barrier
  v_mfma_f32_16x16x32_bf16 v[48:51], a[128:131], a[0:3], v[48:51]
  ds_read_b64_tr_b16 a[144:145], v13 offset:0
  v_mfma_f32_16x16x32_bf16 v[48:51], a[132:135], a[4:7], v[48:51]
  s_cmp_eq_u32 s0, 1
  s_cbranch_scc0 LE4a
  buffer_load_dword v23, v22, s[20:23], s51 offen offset:64 nt
LE4b:
  v_mfma_f32_16x16x32_bf16 v[52:55], a[132:135], a[12:15], v[52:55]
  ds_read_b128 a[64:67], v8 offset:0
  ds_read_b64_tr_b16 a[176:177], v13 offset:40960
  v_mfma_f32_16x16x32_bf16 v[52:55], a[128:131], a[8:11], v[52:55]
  s_add_u32 m0, s42, 147456
  ds_read_b64_tr_b16 a[146:147], v13 offset:2048
  v_mfma_f32_16x16x32_bf16 v[56:59], a[128:131], a[16:19], v[56:59]
  buffer_load_dwordx4 v4, s[8:11], s68 offen offset:0 lds
  v_mfma_f32_16x16x32_bf16 v[56:59], a[132:135], a[20:23], v[56:59]
  ds_read_b128 a[68:71], v8 offset:1024
  ds_read_b64_tr_b16 a[178:179], v13 offset:43008
  v_mfma_f32_16x16x32_bf16 v[60:63], a[132:135], a[28:31], v[60:63]
  ds_read_b64_tr_b16 a[148:149], v13 offset:4096
  v_mfma_f32_16x16x32_bf16 v[60:63], a[128:131], a[24:27], v[60:63]
  buffer_load_dwordx4 v5, s[8:11], s68 offen offset:1024 lds
  v_mfma_f32_16x16x32_bf16 v[112:115], a[128:131], a[32:35], v[112:115]
  ds_read_b128 a[72:75], v8 offset:2048
  v_mfma_f32_16x16x32_bf16 v[112:115], a[132:135], a[36:39], v[112:115]
  ds_read_b64_tr_b16 a[180:181], v13 offset:45056
  v_mfma_f32_16x16x32_bf16 v[116:119], a[132:135], a[44:47], v[116:119]
  s_add_u32 s68, s68, 131072
  s_add_u32 m0, s36, 49152
  v_mfma_f32_16x16x32_bf16 v[116:119], a[128:131], a[40:43], v[116:119]
  buffer_load_dwordx4 v253, s[20:23], s30 offen offset:2048 sc1 lds
  v_mfma_f32_16x16x32_bf16 v[120:123], a[128:131], a[48:51], v[120:123]
  ds_read_b64_tr_b16 a[150:151], v13 offset:6144
  ds_read_b128 a[76:79], v8 offset:3072
  v_mfma_f32_16x16x32_bf16 v[120:123], a[132:135], a[52:55], v[120:123]
  ds_read_b64_tr_b16 a[182:183], v13 offset:47104
  ds_read_b64_tr_b16 a[152:153], v14 offset:0
  v_mfma_f32_16x16x32_bf16 v[124:127], a[132:135], a[60:63], v[124:127]
  buffer_load_dwordx4 v254, s[20:23], s30 offen offset:3072 sc1 lds
  v_mfma_f32_16x16x32_bf16 v[124:127], a[128:131], a[56:59], v[124:127]
  ds_read_b128 a[80:83], v8 offset:4096
  ds_read_b64_tr_b16 a[184:185], v14 offset:40960
  v_mfma_f32_16x16x32_bf16 v[64:67], a[136:139], a[0:3], v[64:67]
  ds_read_b64_tr_b16 a[154:155], v14 offset:2048
  v_mfma_f32_16x16x32_bf16 v[64:67], a[140:143], a[4:7], v[64:67]
  s_sub_u32 s30, s30, 36864
  s_add_u32 m0, s42, 90112
  v_mfma_f32_16x16x32_bf16 v[68:71], a[140:143], a[12:15], v[68:71]
  buffer_load_dwordx4 v4, s[12:15], s33 offen offset:0 lds
  v_mfma_f32_16x16x32_bf16 v[68:71], a[136:139], a[8:11], v[68:71]
  ds_read_b128 a[84:87], v8 offset:5120
  ds_read_b64_tr_b16 a[186:187], v14 offset:43008
  v_mfma_f32_16x16x32_bf16 v[72:75], a[136:139], a[16:19], v[72:75]
  ds_read_b64_tr_b16 a[156:157], v14 offset:4096
  v_mfma_f32_16x16x32_bf16 v[72:75], a[140:143], a[20:23], v[72:75]
  buffer_load_dwordx4 v5, s[12:15], s33 offen offset:1024 lds
  v_mfma_f32_16x16x32_bf16 v[76:79], a[140:143], a[28:31], v[76:79]
  ds_read_b128 a[88:91], v8 offset:6144
  ds_read_b64_tr_b16 a[188:189], v14 offset:45056
  v_mfma_f32_16x16x32_bf16 v[76:79], a[136:139], a[24:27], v[76:79]
  ds_read_b64_tr_b16 a[158:159], v14 offset:6144
  v_mfma_f32_16x16x32_bf16 v[128:131], a[136:139], a[32:35], v[128:131]
  s_sub_u32 s33, s33, 1179648
  s_add_u32 m0, s36, 73728
  v_mfma_f32_16x16x32_bf16 v[128:131], a[140:143], a[36:39], v[128:131]
  buffer_load_dwordx4 v3, s[20:23], s31 offen offset:0 sc1 lds
  v_mfma_f32_16x16x32_bf16 v[132:135], a[140:143], a[44:47], v[132:135]
  ds_read_b128 a[92:95], v8 offset:7168
  ds_read_b64_tr_b16 a[190:191], v14 offset:47104
  v_mfma_f32_16x16x32_bf16 v[132:135], a[136:139], a[40:43], v[132:135]
  v_mfma_f32_16x16x32_bf16 v[136:139], a[136:139], a[48:51], v[136:139]
  buffer_load_dwordx4 v252, s[20:23], s31 offen offset:1024 sc1 lds
  v_mfma_f32_16x16x32_bf16 v[136:139], a[140:143], a[52:55], v[136:139]
  v_mfma_f32_16x16x32_bf16 v[140:143], a[140:143], a[60:63], v[140:143]
  v_mfma_f32_16x16x32_bf16 v[140:143], a[136:139], a[56:59], v[140:143]
  s_waitcnt vmcnt(23) lgkmcnt(0)
  s_barrier
  v_mfma_f32_16x16x32_bf16 v[80:83], a[144:147], a[0:3], v[80:83]
  ds_read_b64_tr_b16 a[128:129], v13 offset:24576
  v_mfma_f32_16x16x32_bf16 v[80:83], a[148:151], a[4:7], v[80:83]
  buffer_load_dwordx4 v253, s[20:23], s31 offen offset:2048 sc1 lds
  v_mfma_f32_16x16x32_bf16 v[84:87], a[148:151], a[12:15], v[84:87]
  ds_read_b128 a[96:99], v8 offset:24576
  v_mfma_f32_16x16x32_bf16 v[84:87], a[144:147], a[8:11], v[84:87]
  ds_read_b64_tr_b16 a[130:131], v13 offset:26624
  v_mfma_f32_16x16x32_bf16 v[88:91], a[144:147], a[16:19], v[88:91]
  buffer_load_dwordx4 v254, s[20:23], s31 offen offset:3072 sc1 lds
  v_mfma_f32_16x16x32_bf16 v[88:91], a[148:151], a[20:23], v[88:91]
  ds_read_b128 a[100:103], v8 offset:25600
  v_mfma_f32_16x16x32_bf16 v[92:95], a[148:151], a[28:31], v[92:95]
  ds_read_b64_tr_b16 a[132:133], v13 offset:28672
  v_mfma_f32_16x16x32_bf16 v[92:95], a[144:147], a[24:27], v[92:95]
  s_sub_u32 s31, s31, 36864
  s_add_u32 m0, s42, 114688
  v_mfma_f32_16x16x32_bf16 v[144:147], a[144:147], a[32:35], v[144:147]
  buffer_load_dwordx4 v4, s[12:15], s34 offen offset:0 lds
  v_mfma_f32_16x16x32_bf16 v[144:147], a[148:151], a[36:39], v[144:147]
  ds_read_b128 a[104:107], v8 offset:26624
  v_mfma_f32_16x16x32_bf16 v[148:151], a[148:151], a[44:47], v[148:151]
  ds_read_b64_tr_b16 a[134:135], v13 offset:30720
  v_mfma_f32_16x16x32_bf16 v[148:151], a[144:147], a[40:43], v[148:151]
  ds_read_b128 a[108:111], v8 offset:27648
  v_mfma_f32_16x16x32_bf16 v[152:155], a[144:147], a[48:51], v[152:155]
  buffer_load_dwordx4 v5, s[12:15], s34 offen offset:1024 lds
  s_branch L_stubQs5
L_stubQ5:
  s_setpc_b64 s[4:5]
L_stubQs5:
  v_mfma_f32_16x16x32_bf16 v[152:155], a[148:151], a[52:55], v[152:155]
  ds_read_b64_tr_b16 a[136:137], v14 offset:24576
  v_mfma_f32_16x16x32_bf16 v[156:159], a[148:151], a[60:63], v[156:159]
  v_mfma_f32_16x16x32_bf16 v[156:159], a[144:147], a[56:59], v[156:159]
  s_sub_u32 s34, s34, 1179648
  s_add_u32 m0, s36, 98304
  v_mfma_f32_16x16x32_bf16 v[96:99], a[152:155], a[0:3], v[96:99]
  buffer_load_dwordx4 v3, s[20:23], s30 offen offset:0 sc1 lds
  v_mfma_f32_16x16x32_bf16 v[96:99], a[156:159], a[4:7], v[96:99]
  ds_read_b128 a[112:115], v8 offset:28672
  ds_read_b64_tr_b16 a[138:139], v14 offset:26624
  v_mfma_f32_16x16x32_bf16 v[100:103], a[156:159], a[12:15], v[100:103]
  ds_read_b128 a[116:119], v8 offset:29696
  v_mfma_f32_16x16x32_bf16 v[100:103], a[152:155], a[8:11], v[100:103]
  v_mfma_f32_16x16x32_bf16 v[104:107], a[152:155], a[16:19], v[104:107]
  buffer_load_dwordx4 v252, s[20:23], s30 offen offset:1024 sc1 lds
  v_mfma_f32_16x16x32_bf16 v[104:107], a[156:159], a[20:23], v[104:107]
  ds_read_b64_tr_b16 a[140:141], v14 offset:28672
  ds_read_b128 a[120:123], v8 offset:30720
  v_mfma_f32_16x16x32_bf16 v[108:111], a[156:159], a[28:31], v[108:111]
  v_mfma_f32_16x16x32_bf16 v[108:111], a[152:155], a[24:27], v[108:111]
  ds_read_b64_tr_b16 a[142:143], v14 offset:30720
  v_mfma_f32_16x16x32_bf16 v[160:163], a[152:155], a[32:35], v[160:163]
  buffer_load_dwordx4 v253, s[20:23], s30 offen offset:2048 sc1 lds
  v_mfma_f32_16x16x32_bf16 v[160:163], a[156:159], a[36:39], v[160:163]
  ds_read_b128 a[124:127], v8 offset:31744
  v_mfma_f32_16x16x32_bf16 v[164:167], a[156:159], a[44:47], v[164:167]
  v_mfma_f32_16x16x32_bf16 v[164:167], a[152:155], a[40:43], v[164:167]
  v_mfma_f32_16x16x32_bf16 v[168:171], a[152:155], a[48:51], v[168:171]
  buffer_load_dwordx4 v254, s[20:23], s30 offen offset:3072 sc1 lds
  v_mfma_f32_16x16x32_bf16 v[168:171], a[156:159], a[52:55], v[168:171]
  s_add_u32 s30, s30, 12288
  v_mfma_f32_16x16x32_bf16 v[172:175], a[156:159], a[60:63], v[172:175]
  v_mfma_f32_16x16x32_bf16 v[172:175], a[152:155], a[56:59], v[172:175]
  s_waitcnt vmcnt(14) lgkmcnt(0)
  s_barrier
  v_cmp_ne_u32 vcc, 0x01010101, v23
  s_nop 0
  s_cmp_eq_u64 vcc, 0
  s_cbranch_scc0 L2_qf_slowQ
L2_qf_okQ:
  v_mfma_f32_16x16x32_bf16 v[48:51], a[128:131], a[64:67], v[48:51]
  s_add_u32 m0, s42, 155648
  ds_read_b64_tr_b16 a[144:145], v9 offset:0
  v_mfma_f32_16x16x32_bf16 v[48:51], a[132:135], a[68:71], v[48:51]
  buffer_load_dwordx4 v4, s[8:11], s68 offen offset:0 lds
  v_mfma_f32_16x16x32_bf16 v[52:55], a[132:135], a[76:79], v[52:55]
  ds_read_b128 a[0:3], v6 offset:0
  ds_read_b64_tr_b16 a[192:193], v13 offset:32768
  v_mfma_f32_16x16x32_bf16 v[52:55], a[128:131], a[72:75], v[52:55]
  ds_read_b64_tr_b16 a[146:147], v9 offset:2048
  v_mfma_f32_16x16x32_bf16 v[56:59], a[128:131], a[80:83], v[56:59]
  buffer_load_dwordx4 v5, s[8:11], s68 offen offset:1024 lds
  v_mfma_f32_16x16x32_bf16 v[56:59], a[132:135], a[84:87], v[56:59]
  ds_read_b128 a[4:7], v6 offset:1024
  ds_read_b64_tr_b16 a[194:195], v13 offset:34816
  v_mfma_f32_16x16x32_bf16 v[60:63], a[132:135], a[92:95], v[60:63]
  ds_read_b64_tr_b16 a[148:149], v9 offset:4096
  v_mfma_f32_16x16x32_bf16 v[60:63], a[128:131], a[88:91], v[60:63]
  s_add_u32 s68, s68, 131072
  s_add_u32 m0, s42, 139264
  v_mfma_f32_16x16x32_bf16 v[112:115], a[128:131], a[96:99], v[112:115]
  buffer_load_dwordx4 v4, s[12:15], s33 offen offset:0 lds
  v_mfma_f32_16x16x32_bf16 v[112:115], a[132:135], a[100:103], v[112:115]
  ds_read_b128 a[8:11], v6 offset:2048
  ds_read_b64_tr_b16 a[196:197], v13 offset:36864
  v_mfma_f32_16x16x32_bf16 v[116:119], a[132:135], a[108:111], v[116:119]
  ds_read_b64_tr_b16 a[150:151], v9 offset:6144
  v_mfma_f32_16x16x32_bf16 v[116:119], a[128:131], a[104:107], v[116:119]
  ds_read_b128 a[12:15], v6 offset:3072
  v_mfma_f32_16x16x32_bf16 v[120:123], a[128:131], a[112:115], v[120:123]
  buffer_load_dwordx4 v5, s[12:15], s33 offen offset:1024 lds
  v_mfma_f32_16x16x32_bf16 v[120:123], a[132:135], a[116:119], v[120:123]
  ds_read_b64_tr_b16 a[198:199], v13 offset:38912
  ds_read_b64_tr_b16 a[152:153], v10 offset:0
  v_mfma_f32_16x16x32_bf16 v[124:127], a[132:135], a[124:127], v[124:127]
  ds_read_b128 a[16:19], v6 offset:4096
  v_mfma_f32_16x16x32_bf16 v[124:127], a[128:131], a[120:123], v[124:127]
  s_add_u32 s33, s33, 393216
  s_add_u32 m0, s36, 122880
  v_mfma_f32_16x16x32_bf16 v[64:67], a[136:139], a[64:67], v[64:67]
  buffer_load_dwordx4 v3, s[20:23], s31 offen offset:0 sc1 lds
  v_mfma_f32_16x16x32_bf16 v[64:67], a[140:143], a[68:71], v[64:67]
  ds_read_b64_tr_b16 a[200:201], v14 offset:32768
  ds_read_b64_tr_b16 a[154:155], v10 offset:2048
  v_mfma_f32_16x16x32_bf16 v[68:71], a[140:143], a[76:79], v[68:71]
  ds_read_b128 a[20:23], v6 offset:5120
  v_mfma_f32_16x16x32_bf16 v[68:71], a[136:139], a[72:75], v[68:71]
  ds_read_b64_tr_b16 a[202:203], v14 offset:34816
  v_mfma_f32_16x16x32_bf16 v[72:75], a[136:139], a[80:83], v[72:75]
  buffer_load_dwordx4 v252, s[20:23], s31 offen offset:1024 sc1 lds
  v_mfma_f32_16x16x32_bf16 v[72:75], a[140:143], a[84:87], v[72:75]
  ds_read_b64_tr_b16 a[156:157], v10 offset:4096
  ds_read_b128 a[24:27], v6 offset:6144
  v_mfma_f32_16x16x32_bf16 v[76:79], a[140:143], a[92:95], v[76:79]
  ds_read_b64_tr_b16 a[204:205], v14 offset:36864
  v_mfma_f32_16x16x32_bf16 v[76:79], a[136:139], a[88:91], v[76:79]
  ds_read_b64_tr_b16 a[158:159], v10 offset:6144
  v_mfma_f32_16x16x32_bf16 v[128:131], a[136:139], a[96:99], v[128:131]
  buffer_load_dwordx4 v253, s[20:23], s31 offen offset:2048 sc1 lds
  v_mfma_f32_16x16x32_bf16 v[128:131], a[140:143], a[100:103], v[128:131]
  ds_read_b128 a[28:31], v6 offset:7168
  ds_read_b64_tr_b16 a[206:207], v14 offset:38912
  v_mfma_f32_16x16x32_bf16 v[132:135], a[140:143], a[108:111], v[132:135]
  v_mfma_f32_16x16x32_bf16 v[132:135], a[136:139], a[104:107], v[132:135]
  v_mfma_f32_16x16x32_bf16 v[136:139], a[136:139], a[112:115], v[136:139]
  buffer_load_dwordx4 v254, s[20:23], s31 offen offset:3072 sc1 lds
  v_mfma_f32_16x16x32_bf16 v[136:139], a[140:143], a[116:119], v[136:139]
  s_add_u32 s31, s31, 12288
  v_mfma_f32_16x16x32_bf16 v[140:143], a[140:143], a[124:127], v[140:143]
  v_mfma_f32_16x16x32_bf16 v[140:143], a[136:139], a[120:123], v[140:143]
  s_waitcnt vmcnt(22) lgkmcnt(0)
  s_barrier
  v_mfma_f32_16x16x32_bf16 v[80:83], a[144:147], a[64:67], v[80:83]
  s_add_u32 m0, s42, 16384
  ds_read_b64_tr_b16 a[128:129], v9 offset:24576
  v_mfma_f32_16x16x32_bf16 v[80:83], a[148:151], a[68:71], v[80:83]
  buffer_load_dwordx4 v4, s[12:15], s34 offen offset:0 lds
  v_mfma_f32_16x16x32_bf16 v[84:87], a[148:151], a[76:79], v[84:87]
  ds_read_b128 a[32:35], v6 offset:24576
  v_mfma_f32_16x16x32_bf16 v[84:87], a[144:147], a[72:75], v[84:87]
  ds_read_b64_tr_b16 a[130:131], v9 offset:26624
  v_mfma_f32_16x16x32_bf16 v[88:91], a[144:147], a[80:83], v[88:91]
  v_mfma_f32_16x16x32_bf16 v[88:91], a[148:151], a[84:87], v[88:91]
  ds_read_b128 a[36:39], v6 offset:25600
  v_mfma_f32_16x16x32_bf16 v[92:95], a[148:151], a[92:95], v[92:95]
  buffer_load_dwordx4 v5, s[12:15], s34 offen offset:1024 lds
  v_mfma_f32_16x16x32_bf16 v[92:95], a[144:147], a[88:91], v[92:95]
  ds_read_b64_tr_b16 a[132:133], v9 offset:28672
  v_mfma_f32_16x16x32_bf16 v[144:147], a[144:147], a[96:99], v[144:147]
  ds_read_b128 a[40:43], v6 offset:26624
  v_mfma_f32_16x16x32_bf16 v[144:147], a[148:151], a[100:103], v[144:147]
  v_mfma_f32_16x16x32_bf16 v[148:151], a[148:151], a[108:111], v[148:151]
  s_add_u32 s34, s34, 393216
  s_add_u32 m0, s36, 0
  v_mfma_f32_16x16x32_bf16 v[148:151], a[144:147], a[104:107], v[148:151]
  buffer_load_dwordx4 v3, s[20:23], s30 offen offset:0 sc1 lds
  v_mfma_f32_16x16x32_bf16 v[152:155], a[144:147], a[112:115], v[152:155]
  ds_read_b64_tr_b16 a[134:135], v9 offset:30720
  ds_read_b128 a[44:47], v6 offset:27648
  v_mfma_f32_16x16x32_bf16 v[152:155], a[148:151], a[116:119], v[152:155]
  ds_read_b64_tr_b16 a[136:137], v10 offset:24576
  v_mfma_f32_16x16x32_bf16 v[156:159], a[148:151], a[124:127], v[156:159]
  v_mfma_f32_16x16x32_bf16 v[156:159], a[144:147], a[120:123], v[156:159]
  ds_read_b128 a[48:51], v6 offset:28672
  v_mfma_f32_16x16x32_bf16 v[96:99], a[152:155], a[64:67], v[96:99]
  buffer_load_dwordx4 v252, s[20:23], s30 offen offset:1024 sc1 lds
  v_mfma_f32_16x16x32_bf16 v[96:99], a[156:159], a[68:71], v[96:99]
  ds_read_b64_tr_b16 a[138:139], v10 offset:26624
  v_mfma_f32_16x16x32_bf16 v[100:103], a[156:159], a[76:79], v[100:103]
  ds_read_b128 a[52:55], v6 offset:29696
  v_mfma_f32_16x16x32_bf16 v[100:103], a[152:155], a[72:75], v[100:103]
  v_mfma_f32_16x16x32_bf16 v[104:107], a[152:155], a[80:83], v[104:107]
  ds_read_b64_tr_b16 a[140:141], v10 offset:28672
  v_mfma_f32_16x16x32_bf16 v[104:107], a[156:159], a[84:87], v[104:107]
  buffer_load_dwordx4 v253, s[20:23], s30 offen offset:2048 sc1 lds
  v_mfma_f32_16x16x32_bf16 v[108:111], a[156:159], a[92:95], v[108:111]
  ds_read_b128 a[56:59], v6 offset:30720
  v_mfma_f32_16x16x32_bf16 v[108:111], a[152:155], a[88:91], v[108:111]
  ds_read_b64_tr_b16 a[142:143], v10 offset:30720
  v_mfma_f32_16x16x32_bf16 v[160:163], a[152:155], a[96:99], v[160:163]
  v_mfma_f32_16x16x32_bf16 v[160:163], a[156:159], a[100:103], v[160:163]
  ds_read_b128 a[60:63], v6 offset:31744
  v_mfma_f32_16x16x32_bf16 v[164:167], a[156:159], a[108:111], v[164:167]
  buffer_load_dwordx4 v254, s[20:23], s30 offen offset:3072 sc1 lds
  v_mfma_f32_16x16x32_bf16 v[164:167], a[152:155], a[104:107], v[164:167]
  s_add_u32 s30, s30, 16384
  v_mfma_f32_16x16x32_bf16 v[168:171], a[152:155], a[112:115], v[168:171]
  v_mfma_f32_16x16x32_bf16 v[168:171], a[156:159], a[116:119], v[168:171]
  v_mfma_f32_16x16x32_bf16 v[172:175], a[156:159], a[124:127], v[172:175]
  v_mfma_f32_16x16x32_bf16 v[172:175], a[152:155], a[120:123], v[172:175]
  s_waitcnt vmcnt(12) lgkmcnt(0)
  s_barrier
  v_mfma_f32_16x16x32_bf16 v[48:51], a[128:131], a[0:3], v[48:51]
  s_add_u32 m0, s42, 147456
  ds_read_b64_tr_b16 a[144:145], v11 offset:0
  v_mfma_f32_16x16x32_bf16 v[48:51], a[132:135], a[4:7], v[48:51]
  buffer_load_dwordx4 v4, s[8:11], s68 offen offset:0 lds
  v_mfma_f32_16x16x32_bf16 v[52:55], a[132:135], a[12:15], v[52:55]
  ds_read_b128 a[64:67], v7 offset:0
  ds_read_b64_tr_b16 a[208:209], v13 offset:40960
  v_mfma_f32_16x16x32_bf16 v[52:55], a[128:131], a[8:11], v[52:55]
  ds_read_b64_tr_b16 a[146:147], v11 offset:2048
  v_mfma_f32_16x16x32_bf16 v[56:59], a[128:131], a[16:19], v[56:59]
  buffer_load_dwordx4 v5, s[8:11], s68 offen offset:1024 lds
  v_mfma_f32_16x16x32_bf16 v[56:59], a[132:135], a[20:23], v[56:59]
  ds_read_b128 a[68:71], v7 offset:1024
  ds_read_b64_tr_b16 a[210:211], v13 offset:43008
  v_mfma_f32_16x16x32_bf16 v[60:63], a[132:135], a[28:31], v[60:63]
  ds_read_b64_tr_b16 a[148:149], v11 offset:4096
  v_mfma_f32_16x16x32_bf16 v[60:63], a[128:131], a[24:27], v[60:63]
  s_add_u32 s68, s68, 131072
  s_add_u32 m0, s42, 40960
  v_mfma_f32_16x16x32_bf16 v[112:115], a[128:131], a[32:35], v[112:115]
  buffer_load_dwordx4 v4, s[12:15], s33 offen offset:0 lds
  v_mfma_f32_16x16x32_bf16 v[112:115], a[132:135], a[36:39], v[112:115]
  ds_read_b128 a[72:75], v7 offset:2048
  ds_read_b64_tr_b16 a[212:213], v13 offset:45056
  v_mfma_f32_16x16x32_bf16 v[116:119], a[132:135], a[44:47], v[116:119]
  ds_read_b64_tr_b16 a[150:151], v11 offset:6144
  v_mfma_f32_16x16x32_bf16 v[116:119], a[128:131], a[40:43], v[116:119]
  ds_read_b128 a[76:79], v7 offset:3072
  v_mfma_f32_16x16x32_bf16 v[120:123], a[128:131], a[48:51], v[120:123]
  buffer_load_dwordx4 v5, s[12:15], s33 offen offset:1024 lds
  v_mfma_f32_16x16x32_bf16 v[120:123], a[132:135], a[52:55], v[120:123]
  ds_read_b64_tr_b16 a[214:215], v13 offset:47104
  ds_read_b64_tr_b16 a[152:153], v12 offset:0
  v_mfma_f32_16x16x32_bf16 v[124:127], a[132:135], a[60:63], v[124:127]
  ds_read_b128 a[80:83], v7 offset:4096
  v_mfma_f32_16x16x32_bf16 v[124:127], a[128:131], a[56:59], v[124:127]
  s_add_u32 s33, s33, 524288
  s_add_u32 m0, s36, 24576
  v_mfma_f32_16x16x32_bf16 v[64:67], a[136:139], a[0:3], v[64:67]
  buffer_load_dwordx4 v3, s[20:23], s31 offen offset:0 sc1 lds
  v_mfma_f32_16x16x32_bf16 v[64:67], a[140:143], a[4:7], v[64:67]
  ds_read_b64_tr_b16 a[216:217], v14 offset:40960
  ds_read_b64_tr_b16 a[154:155], v12 offset:2048
  v_mfma_f32_16x16x32_bf16 v[68:71], a[140:143], a[12:15], v[68:71]
  ds_read_b128 a[84:87], v7 offset:5120
  v_mfma_f32_16x16x32_bf16 v[68:71], a[136:139], a[8:11], v[68:71]
  ds_read_b64_tr_b16 a[218:219], v14 offset:43008
  v_mfma_f32_16x16x32_bf16 v[72:75], a[136:139], a[16:19], v[72:75]
  buffer_load_dwordx4 v252, s[20:23], s31 offen offset:1024 sc1 lds
  v_mfma_f32_16x16x32_bf16 v[72:75], a[140:143], a[20:23], v[72:75]
  ds_read_b64_tr_b16 a[156:157], v12 offset:4096
  ds_read_b128 a[88:91], v7 offset:6144
  v_mfma_f32_16x16x32_bf16 v[76:79], a[140:143], a[28:31], v[76:79]
  ds_read_b64_tr_b16 a[220:221], v14 offset:45056
  v_mfma_f32_16x16x32_bf16 v[76:79], a[136:139], a[24:27], v[76:79]
  ds_read_b64_tr_b16 a[158:159], v12 offset:6144
  v_mfma_f32_16x16x32_bf16 v[128:131], a[136:139], a[32:35], v[128:131]
  buffer_load_dwordx4 v253, s[20:23], s31 offen offset:2048 sc1 lds
  v_mfma_f32_16x16x32_bf16 v[128:131], a[140:143], a[36:39], v[128:131]
  ds_read_b128 a[92:95], v7 offset:7168
  ds_read_b64_tr_b16 a[222:223], v14 offset:47104
  v_mfma_f32_16x16x32_bf16 v[132:135], a[140:143], a[44:47], v[132:135]
  v_mfma_f32_16x16x32_bf16 v[132:135], a[136:139], a[40:43], v[132:135]
  v_mfma_f32_16x16x32_bf16 v[136:139], a[136:139], a[48:51], v[136:139]
  buffer_load_dwordx4 v254, s[20:23], s31 offen offset:3072 sc1 lds
  v_mfma_f32_16x16x32_bf16 v[136:139], a[140:143], a[52:55], v[136:139]
  s_add_u32 s31, s31, 16384
  v_mfma_f32_16x16x32_bf16 v[140:143], a[140:143], a[60:63], v[140:143]
  v_mfma_f32_16x16x32_bf16 v[140:143], a[136:139], a[56:59], v[140:143]
  s_waitcnt vmcnt(20) lgkmcnt(0)
  s_barrier
  v_mfma_f32_16x16x32_bf16 v[80:83], a[144:147], a[0:3], v[80:83]
  s_add_u32 m0, s42, 65536
  ds_read_b64_tr_b16 a[128:129], v11 offset:24576
  v_mfma_f32_16x16x32_bf16 v[80:83], a[148:151], a[4:7], v[80:83]
  buffer_load_dwordx4 v4, s[12:15], s34 offen offset:0 lds
  v_mfma_f32_16x16x32_bf16 v[84:87], a[148:151], a[12:15], v[84:87]
  ds_read_b128 a[96:99], v7 offset:24576
  v_mfma_f32_16x16x32_bf16 v[84:87], a[144:147], a[8:11], v[84:87]
  ds_read_b64_tr_b16 a[130:131], v11 offset:26624
  v_mfma_f32_16x16x32_bf16 v[88:91], a[144:147], a[16:19], v[88:91]
  v_mfma_f32_16x16x32_bf16 v[88:91], a[148:151], a[20:23], v[88:91]
  ds_read_b128 a[100:103], v7 offset:25600
  v_mfma_f32_16x16x32_bf16 v[92:95], a[148:151], a[28:31], v[92:95]
  buffer_load_dwordx4 v5, s[12:15], s34 offen offset:1024 lds
  v_mfma_f32_16x16x32_bf16 v[92:95], a[144:147], a[24:27], v[92:95]
  ds_read_b64_tr_b16 a[132:133], v11 offset:28672
  v_mfma_f32_16x16x32_bf16 v[144:147], a[144:147], a[32:35], v[144:147]
  ds_read_b128 a[104:107], v7 offset:26624
  v_mfma_f32_16x16x32_bf16 v[144:147], a[148:151], a[36:39], v[144:147]
  v_mfma_f32_16x16x32_bf16 v[148:151], a[148:151], a[44:47], v[148:151]
  s_add_u32 s34, s34, 524288
  s_add_u32 m0, s36, 49152
  v_mfma_f32_16x16x32_bf16 v[148:151], a[144:147], a[40:43], v[148:151]
  buffer_load_dwordx4 v3, s[20:23], s30 offen offset:0 sc1 lds
  v_mfma_f32_16x16x32_bf16 v[152:155], a[144:147], a[48:51], v[152:155]
  ds_read_b64_tr_b16 a[134:135], v11 offset:30720
  ds_read_b128 a[108:111], v7 offset:27648
  v_mfma_f32_16x16x32_bf16 v[152:155], a[148:151], a[52:55], v[152:155]
  ds_read_b64_tr_b16 a[136:137], v12 offset:24576
  v_mfma_f32_16x16x32_bf16 v[156:159], a[148:151], a[60:63], v[156:159]
  v_mfma_f32_16x16x32_bf16 v[156:159], a[144:147], a[56:59], v[156:159]
  ds_read_b128 a[112:115], v7 offset:28672
  v_mfma_f32_16x16x32_bf16 v[96:99], a[152:155], a[0:3], v[96:99]
  buffer_load_dwordx4 v252, s[20:23], s30 offen offset:1024 sc1 lds
  v_mfma_f32_16x16x32_bf16 v[96:99], a[156:159], a[4:7], v[96:99]
  ds_read_b64_tr_b16 a[138:139], v12 offset:26624
  v_mfma_f32_16x16x32_bf16 v[100:103], a[156:159], a[12:15], v[100:103]
  ds_read_b128 a[116:119], v7 offset:29696
  v_mfma_f32_16x16x32_bf16 v[100:103], a[152:155], a[8:11], v[100:103]
  v_mfma_f32_16x16x32_bf16 v[104:107], a[152:155], a[16:19], v[104:107]
  ds_read_b64_tr_b16 a[140:141], v12 offset:28672
  v_mfma_f32_16x16x32_bf16 v[104:107], a[156:159], a[20:23], v[104:107]
  buffer_load_dwordx4 v253, s[20:23], s30 offen offset:2048 sc1 lds
  v_mfma_f32_16x16x32_bf16 v[108:111], a[156:159], a[28:31], v[108:111]
  ds_read_b128 a[120:123], v7 offset:30720
  v_mfma_f32_16x16x32_bf16 v[108:111], a[152:155], a[24:27], v[108:111]
  ds_read_b64_tr_b16 a[142:143], v12 offset:30720
  v_mfma_f32_16x16x32_bf16 v[160:163], a[152:155], a[32:35], v[160:163]
  v_mfma_f32_16x16x32_bf16 v[160:163], a[156:159], a[36:39], v[160:163]
  ds_read_b128 a[124:127], v7 offset:31744
  v_mfma_f32_16x16x32_bf16 v[164:167], a[156:159], a[44:47], v[164:167]
  buffer_load_dwordx4 v254, s[20:23], s30 offen offset:3072 sc1 lds
  v_mfma_f32_16x16x32_bf16 v[164:167], a[152:155], a[40:43], v[164:167]
  s_add_u32 s30, s30, 12288
  v_mfma_f32_16x16x32_bf16 v[168:171], a[152:155], a[48:51], v[168:171]
  v_mfma_f32_16x16x32_bf16 v[168:171], a[156:159], a[52:55], v[168:171]
  v_mfma_f32_16x16x32_bf16 v[172:175], a[156:159], a[60:63], v[172:175]
  v_mfma_f32_16x16x32_bf16 v[172:175], a[152:155], a[56:59], v[172:175]
  s_waitcnt vmcnt(12) lgkmcnt(0)
  s_barrier
  v_mfma_f32_16x16x32_bf16 v[48:51], a[128:131], a[64:67], v[48:51]
  s_add_u32 m0, s42, 155648
  ds_read_b64_tr_b16 a[144:145], v13 offset:0
  v_mfma_f32_16x16x32_bf16 v[48:51], a[132:135], a[68:71], v[48:51]
  buffer_load_dwordx4 v4, s[8:11], s68 offen offset:0 lds
  v_mfma_f32_16x16x32_bf16 v[52:55], a[132:135], a[76:79], v[52:55]
  ds_read_b128 a[0:3], v8 offset:0
  ds_read_b64_tr_b16 a[224:225], v13 offset:32768
  v_mfma_f32_16x16x32_bf16 v[52:55], a[128:131], a[72:75], v[52:55]
  ds_read_b64_tr_b16 a[146:147], v13 offset:2048
  v_mfma_f32_16x16x32_bf16 v[56:59], a[128:131], a[80:83], v[56:59]
  buffer_load_dwordx4 v5, s[8:11], s68 offen offset:1024 lds
  v_mfma_f32_16x16x32_bf16 v[56:59], a[132:135], a[84:87], v[56:59]
  ds_read_b128 a[4:7], v8 offset:1024
  ds_read_b64_tr_b16 a[226:227], v13 offset:34816
  v_mfma_f32_16x16x32_bf16 v[60:63], a[132:135], a[92:95], v[60:63]
  ds_read_b64_tr_b16 a[148:149], v13 offset:4096
  v_mfma_f32_16x16x32_bf16 v[60:63], a[128:131], a[88:91], v[60:63]
  s_add_u32 s68, s68, 131072
  s_add_u32 m0, s42, 90112
  v_mfma_f32_16x16x32_bf16 v[112:115], a[128:131], a[96:99], v[112:115]
  buffer_load_dwordx4 v4, s[12:15], s33 offen offset:0 lds
  v_mfma_f32_16x16x32_bf16 v[112:115], a[132:135], a[100:103], v[112:115]
  ds_read_b128 a[8:11], v8 offset:2048
  ds_read_b64_tr_b16 a[228:229], v13 offset:36864
  v_mfma_f32_16x16x32_bf16 v[116:119], a[132:135], a[108:111], v[116:119]
  ds_read_b64_tr_b16 a[150:151], v13 offset:6144
  v_mfma_f32_16x16x32_bf16 v[116:119], a[128:131], a[104:107], v[116:119]
  ds_read_b128 a[12:15], v8 offset:3072
  v_mfma_f32_16x16x32_bf16 v[120:123], a[128:131], a[112:115], v[120:123]
  buffer_load_dwordx4 v5, s[12:15], s33 offen offset:1024 lds
  v_mfma_f32_16x16x32_bf16 v[120:123], a[132:135], a[116:119], v[120:123]
  ds_read_b64_tr_b16 a[230:231], v13 offset:38912
  ds_read_b64_tr_b16 a[152:153], v14 offset:0
  v_mfma_f32_16x16x32_bf16 v[124:127], a[132:135], a[124:127], v[124:127]
  ds_read_b128 a[16:19], v8 offset:4096
  v_mfma_f32_16x16x32_bf16 v[124:127], a[128:131], a[120:123], v[124:127]
  s_add_u32 s33, s33, 393216
  s_add_u32 m0, s36, 73728
  v_mfma_f32_16x16x32_bf16 v[64:67], a[136:139], a[64:67], v[64:67]
  buffer_load_dwordx4 v3, s[20:23], s31 offen offset:0 sc1 lds
  v_mfma_f32_16x16x32_bf16 v[64:67], a[140:143], a[68:71], v[64:67]
  ds_read_b64_tr_b16 a[232:233], v14 offset:32768
  ds_read_b64_tr_b16 a[154:155], v14 offset:2048
  v_mfma_f32_16x16x32_bf16 v[68:71], a[140:143], a[76:79], v[68:71]
  ds_read_b128 a[20:23], v8 offset:5120
  v_mfma_f32_16x16x32_bf16 v[68:71], a[136:139], a[72:75], v[68:71]
  ds_read_b64_tr_b16 a[234:235], v14 offset:34816
  v_mfma_f32_16x16x32_bf16 v[72:75], a[136:139], a[80:83], v[72:75]
  buffer_load_dwordx4 v252, s[20:23], s31 offen offset:1024 sc1 lds
  v_mfma_f32_16x16x32_bf16 v[72:75], a[140:143], a[84:87], v[72:75]
  ds_read_b64_tr_b16 a[156:157], v14 offset:4096
  ds_read_b128 a[24:27], v8 offset:6144
  v_mfma_f32_16x16x32_bf16 v[76:79], a[140:143], a[92:95], v[76:79]
  ds_read_b64_tr_b16 a[236:237], v14 offset:36864
  v_mfma_f32_16x16x32_bf16 v[76:79], a[136:139], a[88:91], v[76:79]
  ds_read_b64_tr_b16 a[158:159], v14 offset:6144
  v_mfma_f32_16x16x32_bf16 v[128:131], a[136:139], a[96:99], v[128:131]
  buffer_load_dwordx4 v253, s[20:23], s31 offen offset:2048 sc1 lds
  v_mfma_f32_16x16x32_bf16 v[128:131], a[140:143], a[100:103], v[128:131]
  ds_read_b128 a[28:31], v8 offset:7168
  ds_read_b64_tr_b16 a[238:239], v14 offset:38912
  v_mfma_f32_16x16x32_bf16 v[132:135], a[140:143], a[108:111], v[132:135]
  v_mfma_f32_16x16x32_bf16 v[132:135], a[136:139], a[104:107], v[132:135]
  v_mfma_f32_16x16x32_bf16 v[136:139], a[136:139], a[112:115], v[136:139]
  buffer_load_dwordx4 v254, s[20:23], s31 offen offset:3072 sc1 lds
  v_mfma_f32_16x16x32_bf16 v[136:139], a[140:143], a[116:119], v[136:139]
  s_add_u32 s31, s31, 12288
  v_mfma_f32_16x16x32_bf16 v[140:143], a[140:143], a[124:127], v[140:143]
  v_mfma_f32_16x16x32_bf16 v[140:143], a[136:139], a[120:123], v[140:143]
  s_waitcnt vmcnt(20) lgkmcnt(0)
  s_barrier
  v_mfma_f32_16x16x32_bf16 v[80:83], a[144:147], a[64:67], v[80:83]
  s_add_u32 m0, s42, 114688
  ds_read_b64_tr_b16 a[128:129], v13 offset:24576
  v_mfma_f32_16x16x32_bf16 v[80:83], a[148:151], a[68:71], v[80:83]
  buffer_load_dwordx4 v4, s[12:15], s34 offen offset:0 lds
  v_mfma_f32_16x16x32_bf16 v[84:87], a[148:151], a[76:79], v[84:87]
  ds_read_b128 a[32:35], v8 offset:24576
  v_mfma_f32_16x16x32_bf16 v[84:87], a[144:147], a[72:75], v[84:87]
  ds_read_b64_tr_b16 a[130:131], v13 offset:26624
  v_mfma_f32_16x16x32_bf16 v[88:91], a[144:147], a[80:83], v[88:91]
  v_mfma_f32_16x16x32_bf16 v[88:91], a[148:151], a[84:87], v[88:91]
  ds_read_b128 a[36:39], v8 offset:25600
  v_mfma_f32_16x16x32_bf16 v[92:95], a[148:151], a[92:95], v[92:95]
  buffer_load_dwordx4 v5, s[12:15], s34 offen offset:1024 lds
  v_mfma_f32_16x16x32_bf16 v[92:95], a[144:147], a[88:91], v[92:95]
  ds_read_b64_tr_b16 a[132:133], v13 offset:28672
  v_mfma_f32_16x16x32_bf16 v[144:147], a[144:147], a[96:99], v[144:147]
  ds_read_b128 a[40:43], v8 offset:26624
  v_mfma_f32_16x16x32_bf16 v[144:147], a[148:151], a[100:103], v[144:147]
  v_mfma_f32_16x16x32_bf16 v[148:151], a[148:151], a[108:111], v[148:151]
  s_add_u32 s34, s34, 393216
  s_add_u32 m0, s36, 98304
  v_mfma_f32_16x16x32_bf16 v[148:151], a[144:147], a[104:107], v[148:151]
  buffer_load_dwordx4 v3, s[20:23], s30 offen offset:0 sc1 lds
  v_mfma_f32_16x16x32_bf16 v[152:155], a[144:147], a[112:115], v[152:155]
  ds_read_b64_tr_b16 a[134:135], v13 offset:30720
  ds_read_b128 a[44:47], v8 offset:27648
  v_mfma_f32_16x16x32_bf16 v[152:155], a[148:151], a[116:119], v[152:155]
  ds_read_b64_tr_b16 a[136:137], v14 offset:24576
  v_mfma_f32_16x16x32_bf16 v[156:159], a[148:151], a[124:127], v[156:159]
  v_mfma_f32_16x16x32_bf16 v[156:159], a[144:147], a[120:123], v[156:159]
  ds_read_b128 a[48:51], v8 offset:28672
  v_mfma_f32_16x16x32_bf16 v[96:99], a[152:155], a[64:67], v[96:99]
  buffer_load_dwordx4 v252, s[20:23], s30 offen offset:1024 sc1 lds
  v_mfma_f32_16x16x32_bf16 v[96:99], a[156:159], a[68:71], v[96:99]
  ds_read_b64_tr_b16 a[138:139], v14 offset:26624
  v_mfma_f32_16x16x32_bf16 v[100:103], a[156:159], a[76:79], v[100:103]
  ds_read_b128 a[52:55], v8 offset:29696
  v_mfma_f32_16x16x32_bf16 v[100:103], a[152:155], a[72:75], v[100:103]
  v_mfma_f32_16x16x32_bf16 v[104:107], a[152:155], a[80:83], v[104:107]
  ds_read_b64_tr_b16 a[140:141], v14 offset:28672
  v_mfma_f32_16x16x32_bf16 v[104:107], a[156:159], a[84:87], v[104:107]
  buffer_load_dwordx4 v253, s[20:23], s30 offen offset:2048 sc1 lds
  v_mfma_f32_16x16x32_bf16 v[108:111], a[156:159], a[92:95], v[108:111]
  ds_read_b128 a[56:59], v8 offset:30720
  v_mfma_f32_16x16x32_bf16 v[108:111], a[152:155], a[88:91], v[108:111]
  ds_read_b64_tr_b16 a[142:143], v14 offset:30720
  v_mfma_f32_16x16x32_bf16 v[160:163], a[152:155], a[96:99], v[160:163]
  v_mfma_f32_16x16x32_bf16 v[160:163], a[156:159], a[100:103], v[160:163]
  ds_read_b128 a[60:63], v8 offset:31744
  v_mfma_f32_16x16x32_bf16 v[164:167], a[156:159], a[108:111], v[164:167]
  buffer_load_dwordx4 v254, s[20:23], s30 offen offset:3072 sc1 lds
  v_mfma_f32_16x16x32_bf16 v[164:167], a[152:155], a[104:107], v[164:167]
  s_sub_u32 s30, s30, 24576
  v_mfma_f32_16x16x32_bf16 v[168:171], a[152:155], a[112:115], v[168:171]
  v_mfma_f32_16x16x32_bf16 v[168:171], a[156:159], a[116:119], v[168:171]
  v_mfma_f32_16x16x32_bf16 v[172:175], a[156:159], a[124:127], v[172:175]
  v_mfma_f32_16x16x32_bf16 v[172:175], a[152:155], a[120:123], v[172:175]
  s_waitcnt vmcnt(12) lgkmcnt(0)
  s_barrier
  v_mfma_f32_16x16x32_bf16 v[48:51], a[128:131], a[0:3], v[48:51]
  s_add_u32 m0, s42, 139264
  ds_read_b64_tr_b16 a[144:145], v9 offset:0
  v_mfma_f32_16x16x32_bf16 v[48:51], a[132:135], a[4:7], v[48:51]
  buffer_load_dwordx4 v4, s[12:15], s33 offen offset:0 lds
  v_mfma_f32_16x16x32_bf16 v[52:55], a[132:135], a[12:15], v[52:55]
  ds_read_b128 a[64:67], v6 offset:0
  ds_read_b64_tr_b16 a[240:241], v13 offset:40960
  v_mfma_f32_16x16x32_bf16 v[52:55], a[128:131], a[8:11], v[52:55]
  ds_read_b64_tr_b16 a[146:147], v9 offset:2048
  v_mfma_f32_16x16x32_bf16 v[56:59], a[128:131], a[16:19], v[56:59]
  ds_read_b128 a[68:71], v6 offset:1024
  v_mfma_f32_16x16x32_bf16 v[56:59], a[132:135], a[20:23], v[56:59]
  ds_read_b64_tr_b16 a[242:243], v13 offset:43008
  v_mfma_f32_16x16x32_bf16 v[60:63], a[132:135], a[28:31], v[60:63]
  buffer_load_dwordx4 v5, s[12:15], s33 offen offset:1024 lds
  v_mfma_f32_16x16x32_bf16 v[60:63], a[128:131], a[24:27], v[60:63]
  ds_read_b64_tr_b16 a[148:149], v9 offset:4096
  ds_read_b128 a[72:75], v6 offset:2048
  v_mfma_f32_16x16x32_bf16 v[112:115], a[128:131], a[32:35], v[112:115]
  v_mfma_f32_16x16x32_bf16 v[112:115], a[132:135], a[36:39], v[112:115]
  ds_read_b64_tr_b16 a[244:245], v13 offset:45056
  v_mfma_f32_16x16x32_bf16 v[116:119], a[132:135], a[44:47], v[116:119]
  s_sub_u32 s33, s33, 786432
  s_add_u32 m0, s36, 122880
  v_mfma_f32_16x16x32_bf16 v[116:119], a[128:131], a[40:43], v[116:119]
  buffer_load_dwordx4 v3, s[20:23], s31 offen offset:0 sc1 lds
  v_mfma_f32_16x16x32_bf16 v[120:123], a[128:131], a[48:51], v[120:123]
  ds_read_b64_tr_b16 a[150:151], v9 offset:6144
  ds_read_b128 a[76:79], v6 offset:3072
  v_mfma_f32_16x16x32_bf16 v[120:123], a[132:135], a[52:55], v[120:123]
  ds_read_b64_tr_b16 a[246:247], v13 offset:47104
  ds_read_b64_tr_b16 a[152:153], v10 offset:0
  v_mfma_f32_16x16x32_bf16 v[124:127], a[132:135], a[60:63], v[124:127]
  ds_read_b128 a[80:83], v6 offset:4096
  v_mfma_f32_16x16x32_bf16 v[124:127], a[128:131], a[56:59], v[124:127]
  ds_read_b64_tr_b16 a[248:249], v14 offset:40960
  v_mfma_f32_16x16x32_bf16 v[64:67], a[136:139], a[0:3], v[64:67]
  buffer_load_dwordx4 v252, s[20:23], s31 offen offset:1024 sc1 lds
  v_mfma_f32_16x16x32_bf16 v[64:67], a[140:143], a[4:7], v[64:67]
  ds_read_b64_tr_b16 a[154:155], v10 offset:2048
  v_mfma_f32_16x16x32_bf16 v[68:71], a[140:143], a[12:15], v[68:71]
  ds_read_b128 a[84:87], v6 offset:5120
  v_mfma_f32_16x16x32_bf16 v[68:71], a[136:139], a[8:11], v[68:71]
  ds_read_b64_tr_b16 a[250:251], v14 offset:43008
  v_mfma_f32_16x16x32_bf16 v[72:75], a[136:139], a[16:19], v[72:75]
  ds_read_b64_tr_b16 a[156:157], v10 offset:4096
  v_mfma_f32_16x16x32_bf16 v[72:75], a[140:143], a[20:23], v[72:75]
  buffer_load_dwordx4 v253, s[20:23], s31 offen offset:2048 sc1 lds
  v_mfma_f32_16x16x32_bf16 v[76:79], a[140:143], a[28:31], v[76:79]
  ds_read_b128 a[88:91], v6 offset:6144
  ds_read_b64_tr_b16 a[252:253], v14 offset:45056
  v_mfma_f32_16x16x32_bf16 v[76:79], a[136:139], a[24:27], v[76:79]
  ds_read_b64_tr_b16 a[158:159], v10 offset:6144
  v_mfma_f32_16x16x32_bf16 v[128:131], a[136:139], a[32:35], v[128:131]
  ds_read_b128 a[92:95], v6 offset:7168
  v_mfma_f32_16x16x32_bf16 v[128:131], a[140:143], a[36:39], v[128:131]
  ds_read_b64_tr_b16 a[254:255], v14 offset:47104
  v_mfma_f32_16x16x32_bf16 v[132:135], a[140:143], a[44:47], v[132:135]
  buffer_load_dwordx4 v254, s[20:23], s31 offen offset:3072 sc1 lds
  v_mfma_f32_16x16x32_bf16 v[132:135], a[136:139], a[40:43], v[132:135]
  s_sub_u32 s31, s31, 24576
  v_mfma_f32_16x16x32_bf16 v[136:139], a[136:139], a[48:51], v[136:139]
  v_mfma_f32_16x16x32_bf16 v[136:139], a[140:143], a[52:55], v[136:139]
  s_and_b32 s3, s41, 1
  s_cmp_gt_u32 s3, s38
  s_cbranch_scc0 L2_r3Q
  v_lshrrev_b32 v28, 1, v1
  v_and_b32 v29, 1, v1
  v_lshlrev_b32 v28, 11, v28
  v_lshl_add_u32 v28, v29, 10, v28
  s_bfe_u32 s6, s86, 0x20003
  s_lshr_b32 s3, s86, 6
  s_lshl_b32 s3, s3, 2
  s_add_u32 s3, s3, s6
  s_lshl_b32 s3, s3, 1
  s_add_u32 s3, s3, s39
  s_lshl_b32 s3, s3, 16
  buffer_load_dword v30, v28, s[8:11], s3 offen offset:384
L2_r3Q:
  v_mfma_f32_16x16x32_bf16 v[140:143], a[140:143], a[60:63], v[140:143]
  v_mfma_f32_16x16x32_bf16 v[140:143], a[136:139], a[56:59], v[140:143]
  s_waitcnt vmcnt(18) lgkmcnt(0)
  s_barrier
  v_mfma_f32_16x16x32_bf16 v[80:83], a[144:147], a[0:3], v[80:83]
  s_add_u32 m0, s42, 16384
  ds_read_b64_tr_b16 a[128:129], v9 offset:24576
  v_mfma_f32_16x16x32_bf16 v[80:83], a[148:151], a[4:7], v[80:83]
  buffer_load_dwordx4 v4, s[12:15], s34 offen offset:0 lds
  v_mfma_f32_16x16x32_bf16 v[84:87], a[148:151], a[12:15], v[84:87]
  ds_read_b128 a[96:99], v6 offset:24576
  v_mfma_f32_16x16x32_bf16 v[84:87], a[144:147], a[8:11], v[84:87]
  s_branch L_stubQs6
L_stubQ6:
  s_setpc_b64 s[4:5]
L_stubQs6:
  ds_read_b64_tr_b16 a[130:131], v9 offset:26624
  v_mfma_f32_16x16x32_bf16 v[88:91], a[144:147], a[16:19], v[88:91]
  v_mfma_f32_16x16x32_bf16 v[88:91], a[148:151], a[20:23], v[88:91]
  ds_read_b128 a[100:103], v6 offset:25600
  v_mfma_f32_16x16x32_bf16 v[92:95], a[148:151], a[28:31], v[92:95]
  buffer_load_dwordx4 v5, s[12:15], s34 offen offset:1024 lds
  v_mfma_f32_16x16x32_bf16 v[92:95], a[144:147], a[24:27], v[92:95]
  ds_read_b64_tr_b16 a[132:133], v9 offset:28672
  v_mfma_f32_16x16x32_bf16 v[144:147], a[144:147], a[32:35], v[144:147]
  ds_read_b128 a[104:107], v6 offset:26624
  v_mfma_f32_16x16x32_bf16 v[144:147], a[148:151], a[36:39], v[144:147]
  v_mfma_f32_16x16x32_bf16 v[148:151], a[148:151], a[44:47], v[148:151]
  s_sub_u32 s34, s34, 786432
  s_add_u32 m0, s36, 0
  v_mfma_f32_16x16x32_bf16 v[148:151], a[144:147], a[40:43], v[148:151]
  buffer_load_dwordx4 v3, s[20:23], s30 offen offset:0 sc1 lds
  v_mfma_f32_16x16x32_bf16 v[152:155], a[144:147], a[48:51], v[152:155]
  ds_read_b64_tr_b16 a[134:135], v9 offset:30720
  ds_read_b128 a[108:111], v6 offset:27648
  v_mfma_f32_16x16x32_bf16 v[152:155], a[148:151], a[52:55], v[152:155]
  ds_read_b64_tr_b16 a[136:137], v10 offset:24576
  v_mfma_f32_16x16x32_bf16 v[156:159], a[148:151], a[60:63], v[156:159]
  v_mfma_f32_16x16x32_bf16 v[156:159], a[144:147], a[56:59], v[156:159]
  ds_read_b128 a[112:115], v6 offset:28672
  v_mfma_f32_16x16x32_bf16 v[96:99], a[152:155], a[0:3], v[96:99]
  buffer_load_dwordx4 v252, s[20:23], s30 offen offset:1024 sc1 lds
  v_mfma_f32_16x16x32_bf16 v[96:99], a[156:159], a[4:7], v[96:99]
  ds_read_b64_tr_b16 a[138:139], v10 offset:26624
  v_mfma_f32_16x16x32_bf16 v[100:103], a[156:159], a[12:15], v[100:103]
  ds_read_b128 a[116:119], v6 offset:29696
  v_mfma_f32_16x16x32_bf16 v[100:103], a[152:155], a[8:11], v[100:103]
  v_mfma_f32_16x16x32_bf16 v[104:107], a[152:155], a[16:19], v[104:107]
  ds_read_b64_tr_b16 a[140:141], v10 offset:28672
  v_mfma_f32_16x16x32_bf16 v[104:107], a[156:159], a[20:23], v[104:107]
  buffer_load_dwordx4 v253, s[20:23], s30 offen offset:2048 sc1 lds
  v_mfma_f32_16x16x32_bf16 v[108:111], a[156:159], a[28:31], v[108:111]
  ds_read_b128 a[120:123], v6 offset:30720
  v_mfma_f32_16x16x32_bf16 v[108:111], a[152:155], a[24:27], v[108:111]
  ds_read_b64_tr_b16 a[142:143], v10 offset:30720
  v_mfma_f32_16x16x32_bf16 v[160:163], a[152:155], a[32:35], v[160:163]
  v_mfma_f32_16x16x32_bf16 v[160:163], a[156:159], a[36:39], v[160:163]
  ds_read_b128 a[124:127], v6 offset:31744
  v_mfma_f32_16x16x32_bf16 v[164:167], a[156:159], a[44:47], v[164:167]
  buffer_load_dwordx4 v254, s[20:23], s30 offen offset:3072 sc1 lds
  v_mfma_f32_16x16x32_bf16 v[164:167], a[152:155], a[40:43], v[164:167]
  s_add_u32 s30, s30, 28672
  v_mfma_f32_16x16x32_bf16 v[168:171], a[152:155], a[48:51], v[168:171]
  v_mfma_f32_16x16x32_bf16 v[168:171], a[156:159], a[52:55], v[168:171]
  v_mfma_f32_16x16x32_bf16 v[172:175], a[156:159], a[60:63], v[172:175]
  v_mfma_f32_16x16x32_bf16 v[172:175], a[152:155], a[56:59], v[172:175]
  s_waitcnt vmcnt(24) lgkmcnt(0)
  s_barrier
  v_mfma_f32_16x16x32_bf16 v[48:51], a[128:131], a[64:67], v[48:51]
  ds_read_b64_tr_b16 a[144:145], v11 offset:0
  v_mfma_f32_16x16x32_bf16 v[48:51], a[132:135], a[68:71], v[48:51]
  buffer_load_dword v45, v34, s[20:23], s50 offen offset:4 sc1
  v_mfma_f32_16x16x32_bf16 v[52:55], a[132:135], a[76:79], v[52:55]
  ds_read_b128 a[0:3], v7 offset:0
  v_mfma_f32_16x16x32_bf16 v[52:55], a[128:131], a[72:75], v[52:55]
  ds_read_b64_tr_b16 a[146:147], v11 offset:2048
  v_mfma_f32_16x16x32_bf16 v[56:59], a[128:131], a[80:83], v[56:59]
  s_add_u32 m0, s42, 40960
  v_mfma_f32_16x16x32_bf16 v[56:59], a[132:135], a[84:87], v[56:59]
  buffer_load_dwordx4 v4, s[12:15], s33 offen offset:0 lds
  v_mfma_f32_16x16x32_bf16 v[60:63], a[132:135], a[92:95], v[60:63]
  ds_read_b128 a[4:7], v7 offset:1024
  ds_read_b64_tr_b16 a[148:149], v11 offset:4096
  v_mfma_f32_16x16x32_bf16 v[60:63], a[128:131], a[88:91], v[60:63]
  v_mfma_f32_16x16x32_bf16 v[112:115], a[128:131], a[96:99], v[112:115]
  ds_read_b128 a[8:11], v7 offset:2048
  v_mfma_f32_16x16x32_bf16 v[112:115], a[132:135], a[100:103], v[112:115]
  buffer_load_dwordx4 v5, s[12:15], s33 offen offset:1024 lds
  v_mfma_f32_16x16x32_bf16 v[116:119], a[132:135], a[108:111], v[116:119]
  ds_read_b64_tr_b16 a[150:151], v11 offset:6144
  v_mfma_f32_16x16x32_bf16 v[116:119], a[128:131], a[104:107], v[116:119]
  ds_read_b128 a[12:15], v7 offset:3072
  v_mfma_f32_16x16x32_bf16 v[120:123], a[128:131], a[112:115], v[120:123]
  v_mfma_f32_16x16x32_bf16 v[120:123], a[132:135], a[116:119], v[120:123]
  s_add_u32 s33, s33, 917504
  s_add_u32 m0, s36, 24576
  v_mfma_f32_16x16x32_bf16 v[124:127], a[132:135], a[124:127], v[124:127]
  buffer_load_dwordx4 v3, s[20:23], s31 offen offset:0 sc1 lds
  v_mfma_f32_16x16x32_bf16 v[124:127], a[128:131], a[120:123], v[124:127]
  ds_read_b64_tr_b16 a[152:153], v12 offset:0
  ds_read_b128 a[16:19], v7 offset:4096
  v_mfma_f32_16x16x32_bf16 v[64:67], a[136:139], a[64:67], v[64:67]
  ds_read_b64_tr_b16 a[154:155], v12 offset:2048
  v_mfma_f32_16x16x32_bf16 v[64:67], a[140:143], a[68:71], v[64:67]
  v_mfma_f32_16x16x32_bf16 v[68:71], a[140:143], a[76:79], v[68:71]
  buffer_load_dwordx4 v252, s[20:23], s31 offen offset:1024 sc1 lds
  v_mfma_f32_16x16x32_bf16 v[68:71], a[136:139], a[72:75], v[68:71]
  ds_read_b128 a[20:23], v7 offset:5120
  v_mfma_f32_16x16x32_bf16 v[72:75], a[136:139], a[80:83], v[72:75]
  ds_read_b64_tr_b16 a[156:157], v12 offset:4096
  v_mfma_f32_16x16x32_bf16 v[72:75], a[140:143], a[84:87], v[72:75]
  ds_read_b128 a[24:27], v7 offset:6144
  v_mfma_f32_16x16x32_bf16 v[76:79], a[140:143], a[92:95], v[76:79]
  v_mfma_f32_16x16x32_bf16 v[76:79], a[136:139], a[88:91], v[76:79]
  buffer_load_dwordx4 v253, s[20:23], s31 offen offset:2048 sc1 lds
  v_mfma_f32_16x16x32_bf16 v[128:131], a[136:139], a[96:99], v[128:131]
  ds_read_b64_tr_b16 a[158:159], v12 offset:6144
  v_mfma_f32_16x16x32_bf16 v[128:131], a[140:143], a[100:103], v[128:131]
  ds_read_b128 a[28:31], v7 offset:7168
  v_mfma_f32_16x16x32_bf16 v[132:135], a[140:143], a[108:111], v[132:135]
  v_mfma_f32_16x16x32_bf16 v[132:135], a[136:139], a[104:107], v[132:135]
  buffer_load_dwordx4 v254, s[20:23], s31 offen offset:3072 sc1 lds
  v_mfma_f32_16x16x32_bf16 v[136:139], a[136:139], a[112:115], v[136:139]
  s_add_u32 s31, s31, 28672
  v_mfma_f32_16x16x32_bf16 v[136:139], a[140:143], a[116:119], v[136:139]
  v_mfma_f32_16x16x32_bf16 v[140:143], a[140:143], a[124:127], v[140:143]
  v_mfma_f32_16x16x32_bf16 v[140:143], a[136:139], a[120:123], v[140:143]
  s_waitcnt vmcnt(25) lgkmcnt(0)
  s_barrier
  v_mfma_f32_16x16x32_bf16 v[80:83], a[144:147], a[64:67], v[80:83]
  s_add_u32 m0, s42, 65536
  ds_read_b64_tr_b16 a[128:129], v11 offset:24576
  v_mfma_f32_16x16x32_bf16 v[80:83], a[148:151], a[68:71], v[80:83]
  buffer_load_dwordx4 v4, s[12:15], s34 offen offset:0 lds
  v_mfma_f32_16x16x32_bf16 v[84:87], a[148:151], a[76:79], v[84:87]
  ds_read_b128 a[32:35], v7 offset:24576
  v_mfma_f32_16x16x32_bf16 v[84:87], a[144:147], a[72:75], v[84:87]
  ds_read_b64_tr_b16 a[130:131], v11 offset:26624
  v_mfma_f32_16x16x32_bf16 v[88:91], a[144:147], a[80:83], v[88:91]
  v_mfma_f32_16x16x32_bf16 v[88:91], a[148:151], a[84:87], v[88:91]
  ds_read_b128 a[36:39], v7 offset:25600
  v_mfma_f32_16x16x32_bf16 v[92:95], a[148:151], a[92:95], v[92:95]
  buffer_load_dwordx4 v5, s[12:15], s34 offen offset:1024 lds
  v_mfma_f32_16x16x32_bf16 v[92:95], a[144:147], a[88:91], v[92:95]
  ds_read_b64_tr_b16 a[132:133], v11 offset:28672
  v_mfma_f32_16x16x32_bf16 v[144:147], a[144:147], a[96:99], v[144:147]
  ds_read_b128 a[40:43], v7 offset:26624
  v_mfma_f32_16x16x32_bf16 v[144:147], a[148:151], a[100:103], v[144:147]
  v_mfma_f32_16x16x32_bf16 v[148:151], a[148:151], a[108:111], v[148:151]
  s_add_u32 s34, s34, 917504
  s_add_u32 m0, s36, 49152
  v_mfma_f32_16x16x32_bf16 v[148:151], a[144:147], a[104:107], v[148:151]
  buffer_load_dwordx4 v3, s[20:23], s30 offen offset:0 sc1 lds
  v_mfma_f32_16x16x32_bf16 v[152:155], a[144:147], a[112:115], v[152:155]
  ds_read_b64_tr_b16 a[134:135], v11 offset:30720
  ds_read_b128 a[44:47], v7 offset:27648
  v_mfma_f32_16x16x32_bf16 v[152:155], a[148:151], a[116:119], v[152:155]
  ds_read_b64_tr_b16 a[136:137], v12 offset:24576
  v_mfma_f32_16x16x32_bf16 v[156:159], a[148:151], a[124:127], v[156:159]
  v_mfma_f32_16x16x32_bf16 v[156:159], a[144:147], a[120:123], v[156:159]
  ds_read_b128 a[48:51], v7 offset:28672
  v_mfma_f32_16x16x32_bf16 v[96:99], a[152:155], a[64:67], v[96:99]
  buffer_load_dwordx4 v252, s[20:23], s30 offen offset:1024 sc1 lds
  v_mfma_f32_16x16x32_bf16 v[96:99], a[156:159], a[68:71], v[96:99]
  ds_read_b64_tr_b16 a[138:139], v12 offset:26624
  v_mfma_f32_16x16x32_bf16 v[100:103], a[156:159], a[76:79], v[100:103]
  ds_read_b128 a[52:55], v7 offset:29696
  v_mfma_f32_16x16x32_bf16 v[100:103], a[152:155], a[72:75], v[100:103]
  v_mfma_f32_16x16x32_bf16 v[104:107], a[152:155], a[80:83], v[104:107]
  ds_read_b64_tr_b16 a[140:141], v12 offset:28672
  v_mfma_f32_16x16x32_bf16 v[104:107], a[156:159], a[84:87], v[104:107]
  buffer_load_dwordx4 v253, s[20:23], s30 offen offset:2048 sc1 lds
  v_mfma_f32_16x16x32_bf16 v[108:111], a[156:159], a[92:95], v[108:111]
  ds_read_b128 a[56:59], v7 offset:30720
  v_mfma_f32_16x16x32_bf16 v[108:111], a[152:155], a[88:91], v[108:111]
  ds_read_b64_tr_b16 a[142:143], v12 offset:30720
  v_mfma_f32_16x16x32_bf16 v[160:163], a[152:155], a[96:99], v[160:163]
  v_mfma_f32_16x16x32_bf16 v[160:163], a[156:159], a[100:103], v[160:163]
  ds_read_b128 a[60:63], v7 offset:31744
  v_mfma_f32_16x16x32_bf16 v[164:167], a[156:159], a[108:111], v[164:167]
  buffer_load_dwordx4 v254, s[20:23], s30 offen offset:3072 sc1 lds
  v_mfma_f32_16x16x32_bf16 v[164:167], a[152:155], a[104:107], v[164:167]
  s_add_u32 s30, s30, s46
  v_mfma_f32_16x16x32_bf16 v[168:171], a[152:155], a[112:115], v[168:171]
  v_mfma_f32_16x16x32_bf16 v[168:171], a[156:159], a[116:119], v[168:171]
  v_mfma_f32_16x16x32_bf16 v[172:175], a[156:159], a[124:127], v[172:175]
  v_mfma_f32_16x16x32_bf16 v[172:175], a[152:155], a[120:123], v[172:175]
  s_waitcnt vmcnt(25) lgkmcnt(0)
  s_barrier
  v_mfma_f32_16x16x32_bf16 v[48:51], a[128:131], a[0:3], v[48:51]
  s_add_u32 m0, s42, 90112
  ds_read_b64_tr_b16 a[144:145], v13 offset:0
  v_mfma_f32_16x16x32_bf16 v[48:51], a[132:135], a[4:7], v[48:51]
  buffer_load_dwordx4 v4, s[12:15], s33 offen offset:0 lds
  v_mfma_f32_16x16x32_bf16 v[52:55], a[132:135], a[12:15], v[52:55]
  ds_read_b128 a[64:67], v8 offset:0
  v_mfma_f32_16x16x32_bf16 v[52:55], a[128:131], a[8:11], v[52:55]
  ds_read_b64_tr_b16 a[146:147], v13 offset:2048
  v_mfma_f32_16x16x32_bf16 v[56:59], a[128:131], a[16:19], v[56:59]
  v_mfma_f32_16x16x32_bf16 v[56:59], a[132:135], a[20:23], v[56:59]
  ds_read_b128 a[68:71], v8 offset:1024
  v_mfma_f32_16x16x32_bf16 v[60:63], a[132:135], a[28:31], v[60:63]
  buffer_load_dwordx4 v5, s[12:15], s33 offen offset:1024 lds
  v_mfma_f32_16x16x32_bf16 v[60:63], a[128:131], a[24:27], v[60:63]
  ds_read_b64_tr_b16 a[148:149], v13 offset:4096
  v_mfma_f32_16x16x32_bf16 v[112:115], a[128:131], a[32:35], v[112:115]
  ds_read_b128 a[72:75], v8 offset:2048
  v_mfma_f32_16x16x32_bf16 v[112:115], a[132:135], a[36:39], v[112:115]
  v_mfma_f32_16x16x32_bf16 v[116:119], a[132:135], a[44:47], v[116:119]
  s_sub_u32 s33, s33, s47
  s_add_u32 m0, s36, 73728
  v_mfma_f32_16x16x32_bf16 v[116:119], a[128:131], a[40:43], v[116:119]
  buffer_load_dwordx4 v3, s[20:23], s31 offen offset:0 sc1 lds
  v_mfma_f32_16x16x32_bf16 v[120:123], a[128:131], a[48:51], v[120:123]
  ds_read_b64_tr_b16 a[150:151], v13 offset:6144
  ds_read_b128 a[76:79], v8 offset:3072
  v_mfma_f32_16x16x32_bf16 v[120:123], a[132:135], a[52:55], v[120:123]
  ds_read_b64_tr_b16 a[152:153], v14 offset:0
  v_mfma_f32_16x16x32_bf16 v[124:127], a[132:135], a[60:63], v[124:127]
  v_mfma_f32_16x16x32_bf16 v[124:127], a[128:131], a[56:59], v[124:127]
  ds_read_b128 a[80:83], v8 offset:4096
  v_mfma_f32_16x16x32_bf16 v[64:67], a[136:139], a[0:3], v[64:67]
  buffer_load_dwordx4 v252, s[20:23], s31 offen offset:1024 sc1 lds
  v_mfma_f32_16x16x32_bf16 v[64:67], a[140:143], a[4:7], v[64:67]
  ds_read_b64_tr_b16 a[154:155], v14 offset:2048
  v_mfma_f32_16x16x32_bf16 v[68:71], a[140:143], a[12:15], v[68:71]
  ds_read_b128 a[84:87], v8 offset:5120
  v_mfma_f32_16x16x32_bf16 v[68:71], a[136:139], a[8:11], v[68:71]
  v_mfma_f32_16x16x32_bf16 v[72:75], a[136:139], a[16:19], v[72:75]
  ds_read_b64_tr_b16 a[156:157], v14 offset:4096
  v_mfma_f32_16x16x32_bf16 v[72:75], a[140:143], a[20:23], v[72:75]
  buffer_load_dwordx4 v253, s[20:23], s31 offen offset:2048 sc1 lds
  v_mfma_f32_16x16x32_bf16 v[76:79], a[140:143], a[28:31], v[76:79]
  ds_read_b128 a[88:91], v8 offset:6144
  v_mfma_f32_16x16x32_bf16 v[76:79], a[136:139], a[24:27], v[76:79]
  ds_read_b64_tr_b16 a[158:159], v14 offset:6144
  v_mfma_f32_16x16x32_bf16 v[128:131], a[136:139], a[32:35], v[128:131]
  v_mfma_f32_16x16x32_bf16 v[128:131], a[140:143], a[36:39], v[128:131]
  ds_read_b128 a[92:95], v8 offset:7168
  v_mfma_f32_16x16x32_bf16 v[132:135], a[140:143], a[44:47], v[132:135]
  buffer_load_dwordx4 v254, s[20:23], s31 offen offset:3072 sc1 lds
  v_mfma_f32_16x16x32_bf16 v[132:135], a[136:139], a[40:43], v[132:135]
  s_add_u32 s31, s31, s46
  v_mfma_f32_16x16x32_bf16 v[136:139], a[136:139], a[48:51], v[136:139]
  v_mfma_f32_16x16x32_bf16 v[136:139], a[140:143], a[52:55], v[136:139]
  v_mfma_f32_16x16x32_bf16 v[140:143], a[140:143], a[60:63], v[140:143]
  v_mfma_f32_16x16x32_bf16 v[140:143], a[136:139], a[56:59], v[140:143]
  s_waitcnt vmcnt(18) lgkmcnt(0)
  s_barrier
  v_cmp_ne_u32 vcc, 1, v45
  s_nop 0
  s_cmp_eq_u64 vcc, 0
  s_cbranch_scc0 L2_o_slowQ
L2_o_okQ:
  v_mfma_f32_16x16x32_bf16 v[80:83], a[144:147], a[0:3], v[80:83]
  s_lshl_b32 s4, s25, 2
  s_and_b32 s5, s41, 2
  s_add_u32 s4, s4, s5
  s_add_u32 s4, s4, s38
  s_lshl_b32 s4, s4, 8
  s_add_u32 s94, s4, 39911424
  v_mfma_f32_16x16x32_bf16 v[80:83], a[148:151], a[4:7], v[80:83]
  buffer_load_dwordx4 v[176:179], v18, s[20:23], s94 offen sc1
  v_mfma_f32_16x16x32_bf16 v[84:87], a[148:151], a[12:15], v[84:87]
  ds_read_b64_tr_b16 a[128:129], v13 offset:24576
  ds_read_b128 a[96:99], v8 offset:24576
  v_mfma_f32_16x16x32_bf16 v[84:87], a[144:147], a[8:11], v[84:87]
  s_xor_b32 s94, s94, 512
  ds_read_b64_tr_b16 a[130:131], v13 offset:26624
  v_mfma_f32_16x16x32_bf16 v[88:91], a[144:147], a[16:19], v[88:91]
  buffer_load_dwordx4 v[180:183], v18, s[20:23], s94 offen sc1
  v_mfma_f32_16x16x32_bf16 v[88:91], a[148:151], a[20:23], v[88:91]
  ds_read_b128 a[100:103], v8 offset:25600
  v_mfma_f32_16x16x32_bf16 v[92:95], a[148:151], a[28:31], v[92:95]
  ds_read_b64_tr_b16 a[132:133], v13 offset:28672
  v_mfma_f32_16x16x32_bf16 v[92:95], a[144:147], a[24:27], v[92:95]
  s_add_u32 m0, s42, 114688
  v_mfma_f32_16x16x32_bf16 v[144:147], a[144:147], a[32:35], v[144:147]
  buffer_load_dwordx4 v4, s[12:15], s34 offen offset:0 lds
  v_mfma_f32_16x16x32_bf16 v[144:147], a[148:151], a[36:39], v[144:147]
  ds_read_b128 a[104:107], v8 offset:26624
  v_mfma_f32_16x16x32_bf16 v[148:151], a[148:151], a[44:47], v[148:151]
  ds_read_b64_tr_b16 a[134:135], v13 offset:30720
  v_mfma_f32_16x16x32_bf16 v[148:151], a[144:147], a[40:43], v[148:151]
  ds_read_b128 a[108:111], v8 offset:27648
  v_mfma_f32_16x16x32_bf16 v[152:155], a[144:147], a[48:51], v[152:155]
  buffer_load_dwordx4 v5, s[12:15], s34 offen offset:1024 lds
  v_mfma_f32_16x16x32_bf16 v[152:155], a[148:151], a[52:55], v[152:155]
  ds_read_b64_tr_b16 a[136:137], v14 offset:24576
  v_mfma_f32_16x16x32_bf16 v[156:159], a[148:151], a[60:63], v[156:159]
  v_mfma_f32_16x16x32_bf16 v[156:159], a[144:147], a[56:59], v[156:159]
  s_sub_u32 s34, s34, s47
  s_add_u32 m0, s36, 98304
  v_mfma_f32_16x16x32_bf16 v[96:99], a[152:155], a[0:3], v[96:99]
  buffer_load_dwordx4 v3, s[20:23], s30 offen offset:0 sc1 lds
  v_mfma_f32_16x16x32_bf16 v[96:99], a[156:159], a[4:7], v[96:99]
  ds_read_b128 a[112:115], v8 offset:28672
  ds_read_b64_tr_b16 a[138:139], v14 offset:26624
  v_mfma_f32_16x16x32_bf16 v[100:103], a[156:159], a[12:15], v[100:103]
  ds_read_b128 a[116:119], v8 offset:29696
  v_mfma_f32_16x16x32_bf16 v[100:103], a[152:155], a[8:11], v[100:103]
  v_mfma_f32_16x16x32_bf16 v[104:107], a[152:155], a[16:19], v[104:107]
  buffer_load_dwordx4 v252, s[20:23], s30 offen offset:1024 sc1 lds
  v_mfma_f32_16x16x32_bf16 v[104:107], a[156:159], a[20:23], v[104:107]
  ds_read_b64_tr_b16 a[140:141], v14 offset:28672
  ds_read_b128 a[120:123], v8 offset:30720
  v_mfma_f32_16x16x32_bf16 v[108:111], a[156:159], a[28:31], v[108:111]
  v_mfma_f32_16x16x32_bf16 v[108:111], a[152:155], a[24:27], v[108:111]
  ds_read_b64_tr_b16 a[142:143], v14 offset:30720
  v_mfma_f32_16x16x32_bf16 v[160:163], a[152:155], a[32:35], v[160:163]
  buffer_load_dwordx4 v253, s[20:23], s30 offen offset:2048 sc1 lds
  v_mfma_f32_16x16x32_bf16 v[160:163], a[156:159], a[36:39], v[160:163]
  ds_read_b128 a[124:127], v8 offset:31744
  v_mfma_f32_16x16x32_bf16 v[164:167], a[156:159], a[44:47], v[164:167]
  v_mfma_f32_16x16x32_bf16 v[164:167], a[152:155], a[40:43], v[164:167]
  v_mfma_f32_16x16x32_bf16 v[168:171], a[152:155], a[48:51], v[168:171]
  buffer_load_dwordx4 v254, s[20:23], s30 offen offset:3072 sc1 lds
  v_mfma_f32_16x16x32_bf16 v[168:171], a[156:159], a[52:55], v[168:171]
  v_mfma_f32_16x16x32_bf16 v[172:175], a[156:159], a[60:63], v[172:175]
  v_mfma_f32_16x16x32_bf16 v[172:175], a[152:155], a[56:59], v[172:175]
  s_waitcnt vmcnt(26) lgkmcnt(0)
  s_barrier
  v_mfma_f32_16x16x32_bf16 v[48:51], a[128:131], a[64:67], v[48:51]
  s_add_u32 m0, s42, 139264
  ds_read_b64_tr_b16 a[144:145], v9 offset:0
  v_mfma_f32_16x16x32_bf16 v[48:51], a[132:135], a[68:71], v[48:51]
  buffer_load_dwordx4 v4, s[8:11], s33 offen offset:0 lds
  v_mfma_f32_16x16x32_bf16 v[52:55], a[132:135], a[76:79], v[52:55]
  ds_read_b128 a[0:3], v6 offset:0
  v_mfma_f32_16x16x32_bf16 v[52:55], a[128:131], a[72:75], v[52:55]
  ds_read_b64_tr_b16 a[146:147], v9 offset:2048
  v_mfma_f32_16x16x32_bf16 v[56:59], a[128:131], a[80:83], v[56:59]
  v_mfma_f32_16x16x32_bf16 v[56:59], a[132:135], a[84:87], v[56:59]
  ds_read_b128 a[4:7], v6 offset:1024
  v_mfma_f32_16x16x32_bf16 v[60:63], a[132:135], a[92:95], v[60:63]
  buffer_load_dwordx4 v5, s[8:11], s33 offen offset:1024 lds
  v_mfma_f32_16x16x32_bf16 v[60:63], a[128:131], a[88:91], v[60:63]
  ds_read_b64_tr_b16 a[148:149], v9 offset:4096
  v_mfma_f32_16x16x32_bf16 v[112:115], a[128:131], a[96:99], v[112:115]
  ds_read_b128 a[8:11], v6 offset:2048
  v_mfma_f32_16x16x32_bf16 v[112:115], a[132:135], a[100:103], v[112:115]
  v_mfma_f32_16x16x32_bf16 v[116:119], a[132:135], a[108:111], v[116:119]
  s_add_u32 m0, s36, 122880
  ds_read_b64_tr_b16 a[150:151], v9 offset:6144
  v_mfma_f32_16x16x32_bf16 v[116:119], a[128:131], a[104:107], v[116:119]
  buffer_load_dwordx4 v3, s[20:23], s31 offen offset:0 sc1 lds
  v_mfma_f32_16x16x32_bf16 v[120:123], a[128:131], a[112:115], v[120:123]
  ds_read_b128 a[12:15], v6 offset:3072
  v_mfma_f32_16x16x32_bf16 v[120:123], a[132:135], a[116:119], v[120:123]
  ds_read_b64_tr_b16 a[152:153], v10 offset:0
  v_mfma_f32_16x16x32_bf16 v[124:127], a[132:135], a[124:127], v[124:127]
  v_mfma_f32_16x16x32_bf16 v[124:127], a[128:131], a[120:123], v[124:127]
  ds_read_b128 a[16:19], v6 offset:4096
  v_mfma_f32_16x16x32_bf16 v[64:67], a[136:139], a[64:67], v[64:67]
  buffer_load_dwordx4 v252, s[20:23], s31 offen offset:1024 sc1 lds
  v_mfma_f32_16x16x32_bf16 v[64:67], a[140:143], a[68:71], v[64:67]
  ds_read_b64_tr_b16 a[154:155], v10 offset:2048
  v_mfma_f32_16x16x32_bf16 v[68:71], a[140:143], a[76:79], v[68:71]
  ds_read_b128 a[20:23], v6 offset:5120
  v_mfma_f32_16x16x32_bf16 v[68:71], a[136:139], a[72:75], v[68:71]
  v_mfma_f32_16x16x32_bf16 v[72:75], a[136:139], a[80:83], v[72:75]
  ds_read_b64_tr_b16 a[156:157], v10 offset:4096
  v_mfma_f32_16x16x32_bf16 v[72:75], a[140:143], a[84:87], v[72:75]
  buffer_load_dwordx4 v253, s[20:23], s31 offen offset:2048 sc1 lds
  v_mfma_f32_16x16x32_bf16 v[76:79], a[140:143], a[92:95], v[76:79]
  ds_read_b128 a[24:27], v6 offset:6144
  v_mfma_f32_16x16x32_bf16 v[76:79], a[136:139], a[88:91], v[76:79]
  ds_read_b64_tr_b16 a[158:159], v10 offset:6144
  v_mfma_f32_16x16x32_bf16 v[128:131], a[136:139], a[96:99], v[128:131]
  v_mfma_f32_16x16x32_bf16 v[128:131], a[140:143], a[100:103], v[128:131]
  ds_read_b128 a[28:31], v6 offset:7168
  v_mfma_f32_16x16x32_bf16 v[132:135], a[140:143], a[108:111], v[132:135]
  buffer_load_dwordx4 v254, s[20:23], s31 offen offset:3072 sc1 lds
  v_mfma_f32_16x16x32_bf16 v[132:135], a[136:139], a[104:107], v[132:135]
  v_mfma_f32_16x16x32_bf16 v[136:139], a[136:139], a[112:115], v[136:139]
  v_mfma_f32_16x16x32_bf16 v[136:139], a[140:143], a[116:119], v[136:139]
  v_mfma_f32_16x16x32_bf16 v[140:143], a[140:143], a[124:127], v[140:143]
  v_mfma_f32_16x16x32_bf16 v[140:143], a[136:139], a[120:123], v[140:143]
  s_waitcnt vmcnt(26) lgkmcnt(0)
  s_barrier
  v_mfma_f32_16x16x32_bf16 v[80:83], a[144:147], a[64:67], v[80:83]
  s_add_u32 m0, s42, 16384
  ds_read_b64_tr_b16 a[128:129], v9 offset:24576
  v_mfma_f32_16x16x32_bf16 v[80:83], a[148:151], a[68:71], v[80:83]
  buffer_load_dwordx4 v4, s[8:11], s34 offen offset:0 lds
  v_mfma_f32_16x16x32_bf16 v[84:87], a[148:151], a[76:79], v[84:87]
  ds_read_b128 a[32:35], v6 offset:24576
  v_mfma_f32_16x16x32_bf16 v[84:87], a[144:147], a[72:75], v[84:87]
  ds_read_b64_tr_b16 a[130:131], v9 offset:26624
  v_mfma_f32_16x16x32_bf16 v[88:91], a[144:147], a[80:83], v[88:91]
  v_mfma_f32_16x16x32_bf16 v[88:91], a[148:151], a[84:87], v[88:91]
  ds_read_b128 a[36:39], v6 offset:25600
  v_mfma_f32_16x16x32_bf16 v[92:95], a[148:151], a[92:95], v[92:95]
  ds_read_b64_tr_b16 a[132:133], v9 offset:28672
  v_mfma_f32_16x16x32_bf16 v[92:95], a[144:147], a[88:91], v[92:95]
  v_mfma_f32_16x16x32_bf16 v[144:147], a[144:147], a[96:99], v[144:147]
  ds_read_b128 a[40:43], v6 offset:26624
  v_mfma_f32_16x16x32_bf16 v[144:147], a[148:151], a[100:103], v[144:147]
  v_mfma_f32_16x16x32_bf16 v[148:151], a[148:151], a[108:111], v[148:151]
  ds_read_b64_tr_b16 a[134:135], v9 offset:30720
  v_mfma_f32_16x16x32_bf16 v[148:151], a[144:147], a[104:107], v[148:151]
  ds_read_b128 a[44:47], v6 offset:27648
  v_mfma_f32_16x16x32_bf16 v[152:155], a[144:147], a[112:115], v[152:155]
  v_mfma_f32_16x16x32_bf16 v[152:155], a[148:151], a[116:119], v[152:155]
  ds_read_b64_tr_b16 a[136:137], v10 offset:24576
  v_mfma_f32_16x16x32_bf16 v[156:159], a[148:151], a[124:127], v[156:159]
  v_mfma_f32_16x16x32_bf16 v[156:159], a[144:147], a[120:123], v[156:159]
  ds_read_b128 a[48:51], v6 offset:28672
  v_mfma_f32_16x16x32_bf16 v[96:99], a[152:155], a[64:67], v[96:99]
  buffer_load_dwordx4 v5, s[8:11], s34 offen offset:1024 lds
  v_mfma_f32_16x16x32_bf16 v[96:99], a[156:159], a[68:71], v[96:99]
  ds_read_b64_tr_b16 a[138:139], v10 offset:26624
  v_mfma_f32_16x16x32_bf16 v[100:103], a[156:159], a[76:79], v[100:103]
  ds_read_b128 a[52:55], v6 offset:29696
  v_mfma_f32_16x16x32_bf16 v[100:103], a[152:155], a[72:75], v[100:103]
  v_mfma_f32_16x16x32_bf16 v[104:107], a[152:155], a[80:83], v[104:107]
  ds_read_b64_tr_b16 a[140:141], v10 offset:28672
  v_mfma_f32_16x16x32_bf16 v[104:107], a[156:159], a[84:87], v[104:107]
  ds_read_b128 a[56:59], v6 offset:30720
  v_mfma_f32_16x16x32_bf16 v[108:111], a[156:159], a[92:95], v[108:111]
  v_mfma_f32_16x16x32_bf16 v[108:111], a[152:155], a[88:91], v[108:111]
  ds_read_b64_tr_b16 a[142:143], v10 offset:30720
  v_mfma_f32_16x16x32_bf16 v[160:163], a[152:155], a[96:99], v[160:163]
  v_mfma_f32_16x16x32_bf16 v[160:163], a[156:159], a[100:103], v[160:163]
  ds_read_b128 a[60:63], v6 offset:31744
  v_mfma_f32_16x16x32_bf16 v[164:167], a[156:159], a[108:111], v[164:167]
  v_mfma_f32_16x16x32_bf16 v[164:167], a[152:155], a[104:107], v[164:167]
  v_mfma_f32_16x16x32_bf16 v[168:171], a[152:155], a[112:115], v[168:171]
  v_mfma_f32_16x16x32_bf16 v[168:171], a[156:159], a[116:119], v[168:171]
  v_mfma_f32_16x16x32_bf16 v[172:175], a[156:159], a[124:127], v[172:175]
  v_mfma_f32_16x16x32_bf16 v[172:175], a[152:155], a[120:123], v[172:175]
  s_waitcnt vmcnt(14) lgkmcnt(0)
  s_barrier
  v_mfma_f32_16x16x32_bf16 v[48:51], a[128:131], a[0:3], v[48:51]
  s_add_u32 m0, s42, 40960
  ds_read_b64_tr_b16 a[144:145], v11 offset:0
  v_mfma_f32_16x16x32_bf16 v[48:51], a[132:135], a[4:7], v[48:51]
  buffer_load_dwordx4 v4, s[8:11], s35 offen offset:0 lds
  v_mfma_f32_16x16x32_bf16 v[52:55], a[132:135], a[12:15], v[52:55]
  ds_read_b128 a[64:67], v7 offset:0
  v_mfma_f32_16x16x32_bf16 v[52:55], a[128:131], a[8:11], v[52:55]
  ds_read_b64_tr_b16 a[146:147], v11 offset:2048
  v_mfma_f32_16x16x32_bf16 v[56:59], a[128:131], a[16:19], v[56:59]
  v_mfma_f32_16x16x32_bf16 v[56:59], a[132:135], a[20:23], v[56:59]
  ds_read_b128 a[68:71], v7 offset:1024
  v_mfma_f32_16x16x32_bf16 v[60:63], a[132:135], a[28:31], v[60:63]
  buffer_load_dwordx4 v5, s[8:11], s35 offen offset:1024 lds
  v_mfma_f32_16x16x32_bf16 v[60:63], a[128:131], a[24:27], v[60:63]
  ds_read_b64_tr_b16 a[148:149], v11 offset:4096
  v_mfma_f32_16x16x32_bf16 v[112:115], a[128:131], a[32:35], v[112:115]
  ds_read_b128 a[72:75], v7 offset:2048
  v_mfma_f32_16x16x32_bf16 v[112:115], a[132:135], a[36:39], v[112:115]
  v_mfma_f32_16x16x32_bf16 v[116:119], a[132:135], a[44:47], v[116:119]
  s_add_u32 s35, s35, 131072
  s_add_u32 m0, s36, 24576
  v_mfma_f32_16x16x32_bf16 v[116:119], a[128:131], a[40:43], v[116:119]
  buffer_load_dwordx4 v3, s[20:23], s32 offen offset:0 sc1 lds
  v_mfma_f32_16x16x32_bf16 v[120:123], a[128:131], a[48:51], v[120:123]
  ds_read_b64_tr_b16 a[150:151], v11 offset:6144
  ds_read_b128 a[76:79], v7 offset:3072
  v_mfma_f32_16x16x32_bf16 v[120:123], a[132:135], a[52:55], v[120:123]
  ds_read_b64_tr_b16 a[152:153], v12 offset:0
  v_mfma_f32_16x16x32_bf16 v[124:127], a[132:135], a[60:63], v[124:127]
  v_mfma_f32_16x16x32_bf16 v[124:127], a[128:131], a[56:59], v[124:127]
  ds_read_b128 a[80:83], v7 offset:4096
  v_mfma_f32_16x16x32_bf16 v[64:67], a[136:139], a[0:3], v[64:67]
  buffer_load_dwordx4 v252, s[20:23], s32 offen offset:1024 sc1 lds
  v_mfma_f32_16x16x32_bf16 v[64:67], a[140:143], a[4:7], v[64:67]
  ds_read_b64_tr_b16 a[154:155], v12 offset:2048
  v_mfma_f32_16x16x32_bf16 v[68:71], a[140:143], a[12:15], v[68:71]
  ds_read_b128 a[84:87], v7 offset:5120
  v_mfma_f32_16x16x32_bf16 v[68:71], a[136:139], a[8:11], v[68:71]
  v_mfma_f32_16x16x32_bf16 v[72:75], a[136:139], a[16:19], v[72:75]
  ds_read_b64_tr_b16 a[156:157], v12 offset:4096
  v_mfma_f32_16x16x32_bf16 v[72:75], a[140:143], a[20:23], v[72:75]
  buffer_load_dwordx4 v253, s[20:23], s32 offen offset:2048 sc1 lds
  v_mfma_f32_16x16x32_bf16 v[76:79], a[140:143], a[28:31], v[76:79]
  ds_read_b128 a[88:91], v7 offset:6144
  v_mfma_f32_16x16x32_bf16 v[76:79], a[136:139], a[24:27], v[76:79]
  ds_read_b64_tr_b16 a[158:159], v12 offset:6144
  v_mfma_f32_16x16x32_bf16 v[128:131], a[136:139], a[32:35], v[128:131]
  v_mfma_f32_16x16x32_bf16 v[128:131], a[140:143], a[36:39], v[128:131]
  ds_read_b128 a[92:95], v7 offset:7168
  v_mfma_f32_16x16x32_bf16 v[132:135], a[140:143], a[44:47], v[132:135]
  buffer_load_dwordx4 v254, s[20:23], s32 offen offset:3072 sc1 lds
  v_mfma_f32_16x16x32_bf16 v[132:135], a[136:139], a[40:43], v[132:135]
  s_add_u32 s32, s32, 4096
  v_mfma_f32_16x16x32_bf16 v[136:139], a[136:139], a[48:51], v[136:139]
  v_mfma_f32_16x16x32_bf16 v[136:139], a[140:143], a[52:55], v[136:139]
  v_mfma_f32_16x16x32_bf16 v[140:143], a[140:143], a[60:63], v[140:143]
  v_mfma_f32_16x16x32_bf16 v[140:143], a[136:139], a[56:59], v[140:143]
  s_waitcnt vmcnt(20) lgkmcnt(0)
  s_barrier
  v_mfma_f32_16x16x32_bf16 v[80:83], a[144:147], a[0:3], v[80:83]
  s_add_u32 m0, s42, 65536
  ds_read_b64_tr_b16 a[128:129], v11 offset:24576
  v_mfma_f32_16x16x32_bf16 v[80:83], a[148:151], a[4:7], v[80:83]
  buffer_load_dwordx4 v4, s[8:11], s35 offen offset:0 lds
  v_mfma_f32_16x16x32_bf16 v[84:87], a[148:151], a[12:15], v[84:87]
  ds_read_b128 a[96:99], v7 offset:24576
  v_mfma_f32_16x16x32_bf16 v[84:87], a[144:147], a[8:11], v[84:87]
  ds_read_b64_tr_b16 a[130:131], v11 offset:26624
  v_mfma_f32_16x16x32_bf16 v[88:91], a[144:147], a[16:19], v[88:91]
  v_mfma_f32_16x16x32_bf16 v[88:91], a[148:151], a[20:23], v[88:91]
  ds_read_b128 a[100:103], v7 offset:25600
  v_mfma_f32_16x16x32_bf16 v[92:95], a[148:151], a[28:31], v[92:95]
  buffer_load_dwordx4 v5, s[8:11], s35 offen offset:1024 lds
  v_mfma_f32_16x16x32_bf16 v[92:95], a[144:147], a[24:27], v[92:95]
  ds_read_b64_tr_b16 a[132:133], v11 offset:28672
  v_mfma_f32_16x16x32_bf16 v[144:147], a[144:147], a[32:35], v[144:147]
  ds_read_b128 a[104:107], v7 offset:26624
  v_mfma_f32_16x16x32_bf16 v[144:147], a[148:151], a[36:39], v[144:147]
  v_mfma_f32_16x16x32_bf16 v[148:151], a[148:151], a[44:47], v[148:151]
  s_add_u32 s35, s35, 131072
  s_add_u32 m0, s36, 49152
  v_mfma_f32_16x16x32_bf16 v[148:151], a[144:147], a[40:43], v[148:151]
  buffer_load_dwordx4 v3, s[20:23], s32 offen offset:0 sc1 lds
  v_mfma_f32_16x16x32_bf16 v[152:155], a[144:147], a[48:51], v[152:155]
  ds_read_b64_tr_b16 a[134:135], v11 offset:30720
  ds_read_b128 a[108:111], v7 offset:27648
  v_mfma_f32_16x16x32_bf16 v[152:155], a[148:151], a[52:55], v[152:155]
  ds_read_b64_tr_b16 a[136:137], v12 offset:24576
  v_mfma_f32_16x16x32_bf16 v[156:159], a[148:151], a[60:63], v[156:159]
  v_mfma_f32_16x16x32_bf16 v[156:159], a[144:147], a[56:59], v[156:159]
  ds_read_b128 a[112:115], v7 offset:28672
  v_mfma_f32_16x16x32_bf16 v[96:99], a[152:155], a[0:3], v[96:99]
  buffer_load_dwordx4 v252, s[20:23], s32 offen offset:1024 sc1 lds
  v_mfma_f32_16x16x32_bf16 v[96:99], a[156:159], a[4:7], v[96:99]
  ds_read_b64_tr_b16 a[138:139], v12 offset:26624
  v_mfma_f32_16x16x32_bf16 v[100:103], a[156:159], a[12:15], v[100:103]
  ds_read_b128 a[116:119], v7 offset:29696
  v_mfma_f32_16x16x32_bf16 v[100:103], a[152:155], a[8:11], v[100:103]
  v_mfma_f32_16x16x32_bf16 v[104:107], a[152:155], a[16:19], v[104:107]
  ds_read_b64_tr_b16 a[140:141], v12 offset:28672
  v_mfma_f32_16x16x32_bf16 v[104:107], a[156:159], a[20:23], v[104:107]
  buffer_load_dwordx4 v253, s[20:23], s32 offen offset:2048 sc1 lds
  v_mfma_f32_16x16x32_bf16 v[108:111], a[156:159], a[28:31], v[108:111]
  ds_read_b128 a[120:123], v7 offset:30720
  v_mfma_f32_16x16x32_bf16 v[108:111], a[152:155], a[24:27], v[108:111]
  ds_read_b64_tr_b16 a[142:143], v12 offset:30720
  v_mfma_f32_16x16x32_bf16 v[160:163], a[152:155], a[32:35], v[160:163]
  v_mfma_f32_16x16x32_bf16 v[160:163], a[156:159], a[36:39], v[160:163]
  ds_read_b128 a[124:127], v7 offset:31744
  s_branch L_stubQs7
L_stubQ7:
  s_setpc_b64 s[4:5]
L_stubQs7:
  v_mfma_f32_16x16x32_bf16 v[164:167], a[156:159], a[44:47], v[164:167]
  buffer_load_dwordx4 v254, s[20:23], s32 offen offset:3072 sc1 lds
  v_mfma_f32_16x16x32_bf16 v[164:167], a[152:155], a[40:43], v[164:167]
  s_add_u32 s32, s32, 4096
  v_mfma_f32_16x16x32_bf16 v[168:171], a[152:155], a[48:51], v[168:171]
  v_mfma_f32_16x16x32_bf16 v[168:171], a[156:159], a[52:55], v[168:171]
  v_mfma_f32_16x16x32_bf16 v[172:175], a[156:159], a[60:63], v[172:175]
  v_mfma_f32_16x16x32_bf16 v[172:175], a[152:155], a[56:59], v[172:175]
  s_waitcnt vmcnt(20) lgkmcnt(0)
  s_barrier
  v_mfma_f32_16x16x32_bf16 v[48:51], a[128:131], a[64:67], v[48:51]
  s_add_u32 m0, s42, 90112
  ds_read_b64_tr_b16 a[144:145], v13 offset:0
  v_mfma_f32_16x16x32_bf16 v[48:51], a[132:135], a[68:71], v[48:51]
  buffer_load_dwordx4 v4, s[8:11], s35 offen offset:0 lds
  v_mfma_f32_16x16x32_bf16 v[52:55], a[132:135], a[76:79], v[52:55]
  ds_read_b128 a[0:3], v8 offset:0
  v_sub_f32 v176, 1.0, v176
  v_mfma_f32_16x16x32_bf16 v[52:55], a[128:131], a[72:75], v[52:55]
  ds_read_b64_tr_b16 a[146:147], v13 offset:2048
  v_mfma_f32_16x16x32_bf16 v[56:59], a[128:131], a[80:83], v[56:59]
  v_sub_f32 v177, 1.0, v177
  v_mfma_f32_16x16x32_bf16 v[56:59], a[132:135], a[84:87], v[56:59]
  ds_read_b128 a[4:7], v8 offset:1024
  v_mfma_f32_16x16x32_bf16 v[60:63], a[132:135], a[92:95], v[60:63]
  buffer_load_dwordx4 v5, s[8:11], s35 offen offset:1024 lds
  v_mfma_f32_16x16x32_bf16 v[60:63], a[128:131], a[88:91], v[60:63]
  ds_read_b64_tr_b16 a[148:149], v13 offset:4096
  v_mfma_f32_16x16x32_bf16 v[112:115], a[128:131], a[96:99], v[112:115]
  ds_read_b128 a[8:11], v8 offset:2048
  v_sub_f32 v178, 1.0, v178
  v_mfma_f32_16x16x32_bf16 v[112:115], a[132:135], a[100:103], v[112:115]
  v_mfma_f32_16x16x32_bf16 v[116:119], a[132:135], a[108:111], v[116:119]
  s_add_u32 s35, s35, 131072
  s_add_u32 m0, s36, 73728
  v_mfma_f32_16x16x32_bf16 v[116:119], a[128:131], a[104:107], v[116:119]
  buffer_load_dwordx4 v3, s[20:23], s32 offen offset:0 sc1 lds
  v_mfma_f32_16x16x32_bf16 v[120:123], a[128:131], a[112:115], v[120:123]
  ds_read_b64_tr_b16 a[150:151], v13 offset:6144
  ds_read_b128 a[12:15], v8 offset:3072
  v_mfma_f32_16x16x32_bf16 v[120:123], a[132:135], a[116:119], v[120:123]
  ds_read_b64_tr_b16 a[152:153], v14 offset:0
  v_sub_f32 v179, 1.0, v179
  v_mfma_f32_16x16x32_bf16 v[124:127], a[132:135], a[124:127], v[124:127]
  v_mfma_f32_16x16x32_bf16 v[124:127], a[128:131], a[120:123], v[124:127]
  ds_read_b128 a[16:19], v8 offset:4096
  v_mfma_f32_16x16x32_bf16 v[64:67], a[136:139], a[64:67], v[64:67]
  buffer_load_dwordx4 v252, s[20:23], s32 offen offset:1024 sc1 lds
  v_mfma_f32_16x16x32_bf16 v[64:67], a[140:143], a[68:71], v[64:67]
  ds_read_b64_tr_b16 a[154:155], v14 offset:2048
  v_sub_f32 v180, 1.0, v180
  v_mfma_f32_16x16x32_bf16 v[68:71], a[140:143], a[76:79], v[68:71]
  ds_read_b128 a[20:23], v8 offset:5120
  v_mfma_f32_16x16x32_bf16 v[68:71], a[136:139], a[72:75], v[68:71]
  v_mfma_f32_16x16x32_bf16 v[72:75], a[136:139], a[80:83], v[72:75]
  ds_read_b64_tr_b16 a[156:157], v14 offset:4096
  v_sub_f32 v181, 1.0, v181
  v_mfma_f32_16x16x32_bf16 v[72:75], a[140:143], a[84:87], v[72:75]
  buffer_load_dwordx4 v253, s[20:23], s32 offen offset:2048 sc1 lds
  v_mfma_f32_16x16x32_bf16 v[76:79], a[140:143], a[92:95], v[76:79]
  ds_read_b128 a[24:27], v8 offset:6144
  v_mfma_f32_16x16x32_bf16 v[76:79], a[136:139], a[88:91], v[76:79]
  ds_read_b64_tr_b16 a[158:159], v14 offset:6144
  v_mfma_f32_16x16x32_bf16 v[128:131], a[136:139], a[96:99], v[128:131]
  v_sub_f32 v182, 1.0, v182
  v_mfma_f32_16x16x32_bf16 v[128:131], a[140:143], a[100:103], v[128:131]
  ds_read_b128 a[28:31], v8 offset:7168
  v_mfma_f32_16x16x32_bf16 v[132:135], a[140:143], a[108:111], v[132:135]
  buffer_load_dwordx4 v254, s[20:23], s32 offen offset:3072 sc1 lds
  v_mfma_f32_16x16x32_bf16 v[132:135], a[136:139], a[104:107], v[132:135]
  s_add_u32 s32, s32, 4096
  v_mfma_f32_16x16x32_bf16 v[136:139], a[136:139], a[112:115], v[136:139]
  v_sub_f32 v183, 1.0, v183
  v_mfma_f32_16x16x32_bf16 v[136:139], a[140:143], a[116:119], v[136:139]
  v_mfma_f32_16x16x32_bf16 v[140:143], a[140:143], a[124:127], v[140:143]
  v_mfma_f32_16x16x32_bf16 v[140:143], a[136:139], a[120:123], v[140:143]
  s_waitcnt vmcnt(20) lgkmcnt(0)
  s_barrier
  v_mfma_f32_16x16x32_bf16 v[80:83], a[144:147], a[64:67], v[80:83]
  s_add_u32 m0, s42, 114688
  ds_read_b64_tr_b16 a[128:129], v13 offset:24576
  v_mfma_f32_16x16x32_bf16 v[80:83], a[148:151], a[68:71], v[80:83]
  buffer_load_dwordx4 v4, s[8:11], s35 offen offset:0 lds
  v_mfma_f32_16x16x32_bf16 v[84:87], a[148:151], a[76:79], v[84:87]
  ds_read_b128 a[32:35], v8 offset:24576
  v_mul_f32 v48, v176, v48
  v_mul_f32 v49, v176, v49
  v_mul_f32 v50, v176, v50
  v_mfma_f32_16x16x32_bf16 v[84:87], a[144:147], a[72:75], v[84:87]
  ds_read_b64_tr_b16 a[130:131], v13 offset:26624
  v_mul_f32 v51, v176, v51
  v_mul_f32 v52, v177, v52
  v_mfma_f32_16x16x32_bf16 v[88:91], a[144:147], a[80:83], v[88:91]
  v_mul_f32 v53, v177, v53
  v_mul_f32 v54, v177, v54
  v_mfma_f32_16x16x32_bf16 v[88:91], a[148:151], a[84:87], v[88:91]
  ds_read_b128 a[36:39], v8 offset:25600
  v_mul_f32 v55, v177, v55
  v_mul_f32 v56, v178, v56
  v_mfma_f32_16x16x32_bf16 v[92:95], a[148:151], a[92:95], v[92:95]
  buffer_load_dwordx4 v5, s[8:11], s35 offen offset:1024 lds
  v_mul_f32 v57, v178, v57
  v_mul_f32 v58, v178, v58
  v_mfma_f32_16x16x32_bf16 v[92:95], a[144:147], a[88:91], v[92:95]
  ds_read_b64_tr_b16 a[132:133], v13 offset:28672
  v_mul_f32 v59, v178, v59
  v_mul_f32 v60, v179, v60
  v_mul_f32 v61, v179, v61
  v_mfma_f32_16x16x32_bf16 v[144:147], a[144:147], a[96:99], v[144:147]
  ds_read_b128 a[40:43], v8 offset:26624
  v_mul_f32 v62, v179, v62
  v_mul_f32 v63, v179, v63
  v_mfma_f32_16x16x32_bf16 v[144:147], a[148:151], a[100:103], v[144:147]
  v_mul_f32 v112, v180, v112
  v_mul_f32 v113, v180, v113
  v_mfma_f32_16x16x32_bf16 v[148:151], a[148:151], a[108:111], v[148:151]
  s_add_u32 s35, s35, 131072
  s_add_u32 m0, s36, 98304
  v_mul_f32 v114, v180, v114
  v_mul_f32 v115, v180, v115
  v_mfma_f32_16x16x32_bf16 v[148:151], a[144:147], a[104:107], v[148:151]
  buffer_load_dwordx4 v3, s[20:23], s32 offen offset:0 sc1 lds
  v_mul_f32 v116, v181, v116
  v_mul_f32 v117, v181, v117
  v_mfma_f32_16x16x32_bf16 v[152:155], a[144:147], a[112:115], v[152:155]
  ds_read_b64_tr_b16 a[134:135], v13 offset:30720
  ds_read_b128 a[44:47], v8 offset:27648
  v_mul_f32 v118, v181, v118
  v_mul_f32 v119, v181, v119
  v_mfma_f32_16x16x32_bf16 v[152:155], a[148:151], a[116:119], v[152:155]
  ds_read_b64_tr_b16 a[136:137], v14 offset:24576
  v_mul_f32 v120, v182, v120
  v_mul_f32 v121, v182, v121
  v_mul_f32 v122, v182, v122
  v_mfma_f32_16x16x32_bf16 v[156:159], a[148:151], a[124:127], v[156:159]
  v_mul_f32 v123, v182, v123
  v_mul_f32 v124, v183, v124
  v_mfma_f32_16x16x32_bf16 v[156:159], a[144:147], a[120:123], v[156:159]
  ds_read_b128 a[48:51], v8 offset:28672
  v_mul_f32 v125, v183, v125
  v_mul_f32 v126, v183, v126
  v_mfma_f32_16x16x32_bf16 v[96:99], a[152:155], a[64:67], v[96:99]
  buffer_load_dwordx4 v252, s[20:23], s32 offen offset:1024 sc1 lds
  v_mul_f32 v127, v183, v127
  v_mul_f32 v64, v176, v64
  v_mfma_f32_16x16x32_bf16 v[96:99], a[156:159], a[68:71], v[96:99]
  ds_read_b64_tr_b16 a[138:139], v14 offset:26624
  v_mul_f32 v65, v176, v65
  v_mul_f32 v66, v176, v66
  v_mul_f32 v67, v176, v67
  v_mfma_f32_16x16x32_bf16 v[100:103], a[156:159], a[76:79], v[100:103]
  ds_read_b128 a[52:55], v8 offset:29696
  v_mul_f32 v68, v177, v68
  v_mul_f32 v69, v177, v69
  v_mfma_f32_16x16x32_bf16 v[100:103], a[152:155], a[72:75], v[100:103]
  v_mul_f32 v70, v177, v70
  v_mul_f32 v71, v177, v71
  v_mfma_f32_16x16x32_bf16 v[104:107], a[152:155], a[80:83], v[104:107]
  ds_read_b64_tr_b16 a[140:141], v14 offset:28672
  v_mul_f32 v72, v178, v72
  v_mul_f32 v73, v178, v73
  v_mfma_f32_16x16x32_bf16 v[104:107], a[156:159], a[84:87], v[104:107]
  buffer_load_dwordx4 v253, s[20:23], s32 offen offset:2048 sc1 lds
  v_mul_f32 v74, v178, v74
  v_mul_f32 v75, v178, v75
  v_mfma_f32_16x16x32_bf16 v[108:111], a[156:159], a[92:95], v[108:111]
  ds_read_b128 a[56:59], v8 offset:30720
  v_mul_f32 v76, v179, v76
  v_mul_f32 v77, v179, v77
  v_mul_f32 v78, v179, v78
  v_mfma_f32_16x16x32_bf16 v[108:111], a[152:155], a[88:91], v[108:111]
  ds_read_b64_tr_b16 a[142:143], v14 offset:30720
  v_mul_f32 v79, v179, v79
  v_mul_f32 v128, v180, v128
  v_mfma_f32_16x16x32_bf16 v[160:163], a[152:155], a[96:99], v[160:163]
  v_mul_f32 v129, v180, v129
  v_mul_f32 v130, v180, v130
  v_mfma_f32_16x16x32_bf16 v[160:163], a[156:159], a[100:103], v[160:163]
  ds_read_b128 a[60:63], v8 offset:31744
  v_mul_f32 v131, v180, v131
  v_mul_f32 v132, v181, v132
  v_mfma_f32_16x16x32_bf16 v[164:167], a[156:159], a[108:111], v[164:167]
  buffer_load_dwordx4 v254, s[20:23], s32 offen offset:3072 sc1 lds
  v_mul_f32 v133, v181, v133
  v_mul_f32 v134, v181, v134
  v_mfma_f32_16x16x32_bf16 v[164:167], a[152:155], a[104:107], v[164:167]
  s_add_u32 s32, s32, 4096
  v_mul_f32 v135, v181, v135
  v_mul_f32 v136, v182, v136
  v_mul_f32 v137, v182, v137
  v_mfma_f32_16x16x32_bf16 v[168:171], a[152:155], a[112:115], v[168:171]
  v_mul_f32 v138, v182, v138
  v_mul_f32 v139, v182, v139
  v_mfma_f32_16x16x32_bf16 v[168:171], a[156:159], a[116:119], v[168:171]
  v_mul_f32 v140, v183, v140
  v_mul_f32 v141, v183, v141
  v_mfma_f32_16x16x32_bf16 v[172:175], a[156:159], a[124:127], v[172:175]
  v_mul_f32 v142, v183, v142
  v_mul_f32 v143, v183, v143
  v_mfma_f32_16x16x32_bf16 v[172:175], a[152:155], a[120:123], v[172:175]
  s_waitcnt vmcnt(24) lgkmcnt(0)
  s_barrier
  v_mfma_f32_16x16x32_bf16 v[48:51], a[128:131], a[0:3], v[48:51]
  s_add_u32 m0, s42, 139264
  ds_read_b64_tr_b16 a[144:145], v9 offset:0
  v_mfma_f32_16x16x32_bf16 v[48:51], a[132:135], a[4:7], v[48:51]
  buffer_load_dwordx4 v4, s[8:11], s35 offen offset:0 lds
  v_mfma_f32_16x16x32_bf16 v[52:55], a[132:135], a[12:15], v[52:55]
  v_mul_f32 v80, v176, v80
  v_mul_f32 v81, v176, v81
  v_mul_f32 v82, v176, v82
  v_mfma_f32_16x16x32_bf16 v[52:55], a[128:131], a[8:11], v[52:55]
  ds_read_b64_tr_b16 a[146:147], v9 offset:2048
  v_mul_f32 v83, v176, v83
  v_mul_f32 v84, v177, v84
  v_mfma_f32_16x16x32_bf16 v[56:59], a[128:131], a[16:19], v[56:59]
  v_mul_f32 v85, v177, v85
  v_mul_f32 v86, v177, v86
  v_mfma_f32_16x16x32_bf16 v[56:59], a[132:135], a[20:23], v[56:59]
  v_mul_f32 v87, v177, v87
  v_mul_f32 v88, v178, v88
  v_mfma_f32_16x16x32_bf16 v[60:63], a[132:135], a[28:31], v[60:63]
  buffer_load_dwordx4 v5, s[8:11], s35 offen offset:1024 lds
  v_mul_f32 v89, v178, v89
  v_mul_f32 v90, v178, v90
  v_mfma_f32_16x16x32_bf16 v[60:63], a[128:131], a[24:27], v[60:63]
  ds_read_b64_tr_b16 a[148:149], v9 offset:4096
  v_mul_f32 v91, v178, v91
  v_mul_f32 v92, v179, v92
  v_mul_f32 v93, v179, v93
  v_mfma_f32_16x16x32_bf16 v[112:115], a[128:131], a[32:35], v[112:115]
  v_mul_f32 v94, v179, v94
  v_mul_f32 v95, v179, v95
  v_mfma_f32_16x16x32_bf16 v[112:115], a[132:135], a[36:39], v[112:115]
  v_mul_f32 v144, v180, v144
  v_mul_f32 v145, v180, v145
  v_mfma_f32_16x16x32_bf16 v[116:119], a[132:135], a[44:47], v[116:119]
  s_add_u32 s35, s35, 131072
  s_add_u32 m0, s36, 122880
  v_mul_f32 v146, v180, v146
  v_mul_f32 v147, v180, v147
  v_mfma_f32_16x16x32_bf16 v[116:119], a[128:131], a[40:43], v[116:119]
  buffer_load_dwordx4 v3, s[20:23], s32 offen offset:0 sc1 lds
  v_mul_f32 v148, v181, v148
  v_mul_f32 v149, v181, v149
  v_mfma_f32_16x16x32_bf16 v[120:123], a[128:131], a[48:51], v[120:123]
  ds_read_b64_tr_b16 a[150:151], v9 offset:6144
  v_mul_f32 v150, v181, v150
  v_mul_f32 v151, v181, v151
  v_mul_f32 v152, v182, v152
  v_mfma_f32_16x16x32_bf16 v[120:123], a[132:135], a[52:55], v[120:123]
  ds_read_b64_tr_b16 a[152:153], v10 offset:0
  v_mul_f32 v153, v182, v153
  v_mul_f32 v154, v182, v154
  v_mfma_f32_16x16x32_bf16 v[124:127], a[132:135], a[60:63], v[124:127]
  v_mul_f32 v155, v182, v155
  v_mul_f32 v156, v183, v156
  v_mfma_f32_16x16x32_bf16 v[124:127], a[128:131], a[56:59], v[124:127]
  v_mul_f32 v157, v183, v157
  v_mul_f32 v158, v183, v158
  v_mfma_f32_16x16x32_bf16 v[64:67], a[136:139], a[0:3], v[64:67]
  buffer_load_dwordx4 v252, s[20:23], s32 offen offset:1024 sc1 lds
  v_mul_f32 v159, v183, v159
  v_mul_f32 v96, v176, v96
  v_mfma_f32_16x16x32_bf16 v[64:67], a[140:143], a[4:7], v[64:67]
  ds_read_b64_tr_b16 a[154:155], v10 offset:2048
  v_mul_f32 v97, v176, v97
  v_mul_f32 v98, v176, v98
  v_mul_f32 v99, v176, v99
  v_mfma_f32_16x16x32_bf16 v[68:71], a[140:143], a[12:15], v[68:71]
  v_mul_f32 v100, v177, v100
  v_mul_f32 v101, v177, v101
  v_mfma_f32_16x16x32_bf16 v[68:71], a[136:139], a[8:11], v[68:71]
  v_mul_f32 v102, v177, v102
  v_mul_f32 v103, v177, v103
  v_mfma_f32_16x16x32_bf16 v[72:75], a[136:139], a[16:19], v[72:75]
  ds_read_b64_tr_b16 a[156:157], v10 offset:4096
  v_mul_f32 v104, v178, v104
  v_mul_f32 v105, v178, v105
  v_mfma_f32_16x16x32_bf16 v[72:75], a[140:143], a[20:23], v[72:75]
  buffer_load_dwordx4 v253, s[20:23], s32 offen offset:2048 sc1 lds
  v_mul_f32 v106, v178, v106
  v_mul_f32 v107, v178, v107
  v_mfma_f32_16x16x32_bf16 v[76:79], a[140:143], a[28:31], v[76:79]
  v_mul_f32 v108, v179, v108
  v_mul_f32 v109, v179, v109
  v_mul_f32 v110, v179, v110
  v_mfma_f32_16x16x32_bf16 v[76:79], a[136:139], a[24:27], v[76:79]
  ds_read_b64_tr_b16 a[158:159], v10 offset:6144
  v_mul_f32 v111, v179, v111
  v_mul_f32 v160, v180, v160
  v_mfma_f32_16x16x32_bf16 v[128:131], a[136:139], a[32:35], v[128:131]
  v_mul_f32 v161, v180, v161
  v_mul_f32 v162, v180, v162
  v_mfma_f32_16x16x32_bf16 v[128:131], a[140:143], a[36:39], v[128:131]
  v_mul_f32 v163, v180, v163
  v_mul_f32 v164, v181, v164
  v_mfma_f32_16x16x32_bf16 v[132:135], a[140:143], a[44:47], v[132:135]
  buffer_load_dwordx4 v254, s[20:23], s32 offen offset:3072 sc1 lds
  v_mul_f32 v165, v181, v165
  v_mul_f32 v166, v181, v166
  v_mfma_f32_16x16x32_bf16 v[132:135], a[136:139], a[40:43], v[132:135]
  s_add_u32 s32, s32, 4096
  v_mul_f32 v167, v181, v167
  v_mul_f32 v168, v182, v168
  v_mul_f32 v169, v182, v169
  v_mfma_f32_16x16x32_bf16 v[136:139], a[136:139], a[48:51], v[136:139]
  v_mul_f32 v170, v182, v170
  v_mul_f32 v171, v182, v171
  v_mfma_f32_16x16x32_bf16 v[136:139], a[140:143], a[52:55], v[136:139]
  v_mul_f32 v172, v183, v172
  v_mul_f32 v173, v183, v173
  v_mfma_f32_16x16x32_bf16 v[140:143], a[140:143], a[60:63], v[140:143]
  v_mul_f32 v174, v183, v174
  v_mul_f32 v175, v183, v175
  v_mfma_f32_16x16x32_bf16 v[140:143], a[136:139], a[56:59], v[140:143]
  s_waitcnt vmcnt(24) lgkmcnt(0)
  s_barrier
  v_mfma_f32_16x16x32_bf16 v[144:147], a[144:147], a[32:35], v[144:147]
  ds_read_b64_tr_b16 a[128:129], v9 offset:24576
  v_mfma_f32_16x16x32_bf16 v[144:147], a[148:151], a[36:39], v[144:147]
  ds_read_b128 a[64:67], v6 offset:24576
  v_mfma_f32_16x16x32_bf16 v[148:151], a[148:151], a[44:47], v[148:151]
  v_mfma_f32_16x16x32_bf16 v[148:151], a[144:147], a[40:43], v[148:151]
  ds_read_b64_tr_b16 a[130:131], v9 offset:26624
  v_mfma_f32_16x16x32_bf16 v[152:155], a[144:147], a[48:51], v[152:155]
  v_mfma_f32_16x16x32_bf16 v[152:155], a[148:151], a[52:55], v[152:155]
  ds_read_b128 a[68:71], v6 offset:25600
  v_mfma_f32_16x16x32_bf16 v[156:159], a[148:151], a[60:63], v[156:159]
  ds_read_b64_tr_b16 a[132:133], v9 offset:28672
  s_add_u32 s95, s49, 32768
  v_cvt_pk_bf16_f32 v24, v48, v49
  v_mfma_f32_16x16x32_bf16 v[156:159], a[144:147], a[56:59], v[156:159]
  v_cvt_pk_bf16_f32 v25, v50, v51
  v_cvt_pk_bf16_f32 v26, v64, v65
  v_mfma_f32_16x16x32_bf16 v[160:163], a[152:155], a[32:35], v[160:163]
  ds_read_b128 a[72:75], v6 offset:26624
  v_cvt_pk_bf16_f32 v27, v66, v67
  v_mfma_f32_16x16x32_bf16 v[160:163], a[156:159], a[36:39], v[160:163]
  buffer_store_dwordx4 v[24:27], v3, s[20:23], s95 offen offset:0 sc1
  v_cvt_pk_bf16_f32 v28, v52, v53
  v_mfma_f32_16x16x32_bf16 v[164:167], a[156:159], a[44:47], v[164:167]
  ds_read_b64_tr_b16 a[134:135], v9 offset:30720
  v_cvt_pk_bf16_f32 v29, v54, v55
  v_cvt_pk_bf16_f32 v30, v68, v69
  v_mfma_f32_16x16x32_bf16 v[164:167], a[152:155], a[40:43], v[164:167]
  ds_read_b128 a[76:79], v6 offset:27648
  v_cvt_pk_bf16_f32 v31, v70, v71
  v_mfma_f32_16x16x32_bf16 v[168:171], a[152:155], a[48:51], v[168:171]
  buffer_store_dwordx4 v[28:31], v3, s[20:23], s95 offen offset:2048 sc1
  v_cvt_pk_bf16_f32 v32, v56, v57
  v_mfma_f32_16x16x32_bf16 v[168:171], a[156:159], a[52:55], v[168:171]
  ds_read_b64_tr_b16 a[136:137], v10 offset:24576
  v_cvt_pk_bf16_f32 v33, v58, v59
  v_mfma_f32_16x16x32_bf16 v[172:175], a[156:159], a[60:63], v[172:175]
  v_cvt_pk_bf16_f32 v34, v72, v73
  v_cvt_pk_bf16_f32 v35, v74, v75
  v_mfma_f32_16x16x32_bf16 v[172:175], a[152:155], a[56:59], v[172:175]
  ds_read_b128 a[80:83], v6 offset:28672
  buffer_store_dwordx4 v[32:35], v255, s[20:23], s95 offen offset:0 sc1
  v_mfma_f32_16x16x32_bf16 v[80:83], a[144:147], a[0:3], v[80:83]
  ds_read_b64_tr_b16 a[138:139], v10 offset:26624
  v_cvt_pk_bf16_f32 v36, v60, v61
  v_cvt_pk_bf16_f32 v37, v62, v63
  v_mfma_f32_16x16x32_bf16 v[80:83], a[148:151], a[4:7], v[80:83]
  v_cvt_pk_bf16_f32 v38, v76, v77
  v_cvt_pk_bf16_f32 v39, v78, v79
  v_mfma_f32_16x16x32_bf16 v[84:87], a[148:151], a[12:15], v[84:87]
  ds_read_b128 a[84:87], v6 offset:29696
  buffer_store_dwordx4 v[36:39], v255, s[20:23], s95 offen offset:2048 sc1
  v_mfma_f32_16x16x32_bf16 v[84:87], a[144:147], a[8:11], v[84:87]
  s_add_u32 s95, s49, 98304
  v_cvt_pk_bf16_f32 v24, v112, v113
  v_mfma_f32_16x16x32_bf16 v[88:91], a[144:147], a[16:19], v[88:91]
  ds_read_b64_tr_b16 a[140:141], v10 offset:28672
  v_cvt_pk_bf16_f32 v25, v114, v115
  v_cvt_pk_bf16_f32 v26, v128, v129
  v_mfma_f32_16x16x32_bf16 v[88:91], a[148:151], a[20:23], v[88:91]
  ds_read_b128 a[88:91], v6 offset:30720
  v_cvt_pk_bf16_f32 v27, v130, v131
  v_mfma_f32_16x16x32_bf16 v[92:95], a[148:151], a[28:31], v[92:95]
  buffer_store_dwordx4 v[24:27], v3, s[20:23], s95 offen offset:0 sc1
  v_cvt_pk_bf16_f32 v28, v116, v117
  v_mfma_f32_16x16x32_bf16 v[92:95], a[144:147], a[24:27], v[92:95]
  ds_read_b64_tr_b16 a[142:143], v10 offset:30720
  v_cvt_pk_bf16_f32 v29, v118, v119
  v_cvt_pk_bf16_f32 v30, v132, v133
  v_mfma_f32_16x16x32_bf16 v[96:99], a[152:155], a[0:3], v[96:99]
  v_cvt_pk_bf16_f32 v31, v134, v135
  v_mfma_f32_16x16x32_bf16 v[96:99], a[156:159], a[4:7], v[96:99]
  ds_read_b128 a[92:95], v6 offset:31744
  buffer_store_dwordx4 v[28:31], v3, s[20:23], s95 offen offset:2048 sc1
  v_mfma_f32_16x16x32_bf16 v[100:103], a[156:159], a[12:15], v[100:103]
  v_cvt_pk_bf16_f32 v32, v120, v121
  v_cvt_pk_bf16_f32 v33, v122, v123
  v_mfma_f32_16x16x32_bf16 v[100:103], a[152:155], a[8:11], v[100:103]
  v_cvt_pk_bf16_f32 v34, v136, v137
  v_cvt_pk_bf16_f32 v35, v138, v139
  v_mfma_f32_16x16x32_bf16 v[104:107], a[152:155], a[16:19], v[104:107]
  buffer_store_dwordx4 v[32:35], v255, s[20:23], s95 offen offset:0 sc1
  v_cvt_pk_bf16_f32 v36, v124, v125
  v_mfma_f32_16x16x32_bf16 v[104:107], a[156:159], a[20:23], v[104:107]
  v_cvt_pk_bf16_f32 v37, v126, v127
  v_mfma_f32_16x16x32_bf16 v[108:111], a[156:159], a[28:31], v[108:111]
  v_cvt_pk_bf16_f32 v38, v140, v141
  v_cvt_pk_bf16_f32 v39, v142, v143
  v_mfma_f32_16x16x32_bf16 v[108:111], a[152:155], a[24:27], v[108:111]
  buffer_store_dwordx4 v[36:39], v255, s[20:23], s95 offen offset:2048 sc1
  s_waitcnt vmcnt(26) lgkmcnt(0)
  s_barrier
  v_mfma_f32_16x16x32_bf16 v[80:83], a[128:131], a[64:67], v[80:83]
  s_add_u32 m0, s42, 16384
  ds_read_b64_tr_b16 a[144:145], v11 offset:0
  s_add_u32 s95, s49, 65536
  v_mfma_f32_16x16x32_bf16 v[80:83], a[132:135], a[68:71], v[80:83]
  buffer_load_dwordx4 v4, s[8:11], s35 offen offset:0 lds
  v_cvt_pk_bf16_f32 v24, v144, v145
  v_mfma_f32_16x16x32_bf16 v[84:87], a[132:135], a[76:79], v[84:87]
  ds_read_b128 a[0:3], v7 offset:0
  ds_read_b64_tr_b16 a[146:147], v11 offset:2048
  v_cvt_pk_bf16_f32 v25, v146, v147
  v_mfma_f32_16x16x32_bf16 v[84:87], a[128:131], a[72:75], v[84:87]
  buffer_load_dwordx4 v5, s[8:11], s35 offen offset:1024 lds
  v_cvt_pk_bf16_f32 v26, v160, v161
  v_mfma_f32_16x16x32_bf16 v[88:91], a[128:131], a[80:83], v[88:91]
  ds_read_b128 a[4:7], v7 offset:1024
  ds_read_b64_tr_b16 a[148:149], v11 offset:4096
  v_cvt_pk_bf16_f32 v27, v162, v163
  v_mfma_f32_16x16x32_bf16 v[88:91], a[132:135], a[84:87], v[88:91]
  s_add_u32 s35, s35, 131072
  s_add_u32 m0, s36, 0
  v_mfma_f32_16x16x32_bf16 v[92:95], a[132:135], a[92:95], v[92:95]
  buffer_load_dwordx4 v3, s[20:23], s32 offen offset:0 sc1 lds
  v_mfma_f32_16x16x32_bf16 v[92:95], a[128:131], a[88:91], v[92:95]
  ds_read_b128 a[8:11], v7 offset:2048
  ds_read_b64_tr_b16 a[150:151], v11 offset:6144
  v_mfma_f32_16x16x32_bf16 v[96:99], a[136:139], a[64:67], v[96:99]
  buffer_load_dwordx4 v252, s[20:23], s32 offen offset:1024 sc1 lds
  v_mfma_f32_16x16x32_bf16 v[96:99], a[140:143], a[68:71], v[96:99]
  ds_read_b128 a[12:15], v7 offset:3072
  ds_read_b64_tr_b16 a[152:153], v12 offset:0
  v_mfma_f32_16x16x32_bf16 v[100:103], a[140:143], a[76:79], v[100:103]
  ds_read_b128 a[16:19], v7 offset:4096
  ds_read_b64_tr_b16 a[154:155], v12 offset:2048
  v_mfma_f32_16x16x32_bf16 v[100:103], a[136:139], a[72:75], v[100:103]
  buffer_load_dwordx4 v253, s[20:23], s32 offen offset:2048 sc1 lds
  v_mfma_f32_16x16x32_bf16 v[104:107], a[136:139], a[80:83], v[104:107]
  ds_read_b128 a[20:23], v7 offset:5120
  ds_read_b64_tr_b16 a[156:157], v12 offset:4096
  ds_read_b128 a[24:27], v7 offset:6144
  v_mfma_f32_16x16x32_bf16 v[104:107], a[140:143], a[84:87], v[104:107]
  buffer_load_dwordx4 v254, s[20:23], s32 offen offset:3072 sc1 lds
  ds_read_b64_tr_b16 a[158:159], v12 offset:6144
  ds_read_b128 a[28:31], v7 offset:7168
  v_mfma_f32_16x16x32_bf16 v[108:111], a[140:143], a[92:95], v[108:111]
  s_add_u32 s32, s32, 4096
  buffer_store_dwordx4 v[24:27], v3, s[20:23], s95 offen offset:0 sc1
  v_mfma_f32_16x16x32_bf16 v[108:111], a[136:139], a[88:91], v[108:111]
  v_cvt_pk_bf16_f32 v28, v148, v149
  v_cvt_pk_bf16_f32 v29, v150, v151
  v_cvt_pk_bf16_f32 v30, v164, v165
  v_cvt_pk_bf16_f32 v31, v166, v167
  buffer_store_dwordx4 v[28:31], v3, s[20:23], s95 offen offset:2048 sc1
  v_cvt_pk_bf16_f32 v32, v152, v153
  v_cvt_pk_bf16_f32 v33, v154, v155
  v_cvt_pk_bf16_f32 v34, v168, v169
  v_cvt_pk_bf16_f32 v35, v170, v171
  buffer_store_dwordx4 v[32:35], v255, s[20:23], s95 offen offset:0 sc1
  v_cvt_pk_bf16_f32 v36, v156, v157
  v_cvt_pk_bf16_f32 v37, v158, v159
  v_cvt_pk_bf16_f32 v38, v172, v173
  v_cvt_pk_bf16_f32 v39, v174, v175
  buffer_store_dwordx4 v[36:39], v255, s[20:23], s95 offen offset:2048 sc1
  s_waitcnt vmcnt(30) lgkmcnt(0)
  s_barrier
  v_mfma_f32_16x16x32_bf16 v[80:83], a[144:147], a[0:3], v[80:83]
  s_add_u32 m0, s36, 24576
  ds_read_b64_tr_b16 a[128:129], v11 offset:24576
  v_mfma_f32_16x16x32_bf16 v[80:83], a[148:151], a[4:7], v[80:83]
  buffer_load_dwordx4 v3, s[20:23], s32 offen offset:0 sc1 lds
  v_mfma_f32_16x16x32_bf16 v[84:87], a[148:151], a[12:15], v[84:87]
  ds_read_b128 a[64:67], v7 offset:24576
  ds_read_b64_tr_b16 a[130:131], v11 offset:26624
  v_mfma_f32_16x16x32_bf16 v[84:87], a[144:147], a[8:11], v[84:87]
  ds_read_b128 a[68:71], v7 offset:25600
  ds_read_b64_tr_b16 a[132:133], v11 offset:28672
  v_mfma_f32_16x16x32_bf16 v[88:91], a[144:147], a[16:19], v[88:91]
  buffer_load_dwordx4 v252, s[20:23], s32 offen offset:1024 sc1 lds
  v_mfma_f32_16x16x32_bf16 v[88:91], a[148:151], a[20:23], v[88:91]
  ds_read_b128 a[72:75], v7 offset:26624
  ds_read_b64_tr_b16 a[134:135], v11 offset:30720
  v_mfma_f32_16x16x32_bf16 v[92:95], a[148:151], a[28:31], v[92:95]
  ds_read_b128 a[76:79], v7 offset:27648
  v_mfma_f32_16x16x32_bf16 v[92:95], a[144:147], a[24:27], v[92:95]
  ds_read_b64_tr_b16 a[136:137], v12 offset:24576
  ds_read_b128 a[80:83], v7 offset:28672
  v_mfma_f32_16x16x32_bf16 v[96:99], a[152:155], a[0:3], v[96:99]
  buffer_load_dwordx4 v253, s[20:23], s32 offen offset:2048 sc1 lds
  v_mfma_f32_16x16x32_bf16 v[96:99], a[156:159], a[4:7], v[96:99]
  ds_read_b64_tr_b16 a[138:139], v12 offset:26624
  ds_read_b128 a[84:87], v7 offset:29696
  v_mfma_f32_16x16x32_bf16 v[100:103], a[156:159], a[12:15], v[100:103]
  ds_read_b64_tr_b16 a[140:141], v12 offset:28672
  v_mfma_f32_16x16x32_bf16 v[100:103], a[152:155], a[8:11], v[100:103]
  ds_read_b128 a[88:91], v7 offset:30720
  v_mfma_f32_16x16x32_bf16 v[104:107], a[152:155], a[16:19], v[104:107]
  buffer_load_dwordx4 v254, s[20:23], s32 offen offset:3072 sc1 lds
  v_mfma_f32_16x16x32_bf16 v[104:107], a[156:159], a[20:23], v[104:107]
  s_add_u32 s32, s32, 4096
  ds_read_b64_tr_b16 a[142:143], v12 offset:30720
  ds_read_b128 a[92:95], v7 offset:31744
  v_mfma_f32_16x16x32_bf16 v[108:111], a[156:159], a[28:31], v[108:111]
  v_mfma_f32_16x16x32_bf16 v[108:111], a[152:155], a[24:27], v[108:111]
  s_waitcnt vmcnt(28) lgkmcnt(0)
  s_barrier
  v_mfma_f32_16x16x32_bf16 v[80:83], a[128:131], a[64:67], v[80:83]
  s_add_u32 m0, s36, 49152
  ds_read_b64_tr_b16 a[144:145], v13 offset:0
  v_mfma_f32_16x16x32_bf16 v[80:83], a[132:135], a[68:71], v[80:83]
  buffer_load_dwordx4 v3, s[20:23], s32 offen offset:0 sc1 lds
  v_mfma_f32_16x16x32_bf16 v[84:87], a[132:135], a[76:79], v[84:87]
  ds_read_b128 a[0:3], v8 offset:0
  ds_read_b64_tr_b16 a[146:147], v13 offset:2048
  v_mfma_f32_16x16x32_bf16 v[84:87], a[128:131], a[72:75], v[84:87]
  ds_read_b128 a[4:7], v8 offset:1024
  ds_read_b64_tr_b16 a[148:149], v13 offset:4096
  v_mfma_f32_16x16x32_bf16 v[88:91], a[128:131], a[80:83], v[88:91]
  buffer_load_dwordx4 v252, s[20:23], s32 offen offset:1024 sc1 lds
  v_mfma_f32_16x16x32_bf16 v[88:91], a[132:135], a[84:87], v[88:91]
  ds_read_b128 a[8:11], v8 offset:2048
  ds_read_b64_tr_b16 a[150:151], v13 offset:6144
  v_mfma_f32_16x16x32_bf16 v[92:95], a[132:135], a[92:95], v[92:95]
  ds_read_b128 a[12:15], v8 offset:3072
  v_mfma_f32_16x16x32_bf16 v[92:95], a[128:131], a[88:91], v[92:95]
  ds_read_b64_tr_b16 a[152:153], v14 offset:0
  ds_read_b128 a[16:19], v8 offset:4096
  v_mfma_f32_16x16x32_bf16 v[96:99], a[136:139], a[64:67], v[96:99]
  buffer_load_dwordx4 v253, s[20:23], s32 offen offset:2048 sc1 lds
  v_mfma_f32_16x16x32_bf16 v[96:99], a[140:143], a[68:71], v[96:99]
  ds_read_b64_tr_b16 a[154:155], v14 offset:2048
  ds_read_b128 a[20:23], v8 offset:5120
  v_mfma_f32_16x16x32_bf16 v[100:103], a[140:143], a[76:79], v[100:103]
  ds_read_b64_tr_b16 a[156:157], v14 offset:4096
  v_mfma_f32_16x16x32_bf16 v[100:103], a[136:139], a[72:75], v[100:103]
  ds_read_b128 a[24:27], v8 offset:6144
  v_mfma_f32_16x16x32_bf16 v[104:107], a[136:139], a[80:83], v[104:107]
  buffer_load_dwordx4 v254, s[20:23], s32 offen offset:3072 sc1 lds
  v_mfma_f32_16x16x32_bf16 v[104:107], a[140:143], a[84:87], v[104:107]
  s_add_u32 s32, s32, 4096
  ds_read_b64_tr_b16 a[158:159], v14 offset:6144
  ds_read_b128 a[28:31], v8 offset:7168
  v_mfma_f32_16x16x32_bf16 v[108:111], a[140:143], a[92:95], v[108:111]
  v_mfma_f32_16x16x32_bf16 v[108:111], a[136:139], a[88:91], v[108:111]
  s_waitcnt vmcnt(8) lgkmcnt(0)
  s_barrier
  v_mfma_f32_16x16x32_bf16 v[80:83], a[144:147], a[0:3], v[80:83]
  ds_read_b64_tr_b16 a[128:129], v13 offset:24576
  ds_read_b128 a[64:67], v8 offset:24576
  v_and_b32 v40, 15, v1
  v_mfma_f32_16x16x32_bf16 v[80:83], a[148:151], a[4:7], v[80:83]
  s_mov_b64 exec, 14
  buffer_store_dword v15, v16, s[20:23], s63 offen sc1
  s_mov_b64 exec, -1
  v_mfma_f32_16x16x32_bf16 v[84:87], a[148:151], a[12:15], v[84:87]
  ds_read_b64_tr_b16 a[130:131], v13 offset:26624
  ds_read_b128 a[68:71], v8 offset:25600
  v_bfe_u32 v41, v1, 4, 1
  v_lshrrev_b32 v42, 5, v1
  v_mfma_f32_16x16x32_bf16 v[84:87], a[144:147], a[8:11], v[84:87]
  s_add_u32 m0, s36, 73728
  ds_read_b64_tr_b16 a[132:133], v13 offset:28672
  v_lshlrev_b32 v40, 11, v40
  v_mfma_f32_16x16x32_bf16 v[88:91], a[144:147], a[16:19], v[88:91]
  buffer_load_dwordx4 v3, s[20:23], s32 offen offset:0 sc1 lds
  v_lshl_add_u32 v40, v41, 5, v40
  v_mfma_f32_16x16x32_bf16 v[88:91], a[148:151], a[20:23], v[88:91]
  ds_read_b128 a[72:75], v8 offset:26624
  ds_read_b64_tr_b16 a[134:135], v13 offset:30720
  v_lshl_add_u32 v40, v42, 4, v40
  v_mfma_f32_16x16x32_bf16 v[92:95], a[148:151], a[28:31], v[92:95]
  ds_read_b128 a[76:79], v8 offset:27648
  s_lshl_b32 s4, s25, 19
  v_mfma_f32_16x16x32_bf16 v[92:95], a[144:147], a[24:27], v[92:95]
  buffer_load_dwordx4 v252, s[20:23], s32 offen offset:1024 sc1 lds
  s_lshl_b32 s5, s41, 17
  v_mfma_f32_16x16x32_bf16 v[96:99], a[152:155], a[0:3], v[96:99]
  ds_read_b64_tr_b16 a[136:137], v14 offset:24576
  ds_read_b128 a[80:83], v8 offset:28672
  s_and_b32 s5, s5, 262144
  v_mfma_f32_16x16x32_bf16 v[96:99], a[156:159], a[4:7], v[96:99]
  ds_read_b64_tr_b16 a[138:139], v14 offset:26624
  s_branch L_stubQs8
L_stubQ8:
  s_setpc_b64 s[4:5]
L_stubQs8:
  ds_read_b128 a[84:87], v8 offset:29696
  s_add_u32 s4, s4, s5
  v_mfma_f32_16x16x32_bf16 v[100:103], a[156:159], a[12:15], v[100:103]
  buffer_load_dwordx4 v253, s[20:23], s32 offen offset:2048 sc1 lds
  s_lshl_b32 s5, s38, 17
  v_mfma_f32_16x16x32_bf16 v[100:103], a[152:155], a[8:11], v[100:103]
  ds_read_b64_tr_b16 a[140:141], v14 offset:28672
  ds_read_b128 a[88:91], v8 offset:30720
  s_add_u32 s4, s4, s5
  v_mfma_f32_16x16x32_bf16 v[104:107], a[152:155], a[16:19], v[104:107]
  ds_read_b64_tr_b16 a[142:143], v14 offset:30720
  s_lshl_b32 s5, s39, 6
  v_mfma_f32_16x16x32_bf16 v[104:107], a[156:159], a[20:23], v[104:107]
  buffer_load_dwordx4 v254, s[20:23], s32 offen offset:3072 sc1 lds
  ds_read_b128 a[92:95], v8 offset:31744
  s_add_u32 s4, s4, s5
  v_mfma_f32_16x16x32_bf16 v[108:111], a[156:159], a[28:31], v[108:111]
  s_add_u32 s32, s32, 4096
  s_add_u32 s97, s4, s43
  v_mfma_f32_16x16x32_bf16 v[108:111], a[152:155], a[24:27], v[108:111]
  s_waitcnt vmcnt(13) lgkmcnt(0)
  s_barrier
  v_mfma_f32_16x16x32_bf16 v[80:83], a[128:131], a[64:67], v[80:83]
  s_add_u32 m0, s36, 98304
  ds_read_b64_tr_b16 a[144:145], v9 offset:0
  v_mfma_f32_16x16x32_bf16 v[80:83], a[132:135], a[68:71], v[80:83]
  buffer_load_dwordx4 v3, s[20:23], s32 offen offset:0 sc1 lds
  v_mfma_f32_16x16x32_bf16 v[84:87], a[132:135], a[76:79], v[84:87]
  ds_read_b128 a[0:3], v6 offset:0
  ds_read_b64_tr_b16 a[146:147], v9 offset:2048
  v_mfma_f32_16x16x32_bf16 v[84:87], a[128:131], a[72:75], v[84:87]
  ds_read_b128 a[4:7], v6 offset:1024
  ds_read_b64_tr_b16 a[148:149], v9 offset:4096
  v_mfma_f32_16x16x32_bf16 v[88:91], a[128:131], a[80:83], v[88:91]
  buffer_load_dwordx4 v252, s[20:23], s32 offen offset:1024 sc1 lds
  v_mfma_f32_16x16x32_bf16 v[88:91], a[132:135], a[84:87], v[88:91]
  ds_read_b128 a[8:11], v6 offset:2048
  ds_read_b64_tr_b16 a[150:151], v9 offset:6144
  v_mfma_f32_16x16x32_bf16 v[92:95], a[132:135], a[92:95], v[92:95]
  ds_read_b128 a[12:15], v6 offset:3072
  v_mfma_f32_16x16x32_bf16 v[92:95], a[128:131], a[88:91], v[92:95]
  ds_read_b64_tr_b16 a[152:153], v10 offset:0
  ds_read_b128 a[16:19], v6 offset:4096
  v_mfma_f32_16x16x32_bf16 v[96:99], a[136:139], a[64:67], v[96:99]
  buffer_load_dwordx4 v253, s[20:23], s32 offen offset:2048 sc1 lds
  v_mfma_f32_16x16x32_bf16 v[96:99], a[140:143], a[68:71], v[96:99]
  ds_read_b64_tr_b16 a[154:155], v10 offset:2048
  ds_read_b128 a[20:23], v6 offset:5120
  v_mfma_f32_16x16x32_bf16 v[100:103], a[140:143], a[76:79], v[100:103]
  ds_read_b64_tr_b16 a[156:157], v10 offset:4096
  v_mfma_f32_16x16x32_bf16 v[100:103], a[136:139], a[72:75], v[100:103]
  ds_read_b128 a[24:27], v6 offset:6144
  v_mfma_f32_16x16x32_bf16 v[104:107], a[136:139], a[80:83], v[104:107]
  buffer_load_dwordx4 v254, s[20:23], s32 offen offset:3072 sc1 lds
  v_mfma_f32_16x16x32_bf16 v[104:107], a[140:143], a[84:87], v[104:107]
  s_add_u32 s32, s32, 4096
  ds_read_b64_tr_b16 a[158:159], v10 offset:6144
  ds_read_b128 a[28:31], v6 offset:7168
  v_mfma_f32_16x16x32_bf16 v[108:111], a[140:143], a[92:95], v[108:111]
  v_mfma_f32_16x16x32_bf16 v[108:111], a[136:139], a[88:91], v[108:111]
  s_waitcnt vmcnt(13) lgkmcnt(0)
  s_barrier
  v_mfma_f32_16x16x32_bf16 v[80:83], a[144:147], a[0:3], v[80:83]
  s_lshl_b32 s94, s1, 7
  s_add_u32 s94, s94, s63
  v_mfma_f32_16x16x32_bf16 v[80:83], a[148:151], a[4:7], v[80:83]
  buffer_load_dwordx4 v[44:47], off, s[20:23], s94 sc1
  v_mfma_f32_16x16x32_bf16 v[84:87], a[148:151], a[12:15], v[84:87]
  ds_read_b128 a[64:67], v6 offset:24576
  ds_read_b128 a[68:71], v6 offset:25600
  v_mfma_f32_16x16x32_bf16 v[84:87], a[144:147], a[8:11], v[84:87]
  s_add_u32 m0, s36, 122880
  ds_read_b128 a[72:75], v6 offset:26624
  v_mfma_f32_16x16x32_bf16 v[88:91], a[144:147], a[16:19], v[88:91]
  buffer_load_dwordx4 v3, s[20:23], s32 offen offset:0 sc1 lds
  v_mfma_f32_16x16x32_bf16 v[88:91], a[148:151], a[20:23], v[88:91]
  ds_read_b128 a[76:79], v6 offset:27648
  v_mfma_f32_16x16x32_bf16 v[92:95], a[148:151], a[28:31], v[92:95]
  v_mfma_f32_16x16x32_bf16 v[92:95], a[144:147], a[24:27], v[92:95]
  buffer_load_dwordx4 v252, s[20:23], s32 offen offset:1024 sc1 lds
  v_mfma_f32_16x16x32_bf16 v[96:99], a[152:155], a[0:3], v[96:99]
  ds_read_b128 a[80:83], v6 offset:28672
  ds_read_b128 a[84:87], v6 offset:29696
  v_mfma_f32_16x16x32_bf16 v[96:99], a[156:159], a[4:7], v[96:99]
  v_mfma_f32_16x16x32_bf16 v[100:103], a[156:159], a[12:15], v[100:103]
  buffer_load_dwordx4 v253, s[20:23], s32 offen offset:2048 sc1 lds
  v_mfma_f32_16x16x32_bf16 v[100:103], a[152:155], a[8:11], v[100:103]
  ds_read_b128 a[88:91], v6 offset:30720
  v_mfma_f32_16x16x32_bf16 v[104:107], a[152:155], a[16:19], v[104:107]
  ds_read_b128 a[92:95], v6 offset:31744
  v_mfma_f32_16x16x32_bf16 v[104:107], a[156:159], a[20:23], v[104:107]
  buffer_load_dwordx4 v254, s[20:23], s32 offen offset:3072 sc1 lds
  v_mfma_f32_16x16x32_bf16 v[108:111], a[156:159], a[28:31], v[108:111]
  s_add_u32 s32, s32, 4096
  v_mfma_f32_16x16x32_bf16 v[108:111], a[152:155], a[24:27], v[108:111]
  s_waitcnt vmcnt(14) lgkmcnt(0)
  s_barrier
  v_mfma_f32_16x16x32_bf16 v[80:83], a[160:163], a[64:67], v[80:83]
  s_add_u32 m0, s36, 0
  ds_read_b128 a[0:3], v7 offset:0
  v_mfma_f32_16x16x32_bf16 v[80:83], a[164:167], a[68:71], v[80:83]
  buffer_load_dwordx4 v3, s[20:23], s32 offen offset:0 sc1 lds
  v_mfma_f32_16x16x32_bf16 v[84:87], a[164:167], a[76:79], v[84:87]
  ds_read_b128 a[4:7], v7 offset:1024
  v_mfma_f32_16x16x32_bf16 v[84:87], a[160:163], a[72:75], v[84:87]
  ds_read_b128 a[8:11], v7 offset:2048
  v_mfma_f32_16x16x32_bf16 v[88:91], a[160:163], a[80:83], v[88:91]
  buffer_load_dwordx4 v252, s[20:23], s32 offen offset:1024 sc1 lds
  v_mfma_f32_16x16x32_bf16 v[88:91], a[164:167], a[84:87], v[88:91]
  ds_read_b128 a[12:15], v7 offset:3072
  v_mfma_f32_16x16x32_bf16 v[92:95], a[164:167], a[92:95], v[92:95]
  v_mfma_f32_16x16x32_bf16 v[92:95], a[160:163], a[88:91], v[92:95]
  ds_read_b128 a[16:19], v7 offset:4096
  v_mfma_f32_16x16x32_bf16 v[96:99], a[168:171], a[64:67], v[96:99]
  buffer_load_dwordx4 v253, s[20:23], s32 offen offset:2048 sc1 lds
  v_mfma_f32_16x16x32_bf16 v[96:99], a[172:175], a[68:71], v[96:99]
  ds_read_b128 a[20:23], v7 offset:5120
  v_mfma_f32_16x16x32_bf16 v[100:103], a[172:175], a[76:79], v[100:103]
  ds_read_b128 a[24:27], v7 offset:6144
  v_mfma_f32_16x16x32_bf16 v[100:103], a[168:171], a[72:75], v[100:103]
  v_mfma_f32_16x16x32_bf16 v[104:107], a[168:171], a[80:83], v[104:107]
  buffer_load_dwordx4 v254, s[20:23], s32 offen offset:3072 sc1 lds
  v_mfma_f32_16x16x32_bf16 v[104:107], a[172:175], a[84:87], v[104:107]
  s_add_u32 s32, s32, 4096
  ds_read_b128 a[28:31], v7 offset:7168
  v_mfma_f32_16x16x32_bf16 v[108:111], a[172:175], a[92:95], v[108:111]
  v_mfma_f32_16x16x32_bf16 v[108:111], a[168:171], a[88:91], v[108:111]
  s_waitcnt vmcnt(8) lgkmcnt(0)
  s_barrier
  v_and_b32 v44, v45, v46
  v_and_b32 v44, v44, v47
  s_nop 0
  v_readfirstlane_b32 s4, v44
  s_nop 0
  s_cmp_eq_u32 s4, 1
  s_cbranch_scc0 L2_p_slowQ
L2_p_okQ:
  v_mfma_f32_16x16x32_bf16 v[80:83], a[176:179], a[0:3], v[80:83]
  ds_read_b128 a[64:67], v7 offset:24576
  v_mfma_f32_16x16x32_bf16 v[80:83], a[180:183], a[4:7], v[80:83]
  buffer_load_dwordx4 v[112:115], v3, s[20:23], s60 offen offset:0 sc1
  v_mfma_f32_16x16x32_bf16 v[84:87], a[180:183], a[12:15], v[84:87]
  ds_read_b128 a[68:71], v7 offset:25600
  v_mfma_f32_16x16x32_bf16 v[84:87], a[176:179], a[8:11], v[84:87]
  ds_read_b128 a[72:75], v7 offset:26624
  v_mfma_f32_16x16x32_bf16 v[88:91], a[176:179], a[16:19], v[88:91]
  buffer_load_dwordx4 v[116:119], v3, s[20:23], s60 offen offset:2048 sc1
  v_mfma_f32_16x16x32_bf16 v[88:91], a[180:183], a[20:23], v[88:91]
  ds_read_b128 a[76:79], v7 offset:27648
  v_mfma_f32_16x16x32_bf16 v[92:95], a[180:183], a[28:31], v[92:95]
  v_mfma_f32_16x16x32_bf16 v[92:95], a[176:179], a[24:27], v[92:95]
  ds_read_b128 a[80:83], v7 offset:28672
  v_mfma_f32_16x16x32_bf16 v[96:99], a[184:187], a[0:3], v[96:99]
  buffer_load_dwordx4 v[120:123], v255, s[20:23], s60 offen offset:0 sc1
  v_mfma_f32_16x16x32_bf16 v[96:99], a[188:191], a[4:7], v[96:99]
  ds_read_b128 a[84:87], v7 offset:29696
  v_mfma_f32_16x16x32_bf16 v[100:103], a[188:191], a[12:15], v[100:103]
  ds_read_b128 a[88:91], v7 offset:30720
  v_mfma_f32_16x16x32_bf16 v[100:103], a[184:187], a[8:11], v[100:103]
  v_mfma_f32_16x16x32_bf16 v[104:107], a[184:187], a[16:19], v[104:107]
  buffer_load_dwordx4 v[124:127], v255, s[20:23], s60 offen offset:2048 sc1
  v_mfma_f32_16x16x32_bf16 v[104:107], a[188:191], a[20:23], v[104:107]
  ds_read_b128 a[92:95], v7 offset:31744
  v_mfma_f32_16x16x32_bf16 v[108:111], a[188:191], a[28:31], v[108:111]
  v_mfma_f32_16x16x32_bf16 v[108:111], a[184:187], a[24:27], v[108:111]
  s_waitcnt vmcnt(12) lgkmcnt(0)
  s_barrier
  v_mfma_f32_16x16x32_bf16 v[80:83], a[192:195], a[64:67], v[80:83]
  ds_read_b128 a[0:3], v8 offset:0
  v_mfma_f32_16x16x32_bf16 v[80:83], a[196:199], a[68:71], v[80:83]
  buffer_load_dwordx4 v[128:131], v3, s[20:23], s61 offen offset:0 sc1
  v_mfma_f32_16x16x32_bf16 v[84:87], a[196:199], a[76:79], v[84:87]
  ds_read_b128 a[4:7], v8 offset:1024
  v_mfma_f32_16x16x32_bf16 v[84:87], a[192:195], a[72:75], v[84:87]
  ds_read_b128 a[8:11], v8 offset:2048
  v_mfma_f32_16x16x32_bf16 v[88:91], a[192:195], a[80:83], v[88:91]
  buffer_load_dwordx4 v[132:135], v3, s[20:23], s61 offen offset:2048 sc1
  v_mfma_f32_16x16x32_bf16 v[88:91], a[196:199], a[84:87], v[88:91]
  ds_read_b128 a[12:15], v8 offset:3072
  v_mfma_f32_16x16x32_bf16 v[92:95], a[196:199], a[92:95], v[92:95]
  v_mfma_f32_16x16x32_bf16 v[92:95], a[192:195], a[88:91], v[92:95]
  ds_read_b128 a[16:19], v8 offset:4096
  v_mfma_f32_16x16x32_bf16 v[96:99], a[200:203], a[64:67], v[96:99]
  buffer_load_dwordx4 v[136:139], v255, s[20:23], s61 offen offset:0 sc1
  v_mfma_f32_16x16x32_bf16 v[96:99], a[204:207], a[68:71], v[96:99]
  ds_read_b128 a[20:23], v8 offset:5120
  v_mfma_f32_16x16x32_bf16 v[100:103], a[204:207], a[76:79], v[100:103]
  ds_read_b128 a[24:27], v8 offset:6144
  v_mfma_f32_16x16x32_bf16 v[100:103], a[200:203], a[72:75], v[100:103]
  v_mfma_f32_16x16x32_bf16 v[104:107], a[200:203], a[80:83], v[104:107]
  buffer_load_dwordx4 v[140:143], v255, s[20:23], s61 offen offset:2048 sc1
  v_mfma_f32_16x16x32_bf16 v[104:107], a[204:207], a[84:87], v[104:107]
  ds_read_b128 a[28:31], v8 offset:7168
  v_mfma_f32_16x16x32_bf16 v[108:111], a[204:207], a[92:95], v[108:111]
  v_mfma_f32_16x16x32_bf16 v[108:111], a[200:203], a[88:91], v[108:111]
  s_waitcnt vmcnt(12) lgkmcnt(0)
  s_barrier
  v_mfma_f32_16x16x32_bf16 v[80:83], a[208:211], a[0:3], v[80:83]
  ds_read_b128 a[64:67], v8 offset:24576
  v_mfma_f32_16x16x32_bf16 v[80:83], a[212:215], a[4:7], v[80:83]
  buffer_load_dwordx4 v[144:147], v3, s[20:23], s62 offen offset:0 sc1
  v_mfma_f32_16x16x32_bf16 v[84:87], a[212:215], a[12:15], v[84:87]
  ds_read_b128 a[68:71], v8 offset:25600
  v_mfma_f32_16x16x32_bf16 v[84:87], a[208:211], a[8:11], v[84:87]
  ds_read_b128 a[72:75], v8 offset:26624
  v_mfma_f32_16x16x32_bf16 v[88:91], a[208:211], a[16:19], v[88:91]
  buffer_load_dwordx4 v[148:151], v3, s[20:23], s62 offen offset:2048 sc1
  v_mfma_f32_16x16x32_bf16 v[88:91], a[212:215], a[20:23], v[88:91]
  ds_read_b128 a[76:79], v8 offset:27648
  v_mfma_f32_16x16x32_bf16 v[92:95], a[212:215], a[28:31], v[92:95]
  v_mfma_f32_16x16x32_bf16 v[92:95], a[208:211], a[24:27], v[92:95]
  ds_read_b128 a[80:83], v8 offset:28672
  v_mfma_f32_16x16x32_bf16 v[96:99], a[216:219], a[0:3], v[96:99]
  buffer_load_dwordx4 v[152:155], v255, s[20:23], s62 offen offset:0 sc1
  v_mfma_f32_16x16x32_bf16 v[96:99], a[220:223], a[4:7], v[96:99]
  ds_read_b128 a[84:87], v8 offset:29696
  v_mfma_f32_16x16x32_bf16 v[100:103], a[220:223], a[12:15], v[100:103]
  ds_read_b128 a[88:91], v8 offset:30720
  v_mfma_f32_16x16x32_bf16 v[100:103], a[216:219], a[8:11], v[100:103]
  v_mfma_f32_16x16x32_bf16 v[104:107], a[216:219], a[16:19], v[104:107]
  buffer_load_dwordx4 v[156:159], v255, s[20:23], s62 offen offset:2048 sc1
  v_mfma_f32_16x16x32_bf16 v[104:107], a[220:223], a[20:23], v[104:107]
  ds_read_b128 a[92:95], v8 offset:31744
  v_mfma_f32_16x16x32_bf16 v[108:111], a[220:223], a[28:31], v[108:111]
  v_mfma_f32_16x16x32_bf16 v[108:111], a[216:219], a[24:27], v[108:111]
  s_waitcnt vmcnt(8) lgkmcnt(0)
  s_barrier
  v_mfma_f32_16x16x32_bf16 v[80:83], a[224:227], a[64:67], v[80:83]
  ds_read_b128 a[0:3], v6 offset:0
  v_mfma_f32_16x16x32_bf16 v[80:83], v[246:249], v[112:115], v[80:83]
  v_mfma_f32_16x16x32_bf16 v[80:83], a[228:231], a[68:71], v[80:83]
  ds_read_b128 a[4:7], v6 offset:1024
  v_mfma_f32_16x16x32_bf16 v[96:99], v[244:247], v[112:115], v[96:99]
  v_mfma_f32_16x16x32_bf16 v[84:87], a[228:231], a[76:79], v[84:87]
  v_mfma_f32_16x16x32_bf16 v[84:87], v[246:249], v[116:119], v[84:87]
  v_mfma_f32_16x16x32_bf16 v[84:87], a[224:227], a[72:75], v[84:87]
  ds_read_b128 a[8:11], v6 offset:2048
  v_mfma_f32_16x16x32_bf16 v[100:103], v[244:247], v[116:119], v[100:103]
  v_mfma_f32_16x16x32_bf16 v[88:91], a[224:227], a[80:83], v[88:91]
  v_mfma_f32_16x16x32_bf16 v[88:91], a[228:231], a[84:87], v[88:91]
  ds_read_b128 a[12:15], v6 offset:3072
  v_mfma_f32_16x16x32_bf16 v[88:91], v[246:249], v[120:123], v[88:91]
  v_mfma_f32_16x16x32_bf16 v[92:95], a[228:231], a[92:95], v[92:95]
  v_mfma_f32_16x16x32_bf16 v[104:107], v[244:247], v[120:123], v[104:107]
  v_mfma_f32_16x16x32_bf16 v[92:95], a[224:227], a[88:91], v[92:95]
  ds_read_b128 a[16:19], v6 offset:4096
  v_mfma_f32_16x16x32_bf16 v[92:95], v[246:249], v[124:127], v[92:95]
  v_mfma_f32_16x16x32_bf16 v[96:99], a[232:235], a[64:67], v[96:99]
  ds_read_b128 a[20:23], v6 offset:5120
  v_mfma_f32_16x16x32_bf16 v[108:111], v[244:247], v[124:127], v[108:111]
  v_mfma_f32_16x16x32_bf16 v[96:99], a[236:239], a[68:71], v[96:99]
  v_mfma_f32_16x16x32_bf16 v[100:103], a[236:239], a[76:79], v[100:103]
  ds_read_b128 a[24:27], v6 offset:6144
  v_mfma_f32_16x16x32_bf16 v[100:103], a[232:235], a[72:75], v[100:103]
  v_mfma_f32_16x16x32_bf16 v[104:107], a[232:235], a[80:83], v[104:107]
  ds_read_b128 a[28:31], v6 offset:7168
  v_mfma_f32_16x16x32_bf16 v[104:107], a[236:239], a[84:87], v[104:107]
  v_mfma_f32_16x16x32_bf16 v[108:111], a[236:239], a[92:95], v[108:111]
  v_mfma_f32_16x16x32_bf16 v[108:111], a[232:235], a[88:91], v[108:111]
  s_waitcnt vmcnt(4) lgkmcnt(0)
  v_mfma_f32_16x16x32_bf16 v[80:83], a[240:243], a[0:3], v[80:83]
  v_mfma_f32_16x16x32_bf16 v[80:83], v[246:249], v[128:131], v[80:83]
  v_mfma_f32_16x16x32_bf16 v[80:83], a[244:247], a[4:7], v[80:83]
  v_mfma_f32_16x16x32_bf16 v[96:99], v[244:247], v[128:131], v[96:99]
  v_mfma_f32_16x16x32_bf16 v[84:87], a[244:247], a[12:15], v[84:87]
  v_mfma_f32_16x16x32_bf16 v[84:87], v[246:249], v[132:135], v[84:87]
  v_mfma_f32_16x16x32_bf16 v[84:87], a[240:243], a[8:11], v[84:87]
  v_mfma_f32_16x16x32_bf16 v[100:103], v[244:247], v[132:135], v[100:103]
  v_mfma_f32_16x16x32_bf16 v[88:91], a[240:243], a[16:19], v[88:91]
  v_mfma_f32_16x16x32_bf16 v[88:91], a[244:247], a[20:23], v[88:91]
  v_mfma_f32_16x16x32_bf16 v[88:91], v[246:249], v[136:139], v[88:91]
  v_mfma_f32_16x16x32_bf16 v[92:95], a[244:247], a[28:31], v[92:95]
  v_mfma_f32_16x16x32_bf16 v[104:107], v[244:247], v[136:139], v[104:107]
  v_mfma_f32_16x16x32_bf16 v[92:95], a[240:243], a[24:27], v[92:95]
  v_mfma_f32_16x16x32_bf16 v[92:95], v[246:249], v[140:143], v[92:95]
  v_mfma_f32_16x16x32_bf16 v[96:99], a[248:251], a[0:3], v[96:99]
  v_mfma_f32_16x16x32_bf16 v[108:111], v[244:247], v[140:143], v[108:111]
  v_mfma_f32_16x16x32_bf16 v[96:99], a[252:255], a[4:7], v[96:99]
  v_mfma_f32_16x16x32_bf16 v[100:103], a[252:255], a[12:15], v[100:103]
  v_mfma_f32_16x16x32_bf16 v[100:103], a[248:251], a[8:11], v[100:103]
  v_mfma_f32_16x16x32_bf16 v[104:107], a[248:251], a[16:19], v[104:107]
  v_mfma_f32_16x16x32_bf16 v[104:107], a[252:255], a[20:23], v[104:107]
  v_mfma_f32_16x16x32_bf16 v[108:111], a[252:255], a[28:31], v[108:111]
  v_mfma_f32_16x16x32_bf16 v[108:111], a[248:251], a[24:27], v[108:111]
  s_waitcnt vmcnt(0)
  v_mfma_f32_16x16x32_bf16 v[80:83], v[246:249], v[144:147], v[80:83]
  v_mfma_f32_16x16x32_bf16 v[96:99], v[244:247], v[144:147], v[96:99]
  v_mfma_f32_16x16x32_bf16 v[84:87], v[246:249], v[148:151], v[84:87]
  v_mfma_f32_16x16x32_bf16 v[100:103], v[244:247], v[148:151], v[100:103]
  v_mfma_f32_16x16x32_bf16 v[88:91], v[246:249], v[152:155], v[88:91]
  v_mfma_f32_16x16x32_bf16 v[104:107], v[244:247], v[152:155], v[104:107]
  v_mfma_f32_16x16x32_bf16 v[92:95], v[246:249], v[156:159], v[92:95]
  v_mfma_f32_16x16x32_bf16 v[108:111], v[244:247], v[156:159], v[108:111]
  s_nop 7
  s_nop 1
  v_cvt_pk_bf16_f32 v48, v80, v81
  v_cvt_pk_bf16_f32 v49, v82, v83
  v_cvt_pk_bf16_f32 v50, v96, v97
  v_cvt_pk_bf16_f32 v51, v98, v99
  s_nop 1
  v_permlane16_swap_b32 v48, v50
  v_permlane16_swap_b32 v49, v51
  buffer_store_dwordx4 v[48:51], v40, s[16:19], s97 offen sc1
  s_add_u32 s97, s97, 32768
  v_cvt_pk_bf16_f32 v52, v84, v85
  v_cvt_pk_bf16_f32 v53, v86, v87
  v_cvt_pk_bf16_f32 v54, v100, v101
  v_cvt_pk_bf16_f32 v55, v102, v103
  s_nop 1
  v_permlane16_swap_b32 v52, v54
  v_permlane16_swap_b32 v53, v55
  buffer_store_dwordx4 v[52:55], v40, s[16:19], s97 offen sc1
  s_add_u32 s97, s97, 32768
  v_cvt_pk_bf16_f32 v56, v88, v89
  v_cvt_pk_bf16_f32 v57, v90, v91
  v_cvt_pk_bf16_f32 v58, v104, v105
  v_cvt_pk_bf16_f32 v59, v106, v107
  s_nop 1
  v_permlane16_swap_b32 v56, v58
  v_permlane16_swap_b32 v57, v59
  buffer_store_dwordx4 v[56:59], v40, s[16:19], s97 offen sc1
  s_add_u32 s97, s97, 32768
  v_cvt_pk_bf16_f32 v60, v92, v93
  v_cvt_pk_bf16_f32 v61, v94, v95
  v_cvt_pk_bf16_f32 v62, v108, v109
  v_cvt_pk_bf16_f32 v63, v110, v111
  s_nop 1
  v_permlane16_swap_b32 v60, v62
  v_permlane16_swap_b32 v61, v63
  buffer_store_dwordx4 v[60:63], v40, s[16:19], s97 offen sc1
  s_endpgm
L2_oolQ:
L_stubQ9:
L_stubQ10:
L_stubQ11:
  s_setpc_b64 s[4:5]
L1_loopQ_is:
  s_mov_b32 s0, 0
L1_loopQ_il:
  s_add_u32 s0, s0, 1
  s_cmp_gt_u32 s0, 262144
  s_cbranch_scc1 L1_loopQ_ir
  s_sleep 8
  buffer_load_dword v47, v46, s[20:23], s69 offen sc1
  s_waitcnt vmcnt(0)
  v_cmp_eq_u32 vcc, 0, v47
  v_cmp_ne_u32 s[6:7], s53, v47
  s_nop 1
  s_cmp_lg_u64 vcc, 0
  s_cbranch_scc1 L1_loopQ_il
  s_branch L1_loopQ_ir
LE1a:
  buffer_load_dword v23, v22, s[20:23], s51 offen offset:68 sc1
  s_branch LE1b
LE2a:
  buffer_store_byte v15, off, s[20:23], s55 offset:64 sc1
  s_branch LE2b
LE3a:
  buffer_load_dword v23, v22, s[20:23], s51 offen offset:68 sc1
  s_branch LE3b
L2_h_slowQ:
  s_mov_b32 s3, 0
L2_h_spinQ:
  s_add_u32 s3, s3, 1
  s_cmp_gt_u32 s3, 262144
  s_cbranch_scc1 L2_h_okQ
  s_cmp_eq_u32 s0, 1
  s_cbranch_scc0 LE3a
  buffer_load_dword v23, v22, s[20:23], s51 offen offset:68 nt
LE3b:
  s_waitcnt vmcnt(0)
  v_cmp_ne_u32 vcc, 0x01010101, v23
  s_nop 0
  s_cmp_eq_u64 vcc, 0
  s_cbranch_scc0 L2_h_spinQ
  s_branch L2_h_okQ
LE4a:
  buffer_load_dword v23, v22, s[20:23], s51 offen offset:64 sc1
  s_branch LE4b
LE5a:
  buffer_load_dword v23, v22, s[20:23], s51 offen offset:64 sc1
  s_branch LE5b
L2_qf_slowQ:
  s_mov_b32 s3, 0
L2_qf_spinQ:
  s_add_u32 s3, s3, 1
  s_cmp_gt_u32 s3, 262144
  s_cbranch_scc1 L2_qf_okQ
  s_sleep 4
  s_cmp_eq_u32 s0, 1
  s_cbranch_scc0 LE5a
  buffer_load_dword v23, v22, s[20:23], s51 offen offset:64 nt
LE5b:
  s_waitcnt vmcnt(0)
  v_cmp_ne_u32 vcc, 0x01010101, v23
  s_nop 0
  s_cmp_eq_u64 vcc, 0
  s_cbranch_scc0 L2_qf_spinQ
  s_branch L2_qf_okQ
L2_o_slowQ:
  s_mov_b32 s3, 0
L2_o_spinQ:
  s_add_u32 s3, s3, 1
  s_cmp_gt_u32 s3, 262144
  s_cbranch_scc1 L2_o_okQ
  s_sleep 4
  buffer_load_dword v45, v34, s[20:23], s50 offen offset:4 sc1
  s_waitcnt vmcnt(0)
  v_cmp_ne_u32 vcc, 1, v45
  s_nop 0
  s_cmp_eq_u64 vcc, 0
  s_cbranch_scc0 L2_o_spinQ
  s_branch L2_o_okQ
L2_p_slowQ:
  s_mov_b32 s3, 0
L2_p_spinQ:
  s_add_u32 s3, s3, 1
  s_cmp_gt_u32 s3, 262144
  s_cbranch_scc1 L2_p_okQ
  s_sleep 4
  buffer_load_dwordx4 v[44:47], off, s[20:23], s94 sc1
  s_waitcnt vmcnt(0)
  v_and_b32 v44, v45, v46
  v_and_b32 v44, v44, v47
  s_nop 0
  v_readfirstlane_b32 s4, v44
  s_nop 0
  s_cmp_eq_u32 s4, 1
  s_cbranch_scc0 L2_p_spinQ
  s_branch L2_p_okQ
L2_endQ:
  .p2align 12
L_stubH0:
  s_setpc_b64 s[4:5]
  s_nop 0
L1_firstH:
  v_mfma_f32_16x16x32_bf16 v[48:51], a[128:131], a[0:3], 0
  v_mfma_f32_16x16x32_bf16 v[48:51], a[132:135], a[4:7], v[48:51]
  s_add_u32 m0, s36, 65536
  v_mfma_f32_16x16x32_bf16 v[52:55], a[132:135], a[12:15], 0
  buffer_load_dwordx4 v4, s[8:11], s31 offen offset:0 lds
  v_mfma_f32_16x16x32_bf16 v[52:55], a[128:131], a[8:11], v[52:55]
  v_mfma_f32_16x16x32_bf16 v[56:59], a[128:131], a[16:19], 0
  v_mfma_f32_16x16x32_bf16 v[56:59], a[132:135], a[20:23], v[56:59]
  v_mfma_f32_16x16x32_bf16 v[60:63], a[132:135], a[28:31], 0
  buffer_load_dwordx4 v5, s[8:11], s31 offen offset:1024 lds
  v_mfma_f32_16x16x32_bf16 v[60:63], a[128:131], a[24:27], v[60:63]
  s_waitcnt vmcnt(6)
  s_barrier
  s_cmp_eq_u32 s38, 0
  s_cbranch_scc0 L1_loopHf_t1
  buffer_load_dword a255, v3, s[88:91], s92 offen
  s_add_u32 s92, s92, s93
L1_loopHf_t1:
  v_mfma_f32_16x16x32_bf16 v[64:67], a[128:131], a[32:35], 0
  ds_read_b64_tr_b16 a[144:145], v20 offset:32768
  ds_read_b64_tr_b16 a[146:147], v20 offset:33280
  v_mfma_f32_16x16x32_bf16 v[64:67], a[132:135], a[36:39], v[64:67]
  ds_read_b64_tr_b16 a[148:149], v20 offset:36864
  ds_read_b64_tr_b16 a[150:151], v20 offset:37376
  v_mfma_f32_16x16x32_bf16 v[68:71], a[132:135], a[44:47], 0
  buffer_load_dwordx4 v6, s[8:11], s31 offen offset:2048 lds
  ds_read_b128 a[64:67], v16 offset:32768
  v_mfma_f32_16x16x32_bf16 v[68:71], a[128:131], a[40:43], v[68:71]
  ds_read_b64_tr_b16 a[152:153], v21 offset:32768
  v_mfma_f32_16x16x32_bf16 v[72:75], a[128:131], a[48:51], 0
  v_mfma_f32_16x16x32_bf16 v[72:75], a[132:135], a[52:55], v[72:75]
  ds_read_b128 a[68:71], v17 offset:32768
  v_mfma_f32_16x16x32_bf16 v[76:79], a[132:135], a[60:63], 0
  v_mfma_f32_16x16x32_bf16 v[76:79], a[128:131], a[56:59], v[76:79]
  buffer_load_dwordx4 v7, s[8:11], s31 offen offset:3072 lds
  ds_read_b64_tr_b16 a[154:155], v21 offset:33280
  v_mfma_f32_16x16x32_bf16 v[80:83], a[136:139], a[0:3], 0
  ds_read_b64_tr_b16 a[156:157], v21 offset:36864
  v_mfma_f32_16x16x32_bf16 v[80:83], a[140:143], a[4:7], v[80:83]
  v_mfma_f32_16x16x32_bf16 v[84:87], a[140:143], a[12:15], 0
  s_add_u32 s31, s31, 128
  s_add_u32 m0, s36, 114688
  ds_read_b128 a[72:75], v16 offset:34816
  v_mfma_f32_16x16x32_bf16 v[84:87], a[136:139], a[8:11], v[84:87]
  buffer_load_dwordx4 v12, s[16:19], s33 offen offset:0 lds
  v_mfma_f32_16x16x32_bf16 v[88:91], a[136:139], a[16:19], 0
  ds_read_b64_tr_b16 a[158:159], v21 offset:37376
  v_mfma_f32_16x16x32_bf16 v[88:91], a[140:143], a[20:23], v[88:91]
  ds_read_b128 a[76:79], v17 offset:34816
  v_mfma_f32_16x16x32_bf16 v[92:95], a[140:143], a[28:31], 0
  v_mfma_f32_16x16x32_bf16 v[92:95], a[136:139], a[24:27], v[92:95]
  ds_read_b64_tr_b16 a[160:161], v20 offset:40960
  v_mfma_f32_16x16x32_bf16 v[96:99], a[136:139], a[32:35], 0
  buffer_load_dwordx4 v13, s[16:19], s33 offen offset:1024 lds
  v_mfma_f32_16x16x32_bf16 v[96:99], a[140:143], a[36:39], v[96:99]
  ds_read_b64_tr_b16 a[162:163], v20 offset:41472
  v_mfma_f32_16x16x32_bf16 v[100:103], a[140:143], a[44:47], 0
  v_mfma_f32_16x16x32_bf16 v[100:103], a[136:139], a[40:43], v[100:103]
  ds_read_b128 a[80:83], v16 offset:36864
  v_mfma_f32_16x16x32_bf16 v[104:107], a[136:139], a[48:51], 0
  buffer_load_dwordx4 v14, s[16:19], s33 offen offset:2048 lds
  ds_read_b64_tr_b16 a[164:165], v20 offset:45056
  v_mfma_f32_16x16x32_bf16 v[104:107], a[140:143], a[52:55], v[104:107]
  v_mfma_f32_16x16x32_bf16 v[108:111], a[140:143], a[60:63], 0
  ds_read_b128 a[84:87], v17 offset:36864
  v_mfma_f32_16x16x32_bf16 v[108:111], a[136:139], a[56:59], v[108:111]
  s_waitcnt lgkmcnt(13)
  v_mfma_f32_16x16x32_bf16 v[112:115], a[144:147], a[0:3], 0
  s_lshl_b32 s32, s51, 7
  ds_read_b64_tr_b16 a[166:167], v20 offset:45568
  v_mfma_f32_16x16x32_bf16 v[112:115], a[148:151], a[4:7], v[112:115]
  buffer_load_dwordx4 v15, s[16:19], s33 offen offset:3072 lds
  s_mul_i32 s3, s24, 114688
  v_mfma_f32_16x16x32_bf16 v[116:119], a[148:151], a[12:15], 0
  ds_read_b64_tr_b16 a[168:169], v21 offset:40960
  v_mfma_f32_16x16x32_bf16 v[116:119], a[144:147], a[8:11], v[116:119]
  s_add_u32 s32, s32, s3
  ds_read_b128 a[88:91], v16 offset:38912
  v_mfma_f32_16x16x32_bf16 v[120:123], a[144:147], a[16:19], 0
  s_add_u32 s33, s33, s35
  s_add_u32 m0, s36, 98304
  v_mfma_f32_16x16x32_bf16 v[120:123], a[148:151], a[20:23], v[120:123]
  buffer_load_dwordx4 v4, s[8:11], s30 offen offset:0 lds
  s_add_u32 s32, s32, 917504
  v_mfma_f32_16x16x32_bf16 v[124:127], a[148:151], a[28:31], 0
  s_mov_b32 s14, 7340032
  ds_read_b64_tr_b16 a[170:171], v21 offset:41472
  ds_read_b128 a[92:95], v17 offset:38912
  v_mfma_f32_16x16x32_bf16 v[124:127], a[144:147], a[24:27], v[124:127]
  v_mfma_f32_16x16x32_bf16 v[128:131], a[144:147], a[32:35], 0
  s_lshl_b32 s42, s24, 11
  ds_read_b64_tr_b16 a[172:173], v21 offset:45056
  v_mfma_f32_16x16x32_bf16 v[128:131], a[148:151], a[36:39], v[128:131]
  v_mfma_f32_16x16x32_bf16 v[132:135], a[148:151], a[44:47], 0
  ds_read_b64_tr_b16 a[174:175], v21 offset:45568
  v_mfma_f32_16x16x32_bf16 v[132:135], a[144:147], a[40:43], v[132:135]
  v_mfma_f32_16x16x32_bf16 v[136:139], a[144:147], a[48:51], 0
  v_mfma_f32_16x16x32_bf16 v[136:139], a[148:151], a[52:55], v[136:139]
  v_mfma_f32_16x16x32_bf16 v[140:143], a[148:151], a[60:63], 0
  v_mfma_f32_16x16x32_bf16 v[140:143], a[144:147], a[56:59], v[140:143]
  s_waitcnt vmcnt(5) lgkmcnt(0)
  s_barrier
  v_mfma_f32_16x16x32_bf16 v[144:147], a[152:155], a[0:3], 0
  ds_read_b64_tr_b16 a[128:129], v22 offset:8192
  v_mfma_f32_16x16x32_bf16 v[144:147], a[156:159], a[4:7], v[144:147]
  v_mfma_f32_16x16x32_bf16 v[148:151], a[156:159], a[12:15], 0
  buffer_load_dwordx4 v5, s[8:11], s30 offen offset:1024 lds
  v_mfma_f32_16x16x32_bf16 v[148:151], a[152:155], a[8:11], v[148:151]
  ds_read_b64_tr_b16 a[130:131], v22 offset:8704
  v_mfma_f32_16x16x32_bf16 v[152:155], a[152:155], a[16:19], 0
  v_mfma_f32_16x16x32_bf16 v[152:155], a[156:159], a[20:23], v[152:155]
  ds_read_b64_tr_b16 a[132:133], v22 offset:12288
  v_mfma_f32_16x16x32_bf16 v[156:159], a[156:159], a[28:31], 0
  buffer_load_dwordx4 v6, s[8:11], s30 offen offset:2048 lds
  v_mfma_f32_16x16x32_bf16 v[156:159], a[152:155], a[24:27], v[156:159]
  ds_read_b64_tr_b16 a[134:135], v22 offset:12800
  v_mfma_f32_16x16x32_bf16 v[160:163], a[152:155], a[32:35], 0
  v_mfma_f32_16x16x32_bf16 v[160:163], a[156:159], a[36:39], v[160:163]
  v_mfma_f32_16x16x32_bf16 v[164:167], a[156:159], a[44:47], 0
  buffer_load_dwordx4 v7, s[8:11], s30 offen offset:3072 lds
  v_mfma_f32_16x16x32_bf16 v[164:167], a[152:155], a[40:43], v[164:167]
  ds_read_b128 a[96:99], v18 offset:0
  v_mfma_f32_16x16x32_bf16 v[168:171], a[152:155], a[48:51], 0
  ds_read_b128 a[100:103], v19 offset:0
  v_mfma_f32_16x16x32_bf16 v[168:171], a[156:159], a[52:55], v[168:171]
  v_mfma_f32_16x16x32_bf16 v[172:175], a[156:159], a[60:63], 0
  s_add_u32 s30, s30, 128
  s_add_u32 m0, s42, 24576
  v_mfma_f32_16x16x32_bf16 v[172:175], a[152:155], a[56:59], v[172:175]
  buffer_load_dwordx4 v8, s[12:15], s32 offen offset:0 lds
  v_mfma_f32_16x16x32_bf16 v[176:179], a[160:163], a[0:3], 0
  ds_read_b64_tr_b16 a[136:137], v23 offset:8192
  v_mfma_f32_16x16x32_bf16 v[176:179], a[164:167], a[4:7], v[176:179]
  ds_read_b128 a[104:107], v18 offset:2048
  v_mfma_f32_16x16x32_bf16 v[180:183], a[164:167], a[12:15], 0
  v_mfma_f32_16x16x32_bf16 v[180:183], a[160:163], a[8:11], v[180:183]
  buffer_load_dwordx4 v9, s[12:15], s32 offen offset:1024 lds
  v_mfma_f32_16x16x32_bf16 v[184:187], a[160:163], a[16:19], 0
  ds_read_b128 a[108:111], v19 offset:2048
  v_mfma_f32_16x16x32_bf16 v[184:187], a[164:167], a[20:23], v[184:187]
  v_mfma_f32_16x16x32_bf16 v[188:191], a[164:167], a[28:31], 0
  ds_read_b64_tr_b16 a[138:139], v23 offset:8704
  v_mfma_f32_16x16x32_bf16 v[188:191], a[160:163], a[24:27], v[188:191]
  s_add_u32 s32, s32, s34
  s_add_u32 m0, s36, 0
  v_mfma_f32_16x16x32_bf16 v[192:195], a[160:163], a[32:35], 0
  buffer_load_dwordx4 v4, s[8:11], s31 offen offset:0 lds
  v_mfma_f32_16x16x32_bf16 v[192:195], a[164:167], a[36:39], v[192:195]
  s_getpc_b64 s[4:5]
L1_loopHf_h10a:
  s_add_u32 s4, s4, L1_loopHf_h10b-L1_loopHf_h10a
  s_addc_u32 s5, s5, 0
  s_cmp_eq_u32 s24, 1
  s_cbranch_scc1 L_stubH1
L1_loopHf_h10b:
  v_mfma_f32_16x16x32_bf16 v[196:199], a[164:167], a[44:47], 0
  ds_read_b128 a[112:115], v18 offset:4096
  v_mfma_f32_16x16x32_bf16 v[196:199], a[160:163], a[40:43], v[196:199]
  ds_read_b128 a[116:119], v19 offset:4096
  v_mfma_f32_16x16x32_bf16 v[200:203], a[160:163], a[48:51], 0
  buffer_load_dwordx4 v5, s[8:11], s31 offen offset:1024 lds
  v_mfma_f32_16x16x32_bf16 v[200:203], a[164:167], a[52:55], v[200:203]
  v_mfma_f32_16x16x32_bf16 v[204:207], a[164:167], a[60:63], 0
  ds_read_b64_tr_b16 a[140:141], v23 offset:12288
  v_mfma_f32_16x16x32_bf16 v[204:207], a[160:163], a[56:59], v[204:207]
  v_mfma_f32_16x16x32_bf16 v[208:211], a[168:171], a[0:3], 0
  ds_read_b128 a[120:123], v18 offset:6144
  v_mfma_f32_16x16x32_bf16 v[208:211], a[172:175], a[4:7], v[208:211]
  buffer_load_dwordx4 v6, s[8:11], s31 offen offset:2048 lds
  v_mfma_f32_16x16x32_bf16 v[212:215], a[172:175], a[12:15], 0
  v_mfma_f32_16x16x32_bf16 v[212:215], a[168:171], a[8:11], v[212:215]
  ds_read_b128 a[124:127], v19 offset:6144
  v_mfma_f32_16x16x32_bf16 v[216:219], a[168:171], a[16:19], 0
  v_mfma_f32_16x16x32_bf16 v[216:219], a[172:175], a[20:23], v[216:219]
  buffer_load_dwordx4 v7, s[8:11], s31 offen offset:3072 lds
  v_mfma_f32_16x16x32_bf16 v[220:223], a[172:175], a[28:31], 0
  s_add_u32 s31, s31, 128
  v_mfma_f32_16x16x32_bf16 v[220:223], a[168:171], a[24:27], v[220:223]
  ds_read_b64_tr_b16 a[142:143], v23 offset:12800
  v_mfma_f32_16x16x32_bf16 v[224:227], a[168:171], a[32:35], 0
  v_mfma_f32_16x16x32_bf16 v[224:227], a[172:175], a[36:39], v[224:227]
  v_mfma_f32_16x16x32_bf16 v[228:231], a[172:175], a[44:47], 0
  v_mfma_f32_16x16x32_bf16 v[228:231], a[168:171], a[40:43], v[228:231]
  v_mfma_f32_16x16x32_bf16 v[232:235], a[168:171], a[48:51], 0
  v_mfma_f32_16x16x32_bf16 v[232:235], a[172:175], a[52:55], v[232:235]
  v_mfma_f32_16x16x32_bf16 v[236:239], a[172:175], a[60:63], 0
  v_mfma_f32_16x16x32_bf16 v[236:239], a[168:171], a[56:59], v[236:239]
  s_waitcnt vmcnt(6) lgkmcnt(0)
  s_barrier
  v_mfma_f32_16x16x32_bf16 v[48:51], a[128:131], a[64:67], v[48:51]
  ds_read_b64_tr_b16 a[144:145], v22 offset:32768
  v_mfma_f32_16x16x32_bf16 v[48:51], a[132:135], a[68:71], v[48:51]
  s_add_u32 m0, s36, 49152
  v_mfma_f32_16x16x32_bf16 v[52:55], a[132:135], a[76:79], v[52:55]
  buffer_load_dwordx4 v12, s[16:19], s33 offen offset:0 lds
  v_mfma_f32_16x16x32_bf16 v[52:55], a[128:131], a[72:75], v[52:55]
  ds_read_b64_tr_b16 a[146:147], v22 offset:33280
  v_mfma_f32_16x16x32_bf16 v[56:59], a[128:131], a[80:83], v[56:59]
  ds_read_b64_tr_b16 a[148:149], v22 offset:36864
  v_mfma_f32_16x16x32_bf16 v[56:59], a[132:135], a[84:87], v[56:59]
  ds_read_b64_tr_b16 a[150:151], v22 offset:37376
  v_mfma_f32_16x16x32_bf16 v[60:63], a[132:135], a[92:95], v[60:63]
  buffer_load_dwordx4 v13, s[16:19], s33 offen offset:1024 lds
  v_mfma_f32_16x16x32_bf16 v[60:63], a[128:131], a[88:91], v[60:63]
  ds_read_b128 a[0:3], v18 offset:32768
  v_mfma_f32_16x16x32_bf16 v[64:67], a[128:131], a[96:99], v[64:67]
  ds_read_b64_tr_b16 a[152:153], v23 offset:32768
  v_mfma_f32_16x16x32_bf16 v[64:67], a[132:135], a[100:103], v[64:67]
  v_mfma_f32_16x16x32_bf16 v[68:71], a[132:135], a[108:111], v[68:71]
  buffer_load_dwordx4 v14, s[16:19], s33 offen offset:2048 lds
  v_mfma_f32_16x16x32_bf16 v[68:71], a[128:131], a[104:107], v[68:71]
  ds_read_b128 a[4:7], v19 offset:32768
  v_mfma_f32_16x16x32_bf16 v[72:75], a[128:131], a[112:115], v[72:75]
  ds_read_b64_tr_b16 a[154:155], v23 offset:33280
  v_mfma_f32_16x16x32_bf16 v[72:75], a[132:135], a[116:119], v[72:75]
  ds_read_b64_tr_b16 a[156:157], v23 offset:36864
  v_mfma_f32_16x16x32_bf16 v[76:79], a[132:135], a[124:127], v[76:79]
  v_mfma_f32_16x16x32_bf16 v[76:79], a[128:131], a[120:123], v[76:79]
  buffer_load_dwordx4 v15, s[16:19], s33 offen offset:3072 lds
  v_mfma_f32_16x16x32_bf16 v[80:83], a[136:139], a[64:67], v[80:83]
  ds_read_b128 a[8:11], v18 offset:34816
  v_mfma_f32_16x16x32_bf16 v[80:83], a[140:143], a[68:71], v[80:83]
  ds_read_b64_tr_b16 a[158:159], v23 offset:37376
  v_mfma_f32_16x16x32_bf16 v[84:87], a[140:143], a[76:79], v[84:87]
  s_add_u32 s33, s33, s35
  s_add_u32 m0, s36, 32768
  v_mfma_f32_16x16x32_bf16 v[84:87], a[136:139], a[72:75], v[84:87]
  buffer_load_dwordx4 v4, s[8:11], s30 offen offset:0 lds
  v_mfma_f32_16x16x32_bf16 v[88:91], a[136:139], a[80:83], v[88:91]
  ds_read_b128 a[12:15], v19 offset:34816
  v_mfma_f32_16x16x32_bf16 v[88:91], a[140:143], a[84:87], v[88:91]
  ds_read_b64_tr_b16 a[160:161], v22 offset:40960
  v_mfma_f32_16x16x32_bf16 v[92:95], a[140:143], a[92:95], v[92:95]
  ds_read_b64_tr_b16 a[162:163], v22 offset:41472
  v_mfma_f32_16x16x32_bf16 v[92:95], a[136:139], a[88:91], v[92:95]
  ds_read_b128 a[16:19], v18 offset:36864
  v_mfma_f32_16x16x32_bf16 v[96:99], a[136:139], a[96:99], v[96:99]
  buffer_load_dwordx4 v5, s[8:11], s30 offen offset:1024 lds
  v_mfma_f32_16x16x32_bf16 v[96:99], a[140:143], a[100:103], v[96:99]
  s_getpc_b64 s[4:5]
L1_loopHf_h20a:
  s_add_u32 s4, s4, L1_loopHf_h20b-L1_loopHf_h20a
  s_addc_u32 s5, s5, 0
  s_cmp_eq_u32 s24, 2
  s_cbranch_scc1 L_stubH2
  s_cmp_eq_u32 s24, 3
  s_cbranch_scc1 L_stubH3
  s_cmp_eq_u32 s24, 0
  s_cbranch_scc1 L_stubH4
  s_cmp_eq_u32 s24, 1
  s_cbranch_scc1 L_stubH5
L1_loopHf_h20b:
  v_mfma_f32_16x16x32_bf16 v[100:103], a[140:143], a[108:111], v[100:103]
  ds_read_b64_tr_b16 a[164:165], v22 offset:45056
  v_mfma_f32_16x16x32_bf16 v[100:103], a[136:139], a[104:107], v[100:103]
  ds_read_b128 a[20:23], v19 offset:36864
  v_mfma_f32_16x16x32_bf16 v[104:107], a[136:139], a[112:115], v[104:107]
  buffer_load_dwordx4 v6, s[8:11], s30 offen offset:2048 lds
  v_mfma_f32_16x16x32_bf16 v[104:107], a[140:143], a[116:119], v[104:107]
  ds_read_b64_tr_b16 a[166:167], v22 offset:45568
  v_mfma_f32_16x16x32_bf16 v[108:111], a[140:143], a[124:127], v[108:111]
  ds_read_b64_tr_b16 a[168:169], v23 offset:40960
  v_mfma_f32_16x16x32_bf16 v[108:111], a[136:139], a[120:123], v[108:111]
  ds_read_b128 a[24:27], v18 offset:38912
  s_waitcnt lgkmcnt(15)
  v_mfma_f32_16x16x32_bf16 v[112:115], a[144:147], a[64:67], v[112:115]
  v_mfma_f32_16x16x32_bf16 v[112:115], a[148:151], a[68:71], v[112:115]
  buffer_load_dwordx4 v7, s[8:11], s30 offen offset:3072 lds
  v_mfma_f32_16x16x32_bf16 v[116:119], a[148:151], a[76:79], v[116:119]
  ds_read_b64_tr_b16 a[170:171], v23 offset:41472
  v_mfma_f32_16x16x32_bf16 v[116:119], a[144:147], a[72:75], v[116:119]
  ds_read_b128 a[28:31], v19 offset:38912
  v_mfma_f32_16x16x32_bf16 v[120:123], a[144:147], a[80:83], v[120:123]
  s_add_u32 s30, s30, 128
  s_add_u32 m0, s42, 90112
  v_mfma_f32_16x16x32_bf16 v[120:123], a[148:151], a[84:87], v[120:123]
  buffer_load_dwordx4 v8, s[12:15], s32 offen offset:0 lds
  v_mfma_f32_16x16x32_bf16 v[124:127], a[148:151], a[92:95], v[124:127]
  ds_read_b64_tr_b16 a[172:173], v23 offset:45056
  v_mfma_f32_16x16x32_bf16 v[124:127], a[144:147], a[88:91], v[124:127]
  ds_read_b64_tr_b16 a[174:175], v23 offset:45568
  v_mfma_f32_16x16x32_bf16 v[128:131], a[144:147], a[96:99], v[128:131]
  v_mfma_f32_16x16x32_bf16 v[128:131], a[148:151], a[100:103], v[128:131]
  v_mfma_f32_16x16x32_bf16 v[132:135], a[148:151], a[108:111], v[132:135]
  v_mfma_f32_16x16x32_bf16 v[132:135], a[144:147], a[104:107], v[132:135]
  s_cmp_eq_u32 s38, 0
  s_cbranch_scc0 L1_loopHf_x2
  buffer_load_dword a255, v3, s[88:91], s92 offen
  s_add_u32 s92, s92, s93
  s_branch L1_loopHf_x4
L1_loopHf_x2:
  s_cmp_eq_u32 s39, 0
  s_cbranch_scc0 L1_loopHf_x3
  buffer_load_dword a255, v34, s[64:67], 0 offen
  s_branch L1_loopHf_x4
L1_loopHf_x3:
  s_lshr_b32 s3, s86, 3
  s_lshr_b32 s4, s86, 5
  s_add_u32 s3, s3, s4
  s_and_b32 s99, s3, 3
  s_and_b32 s3, s52, 7
  s_mov_b32 s28, 0x18
  s_cbranch_scc1 L1_loopHf_x5
  v_mov_b64 v[36:37], 0
  v_mov_b64 v[38:39], 0
  v_lshrrev_b32 v32, 3, v1
  v_and_b32 v33, 0x70, v2
  v_lshl_add_u32 v32, v32, 14, v33
  s_lshl_b32 s3, s52, 7
  s_add_u32 s3, s3, 39976960
  s_lshl_b32 s4, s52, 4
  s_add_u32 s4, s4, 40042496
  buffer_store_dwordx4 v[36:39], v2, s[20:23], s3 offen sc1
  s_add_u32 s3, s3, -131072
  buffer_store_dwordx4 v[36:39], v2, s[20:23], s3 offen sc1
  s_mov_b32 exec_hi, 0xff
  buffer_store_dwordx4 v[36:39], v32, s[20:23], s4 offen sc1
  s_lshl_b32 s3, s52, 6
  s_add_u32 s3, s3, 40124416
  s_mov_b32 exec_hi, 0
  buffer_store_dwordx4 v[36:39], v2, s[20:23], s3 offen sc1
  s_lshl_b32 s3, s52, 5
  s_add_u32 s3, s3, 39911424
  s_mov_b64 exec, 0xffff
  buffer_store_dwordx4 v[36:39], v2, s[20:23], s3 offen sc1
  s_mov_b64 exec, -1
L1_loopHf_x5:
  s_or_b32 s98, s98, s28
L1_loopHf_x4:
  s_add_u32 s55, s55, s24
  v_mfma_f32_16x16x32_bf16 v[136:139], a[144:147], a[112:115], v[136:139]
  v_mfma_f32_16x16x32_bf16 v[136:139], a[148:151], a[116:119], v[136:139]
  v_mfma_f32_16x16x32_bf16 v[140:143], a[148:151], a[124:127], v[140:143]
  v_mfma_f32_16x16x32_bf16 v[140:143], a[144:147], a[120:123], v[140:143]
  s_waitcnt vmcnt(9) lgkmcnt(0)
  s_barrier
  v_mfma_f32_16x16x32_bf16 v[144:147], a[152:155], a[64:67], v[144:147]
  ds_read_b64_tr_b16 a[128:129], v20 offset:8192
  v_mfma_f32_16x16x32_bf16 v[144:147], a[156:159], a[68:71], v[144:147]
  v_mfma_f32_16x16x32_bf16 v[148:151], a[156:159], a[76:79], v[148:151]
  buffer_load_dwordx4 v9, s[12:15], s32 offen offset:1024 lds
  v_mfma_f32_16x16x32_bf16 v[148:151], a[152:155], a[72:75], v[148:151]
  ds_read_b64_tr_b16 a[130:131], v20 offset:8704
  v_mfma_f32_16x16x32_bf16 v[152:155], a[152:155], a[80:83], v[152:155]
  v_mfma_f32_16x16x32_bf16 v[152:155], a[156:159], a[84:87], v[152:155]
  s_add_u32 s32, s32, s34
  s_add_u32 m0, s36, 65536
  v_mfma_f32_16x16x32_bf16 v[156:159], a[156:159], a[92:95], v[156:159]
  buffer_load_dwordx4 v4, s[8:11], s31 offen offset:0 lds
  v_mfma_f32_16x16x32_bf16 v[156:159], a[152:155], a[88:91], v[156:159]
  ds_read_b64_tr_b16 a[132:133], v20 offset:12288
  v_mfma_f32_16x16x32_bf16 v[160:163], a[152:155], a[96:99], v[160:163]
  ds_read_b64_tr_b16 a[134:135], v20 offset:12800
  v_mfma_f32_16x16x32_bf16 v[160:163], a[156:159], a[100:103], v[160:163]
  v_mfma_f32_16x16x32_bf16 v[164:167], a[156:159], a[108:111], v[164:167]
  buffer_load_dwordx4 v5, s[8:11], s31 offen offset:1024 lds
  v_mfma_f32_16x16x32_bf16 v[164:167], a[152:155], a[104:107], v[164:167]
  ds_read_b128 a[32:35], v16 offset:0
  v_mfma_f32_16x16x32_bf16 v[168:171], a[152:155], a[112:115], v[168:171]
  ds_read_b128 a[36:39], v17 offset:0
  v_mfma_f32_16x16x32_bf16 v[168:171], a[156:159], a[116:119], v[168:171]
  v_mfma_f32_16x16x32_bf16 v[172:175], a[156:159], a[124:127], v[172:175]
  v_mfma_f32_16x16x32_bf16 v[172:175], a[152:155], a[120:123], v[172:175]
  buffer_load_dwordx4 v6, s[8:11], s31 offen offset:2048 lds
  v_mfma_f32_16x16x32_bf16 v[176:179], a[160:163], a[64:67], v[176:179]
  ds_read_b64_tr_b16 a[136:137], v21 offset:8192
  v_mfma_f32_16x16x32_bf16 v[176:179], a[164:167], a[68:71], v[176:179]
  ds_read_b128 a[40:43], v16 offset:2048
  v_mfma_f32_16x16x32_bf16 v[180:183], a[164:167], a[76:79], v[180:183]
  v_mfma_f32_16x16x32_bf16 v[180:183], a[160:163], a[72:75], v[180:183]
  buffer_load_dwordx4 v7, s[8:11], s31 offen offset:3072 lds
  v_mfma_f32_16x16x32_bf16 v[184:187], a[160:163], a[80:83], v[184:187]
  ds_read_b128 a[44:47], v17 offset:2048
  v_mfma_f32_16x16x32_bf16 v[184:187], a[164:167], a[84:87], v[184:187]
  v_mfma_f32_16x16x32_bf16 v[188:191], a[164:167], a[92:95], v[188:191]
  ds_read_b64_tr_b16 a[138:139], v21 offset:8704
  v_mfma_f32_16x16x32_bf16 v[188:191], a[160:163], a[88:91], v[188:191]
  s_add_u32 s31, s31, 128
  s_add_u32 m0, s36, 114688
  v_mfma_f32_16x16x32_bf16 v[192:195], a[160:163], a[96:99], v[192:195]
  buffer_load_dwordx4 v12, s[16:19], s33 offen offset:0 lds
  v_mfma_f32_16x16x32_bf16 v[192:195], a[164:167], a[100:103], v[192:195]
  s_getpc_b64 s[4:5]
L1_loopHf_h30a:
  s_add_u32 s4, s4, L1_loopHf_h30b-L1_loopHf_h30a
  s_addc_u32 s5, s5, 0
  s_cmp_eq_u32 s24, 2
  s_cbranch_scc1 L_stubH6
  s_cmp_eq_u32 s24, 3
  s_cbranch_scc1 L_stubH7
  s_cmp_eq_u32 s24, 0
  s_cbranch_scc1 L_stubH8
  s_cmp_eq_u32 s24, 1
  s_cbranch_scc1 L_stubH9
L1_loopHf_h30b:
  v_mfma_f32_16x16x32_bf16 v[196:199], a[164:167], a[108:111], v[196:199]
  ds_read_b128 a[48:51], v16 offset:4096
  v_mfma_f32_16x16x32_bf16 v[196:199], a[160:163], a[104:107], v[196:199]
  ds_read_b128 a[52:55], v17 offset:4096
  v_mfma_f32_16x16x32_bf16 v[200:203], a[160:163], a[112:115], v[200:203]
  buffer_load_dwordx4 v13, s[16:19], s33 offen offset:1024 lds
  v_mfma_f32_16x16x32_bf16 v[200:203], a[164:167], a[116:119], v[200:203]
  v_mfma_f32_16x16x32_bf16 v[204:207], a[164:167], a[124:127], v[204:207]
  ds_read_b64_tr_b16 a[140:141], v21 offset:12288
  v_mfma_f32_16x16x32_bf16 v[204:207], a[160:163], a[120:123], v[204:207]
  v_mfma_f32_16x16x32_bf16 v[208:211], a[168:171], a[64:67], v[208:211]
  ds_read_b128 a[56:59], v16 offset:6144
  v_mfma_f32_16x16x32_bf16 v[208:211], a[172:175], a[68:71], v[208:211]
  buffer_load_dwordx4 v14, s[16:19], s33 offen offset:2048 lds
  v_mfma_f32_16x16x32_bf16 v[212:215], a[172:175], a[76:79], v[212:215]
  v_mfma_f32_16x16x32_bf16 v[212:215], a[168:171], a[72:75], v[212:215]
  ds_read_b128 a[60:63], v17 offset:6144
  v_mfma_f32_16x16x32_bf16 v[216:219], a[168:171], a[80:83], v[216:219]
  v_mfma_f32_16x16x32_bf16 v[216:219], a[172:175], a[84:87], v[216:219]
  buffer_load_dwordx4 v15, s[16:19], s33 offen offset:3072 lds
  v_mfma_f32_16x16x32_bf16 v[220:223], a[172:175], a[92:95], v[220:223]
  s_add_u32 s33, s33, s35
  v_mfma_f32_16x16x32_bf16 v[220:223], a[168:171], a[88:91], v[220:223]
  ds_read_b64_tr_b16 a[142:143], v21 offset:12800
  v_mfma_f32_16x16x32_bf16 v[224:227], a[168:171], a[96:99], v[224:227]
  v_mfma_f32_16x16x32_bf16 v[224:227], a[172:175], a[100:103], v[224:227]
  v_mfma_f32_16x16x32_bf16 v[228:231], a[172:175], a[108:111], v[228:231]
  v_mfma_f32_16x16x32_bf16 v[228:231], a[168:171], a[104:107], v[228:231]
  s_cmp_eq_u32 s38, 0
  v_mfma_f32_16x16x32_bf16 v[232:235], a[168:171], a[112:115], v[232:235]
  s_cbranch_scc1 L1_loopHf_nt3_o
L1_loopHf_nt3:
  v_mfma_f32_16x16x32_bf16 v[232:235], a[172:175], a[116:119], v[232:235]
  v_mfma_f32_16x16x32_bf16 v[236:239], a[172:175], a[124:127], v[236:239]
  v_mfma_f32_16x16x32_bf16 v[236:239], a[168:171], a[120:123], v[236:239]
  s_waitcnt vmcnt(10) lgkmcnt(0)
  s_barrier
  s_branch L1_loopH
L1_loopHf_nt3_o:
  buffer_load_dword a255, v3, s[88:91], s92 offen
  s_add_u32 s92, s92, s93
  s_branch L1_loopHf_nt3
L1_loopH_nt0_o:
  s_bitcmp1_b32 s28, s37
  s_cbranch_scc1 L1_loopH_w3
  buffer_load_dword a255, v3, s[88:91], s92 offen
  s_add_u32 s92, s92, s93
  s_branch L1_loopH_nt0
L1_loopH_nt1_o:
  s_bitcmp1_b32 s28, s37
  s_cbranch_scc1 L1_loopH_w3
  buffer_load_dword a255, v3, s[88:91], s92 offen
  s_add_u32 s92, s92, s93
  s_branch L1_loopH_nt1
L1_loopH_nt2_o:
  s_bitcmp1_b32 s28, s37
  s_cbranch_scc1 L1_loopH_w3
  buffer_load_dword a255, v3, s[88:91], s92 offen
  s_add_u32 s92, s92, s93
  s_branch L1_loopH_nt2
L1_loopH_nd_o:
  buffer_load_dword v47, v46, s[20:23], s69 offen sc1
  s_branch L1_loopH_nd
L1_loopH_nt3_o:
  s_bitcmp1_b32 s28, s37
  s_cbranch_scc1 L1_loopH_w3
  buffer_load_dword a255, v3, s[88:91], s92 offen
  s_add_u32 s92, s92, s93
  s_branch L1_loopH_nt3
L1_loopH_w3:
  s_cmp_eq_u32 s37, 4
  s_cbranch_scc1 L1_loopH_w3c
  buffer_load_dword v47, v43, s[56:59], 0 offen
  s_branch L1_loopH_w3r
L1_loopH_w3c:
  s_mov_b32 s3, 0
L1_loopH_w3d:
  v_cmp_eq_u32 vcc, 0, v47
  s_add_u32 s3, s3, 1
  s_cmp_eq_u64 vcc, 0
  s_cbranch_scc1 L1_loopH_w3e
  s_cmp_gt_u32 s3, 262144
  s_cbranch_scc1 L1_loopH_w3e
  s_sleep 8
  buffer_load_dword v47, v43, s[56:59], 0 offen sc1
  s_waitcnt vmcnt(0)
  s_branch L1_loopH_w3d
L1_loopH_w3e:
  s_and_b32 s3, s52, 7
  s_lshl_b32 s3, s3, 2
  s_add_u32 s3, s3, s69
  s_mov_b64 exec, 1
  buffer_store_dword v44, off, s[20:23], s3 sc1
  s_mov_b64 exec, -1
L1_loopH_w3r:
  s_cmp_eq_u32 s87, 0
  s_cbranch_scc1 L1_loopH_nt0
  s_cmp_eq_u32 s87, 1
  s_cbranch_scc1 L1_loopH_nt1
  s_cmp_eq_u32 s87, 2
  s_cbranch_scc1 L1_loopH_nt2
  s_branch L1_loopH_nt3
  .p2align 12
L_stubH1:
  s_setpc_b64 s[4:5]
  s_nop 0
L1_loopH:
  v_mfma_f32_16x16x32_bf16 v[48:51], a[128:131], a[0:3], v[48:51]
  ds_read_b64_tr_b16 a[144:145], v20 offset:32768
  v_mfma_f32_16x16x32_bf16 v[48:51], a[132:135], a[4:7], v[48:51]
  s_bitcmp1_b32 s98, s37
  s_cselect_b32 s87, s99, 7
  v_mfma_f32_16x16x32_bf16 v[52:55], a[132:135], a[12:15], v[52:55]
  s_add_u32 m0, s36, 98304
  v_mfma_f32_16x16x32_bf16 v[52:55], a[128:131], a[8:11], v[52:55]
  buffer_load_dwordx4 v4, s[8:11], s30 offen offset:0 lds
  v_mfma_f32_16x16x32_bf16 v[56:59], a[128:131], a[16:19], v[56:59]
  ds_read_b64_tr_b16 a[146:147], v20 offset:33280
  v_mfma_f32_16x16x32_bf16 v[56:59], a[132:135], a[20:23], v[56:59]
  ds_read_b64_tr_b16 a[148:149], v20 offset:36864
  v_mfma_f32_16x16x32_bf16 v[60:63], a[132:135], a[28:31], v[60:63]
  ds_read_b64_tr_b16 a[150:151], v20 offset:37376
  v_mfma_f32_16x16x32_bf16 v[60:63], a[128:131], a[24:27], v[60:63]
  ds_read_b128 a[64:67], v16 offset:32768
  v_mfma_f32_16x16x32_bf16 v[64:67], a[128:131], a[32:35], v[64:67]
  ds_read_b64_tr_b16 a[152:153], v21 offset:32768
  v_mfma_f32_16x16x32_bf16 v[64:67], a[132:135], a[36:39], v[64:67]
  buffer_load_dwordx4 v5, s[8:11], s30 offen offset:1024 lds
  v_mfma_f32_16x16x32_bf16 v[68:71], a[132:135], a[44:47], v[68:71]
  ds_read_b128 a[68:71], v17 offset:32768
  v_mfma_f32_16x16x32_bf16 v[68:71], a[128:131], a[40:43], v[68:71]
  ds_read_b64_tr_b16 a[154:155], v21 offset:33280
  v_mfma_f32_16x16x32_bf16 v[72:75], a[128:131], a[48:51], v[72:75]
  v_mfma_f32_16x16x32_bf16 v[72:75], a[132:135], a[52:55], v[72:75]
  ds_read_b64_tr_b16 a[156:157], v21 offset:36864
  v_mfma_f32_16x16x32_bf16 v[76:79], a[132:135], a[60:63], v[76:79]
  v_mfma_f32_16x16x32_bf16 v[76:79], a[128:131], a[56:59], v[76:79]
  buffer_load_dwordx4 v6, s[8:11], s30 offen offset:2048 lds
  v_mfma_f32_16x16x32_bf16 v[80:83], a[136:139], a[0:3], v[80:83]
  ds_read_b128 a[72:75], v16 offset:34816
  v_mfma_f32_16x16x32_bf16 v[80:83], a[140:143], a[4:7], v[80:83]
  ds_read_b64_tr_b16 a[158:159], v21 offset:37376
  v_mfma_f32_16x16x32_bf16 v[84:87], a[140:143], a[12:15], v[84:87]
  ds_read_b128 a[76:79], v17 offset:34816
  v_mfma_f32_16x16x32_bf16 v[84:87], a[136:139], a[8:11], v[84:87]
  v_mfma_f32_16x16x32_bf16 v[88:91], a[136:139], a[16:19], v[88:91]
  ds_read_b64_tr_b16 a[160:161], v20 offset:40960
  v_mfma_f32_16x16x32_bf16 v[88:91], a[140:143], a[20:23], v[88:91]
  buffer_load_dwordx4 v7, s[8:11], s30 offen offset:3072 lds
  v_mfma_f32_16x16x32_bf16 v[92:95], a[140:143], a[28:31], v[92:95]
  ds_read_b64_tr_b16 a[162:163], v20 offset:41472
  v_mfma_f32_16x16x32_bf16 v[92:95], a[136:139], a[24:27], v[92:95]
  ds_read_b128 a[80:83], v16 offset:36864
  v_mfma_f32_16x16x32_bf16 v[96:99], a[136:139], a[32:35], v[96:99]
  v_mfma_f32_16x16x32_bf16 v[96:99], a[140:143], a[36:39], v[96:99]
  ds_read_b64_tr_b16 a[164:165], v20 offset:45056
  v_mfma_f32_16x16x32_bf16 v[100:103], a[140:143], a[44:47], v[100:103]
  s_add_u32 s30, s30, 128
  s_add_u32 m0, s42, 24576
  v_mfma_f32_16x16x32_bf16 v[100:103], a[136:139], a[40:43], v[100:103]
  buffer_load_dwordx4 v8, s[12:15], s32 offen offset:0 lds
  v_mfma_f32_16x16x32_bf16 v[104:107], a[136:139], a[48:51], v[104:107]
  ds_read_b128 a[84:87], v17 offset:36864
  v_mfma_f32_16x16x32_bf16 v[104:107], a[140:143], a[52:55], v[104:107]
  ds_read_b64_tr_b16 a[166:167], v20 offset:45568
  v_mfma_f32_16x16x32_bf16 v[108:111], a[140:143], a[60:63], v[108:111]
  ds_read_b64_tr_b16 a[168:169], v21 offset:40960
  v_mfma_f32_16x16x32_bf16 v[108:111], a[136:139], a[56:59], v[108:111]
  ds_read_b128 a[88:91], v16 offset:38912
  s_waitcnt lgkmcnt(15)
  v_mfma_f32_16x16x32_bf16 v[112:115], a[144:147], a[0:3], v[112:115]
  v_mfma_f32_16x16x32_bf16 v[112:115], a[148:151], a[4:7], v[112:115]
  buffer_load_dwordx4 v9, s[12:15], s32 offen offset:1024 lds
  v_mfma_f32_16x16x32_bf16 v[116:119], a[148:151], a[12:15], v[116:119]
  s_add_u32 s32, s32, s34
  v_mfma_f32_16x16x32_bf16 v[116:119], a[144:147], a[8:11], v[116:119]
  ds_read_b64_tr_b16 a[170:171], v21 offset:41472
  v_mfma_f32_16x16x32_bf16 v[120:123], a[144:147], a[16:19], v[120:123]
  ds_read_b128 a[92:95], v17 offset:38912
  v_mfma_f32_16x16x32_bf16 v[120:123], a[148:151], a[20:23], v[120:123]
  ds_read_b64_tr_b16 a[172:173], v21 offset:45056
  v_mfma_f32_16x16x32_bf16 v[124:127], a[148:151], a[28:31], v[124:127]
  ds_read_b64_tr_b16 a[174:175], v21 offset:45568
  v_mfma_f32_16x16x32_bf16 v[124:127], a[144:147], a[24:27], v[124:127]
  v_mfma_f32_16x16x32_bf16 v[128:131], a[144:147], a[32:35], v[128:131]
  v_mfma_f32_16x16x32_bf16 v[128:131], a[148:151], a[36:39], v[128:131]
  v_mfma_f32_16x16x32_bf16 v[132:135], a[148:151], a[44:47], v[132:135]
  v_mfma_f32_16x16x32_bf16 v[132:135], a[144:147], a[40:43], v[132:135]
  s_cmp_eq_u32 s87, 0
  v_mfma_f32_16x16x32_bf16 v[136:139], a[144:147], a[48:51], v[136:139]
  s_cbranch_scc1 L1_loopH_nt0_o
L1_loopH_nt0:
  v_mfma_f32_16x16x32_bf16 v[136:139], a[148:151], a[52:55], v[136:139]
  v_mfma_f32_16x16x32_bf16 v[140:143], a[148:151], a[60:63], v[140:143]
  v_mfma_f32_16x16x32_bf16 v[140:143], a[144:147], a[56:59], v[140:143]
  s_waitcnt vmcnt(10) lgkmcnt(0)
  s_barrier
  v_mfma_f32_16x16x32_bf16 v[144:147], a[152:155], a[0:3], v[144:147]
  ds_read_b64_tr_b16 a[128:129], v22 offset:8192
  v_mfma_f32_16x16x32_bf16 v[144:147], a[156:159], a[4:7], v[144:147]
  v_mfma_f32_16x16x32_bf16 v[148:151], a[156:159], a[12:15], v[148:151]
  s_add_u32 m0, s36, 0
  v_mfma_f32_16x16x32_bf16 v[148:151], a[152:155], a[8:11], v[148:151]
  buffer_load_dwordx4 v4, s[8:11], s31 offen offset:0 lds
  v_mfma_f32_16x16x32_bf16 v[152:155], a[152:155], a[16:19], v[152:155]
  ds_read_b64_tr_b16 a[130:131], v22 offset:8704
  v_mfma_f32_16x16x32_bf16 v[152:155], a[156:159], a[20:23], v[152:155]
  ds_read_b64_tr_b16 a[132:133], v22 offset:12288
  v_mfma_f32_16x16x32_bf16 v[156:159], a[156:159], a[28:31], v[156:159]
  v_mfma_f32_16x16x32_bf16 v[156:159], a[152:155], a[24:27], v[156:159]
  ds_read_b64_tr_b16 a[134:135], v22 offset:12800
  v_mfma_f32_16x16x32_bf16 v[160:163], a[152:155], a[32:35], v[160:163]
  buffer_load_dwordx4 v5, s[8:11], s31 offen offset:1024 lds
  v_mfma_f32_16x16x32_bf16 v[160:163], a[156:159], a[36:39], v[160:163]
  v_mfma_f32_16x16x32_bf16 v[164:167], a[156:159], a[44:47], v[164:167]
  ds_read_b128 a[96:99], v18 offset:0
  v_mfma_f32_16x16x32_bf16 v[164:167], a[152:155], a[40:43], v[164:167]
  v_mfma_f32_16x16x32_bf16 v[168:171], a[152:155], a[48:51], v[168:171]
  ds_read_b128 a[100:103], v19 offset:0
  v_mfma_f32_16x16x32_bf16 v[168:171], a[156:159], a[52:55], v[168:171]
  buffer_load_dwordx4 v6, s[8:11], s31 offen offset:2048 lds
  v_mfma_f32_16x16x32_bf16 v[172:175], a[156:159], a[60:63], v[172:175]
  v_mfma_f32_16x16x32_bf16 v[172:175], a[152:155], a[56:59], v[172:175]
  ds_read_b64_tr_b16 a[136:137], v23 offset:8192
  v_mfma_f32_16x16x32_bf16 v[176:179], a[160:163], a[0:3], v[176:179]
  v_mfma_f32_16x16x32_bf16 v[176:179], a[164:167], a[4:7], v[176:179]
  ds_read_b128 a[104:107], v18 offset:2048
  v_mfma_f32_16x16x32_bf16 v[180:183], a[164:167], a[12:15], v[180:183]
  buffer_load_dwordx4 v7, s[8:11], s31 offen offset:3072 lds
  v_mfma_f32_16x16x32_bf16 v[180:183], a[160:163], a[8:11], v[180:183]
  v_mfma_f32_16x16x32_bf16 v[184:187], a[160:163], a[16:19], v[184:187]
  ds_read_b128 a[108:111], v19 offset:2048
  v_mfma_f32_16x16x32_bf16 v[184:187], a[164:167], a[20:23], v[184:187]
  v_mfma_f32_16x16x32_bf16 v[188:191], a[164:167], a[28:31], v[188:191]
  s_add_u32 s31, s31, 128
  s_add_u32 m0, s36, 49152
  v_mfma_f32_16x16x32_bf16 v[188:191], a[160:163], a[24:27], v[188:191]
  buffer_load_dwordx4 v12, s[16:19], s33 offen offset:0 lds
  v_mfma_f32_16x16x32_bf16 v[192:195], a[160:163], a[32:35], v[192:195]
  ds_read_b64_tr_b16 a[138:139], v23 offset:8704
  v_mfma_f32_16x16x32_bf16 v[192:195], a[164:167], a[36:39], v[192:195]
  ds_read_b128 a[112:115], v18 offset:4096
  v_mfma_f32_16x16x32_bf16 v[196:199], a[164:167], a[44:47], v[196:199]
  v_mfma_f32_16x16x32_bf16 v[196:199], a[160:163], a[40:43], v[196:199]
  ds_read_b128 a[116:119], v19 offset:4096
  v_mfma_f32_16x16x32_bf16 v[200:203], a[160:163], a[48:51], v[200:203]
  buffer_load_dwordx4 v13, s[16:19], s33 offen offset:1024 lds
  v_mfma_f32_16x16x32_bf16 v[200:203], a[164:167], a[52:55], v[200:203]
  v_mfma_f32_16x16x32_bf16 v[204:207], a[164:167], a[60:63], v[204:207]
  ds_read_b64_tr_b16 a[140:141], v23 offset:12288
  v_mfma_f32_16x16x32_bf16 v[204:207], a[160:163], a[56:59], v[204:207]
  v_mfma_f32_16x16x32_bf16 v[208:211], a[168:171], a[0:3], v[208:211]
  ds_read_b128 a[120:123], v18 offset:6144
  v_mfma_f32_16x16x32_bf16 v[208:211], a[172:175], a[4:7], v[208:211]
  buffer_load_dwordx4 v14, s[16:19], s33 offen offset:2048 lds
  v_mfma_f32_16x16x32_bf16 v[212:215], a[172:175], a[12:15], v[212:215]
  v_mfma_f32_16x16x32_bf16 v[212:215], a[168:171], a[8:11], v[212:215]
  ds_read_b128 a[124:127], v19 offset:6144
  v_mfma_f32_16x16x32_bf16 v[216:219], a[168:171], a[16:19], v[216:219]
  v_mfma_f32_16x16x32_bf16 v[216:219], a[172:175], a[20:23], v[216:219]
  ds_read_b64_tr_b16 a[142:143], v23 offset:12800
  v_mfma_f32_16x16x32_bf16 v[220:223], a[172:175], a[28:31], v[220:223]
  buffer_load_dwordx4 v15, s[16:19], s33 offen offset:3072 lds
  v_mfma_f32_16x16x32_bf16 v[220:223], a[168:171], a[24:27], v[220:223]
  s_add_u32 s33, s33, s35
  v_mfma_f32_16x16x32_bf16 v[224:227], a[168:171], a[32:35], v[224:227]
  v_mfma_f32_16x16x32_bf16 v[224:227], a[172:175], a[36:39], v[224:227]
  v_mfma_f32_16x16x32_bf16 v[228:231], a[172:175], a[44:47], v[228:231]
  v_mfma_f32_16x16x32_bf16 v[228:231], a[168:171], a[40:43], v[228:231]
  s_cmp_eq_u32 s87, 1
  v_mfma_f32_16x16x32_bf16 v[232:235], a[168:171], a[48:51], v[232:235]
  s_cbranch_scc1 L1_loopH_nt1_o
L1_loopH_nt1:
  v_mfma_f32_16x16x32_bf16 v[232:235], a[172:175], a[52:55], v[232:235]
  v_mfma_f32_16x16x32_bf16 v[236:239], a[172:175], a[60:63], v[236:239]
  v_mfma_f32_16x16x32_bf16 v[236:239], a[168:171], a[56:59], v[236:239]
  s_waitcnt vmcnt(10) lgkmcnt(0)
  s_barrier
  v_mfma_f32_16x16x32_bf16 v[48:51], a[128:131], a[64:67], v[48:51]
  ds_read_b64_tr_b16 a[144:145], v22 offset:32768
  v_mfma_f32_16x16x32_bf16 v[48:51], a[132:135], a[68:71], v[48:51]
  ds_read_b64_tr_b16 a[146:147], v22 offset:33280
  v_mfma_f32_16x16x32_bf16 v[52:55], a[132:135], a[76:79], v[52:55]
  s_add_u32 m0, s36, 32768
  v_mfma_f32_16x16x32_bf16 v[52:55], a[128:131], a[72:75], v[52:55]
  buffer_load_dwordx4 v4, s[8:11], s30 offen offset:0 lds
  v_mfma_f32_16x16x32_bf16 v[56:59], a[128:131], a[80:83], v[56:59]
  ds_read_b64_tr_b16 a[148:149], v22 offset:36864
  v_mfma_f32_16x16x32_bf16 v[56:59], a[132:135], a[84:87], v[56:59]
  ds_read_b64_tr_b16 a[150:151], v22 offset:37376
  v_mfma_f32_16x16x32_bf16 v[60:63], a[132:135], a[92:95], v[60:63]
  ds_read_b128 a[0:3], v18 offset:32768
  v_mfma_f32_16x16x32_bf16 v[60:63], a[128:131], a[88:91], v[60:63]
  v_mfma_f32_16x16x32_bf16 v[64:67], a[128:131], a[96:99], v[64:67]
  ds_read_b64_tr_b16 a[152:153], v23 offset:32768
  v_mfma_f32_16x16x32_bf16 v[64:67], a[132:135], a[100:103], v[64:67]
  buffer_load_dwordx4 v5, s[8:11], s30 offen offset:1024 lds
  v_mfma_f32_16x16x32_bf16 v[68:71], a[132:135], a[108:111], v[68:71]
  ds_read_b128 a[4:7], v19 offset:32768
  v_mfma_f32_16x16x32_bf16 v[68:71], a[128:131], a[104:107], v[68:71]
  ds_read_b64_tr_b16 a[154:155], v23 offset:33280
  v_mfma_f32_16x16x32_bf16 v[72:75], a[128:131], a[112:115], v[72:75]
  v_mfma_f32_16x16x32_bf16 v[72:75], a[132:135], a[116:119], v[72:75]
  ds_read_b64_tr_b16 a[156:157], v23 offset:36864
  v_mfma_f32_16x16x32_bf16 v[76:79], a[132:135], a[124:127], v[76:79]
  v_mfma_f32_16x16x32_bf16 v[76:79], a[128:131], a[120:123], v[76:79]
  buffer_load_dwordx4 v6, s[8:11], s30 offen offset:2048 lds
  v_mfma_f32_16x16x32_bf16 v[80:83], a[136:139], a[64:67], v[80:83]
  ds_read_b128 a[8:11], v18 offset:34816
  v_mfma_f32_16x16x32_bf16 v[80:83], a[140:143], a[68:71], v[80:83]
  ds_read_b64_tr_b16 a[158:159], v23 offset:37376
  v_mfma_f32_16x16x32_bf16 v[84:87], a[140:143], a[76:79], v[84:87]
  ds_read_b128 a[12:15], v19 offset:34816
  v_mfma_f32_16x16x32_bf16 v[84:87], a[136:139], a[72:75], v[84:87]
  v_mfma_f32_16x16x32_bf16 v[88:91], a[136:139], a[80:83], v[88:91]
  ds_read_b64_tr_b16 a[160:161], v22 offset:40960
  v_mfma_f32_16x16x32_bf16 v[88:91], a[140:143], a[84:87], v[88:91]
  buffer_load_dwordx4 v7, s[8:11], s30 offen offset:3072 lds
  v_mfma_f32_16x16x32_bf16 v[92:95], a[140:143], a[92:95], v[92:95]
  ds_read_b64_tr_b16 a[162:163], v22 offset:41472
  v_mfma_f32_16x16x32_bf16 v[92:95], a[136:139], a[88:91], v[92:95]
  ds_read_b128 a[16:19], v18 offset:36864
  v_mfma_f32_16x16x32_bf16 v[96:99], a[136:139], a[96:99], v[96:99]
  v_mfma_f32_16x16x32_bf16 v[96:99], a[140:143], a[100:103], v[96:99]
  ds_read_b64_tr_b16 a[164:165], v22 offset:45056
  v_mfma_f32_16x16x32_bf16 v[100:103], a[140:143], a[108:111], v[100:103]
  s_add_u32 s30, s30, 128
  s_add_u32 m0, s42, 90112
  v_mfma_f32_16x16x32_bf16 v[100:103], a[136:139], a[104:107], v[100:103]
  buffer_load_dwordx4 v8, s[12:15], s32 offen offset:0 lds
  v_mfma_f32_16x16x32_bf16 v[104:107], a[136:139], a[112:115], v[104:107]
  ds_read_b128 a[20:23], v19 offset:36864
  v_mfma_f32_16x16x32_bf16 v[104:107], a[140:143], a[116:119], v[104:107]
  ds_read_b64_tr_b16 a[166:167], v22 offset:45568
  v_mfma_f32_16x16x32_bf16 v[108:111], a[140:143], a[124:127], v[108:111]
  ds_read_b64_tr_b16 a[168:169], v23 offset:40960
  v_mfma_f32_16x16x32_bf16 v[108:111], a[136:139], a[120:123], v[108:111]
  ds_read_b128 a[24:27], v18 offset:38912
  s_waitcnt lgkmcnt(15)
  v_mfma_f32_16x16x32_bf16 v[112:115], a[144:147], a[64:67], v[112:115]
  v_mfma_f32_16x16x32_bf16 v[112:115], a[148:151], a[68:71], v[112:115]
  buffer_load_dwordx4 v9, s[12:15], s32 offen offset:1024 lds
  v_mfma_f32_16x16x32_bf16 v[116:119], a[148:151], a[76:79], v[116:119]
  s_add_u32 s32, s32, s34
  v_mfma_f32_16x16x32_bf16 v[116:119], a[144:147], a[72:75], v[116:119]
  ds_read_b64_tr_b16 a[170:171], v23 offset:41472
  v_mfma_f32_16x16x32_bf16 v[120:123], a[144:147], a[80:83], v[120:123]
  ds_read_b128 a[28:31], v19 offset:38912
  v_mfma_f32_16x16x32_bf16 v[120:123], a[148:151], a[84:87], v[120:123]
  ds_read_b64_tr_b16 a[172:173], v23 offset:45056
  v_mfma_f32_16x16x32_bf16 v[124:127], a[148:151], a[92:95], v[124:127]
  ds_read_b64_tr_b16 a[174:175], v23 offset:45568
  v_mfma_f32_16x16x32_bf16 v[124:127], a[144:147], a[88:91], v[124:127]
  v_mfma_f32_16x16x32_bf16 v[128:131], a[144:147], a[96:99], v[128:131]
  v_mfma_f32_16x16x32_bf16 v[128:131], a[148:151], a[100:103], v[128:131]
  s_cmp_eq_u32 s37, 6
  v_mfma_f32_16x16x32_bf16 v[132:135], a[148:151], a[108:111], v[132:135]
  s_cbranch_scc1 L1_loopH_nd_o
L1_loopH_nd:
  v_mfma_f32_16x16x32_bf16 v[132:135], a[144:147], a[104:107], v[132:135]
  s_cmp_eq_u32 s87, 2
  v_mfma_f32_16x16x32_bf16 v[136:139], a[144:147], a[112:115], v[136:139]
  s_cbranch_scc1 L1_loopH_nt2_o
L1_loopH_nt2:
  v_mfma_f32_16x16x32_bf16 v[136:139], a[148:151], a[116:119], v[136:139]
  v_mfma_f32_16x16x32_bf16 v[140:143], a[148:151], a[124:127], v[140:143]
  v_mfma_f32_16x16x32_bf16 v[140:143], a[144:147], a[120:123], v[140:143]
  s_waitcnt vmcnt(10) lgkmcnt(0)
  s_barrier
  v_mfma_f32_16x16x32_bf16 v[144:147], a[152:155], a[64:67], v[144:147]
  ds_read_b64_tr_b16 a[128:129], v20 offset:8192
  v_mfma_f32_16x16x32_bf16 v[144:147], a[156:159], a[68:71], v[144:147]
  v_mfma_f32_16x16x32_bf16 v[148:151], a[156:159], a[76:79], v[148:151]
  s_add_u32 m0, s36, 65536
  v_mfma_f32_16x16x32_bf16 v[148:151], a[152:155], a[72:75], v[148:151]
  buffer_load_dwordx4 v4, s[8:11], s31 offen offset:0 lds
  v_mfma_f32_16x16x32_bf16 v[152:155], a[152:155], a[80:83], v[152:155]
  ds_read_b64_tr_b16 a[130:131], v20 offset:8704
  v_mfma_f32_16x16x32_bf16 v[152:155], a[156:159], a[84:87], v[152:155]
  ds_read_b64_tr_b16 a[132:133], v20 offset:12288
  v_mfma_f32_16x16x32_bf16 v[156:159], a[156:159], a[92:95], v[156:159]
  v_mfma_f32_16x16x32_bf16 v[156:159], a[152:155], a[88:91], v[156:159]
  ds_read_b64_tr_b16 a[134:135], v20 offset:12800
  v_mfma_f32_16x16x32_bf16 v[160:163], a[152:155], a[96:99], v[160:163]
  buffer_load_dwordx4 v5, s[8:11], s31 offen offset:1024 lds
  v_mfma_f32_16x16x32_bf16 v[160:163], a[156:159], a[100:103], v[160:163]
  v_mfma_f32_16x16x32_bf16 v[164:167], a[156:159], a[108:111], v[164:167]
  ds_read_b128 a[32:35], v16 offset:0
  v_mfma_f32_16x16x32_bf16 v[164:167], a[152:155], a[104:107], v[164:167]
  v_mfma_f32_16x16x32_bf16 v[168:171], a[152:155], a[112:115], v[168:171]
  ds_read_b128 a[36:39], v17 offset:0
  v_mfma_f32_16x16x32_bf16 v[168:171], a[156:159], a[116:119], v[168:171]
  buffer_load_dwordx4 v6, s[8:11], s31 offen offset:2048 lds
  v_mfma_f32_16x16x32_bf16 v[172:175], a[156:159], a[124:127], v[172:175]
  v_mfma_f32_16x16x32_bf16 v[172:175], a[152:155], a[120:123], v[172:175]
  ds_read_b64_tr_b16 a[136:137], v21 offset:8192
  v_mfma_f32_16x16x32_bf16 v[176:179], a[160:163], a[64:67], v[176:179]
  v_mfma_f32_16x16x32_bf16 v[176:179], a[164:167], a[68:71], v[176:179]
  ds_read_b128 a[40:43], v16 offset:2048
  v_mfma_f32_16x16x32_bf16 v[180:183], a[164:167], a[76:79], v[180:183]
  buffer_load_dwordx4 v7, s[8:11], s31 offen offset:3072 lds
  v_mfma_f32_16x16x32_bf16 v[180:183], a[160:163], a[72:75], v[180:183]
  v_mfma_f32_16x16x32_bf16 v[184:187], a[160:163], a[80:83], v[184:187]
  ds_read_b128 a[44:47], v17 offset:2048
  v_mfma_f32_16x16x32_bf16 v[184:187], a[164:167], a[84:87], v[184:187]
  v_mfma_f32_16x16x32_bf16 v[188:191], a[164:167], a[92:95], v[188:191]
  s_add_u32 s31, s31, 128
  s_add_u32 m0, s36, 114688
  v_mfma_f32_16x16x32_bf16 v[188:191], a[160:163], a[88:91], v[188:191]
  buffer_load_dwordx4 v12, s[16:19], s33 offen offset:0 lds
  v_mfma_f32_16x16x32_bf16 v[192:195], a[160:163], a[96:99], v[192:195]
  ds_read_b64_tr_b16 a[138:139], v21 offset:8704
  v_mfma_f32_16x16x32_bf16 v[192:195], a[164:167], a[100:103], v[192:195]
  ds_read_b128 a[48:51], v16 offset:4096
  v_mfma_f32_16x16x32_bf16 v[196:199], a[164:167], a[108:111], v[196:199]
  v_mfma_f32_16x16x32_bf16 v[196:199], a[160:163], a[104:107], v[196:199]
  ds_read_b128 a[52:55], v17 offset:4096
  v_mfma_f32_16x16x32_bf16 v[200:203], a[160:163], a[112:115], v[200:203]
  buffer_load_dwordx4 v13, s[16:19], s33 offen offset:1024 lds
  v_mfma_f32_16x16x32_bf16 v[200:203], a[164:167], a[116:119], v[200:203]
  v_mfma_f32_16x16x32_bf16 v[204:207], a[164:167], a[124:127], v[204:207]
  ds_read_b64_tr_b16 a[140:141], v21 offset:12288
  v_mfma_f32_16x16x32_bf16 v[204:207], a[160:163], a[120:123], v[204:207]
  v_mfma_f32_16x16x32_bf16 v[208:211], a[168:171], a[64:67], v[208:211]
  ds_read_b128 a[56:59], v16 offset:6144
  v_mfma_f32_16x16x32_bf16 v[208:211], a[172:175], a[68:71], v[208:211]
  buffer_load_dwordx4 v14, s[16:19], s33 offen offset:2048 lds
  v_mfma_f32_16x16x32_bf16 v[212:215], a[172:175], a[76:79], v[212:215]
  v_mfma_f32_16x16x32_bf16 v[212:215], a[168:171], a[72:75], v[212:215]
  ds_read_b128 a[60:63], v17 offset:6144
  v_mfma_f32_16x16x32_bf16 v[216:219], a[168:171], a[80:83], v[216:219]
  v_mfma_f32_16x16x32_bf16 v[216:219], a[172:175], a[84:87], v[216:219]
  ds_read_b64_tr_b16 a[142:143], v21 offset:12800
  v_mfma_f32_16x16x32_bf16 v[220:223], a[172:175], a[92:95], v[220:223]
  buffer_load_dwordx4 v15, s[16:19], s33 offen offset:3072 lds
  v_mfma_f32_16x16x32_bf16 v[220:223], a[168:171], a[88:91], v[220:223]
  s_add_u32 s33, s33, s35
  v_mfma_f32_16x16x32_bf16 v[224:227], a[168:171], a[96:99], v[224:227]
  v_mfma_f32_16x16x32_bf16 v[224:227], a[172:175], a[100:103], v[224:227]
  v_mfma_f32_16x16x32_bf16 v[228:231], a[172:175], a[108:111], v[228:231]
  v_mfma_f32_16x16x32_bf16 v[228:231], a[168:171], a[104:107], v[228:231]
  s_cmp_eq_u32 s87, 3
  v_mfma_f32_16x16x32_bf16 v[232:235], a[168:171], a[112:115], v[232:235]
  s_cbranch_scc1 L1_loopH_nt3_o
L1_loopH_nt3:
  v_mfma_f32_16x16x32_bf16 v[232:235], a[172:175], a[116:119], v[232:235]
  s_add_u32 s37, s37, 1
  v_mfma_f32_16x16x32_bf16 v[236:239], a[172:175], a[124:127], v[236:239]
  s_cmp_lt_u32 s37, 7
  v_mfma_f32_16x16x32_bf16 v[236:239], a[168:171], a[120:123], v[236:239]
  s_waitcnt vmcnt(10) lgkmcnt(0)
  s_barrier
  s_cbranch_scc1 L1_loopH
  v_mfma_f32_16x16x32_bf16 v[48:51], a[128:131], a[0:3], v[48:51]
  s_getpc_b64 s[88:89]
L1_loopH_cp:
  s_add_u32 s88, s88, L2_entryH-L1_loopH_cp
  s_addc_u32 s89, s89, 0
  v_and_b32 v29, 7, v1
  v_mfma_f32_16x16x32_bf16 v[48:51], a[132:135], a[4:7], v[48:51]
  s_mov_b32 s90, L2_endH-L2_entryH
  s_bfe_u32 s6, s86, 0x20003
  s_lshr_b32 s3, s86, 6
  v_lshrrev_b32 v30, 4, v1
  v_mfma_f32_16x16x32_bf16 v[52:55], a[132:135], a[12:15], v[52:55]
  s_lshl_b32 s3, s3, 2
  v_lshl_add_u32 v29, v30, 3, v29
  v_lshlrev_b32 v29, 4, v29
  v_bfe_u32 v30, v1, 3, 1
  v_mfma_f32_16x16x32_bf16 v[52:55], a[128:131], a[8:11], v[52:55]
  s_add_u32 s6, s6, s3
  s_lshl_b32 s3, s6, 2
  v_lshl_add_u32 v30, v30, 11, v29
  v_mfma_f32_16x16x32_bf16 v[56:59], a[128:131], a[16:19], v[56:59]
  s_add_u32 s3, s3, s24
  s_lshl_b32 s92, s3, 9
  v_add_u32 v31, 4096, v30
  v_mfma_f32_16x16x32_bf16 v[56:59], a[132:135], a[20:23], v[56:59]
  v_lshlrev_b32 v3, 7, v1
  s_lshr_b32 s87, s52, 1
  s_lshl_b32 s87, s87, 2
  v_mfma_f32_16x16x32_bf16 v[60:63], a[132:135], a[28:31], v[60:63]
  s_mov_b64 exec, 15
  buffer_load_dword a255, v3, s[88:91], s92 offen
  s_mov_b64 exec, -1
  v_mfma_f32_16x16x32_bf16 v[60:63], a[128:131], a[24:27], v[60:63]
  s_add_u32 s87, s87, s24
  s_lshl_b32 s87, s87, 13
  ds_read_b64_tr_b16 a[144:145], v20 offset:32768
  v_mfma_f32_16x16x32_bf16 v[64:67], a[128:131], a[32:35], v[64:67]
  ds_read_b64_tr_b16 a[146:147], v20 offset:33280
  ds_read_b64_tr_b16 a[148:149], v20 offset:36864
  ds_read_b64_tr_b16 a[150:151], v20 offset:37376
  v_mfma_f32_16x16x32_bf16 v[64:67], a[132:135], a[36:39], v[64:67]
  buffer_load_dwordx4 a[192:195], v30, s[8:11], s87 offen offset:0
  ds_read_b128 a[64:67], v16 offset:32768
  v_mfma_f32_16x16x32_bf16 v[68:71], a[132:135], a[44:47], v[68:71]
  ds_read_b64_tr_b16 a[152:153], v21 offset:32768
  ds_read_b128 a[68:71], v17 offset:32768
  ds_read_b64_tr_b16 a[154:155], v21 offset:33280
  v_mfma_f32_16x16x32_bf16 v[68:71], a[128:131], a[40:43], v[68:71]
  ds_read_b64_tr_b16 a[156:157], v21 offset:36864
  ds_read_b128 a[72:75], v16 offset:34816
  ds_read_b64_tr_b16 a[158:159], v21 offset:37376
  v_mfma_f32_16x16x32_bf16 v[72:75], a[128:131], a[48:51], v[72:75]
  buffer_load_dwordx4 a[208:211], v29, s[64:67], 0 offen offset:0
  ds_read_b128 a[76:79], v17 offset:34816
  v_mfma_f32_16x16x32_bf16 v[72:75], a[132:135], a[52:55], v[72:75]
  ds_read_b64_tr_b16 a[160:161], v20 offset:40960
  ds_read_b64_tr_b16 a[162:163], v20 offset:41472
  s_mov_b32 s12, s46
  v_mfma_f32_16x16x32_bf16 v[76:79], a[132:135], a[60:63], v[76:79]
  ds_read_b128 a[80:83], v16 offset:36864
  s_mov_b32 s13, s47
  s_mov_b32 s14, 7340032
  v_mfma_f32_16x16x32_bf16 v[76:79], a[128:131], a[56:59], v[76:79]
  ds_read_b64_tr_b16 a[164:165], v20 offset:45056
  s_and_b32 s41, s1, 3
  s_lshr_b32 s40, s1, 5
  v_mfma_f32_16x16x32_bf16 v[80:83], a[136:139], a[0:3], v[80:83]
  buffer_load_dwordx4 a[224:227], v31, s[8:11], s87 offen offset:0
  ds_read_b128 a[84:87], v17 offset:36864
  v_mfma_f32_16x16x32_bf16 v[80:83], a[140:143], a[4:7], v[80:83]
  ds_read_b64_tr_b16 a[166:167], v20 offset:45568
  s_lshl_b32 s42, s24, 11
  s_lshl_b32 s3, s40, 1
  v_mfma_f32_16x16x32_bf16 v[84:87], a[140:143], a[12:15], v[84:87]
  ds_read_b64_tr_b16 a[168:169], v21 offset:40960
  s_and_b32 s4, s41, 1
  s_add_u32 s3, s3, s4
  v_mfma_f32_16x16x32_bf16 v[84:87], a[136:139], a[8:11], v[84:87]
  buffer_load_dwordx4 a[196:199], v30, s[8:11], s87 offen offset:512
  ds_read_b128 a[88:91], v16 offset:38912
  v_mfma_f32_16x16x32_bf16 v[88:91], a[136:139], a[16:19], v[88:91]
  ds_read_b64_tr_b16 a[170:171], v21 offset:41472
  s_lshl_b32 s43, s3, 7
  s_lshl_b32 s3, s24, 15
  v_mfma_f32_16x16x32_bf16 v[88:91], a[140:143], a[20:23], v[88:91]
  ds_read_b128 a[92:95], v17 offset:38912
  s_add_u32 s35, s3, s43
  s_mul_i32 s7, s41, 14
  v_mfma_f32_16x16x32_bf16 v[92:95], a[140:143], a[28:31], v[92:95]
  ds_read_b64_tr_b16 a[172:173], v21 offset:45056
  s_add_u32 s7, s7, 0
  s_lshl_b32 s5, s7, 17
  v_mfma_f32_16x16x32_bf16 v[92:95], a[136:139], a[24:27], v[92:95]
  buffer_load_dwordx4 a[212:215], v29, s[64:67], 0 offen offset:512
  ds_read_b64_tr_b16 a[174:175], v21 offset:45568
  v_mfma_f32_16x16x32_bf16 v[96:99], a[136:139], a[32:35], v[96:99]
  s_add_u32 s34, s35, s5
  s_xor_b32 s33, s34, 128
  v_lshrrev_b32 v6, 3, v1
  v_mfma_f32_16x16x32_bf16 v[96:99], a[140:143], a[36:39], v[96:99]
  v_lshrrev_b32 v7, 4, v1
  v_and_b32 v8, 7, v1
  v_lshlrev_b32 v7, 1, v7
  v_mfma_f32_16x16x32_bf16 v[100:103], a[140:143], a[44:47], v[100:103]
  buffer_load_dwordx4 a[228:231], v31, s[8:11], s87 offen offset:512
  v_xor_b32 v7, v7, v8
  v_mfma_f32_16x16x32_bf16 v[100:103], a[136:139], a[40:43], v[100:103]
  v_lshlrev_b32 v7, 4, v7
  v_lshl_add_u32 v4, v6, 11, v7
  v_add_u32 v5, 15360, v4
  v_mfma_f32_16x16x32_bf16 v[104:107], a[136:139], a[48:51], v[104:107]
  v_mov_b32 v15, 1
  v_add_u32 v6, 40, v1
  v_lshrrev_b32 v6, 6, v6
  v_mfma_f32_16x16x32_bf16 v[104:107], a[140:143], a[52:55], v[104:107]
  v_lshl_add_u32 v3, v6, 7, v2
  s_lshl_b32 s3, s25, 4
  s_lshl_b32 s5, s24, 1
  v_mfma_f32_16x16x32_bf16 v[108:111], a[140:143], a[60:63], v[108:111]
  buffer_load_dwordx4 a[200:203], v30, s[8:11], s87 offen offset:1024
  s_add_u32 s3, s3, s5
  s_waitcnt vmcnt(12) lgkmcnt(0)
  s_barrier
  v_mfma_f32_16x16x32_bf16 v[108:111], a[136:139], a[56:59], v[108:111]
  ds_read_b128 a[96:99], v18 offset:0
  s_lshl_b32 s5, s41, 2
  s_and_b32 s5, s5, 8
  v_mfma_f32_16x16x32_bf16 v[112:115], a[144:147], a[0:3], v[112:115]
  ds_read_b128 a[100:103], v19 offset:0
  s_add_u32 s5, s3, s5
  s_xor_b32 s6, s5, 8
  v_mfma_f32_16x16x32_bf16 v[112:115], a[148:151], a[4:7], v[112:115]
  s_mul_i32 s5, s5, 294912
  v_mfma_f32_16x16x32_bf16 v[116:119], a[148:151], a[12:15], v[116:119]
  buffer_load_dwordx4 a[216:219], v29, s[64:67], 0 offen offset:1024
  ds_read_b64_tr_b16 a[128:129], v22 offset:8192
  v_mfma_f32_16x16x32_bf16 v[116:119], a[144:147], a[8:11], v[116:119]
  s_mul_i32 s6, s6, 294912
  s_lshl_b32 s7, s7, 12
  s_add_u32 s32, s5, 229376
  v_mfma_f32_16x16x32_bf16 v[120:123], a[144:147], a[16:19], v[120:123]
  ds_read_b64_tr_b16 a[130:131], v22 offset:8704
  s_add_u32 s30, s5, s7
  v_mfma_f32_16x16x32_bf16 v[120:123], a[148:151], a[20:23], v[120:123]
  buffer_load_dwordx4 a[232:235], v31, s[8:11], s87 offen offset:1024
  ds_read_b64_tr_b16 a[132:133], v22 offset:12288
  s_add_u32 s31, s6, s7
  v_mfma_f32_16x16x32_bf16 v[124:127], a[148:151], a[28:31], v[124:127]
  v_mfma_f32_16x16x32_bf16 v[124:127], a[144:147], a[24:27], v[124:127]
  ds_read_b64_tr_b16 a[134:135], v22 offset:12800
  v_cmp_eq_u32 vcc, 0, v47
  v_cmp_ne_u32 s[6:7], s53, v47
  v_mfma_f32_16x16x32_bf16 v[128:131], a[144:147], a[32:35], v[128:131]
  s_nop 0
  v_mfma_f32_16x16x32_bf16 v[128:131], a[148:151], a[36:39], v[128:131]
  buffer_load_dwordx4 a[204:207], v30, s[8:11], s87 offen offset:1536
  ds_read_b128 a[104:107], v18 offset:2048
  s_cmp_lg_u64 vcc, 0
  s_cbranch_scc1 L1_loopH_is
L1_loopH_ir:
  v_mfma_f32_16x16x32_bf16 v[132:135], a[148:151], a[44:47], v[132:135]
  ds_read_b128 a[108:111], v19 offset:2048
  s_cmp_lg_u64 s[6:7], 0
  s_cselect_b32 s0, 0, 1
  v_mfma_f32_16x16x32_bf16 v[132:135], a[144:147], a[40:43], v[132:135]
  s_bfe_u32 s6, s86, 0x20003
  s_lshr_b32 s3, s86, 6
  s_lshl_b32 s3, s3, 2
  s_add_u32 s6, s6, s3
  s_mul_i32 s4, s41, 28
  s_lshl_b32 s3, s24, 4
  s_add_u32 s3, s3, s6
  s_cmp_lt_u32 s3, 28
  s_cbranch_scc0 L1_loopH_r3
  v_lshrrev_b32 v36, 1, v1
  v_and_b32 v37, 1, v1
  v_lshlrev_b32 v36, 11, v36
  v_lshl_add_u32 v36, v37, 10, v36
  s_add_u32 s3, s3, s4
  s_lshl_b32 s3, s3, 16
  buffer_load_dword a255, v36, s[12:15], s3 offen offset:384
L1_loopH_r3:
  v_mfma_f32_16x16x32_bf16 v[136:139], a[144:147], a[48:51], v[136:139]
  buffer_load_dwordx4 a[220:223], v29, s[64:67], 0 offen offset:1536
  ds_read_b64_tr_b16 a[136:137], v23 offset:8192
  v_mfma_f32_16x16x32_bf16 v[136:139], a[148:151], a[52:55], v[136:139]
  s_lshl_b32 s4, s29, 1
  s_lshl_b32 s5, s25, 4
  s_lshl_b32 s6, s38, 3
  v_mfma_f32_16x16x32_bf16 v[140:143], a[148:151], a[60:63], v[140:143]
  ds_read_b128 a[112:115], v18 offset:4096
  s_add_u32 s5, s5, s6
  v_mfma_f32_16x16x32_bf16 v[140:143], a[144:147], a[56:59], v[140:143]
  ds_read_b64_tr_b16 a[138:139], v23 offset:8704
  s_add_u32 s5, s5, s4
  v_mfma_f32_16x16x32_bf16 v[144:147], a[152:155], a[0:3], v[144:147]
  buffer_load_dwordx4 a[236:239], v31, s[8:11], s87 offen offset:1536
  s_xor_b32 s88, s5, 0
  v_mfma_f32_16x16x32_bf16 v[144:147], a[156:159], a[4:7], v[144:147]
  ds_read_b128 a[116:119], v19 offset:4096
  s_mul_i32 s88, s88, 294912
  v_mfma_f32_16x16x32_bf16 v[148:151], a[156:159], a[12:15], v[148:151]
  s_xor_b32 s89, s5, 1
  s_mul_i32 s89, s89, 294912
  v_mfma_f32_16x16x32_bf16 v[148:151], a[152:155], a[8:11], v[148:151]
  ds_read_b128 a[120:123], v18 offset:6144
  s_xor_b32 s90, s5, 2
  v_mfma_f32_16x16x32_bf16 v[152:155], a[152:155], a[16:19], v[152:155]
  s_mov_b32 s8, s96
  s_mov_b32 s9, s97
  s_add_u32 m0, s42, 40960
  v_mfma_f32_16x16x32_bf16 v[152:155], a[156:159], a[20:23], v[152:155]
  s_mov_b32 s10, 2097152
  buffer_load_dwordx4 v4, s[12:15], s33 offen offset:0 lds
  v_mfma_f32_16x16x32_bf16 v[156:159], a[156:159], a[28:31], v[156:159]
  ds_read_b64_tr_b16 a[140:141], v23 offset:12288
  ds_read_b128 a[124:127], v19 offset:6144
  s_mul_i32 s90, s90, 294912
  v_mfma_f32_16x16x32_bf16 v[156:159], a[152:155], a[24:27], v[156:159]
  s_xor_b32 s91, s5, 3
  s_mul_i32 s91, s91, 294912
  s_xor_b32 s92, s5, 4
  v_mfma_f32_16x16x32_bf16 v[160:163], a[152:155], a[32:35], v[160:163]
  ds_read_b64_tr_b16 a[142:143], v23 offset:12800
  s_mul_i32 s92, s92, 294912
  s_xor_b32 s93, s5, 5
  v_mfma_f32_16x16x32_bf16 v[160:163], a[156:159], a[36:39], v[160:163]
  s_mul_i32 s93, s93, 294912
  v_mfma_f32_16x16x32_bf16 v[164:167], a[156:159], a[44:47], v[164:167]
  buffer_load_dwordx4 v5, s[12:15], s33 offen offset:1024 lds
  s_xor_b32 s98, s5, 6
  s_branch L_stubHs2
L_stubH2:
  s_setpc_b64 s[4:5]
L_stubHs2:
  v_mfma_f32_16x16x32_bf16 v[164:167], a[152:155], a[40:43], v[164:167]
  s_add_u32 s33, s33, 393216
  s_mul_i32 s98, s98, 294912
  v_mfma_f32_16x16x32_bf16 v[168:171], a[152:155], a[48:51], v[168:171]
  s_xor_b32 s99, s5, 7
  v_mfma_f32_16x16x32_bf16 v[168:171], a[156:159], a[52:55], v[168:171]
  s_mul_i32 s99, s99, 294912
  v_mfma_f32_16x16x32_bf16 v[172:175], a[156:159], a[60:63], v[172:175]
  s_bfe_u32 s6, s86, 0x20003
  s_lshr_b32 s3, s86, 6
  s_lshl_b32 s3, s3, 2
  s_add_u32 s6, s6, s3
  s_and_b32 s4, s41, 1
  s_xor_b32 s3, s24, 2
  s_xor_b32 s4, s4, 1
  s_or_b32 s3, s3, s4
  s_lshl_b32 s3, s3, 4
  s_add_u32 s3, s3, s6
  s_cmp_lt_u32 s3, 12
  s_cbranch_scc0 L1_loopH_r4
  v_lshrrev_b32 v36, 1, v1
  v_and_b32 v37, 1, v1
  v_lshlrev_b32 v36, 11, v36
  v_lshl_add_u32 v36, v37, 10, v36
  s_add_u32 s3, s3, 20
  s_lshl_b32 s3, s3, 16
  buffer_load_dword a255, v36, s[8:11], s3 offen offset:384
L1_loopH_r4:
  v_mfma_f32_16x16x32_bf16 v[172:175], a[152:155], a[56:59], v[172:175]
  s_waitcnt vmcnt(15) lgkmcnt(0)
  s_barrier
  v_mfma_f32_16x16x32_bf16 v[48:51], a[128:131], a[64:67], v[48:51]
  s_add_u32 m0, s42, 65536
  ds_read_b64_tr_b16 a[144:145], v22 offset:32768
  s_lshl_b32 s4, s51, 1
  v_mfma_f32_16x16x32_bf16 v[48:51], a[132:135], a[68:71], v[48:51]
  buffer_load_dwordx4 v4, s[12:15], s34 offen offset:0 lds
  ds_read_b64_tr_b16 a[146:147], v22 offset:33280
  s_add_u32 s4, s4, s39
  v_mfma_f32_16x16x32_bf16 v[80:83], a[140:143], a[68:71], v[80:83]
  ds_read_b64_tr_b16 a[148:149], v22 offset:36864
  s_lshl_b32 s50, s4, 11
  v_mfma_f32_16x16x32_bf16 v[80:83], a[136:139], a[64:67], v[80:83]
  ds_read_b64_tr_b16 a[150:151], v22 offset:37376
  v_mfma_f32_16x16x32_bf16 v[52:55], a[128:131], a[72:75], v[52:55]
  buffer_load_dwordx4 v5, s[12:15], s34 offen offset:1024 lds
  v_mfma_f32_16x16x32_bf16 v[52:55], a[132:135], a[76:79], v[52:55]
  ds_read_b64_tr_b16 a[152:153], v23 offset:32768
  v_mfma_f32_16x16x32_bf16 v[84:87], a[140:143], a[76:79], v[84:87]
  ds_read_b64_tr_b16 a[154:155], v23 offset:33280
  v_add_u32 v252, 1024, v3
  v_add_u32 v253, 292864, v3
  v_mfma_f32_16x16x32_bf16 v[84:87], a[136:139], a[72:75], v[84:87]
  s_add_u32 s34, s34, 393216
  s_add_u32 m0, s42, 90112
  ds_read_b64_tr_b16 a[156:157], v23 offset:36864
  v_mfma_f32_16x16x32_bf16 v[56:59], a[128:131], a[80:83], v[56:59]
  buffer_load_dwordx4 v4, s[12:15], s33 offen offset:0 lds
  ds_read_b64_tr_b16 a[158:159], v23 offset:37376
  v_mfma_f32_16x16x32_bf16 v[56:59], a[132:135], a[84:87], v[56:59]
  v_add_u32 v254, 293888, v3
  v_add_u32 v255, 4096, v3
  v_add_u32 v20, s50, v3
  v_mfma_f32_16x16x32_bf16 v[88:91], a[140:143], a[84:87], v[88:91]
  ds_read_b64_tr_b16 a[176:177], v22 offset:40960
  v_add_u32 v19, 4096, v20
  v_add_u32 v21, 8192, v20
  v_mfma_f32_16x16x32_bf16 v[88:91], a[136:139], a[80:83], v[88:91]
  ds_read_b64_tr_b16 a[178:179], v22 offset:41472
  v_cvt_pk_bf16_f32 v24, v48, v49
  v_cvt_pk_bf16_f32 v25, v50, v51
  v_mfma_f32_16x16x32_bf16 v[60:63], a[128:131], a[88:91], v[60:63]
  buffer_load_dwordx4 v5, s[12:15], s33 offen offset:1024 lds
  ds_read_b64_tr_b16 a[180:181], v22 offset:45056
  v_mfma_f32_16x16x32_bf16 v[60:63], a[132:135], a[92:95], v[60:63]
  s_add_u32 s33, s33, 524288
  ds_read_b64_tr_b16 a[182:183], v22 offset:45568
  v_cvt_pk_bf16_f32 v26, v80, v81
  v_mfma_f32_16x16x32_bf16 v[92:95], a[140:143], a[92:95], v[92:95]
  ds_read_b64_tr_b16 a[184:185], v23 offset:40960
  v_cvt_pk_bf16_f32 v27, v82, v83
  v_pk_max_i16 v24, v24, 0
  v_mfma_f32_16x16x32_bf16 v[92:95], a[136:139], a[88:91], v[92:95]
  ds_read_b64_tr_b16 a[186:187], v23 offset:41472
  v_pk_max_i16 v25, v25, 0
  v_pk_max_i16 v26, v26, 0
  v_mfma_f32_16x16x32_bf16 v[64:67], a[128:131], a[96:99], v[64:67]
  ds_read_b64_tr_b16 a[188:189], v23 offset:45056
  v_pk_max_i16 v27, v27, 0
  v_mfma_f32_16x16x32_bf16 v[64:67], a[132:135], a[100:103], v[64:67]
  ds_read_b64_tr_b16 a[190:191], v23 offset:45568
  buffer_store_dwordx4 v[24:27], v20, s[20:23], s88 offen offset:0 sc1
  v_mfma_f32_16x16x32_bf16 v[96:99], a[140:143], a[100:103], v[96:99]
  v_cvt_pk_bf16_f32 v28, v52, v53
  v_cvt_pk_bf16_f32 v29, v54, v55
  v_cvt_pk_bf16_f32 v30, v84, v85
  v_mfma_f32_16x16x32_bf16 v[96:99], a[136:139], a[96:99], v[96:99]
  v_cvt_pk_bf16_f32 v31, v86, v87
  v_pk_max_i16 v28, v28, 0
  v_pk_max_i16 v29, v29, 0
  v_mfma_f32_16x16x32_bf16 v[68:71], a[128:131], a[104:107], v[68:71]
  v_pk_max_i16 v30, v30, 0
  v_pk_max_i16 v31, v31, 0
  v_mfma_f32_16x16x32_bf16 v[68:71], a[132:135], a[108:111], v[68:71]
  buffer_store_dwordx4 v[28:31], v20, s[20:23], s89 offen offset:0 sc1
  v_cvt_pk_bf16_f32 v32, v56, v57
  v_mfma_f32_16x16x32_bf16 v[100:103], a[140:143], a[108:111], v[100:103]
  v_cvt_pk_bf16_f32 v33, v58, v59
  v_cvt_pk_bf16_f32 v34, v88, v89
  v_cvt_pk_bf16_f32 v35, v90, v91
  v_mfma_f32_16x16x32_bf16 v[100:103], a[136:139], a[104:107], v[100:103]
  v_pk_max_i16 v32, v32, 0
  v_pk_max_i16 v33, v33, 0
  v_pk_max_i16 v34, v34, 0
  v_mfma_f32_16x16x32_bf16 v[72:75], a[128:131], a[112:115], v[72:75]
  v_pk_max_i16 v35, v35, 0
  buffer_store_dwordx4 v[32:35], v20, s[20:23], s90 offen offset:0 sc1
  s_waitcnt lgkmcnt(0)
  s_barrier
  v_mfma_f32_16x16x32_bf16 v[72:75], a[132:135], a[116:119], v[72:75]
  s_add_u32 m0, s42, 114688
  v_cvt_pk_bf16_f32 v36, v60, v61
  v_cvt_pk_bf16_f32 v37, v62, v63
  v_mfma_f32_16x16x32_bf16 v[104:107], a[140:143], a[116:119], v[104:107]
  buffer_load_dwordx4 v4, s[12:15], s34 offen offset:0 lds
  v_cvt_pk_bf16_f32 v38, v92, v93
  v_mfma_f32_16x16x32_bf16 v[104:107], a[136:139], a[112:115], v[104:107]
  v_cvt_pk_bf16_f32 v39, v94, v95
  v_pk_max_i16 v36, v36, 0
  v_pk_max_i16 v37, v37, 0
  v_mfma_f32_16x16x32_bf16 v[76:79], a[128:131], a[120:123], v[76:79]
  v_pk_max_i16 v38, v38, 0
  v_pk_max_i16 v39, v39, 0
  v_mfma_f32_16x16x32_bf16 v[76:79], a[132:135], a[124:127], v[76:79]
  buffer_load_dwordx4 v5, s[12:15], s34 offen offset:1024 lds
  v_mfma_f32_16x16x32_bf16 v[108:111], a[140:143], a[124:127], v[108:111]
  buffer_store_dwordx4 v[36:39], v20, s[20:23], s91 offen offset:0 sc1
  v_cvt_pk_bf16_f32 v24, v64, v65
  v_mfma_f32_16x16x32_bf16 v[108:111], a[136:139], a[120:123], v[108:111]
  v_cvt_pk_bf16_f32 v25, v66, v67
  v_cvt_pk_bf16_f32 v26, v96, v97
  v_cvt_pk_bf16_f32 v27, v98, v99
  v_mfma_f32_16x16x32_bf16 v[112:115], a[144:147], a[64:67], v[112:115]
  s_add_u32 s34, s34, 524288
  s_add_u32 m0, s42, 139264
  v_pk_max_i16 v24, v24, 0
  v_mfma_f32_16x16x32_bf16 v[112:115], a[148:151], a[68:71], v[112:115]
  buffer_load_dwordx4 v4, s[12:15], s33 offen offset:0 lds
  v_pk_max_i16 v25, v25, 0
  v_mfma_f32_16x16x32_bf16 v[144:147], a[156:159], a[68:71], v[144:147]
  v_pk_max_i16 v26, v26, 0
  v_pk_max_i16 v27, v27, 0
  v_mfma_f32_16x16x32_bf16 v[144:147], a[152:155], a[64:67], v[144:147]
  buffer_store_dwordx4 v[24:27], v20, s[20:23], s92 offen offset:0 sc1
  v_cvt_pk_bf16_f32 v28, v68, v69
  v_mfma_f32_16x16x32_bf16 v[116:119], a[144:147], a[72:75], v[116:119]
  v_cvt_pk_bf16_f32 v29, v70, v71
  v_cvt_pk_bf16_f32 v30, v100, v101
  v_cvt_pk_bf16_f32 v31, v102, v103
  v_mfma_f32_16x16x32_bf16 v[116:119], a[148:151], a[76:79], v[116:119]
  buffer_load_dwordx4 v5, s[12:15], s33 offen offset:1024 lds
  v_pk_max_i16 v28, v28, 0
  v_mfma_f32_16x16x32_bf16 v[148:151], a[156:159], a[76:79], v[148:151]
  s_add_u32 s33, s33, 393216
  v_pk_max_i16 v29, v29, 0
  v_pk_max_i16 v30, v30, 0
  v_mfma_f32_16x16x32_bf16 v[148:151], a[152:155], a[72:75], v[148:151]
  v_pk_max_i16 v31, v31, 0
  buffer_store_dwordx4 v[28:31], v20, s[20:23], s93 offen offset:0 sc1
  v_mfma_f32_16x16x32_bf16 v[120:123], a[144:147], a[80:83], v[120:123]
  v_cvt_pk_bf16_f32 v32, v72, v73
  v_cvt_pk_bf16_f32 v33, v74, v75
  v_cvt_pk_bf16_f32 v34, v104, v105
  v_mfma_f32_16x16x32_bf16 v[120:123], a[148:151], a[84:87], v[120:123]
  v_cvt_pk_bf16_f32 v35, v106, v107
  v_pk_max_i16 v32, v32, 0
  v_pk_max_i16 v33, v33, 0
  v_mfma_f32_16x16x32_bf16 v[152:155], a[156:159], a[84:87], v[152:155]
  v_pk_max_i16 v34, v34, 0
  v_pk_max_i16 v35, v35, 0
  v_mfma_f32_16x16x32_bf16 v[152:155], a[152:155], a[80:83], v[152:155]
  buffer_store_dwordx4 v[32:35], v20, s[20:23], s98 offen offset:0 sc1
  v_cvt_pk_bf16_f32 v36, v76, v77
  v_mfma_f32_16x16x32_bf16 v[124:127], a[144:147], a[88:91], v[124:127]
  v_cvt_pk_bf16_f32 v37, v78, v79
  v_cvt_pk_bf16_f32 v38, v108, v109
  v_cvt_pk_bf16_f32 v39, v110, v111
  v_mfma_f32_16x16x32_bf16 v[124:127], a[148:151], a[92:95], v[124:127]
  v_pk_max_i16 v36, v36, 0
  v_pk_max_i16 v37, v37, 0
  v_pk_max_i16 v38, v38, 0
  v_mfma_f32_16x16x32_bf16 v[156:159], a[156:159], a[92:95], v[156:159]
  v_pk_max_i16 v39, v39, 0
  buffer_store_dwordx4 v[36:39], v20, s[20:23], s99 offen offset:0 sc1
  v_mfma_f32_16x16x32_bf16 v[156:159], a[152:155], a[88:91], v[156:159]
  v_cvt_pk_bf16_f32 v24, v112, v113
  v_cvt_pk_bf16_f32 v25, v114, v115
  v_cvt_pk_bf16_f32 v26, v144, v145
  v_mfma_f32_16x16x32_bf16 v[128:131], a[144:147], a[96:99], v[128:131]
  v_cvt_pk_bf16_f32 v27, v146, v147
  v_pk_max_i16 v24, v24, 0
  v_pk_max_i16 v25, v25, 0
  v_mfma_f32_16x16x32_bf16 v[128:131], a[148:151], a[100:103], v[128:131]
  v_pk_max_i16 v26, v26, 0
  v_pk_max_i16 v27, v27, 0
  v_mfma_f32_16x16x32_bf16 v[160:163], a[156:159], a[100:103], v[160:163]
  buffer_store_dwordx4 v[24:27], v19, s[20:23], s88 offen offset:0 sc1
  v_cvt_pk_bf16_f32 v28, v116, v117
  v_mfma_f32_16x16x32_bf16 v[160:163], a[152:155], a[96:99], v[160:163]
  v_cvt_pk_bf16_f32 v29, v118, v119
  v_cvt_pk_bf16_f32 v30, v148, v149
  v_cvt_pk_bf16_f32 v31, v150, v151
  v_mfma_f32_16x16x32_bf16 v[132:135], a[144:147], a[104:107], v[132:135]
  v_pk_max_i16 v28, v28, 0
  v_pk_max_i16 v29, v29, 0
  v_pk_max_i16 v30, v30, 0
  v_mfma_f32_16x16x32_bf16 v[132:135], a[148:151], a[108:111], v[132:135]
  v_pk_max_i16 v31, v31, 0
  buffer_store_dwordx4 v[28:31], v19, s[20:23], s89 offen offset:0 sc1
  v_mfma_f32_16x16x32_bf16 v[164:167], a[156:159], a[108:111], v[164:167]
  v_cvt_pk_bf16_f32 v32, v120, v121
  v_cvt_pk_bf16_f32 v33, v122, v123
  v_cvt_pk_bf16_f32 v34, v152, v153
  v_mfma_f32_16x16x32_bf16 v[164:167], a[152:155], a[104:107], v[164:167]
  v_cvt_pk_bf16_f32 v35, v154, v155
  v_pk_max_i16 v32, v32, 0
  v_pk_max_i16 v33, v33, 0
  v_mfma_f32_16x16x32_bf16 v[136:139], a[144:147], a[112:115], v[136:139]
  v_pk_max_i16 v34, v34, 0
  v_pk_max_i16 v35, v35, 0
  v_mfma_f32_16x16x32_bf16 v[136:139], a[148:151], a[116:119], v[136:139]
  buffer_store_dwordx4 v[32:35], v19, s[20:23], s90 offen offset:0 sc1
  v_cvt_pk_bf16_f32 v36, v124, v125
  v_mfma_f32_16x16x32_bf16 v[168:171], a[156:159], a[116:119], v[168:171]
  v_cvt_pk_bf16_f32 v37, v126, v127
  v_cvt_pk_bf16_f32 v38, v156, v157
  v_cvt_pk_bf16_f32 v39, v158, v159
  v_mfma_f32_16x16x32_bf16 v[168:171], a[152:155], a[112:115], v[168:171]
  v_pk_max_i16 v36, v36, 0
  v_pk_max_i16 v37, v37, 0
  v_pk_max_i16 v38, v38, 0
  v_mfma_f32_16x16x32_bf16 v[140:143], a[144:147], a[120:123], v[140:143]
  v_pk_max_i16 v39, v39, 0
  buffer_store_dwordx4 v[36:39], v19, s[20:23], s91 offen offset:0 sc1
  v_mfma_f32_16x16x32_bf16 v[140:143], a[148:151], a[124:127], v[140:143]
  v_cvt_pk_bf16_f32 v24, v128, v129
  v_cvt_pk_bf16_f32 v25, v130, v131
  v_cvt_pk_bf16_f32 v26, v160, v161
  v_mfma_f32_16x16x32_bf16 v[172:175], a[156:159], a[124:127], v[172:175]
  v_cvt_pk_bf16_f32 v27, v162, v163
  v_pk_max_i16 v24, v24, 0
  v_pk_max_i16 v25, v25, 0
  v_mfma_f32_16x16x32_bf16 v[172:175], a[152:155], a[120:123], v[172:175]
  v_pk_max_i16 v26, v26, 0
  v_pk_max_i16 v27, v27, 0
  v_mfma_f32_16x16x32_bf16 v[176:179], a[160:163], a[0:3], v[176:179]
  buffer_store_dwordx4 v[24:27], v19, s[20:23], s92 offen offset:0 sc1
  v_cvt_pk_bf16_f32 v28, v132, v133
  v_mfma_f32_16x16x32_bf16 v[176:179], a[164:167], a[4:7], v[176:179]
  v_cvt_pk_bf16_f32 v29, v134, v135
  v_cvt_pk_bf16_f32 v30, v164, v165
  v_cvt_pk_bf16_f32 v31, v166, v167
  v_mfma_f32_16x16x32_bf16 v[176:179], a[176:179], a[64:67], v[176:179]
  v_pk_max_i16 v28, v28, 0
  v_pk_max_i16 v29, v29, 0
  v_pk_max_i16 v30, v30, 0
  v_mfma_f32_16x16x32_bf16 v[176:179], a[180:183], a[68:71], v[176:179]
  v_pk_max_i16 v31, v31, 0
  buffer_store_dwordx4 v[28:31], v19, s[20:23], s93 offen offset:0 sc1
  v_mfma_f32_16x16x32_bf16 v[208:211], a[168:171], a[0:3], v[208:211]
  s_waitcnt vmcnt(6)
  s_mov_b64 exec, 1
  s_cmp_eq_u32 s0, 1
  s_cbranch_scc0 LE6a
  buffer_store_byte v15, off, s[20:23], s55 offset:0
LE6b:
  s_mov_b64 exec, -1
  v_mfma_f32_16x16x32_bf16 v[208:211], a[172:175], a[4:7], v[208:211]
  v_and_b32 v22, 3, v1
  v_lshlrev_b32 v22, 3, v22
  s_and_b32 s51, s55, 0xffffff80
  v_mfma_f32_16x16x32_bf16 v[208:211], a[184:187], a[64:67], v[208:211]
  v_cvt_pk_bf16_f32 v32, v136, v137
  v_cvt_pk_bf16_f32 v33, v138, v139
  v_cvt_pk_bf16_f32 v34, v168, v169
  v_mfma_f32_16x16x32_bf16 v[208:211], a[188:191], a[68:71], v[208:211]
  v_cvt_pk_bf16_f32 v35, v170, v171
  v_pk_max_i16 v32, v32, 0
  v_pk_max_i16 v33, v33, 0
  v_mfma_f32_16x16x32_bf16 v[180:183], a[160:163], a[8:11], v[180:183]
  v_pk_max_i16 v34, v34, 0
  v_pk_max_i16 v35, v35, 0
  v_mfma_f32_16x16x32_bf16 v[180:183], a[164:167], a[12:15], v[180:183]
  buffer_store_dwordx4 v[32:35], v19, s[20:23], s98 offen offset:0 sc1
  v_cvt_pk_bf16_f32 v36, v140, v141
  v_mfma_f32_16x16x32_bf16 v[180:183], a[176:179], a[72:75], v[180:183]
  v_cvt_pk_bf16_f32 v37, v142, v143
  v_cvt_pk_bf16_f32 v38, v172, v173
  v_cvt_pk_bf16_f32 v39, v174, v175
  v_mfma_f32_16x16x32_bf16 v[180:183], a[180:183], a[76:79], v[180:183]
  v_pk_max_i16 v36, v36, 0
  v_pk_max_i16 v37, v37, 0
  v_pk_max_i16 v38, v38, 0
  v_mfma_f32_16x16x32_bf16 v[212:215], a[168:171], a[8:11], v[212:215]
  v_pk_max_i16 v39, v39, 0
  buffer_store_dwordx4 v[36:39], v19, s[20:23], s99 offen offset:0 sc1
  v_mfma_f32_16x16x32_bf16 v[212:215], a[172:175], a[12:15], v[212:215]
  v_cvt_pk_bf16_f32 v24, v176, v177
  v_cvt_pk_bf16_f32 v25, v178, v179
  v_cvt_pk_bf16_f32 v26, v208, v209
  v_mfma_f32_16x16x32_bf16 v[212:215], a[184:187], a[72:75], v[212:215]
  v_cvt_pk_bf16_f32 v27, v210, v211
  v_pk_max_i16 v24, v24, 0
  v_pk_max_i16 v25, v25, 0
  v_mfma_f32_16x16x32_bf16 v[212:215], a[188:191], a[76:79], v[212:215]
  v_pk_max_i16 v26, v26, 0
  v_pk_max_i16 v27, v27, 0
  v_mfma_f32_16x16x32_bf16 v[184:187], a[160:163], a[16:19], v[184:187]
  buffer_store_dwordx4 v[24:27], v21, s[20:23], s88 offen offset:0 sc1
  v_mfma_f32_16x16x32_bf16 v[184:187], a[164:167], a[20:23], v[184:187]
  v_mfma_f32_16x16x32_bf16 v[184:187], a[176:179], a[80:83], v[184:187]
  v_mfma_f32_16x16x32_bf16 v[184:187], a[180:183], a[84:87], v[184:187]
  v_mfma_f32_16x16x32_bf16 v[216:219], a[168:171], a[16:19], v[216:219]
  v_mfma_f32_16x16x32_bf16 v[216:219], a[172:175], a[20:23], v[216:219]
  v_cvt_pk_bf16_f32 v28, v180, v181
  v_cvt_pk_bf16_f32 v29, v182, v183
  v_cvt_pk_bf16_f32 v30, v212, v213
  v_mfma_f32_16x16x32_bf16 v[216:219], a[184:187], a[80:83], v[216:219]
  v_cvt_pk_bf16_f32 v31, v214, v215
  v_pk_max_i16 v28, v28, 0
  v_pk_max_i16 v29, v29, 0
  v_mfma_f32_16x16x32_bf16 v[216:219], a[188:191], a[84:87], v[216:219]
  v_pk_max_i16 v30, v30, 0
  v_pk_max_i16 v31, v31, 0
  v_mfma_f32_16x16x32_bf16 v[188:191], a[160:163], a[24:27], v[188:191]
  buffer_store_dwordx4 v[28:31], v21, s[20:23], s89 offen offset:0 sc1
  v_mfma_f32_16x16x32_bf16 v[188:191], a[164:167], a[28:31], v[188:191]
  v_mfma_f32_16x16x32_bf16 v[188:191], a[176:179], a[88:91], v[188:191]
  v_mfma_f32_16x16x32_bf16 v[188:191], a[180:183], a[92:95], v[188:191]
  v_mfma_f32_16x16x32_bf16 v[220:223], a[168:171], a[24:27], v[220:223]
  v_mfma_f32_16x16x32_bf16 v[220:223], a[172:175], a[28:31], v[220:223]
  v_cvt_pk_bf16_f32 v32, v184, v185
  v_cvt_pk_bf16_f32 v33, v186, v187
  v_cvt_pk_bf16_f32 v34, v216, v217
  v_mfma_f32_16x16x32_bf16 v[220:223], a[184:187], a[88:91], v[220:223]
  v_cvt_pk_bf16_f32 v35, v218, v219
  v_pk_max_i16 v32, v32, 0
  v_pk_max_i16 v33, v33, 0
  v_mfma_f32_16x16x32_bf16 v[220:223], a[188:191], a[92:95], v[220:223]
  v_pk_max_i16 v34, v34, 0
  v_pk_max_i16 v35, v35, 0
  v_mfma_f32_16x16x32_bf16 v[192:195], a[160:163], a[32:35], v[192:195]
  buffer_store_dwordx4 v[32:35], v21, s[20:23], s90 offen offset:0 sc1
  v_mfma_f32_16x16x32_bf16 v[192:195], a[164:167], a[36:39], v[192:195]
  v_mfma_f32_16x16x32_bf16 v[192:195], a[176:179], a[96:99], v[192:195]
  v_mfma_f32_16x16x32_bf16 v[192:195], a[180:183], a[100:103], v[192:195]
  v_mfma_f32_16x16x32_bf16 v[224:227], a[168:171], a[32:35], v[224:227]
  v_mfma_f32_16x16x32_bf16 v[224:227], a[172:175], a[36:39], v[224:227]
  v_cvt_pk_bf16_f32 v36, v188, v189
  v_cvt_pk_bf16_f32 v37, v190, v191
  v_cvt_pk_bf16_f32 v38, v220, v221
  v_mfma_f32_16x16x32_bf16 v[224:227], a[184:187], a[96:99], v[224:227]
  v_cvt_pk_bf16_f32 v39, v222, v223
  v_pk_max_i16 v36, v36, 0
  v_pk_max_i16 v37, v37, 0
  v_mfma_f32_16x16x32_bf16 v[224:227], a[188:191], a[100:103], v[224:227]
  v_pk_max_i16 v38, v38, 0
  v_pk_max_i16 v39, v39, 0
  v_mfma_f32_16x16x32_bf16 v[196:199], a[160:163], a[40:43], v[196:199]
  buffer_store_dwordx4 v[36:39], v21, s[20:23], s91 offen offset:0 sc1
  s_cmp_eq_u32 s0, 1
  s_cbranch_scc0 LE7a
  buffer_load_dword v23, v22, s[20:23], s51 offen offset:4 nt
LE7b:
  v_mfma_f32_16x16x32_bf16 v[196:199], a[164:167], a[44:47], v[196:199]
  v_mfma_f32_16x16x32_bf16 v[196:199], a[176:179], a[104:107], v[196:199]
  v_mfma_f32_16x16x32_bf16 v[196:199], a[180:183], a[108:111], v[196:199]
  v_mfma_f32_16x16x32_bf16 v[228:231], a[168:171], a[40:43], v[228:231]
  v_mfma_f32_16x16x32_bf16 v[228:231], a[172:175], a[44:47], v[228:231]
  v_cvt_pk_bf16_f32 v24, v192, v193
  v_cvt_pk_bf16_f32 v25, v194, v195
  v_cvt_pk_bf16_f32 v26, v224, v225
  v_mfma_f32_16x16x32_bf16 v[228:231], a[184:187], a[104:107], v[228:231]
  v_cvt_pk_bf16_f32 v27, v226, v227
  v_pk_max_i16 v24, v24, 0
  v_pk_max_i16 v25, v25, 0
  v_mfma_f32_16x16x32_bf16 v[228:231], a[188:191], a[108:111], v[228:231]
  v_pk_max_i16 v26, v26, 0
  v_pk_max_i16 v27, v27, 0
  v_mfma_f32_16x16x32_bf16 v[200:203], a[160:163], a[48:51], v[200:203]
  buffer_store_dwordx4 v[24:27], v21, s[20:23], s92 offen offset:0 sc1
  v_mfma_f32_16x16x32_bf16 v[200:203], a[164:167], a[52:55], v[200:203]
  v_mfma_f32_16x16x32_bf16 v[200:203], a[176:179], a[112:115], v[200:203]
  v_mfma_f32_16x16x32_bf16 v[200:203], a[180:183], a[116:119], v[200:203]
  v_mfma_f32_16x16x32_bf16 v[232:235], a[168:171], a[48:51], v[232:235]
  v_mfma_f32_16x16x32_bf16 v[232:235], a[172:175], a[52:55], v[232:235]
  v_cvt_pk_bf16_f32 v28, v196, v197
  v_cvt_pk_bf16_f32 v29, v198, v199
  v_cvt_pk_bf16_f32 v30, v228, v229
  v_mfma_f32_16x16x32_bf16 v[232:235], a[184:187], a[112:115], v[232:235]
  v_cvt_pk_bf16_f32 v31, v230, v231
  v_pk_max_i16 v28, v28, 0
  v_pk_max_i16 v29, v29, 0
  v_mfma_f32_16x16x32_bf16 v[232:235], a[188:191], a[116:119], v[232:235]
  v_pk_max_i16 v30, v30, 0
  v_pk_max_i16 v31, v31, 0
  v_mfma_f32_16x16x32_bf16 v[204:207], a[160:163], a[56:59], v[204:207]
  buffer_store_dwordx4 v[28:31], v21, s[20:23], s93 offen offset:0 sc1
  s_waitcnt vmcnt(7)
  s_mov_b64 exec, 1
  s_cmp_eq_u32 s0, 1
  s_cbranch_scc0 LE8a
  buffer_store_byte v15, off, s[20:23], s55 offset:32
LE8b:
  s_mov_b64 exec, -1
  v_mfma_f32_16x16x32_bf16 v[204:207], a[164:167], a[60:63], v[204:207]
  v_mfma_f32_16x16x32_bf16 v[204:207], a[176:179], a[120:123], v[204:207]
  v_mfma_f32_16x16x32_bf16 v[204:207], a[180:183], a[124:127], v[204:207]
  v_mfma_f32_16x16x32_bf16 v[236:239], a[168:171], a[56:59], v[236:239]
  v_mfma_f32_16x16x32_bf16 v[236:239], a[172:175], a[60:63], v[236:239]
  v_cvt_pk_bf16_f32 v32, v200, v201
  v_cvt_pk_bf16_f32 v33, v202, v203
  v_cvt_pk_bf16_f32 v34, v232, v233
  v_mfma_f32_16x16x32_bf16 v[236:239], a[184:187], a[120:123], v[236:239]
  v_cvt_pk_bf16_f32 v35, v234, v235
  v_pk_max_i16 v32, v32, 0
  v_pk_max_i16 v33, v33, 0
  v_mfma_f32_16x16x32_bf16 v[236:239], a[188:191], a[124:127], v[236:239]
  v_pk_max_i16 v34, v34, 0
  v_pk_max_i16 v35, v35, 0
  s_nop 7
  buffer_store_dwordx4 v[32:35], v21, s[20:23], s98 offen offset:0 sc1
  v_cvt_pk_bf16_f32 v36, v204, v205
  v_cvt_pk_bf16_f32 v37, v206, v207
  v_cvt_pk_bf16_f32 v38, v236, v237
  v_cvt_pk_bf16_f32 v39, v238, v239
  v_pk_max_i16 v36, v36, 0
  v_pk_max_i16 v37, v37, 0
  v_pk_max_i16 v38, v38, 0
  v_pk_max_i16 v39, v39, 0
  buffer_store_dwordx4 v[36:39], v21, s[20:23], s99 offen offset:0 sc1
  s_waitcnt vmcnt(5)
L2_entryH:
  v_cmp_ne_u32 vcc, 0x01010101, v23
  s_nop 0
  s_cmp_eq_u64 vcc, 0
  s_cbranch_scc0 L2_h_slowH
L2_h_okH:
  s_add_u32 m0, s36, 0
  s_nop 0
  buffer_load_dwordx4 v3, s[20:23], s30 offen offset:0 sc1 lds
  buffer_load_dwordx4 v252, s[20:23], s30 offen offset:1024 sc1 lds
  buffer_load_dwordx4 v253, s[20:23], s30 offen offset:2048 sc1 lds
  buffer_load_dwordx4 v254, s[20:23], s30 offen offset:3072 sc1 lds
  s_add_u32 s30, s30, 12288
  s_add_u32 m0, s36, 24576
  s_nop 0
  buffer_load_dwordx4 v3, s[20:23], s31 offen offset:0 sc1 lds
  buffer_load_dwordx4 v252, s[20:23], s31 offen offset:1024 sc1 lds
  buffer_load_dwordx4 v253, s[20:23], s31 offen offset:2048 sc1 lds
  buffer_load_dwordx4 v254, s[20:23], s31 offen offset:3072 sc1 lds
  s_add_u32 s31, s31, 12288
  s_add_u32 m0, s36, 49152
  s_nop 0
  buffer_load_dwordx4 v3, s[20:23], s30 offen offset:0 sc1 lds
  buffer_load_dwordx4 v252, s[20:23], s30 offen offset:1024 sc1 lds
  buffer_load_dwordx4 v253, s[20:23], s30 offen offset:2048 sc1 lds
  buffer_load_dwordx4 v254, s[20:23], s30 offen offset:3072 sc1 lds
  s_add_u32 s30, s30, 16384
  s_mov_b32 s16, s60
  s_mov_b32 s17, s61
  s_mov_b32 s18, 4194304
  v_lshrrev_b32 v25, 4, v1
  v_and_b32 v26, 7, v1
  s_lshl_b32 s4, s38, 13
  v_add_u32 v6, s4, v2
  v_add_u32 v7, 49152, v6
  v_add_u32 v8, 98304, v6
  v_lshlrev_b32 v17, 6, v26
  v_lshl_add_u32 v17, v25, 4, v17
  v_lshrrev_b32 v27, 2, v1
  v_lshlrev_b32 v27, 7, v27
  v_bfe_u32 v28, v1, 3, 2
  s_lshl_b32 s4, s39, 1
  v_xor_b32 v28, s4, v28
  v_lshl_add_u32 v27, v28, 5, v27
  v_and_b32 v28, 3, v1
  v_lshl_add_u32 v27, v28, 3, v27
  v_add_u32 v9, 16384, v27
  v_xor_b32 v10, 32, v9
  v_add_u32 v11, 49152, v9
  v_add_u32 v12, 49152, v10
  v_add_u32 v13, 98304, v9
  v_add_u32 v14, 98304, v10
  v_xor_b32 v16, s1, v28
  v_lshlrev_b32 v16, 7, v16
  v_lshl_add_u32 v16, v28, 2, v16
  v_and_b32 v18, 15, v1
  v_lshlrev_b32 v18, 4, v18
  s_and_b32 s44, s52, 30
  s_and_b32 s5, s25, 1
  s_add_u32 s44, s44, s5
  s_and_b32 s45, s25, 6
  s_lshl_b32 s45, s45, 4
  s_lshl_b32 s5, s24, 3
  s_add_u32 s45, s45, s5
  s_and_b32 s50, s48, 0xfffffc00
  v_bfe_u32 v34, v1, 2, 3
  v_lshlrev_b32 v34, 7, v34
  v_lshl_add_u32 v34, v28, 3, v34
  s_lshl_b32 s54, s44, 7
  s_add_u32 s54, s54, 40091648
  s_lshl_b32 s4, s24, 4
  s_add_u32 s63, s4, 39976960
  s_lshl_b32 s3, s1, 17
  s_lshl_b32 s4, s24, 13
  s_add_u32 s4, s4, 41943040
  s_add_u32 s49, s3, s4
  s_xor_b32 s5, s3, 131072
  s_add_u32 s5, s5, s4
  s_add_u32 s60, s5, 32768
  s_xor_b32 s5, s3, 262144
  s_add_u32 s5, s5, s4
  s_add_u32 s61, s5, 65536
  s_xor_b32 s5, s3, 393216
  s_add_u32 s5, s5, s4
  s_add_u32 s62, s5, 98304
  s_waitcnt vmcnt(4)
  s_mov_b64 exec, 1
  s_cmp_eq_u32 s0, 1
  s_cbranch_scc0 LE9a
  buffer_store_byte v15, off, s[20:23], s55 offset:64
LE9b:
  s_mov_b64 exec, -1
  s_barrier
  ds_read_b64_tr_b16 a[128:129], v9 offset:24576
  ds_read_b128 a[32:35], v6 offset:24576
  ds_read_b64_tr_b16 a[130:131], v9 offset:26624
  ds_read_b128 a[36:39], v6 offset:25600
  ds_read_b64_tr_b16 a[132:133], v9 offset:28672
  ds_read_b128 a[40:43], v6 offset:26624
  ds_read_b64_tr_b16 a[134:135], v9 offset:30720
  ds_read_b128 a[44:47], v6 offset:27648
  ds_read_b64_tr_b16 a[136:137], v10 offset:24576
  ds_read_b128 a[48:51], v6 offset:28672
  s_add_u32 m0, s36, 73728
  ds_read_b64_tr_b16 a[138:139], v10 offset:26624
  ds_read_b128 a[52:55], v6 offset:29696
  buffer_load_dwordx4 v3, s[20:23], s31 offen offset:0 sc1 lds
  ds_read_b64_tr_b16 a[140:141], v10 offset:28672
  ds_read_b128 a[56:59], v6 offset:30720
  buffer_load_dwordx4 v252, s[20:23], s31 offen offset:1024 sc1 lds
  ds_read_b64_tr_b16 a[142:143], v10 offset:30720
  ds_read_b128 a[60:63], v6 offset:31744
  ds_read_b128 a[0:3], v6 offset:0
  buffer_load_dwordx4 v253, s[20:23], s31 offen offset:2048 sc1 lds
  ds_read_b128 a[4:7], v6 offset:1024
  ds_read_b128 a[8:11], v6 offset:2048
  buffer_load_dwordx4 v254, s[20:23], s31 offen offset:3072 sc1 lds
  ds_read_b128 a[12:15], v6 offset:3072
  ds_read_b128 a[16:19], v6 offset:4096
  s_add_u32 s31, s31, 16384
  s_branch L_stubHs3
L_stubH3:
  s_setpc_b64 s[4:5]
L_stubHs3:
  ds_read_b128 a[20:23], v6 offset:5120
  ds_read_b128 a[24:27], v6 offset:6144
  ds_read_b128 a[28:31], v6 offset:7168
  s_waitcnt vmcnt(5) lgkmcnt(0)
  s_barrier
  v_mfma_f32_16x16x32_bf16 v[48:51], a[128:131], a[0:3], 0
  s_add_u32 m0, s36, 98304
  ds_read_b64_tr_b16 a[144:145], v11 offset:0
  v_mfma_f32_16x16x32_bf16 v[48:51], a[132:135], a[4:7], v[48:51]
  buffer_load_dwordx4 v3, s[20:23], s30 offen offset:0 sc1 lds
  v_mfma_f32_16x16x32_bf16 v[232:235], a[192:195], a[208:211], 0
  v_mfma_f32_16x16x32_bf16 v[232:235], a[196:199], a[212:215], v[232:235]
  v_mfma_f32_16x16x32_bf16 v[232:235], a[200:203], a[216:219], v[232:235]
  v_mfma_f32_16x16x32_bf16 v[232:235], a[204:207], a[220:223], v[232:235]
  v_mfma_f32_16x16x32_bf16 v[236:239], a[224:227], a[208:211], 0
  v_mfma_f32_16x16x32_bf16 v[236:239], a[228:231], a[212:215], v[236:239]
  v_mfma_f32_16x16x32_bf16 v[236:239], a[232:235], a[216:219], v[236:239]
  v_mfma_f32_16x16x32_bf16 v[236:239], a[236:239], a[220:223], v[236:239]
  v_mfma_f32_16x16x32_bf16 v[52:55], a[132:135], a[12:15], 0
  ds_read_b128 a[64:67], v7 offset:0
  v_mfma_f32_16x16x32_bf16 v[52:55], a[128:131], a[8:11], v[52:55]
  ds_read_b64_tr_b16 a[146:147], v11 offset:2048
  v_mfma_f32_16x16x32_bf16 v[56:59], a[128:131], a[16:19], 0
  buffer_load_dwordx4 v252, s[20:23], s30 offen offset:1024 sc1 lds
  v_mfma_f32_16x16x32_bf16 v[56:59], a[132:135], a[20:23], v[56:59]
  ds_read_b128 a[68:71], v7 offset:1024
  v_mfma_f32_16x16x32_bf16 v[60:63], a[132:135], a[28:31], 0
  ds_read_b64_tr_b16 a[148:149], v11 offset:4096
  s_mov_b32 s6, 0x00100001
  v_mfma_f32_16x16x32_bf16 v[60:63], a[128:131], a[24:27], v[60:63]
  s_mov_b32 s7, 0x10000100
  v_mfma_f32_16x16x32_bf16 v[112:115], a[128:131], a[32:35], 0
  buffer_load_dwordx4 v253, s[20:23], s30 offen offset:2048 sc1 lds
  v_mfma_f32_16x16x32_bf16 v[112:115], a[132:135], a[36:39], v[112:115]
  ds_read_b128 a[72:75], v7 offset:2048
  v_mov_b32 v27, 0x3f80
  v_mfma_f32_16x16x32_bf16 v[116:119], a[132:135], a[44:47], 0
  ds_read_b64_tr_b16 a[150:151], v11 offset:6144
  v_mov_b32 v244, 0
  v_mfma_f32_16x16x32_bf16 v[116:119], a[128:131], a[40:43], v[116:119]
  ds_read_b128 a[76:79], v7 offset:3072
  v_mov_b32 v245, 0
  v_mfma_f32_16x16x32_bf16 v[120:123], a[128:131], a[48:51], 0
  buffer_load_dwordx4 v254, s[20:23], s30 offen offset:3072 sc1 lds
  v_mfma_f32_16x16x32_bf16 v[120:123], a[132:135], a[52:55], v[120:123]
  ds_read_b64_tr_b16 a[152:153], v12 offset:0
  v_mov_b32 v248, 0
  v_mfma_f32_16x16x32_bf16 v[124:127], a[132:135], a[60:63], 0
  v_mov_b32 v249, 0
  v_cndmask_b32 v40, 0, v232, s[6:7]
  v_mfma_f32_16x16x32_bf16 v[124:127], a[128:131], a[56:59], v[124:127]
  s_add_u32 s30, s30, 12288
  s_add_u32 m0, s36, 122880
  v_mfma_f32_16x16x32_bf16 v[64:67], a[136:139], a[0:3], 0
  buffer_load_dwordx4 v3, s[20:23], s31 offen offset:0 sc1 lds
  v_mfma_f32_16x16x32_bf16 v[64:67], a[140:143], a[4:7], v[64:67]
  ds_read_b128 a[80:83], v7 offset:4096
  ds_read_b64_tr_b16 a[154:155], v12 offset:2048
  v_mfma_f32_16x16x32_bf16 v[68:71], a[140:143], a[12:15], 0
  ds_read_b128 a[84:87], v7 offset:5120
  v_cndmask_b32 v41, 0, v236, s[6:7]
  v_mfma_f32_16x16x32_bf16 v[68:71], a[136:139], a[8:11], v[68:71]
  v_cndmask_b32 v246, 0, v27, s[6:7]
  s_lshl_b64 s[6:7], s[6:7], 1
  v_mfma_f32_16x16x32_bf16 v[72:75], a[136:139], a[16:19], 0
  buffer_load_dwordx4 v252, s[20:23], s31 offen offset:1024 sc1 lds
  v_mfma_f32_16x16x32_bf16 v[72:75], a[140:143], a[20:23], v[72:75]
  ds_read_b64_tr_b16 a[156:157], v12 offset:4096
  ds_read_b128 a[88:91], v7 offset:6144
  v_mfma_f32_16x16x32_bf16 v[76:79], a[140:143], a[28:31], 0
  v_cndmask_b32 v40, v40, v233, s[6:7]
  v_cndmask_b32 v41, v41, v237, s[6:7]
  v_mfma_f32_16x16x32_bf16 v[76:79], a[136:139], a[24:27], v[76:79]
  ds_read_b64_tr_b16 a[158:159], v12 offset:6144
  v_cndmask_b32 v246, v246, 1.0, s[6:7]
  v_mfma_f32_16x16x32_bf16 v[128:131], a[136:139], a[32:35], 0
  buffer_load_dwordx4 v253, s[20:23], s31 offen offset:2048 sc1 lds
  v_mfma_f32_16x16x32_bf16 v[128:131], a[140:143], a[36:39], v[128:131]
  ds_read_b128 a[92:95], v7 offset:7168
  s_lshl_b64 s[6:7], s[6:7], 1
  v_mfma_f32_16x16x32_bf16 v[132:135], a[140:143], a[44:47], 0
  v_cndmask_b32 v40, v40, v234, s[6:7]
  v_cndmask_b32 v41, v41, v238, s[6:7]
  v_mfma_f32_16x16x32_bf16 v[132:135], a[136:139], a[40:43], v[132:135]
  v_cndmask_b32 v247, 0, v27, s[6:7]
  s_lshl_b64 s[6:7], s[6:7], 1
  v_mfma_f32_16x16x32_bf16 v[136:139], a[136:139], a[48:51], 0
  buffer_load_dwordx4 v254, s[20:23], s31 offen offset:3072 sc1 lds
  v_mfma_f32_16x16x32_bf16 v[136:139], a[140:143], a[52:55], v[136:139]
  s_add_u32 s31, s31, 12288
  v_cndmask_b32 v40, v40, v235, s[6:7]
  v_mfma_f32_16x16x32_bf16 v[140:143], a[140:143], a[60:63], 0
  v_cndmask_b32 v41, v41, v239, s[6:7]
  v_cndmask_b32 v247, v247, 1.0, s[6:7]
  v_mfma_f32_16x16x32_bf16 v[140:143], a[136:139], a[56:59], v[140:143]
  s_waitcnt vmcnt(8) lgkmcnt(0)
  s_barrier
  v_mfma_f32_16x16x32_bf16 v[80:83], a[144:147], a[0:3], 0
  ds_read_b64_tr_b16 a[128:129], v11 offset:24576
  v_mfma_f32_16x16x32_bf16 v[80:83], a[148:151], a[4:7], v[80:83]
  s_cmp_eq_u32 s0, 1
  s_cbranch_scc0 LE11a
  buffer_load_dword v23, v22, s[20:23], s51 offen offset:36 nt
LE11b:
  v_add_f32_dpp v40, v40, v40 quad_perm:[1,0,3,2] row_mask:0xf bank_mask:0xf
  v_add_f32_dpp v41, v41, v41 quad_perm:[1,0,3,2] row_mask:0xf bank_mask:0xf
  v_mfma_f32_16x16x32_bf16 v[84:87], a[148:151], a[12:15], 0
  ds_read_b128 a[96:99], v7 offset:24576
  v_mfma_f32_16x16x32_bf16 v[84:87], a[144:147], a[8:11], v[84:87]
  s_add_u32 s68, s35, 1310720
  s_add_u32 m0, s42, 147456
  v_add_f32_dpp v40, v40, v40 quad_perm:[2,3,0,1] row_mask:0xf bank_mask:0xf
  v_add_f32_dpp v41, v41, v41 quad_perm:[2,3,0,1] row_mask:0xf bank_mask:0xf
  v_mfma_f32_16x16x32_bf16 v[88:91], a[144:147], a[16:19], 0
  buffer_load_dwordx4 v4, s[8:11], s68 offen offset:0 lds
  v_mfma_f32_16x16x32_bf16 v[88:91], a[148:151], a[20:23], v[88:91]
  ds_read_b64_tr_b16 a[130:131], v11 offset:26624
  ds_read_b128 a[100:103], v7 offset:25600
  v_add_f32_dpp v40, v40, v40 row_half_mirror row_mask:0xf bank_mask:0xf
  v_add_f32_dpp v41, v41, v41 row_half_mirror row_mask:0xf bank_mask:0xf
  v_mfma_f32_16x16x32_bf16 v[92:95], a[148:151], a[28:31], 0
  ds_read_b64_tr_b16 a[132:133], v11 offset:28672
  v_mfma_f32_16x16x32_bf16 v[92:95], a[144:147], a[24:27], v[92:95]
  buffer_load_dwordx4 v5, s[8:11], s68 offen offset:1024 lds
  v_add_f32_dpp v40, v40, v40 row_mirror row_mask:0xf bank_mask:0xf
  v_add_f32_dpp v41, v41, v41 row_mirror row_mask:0xf bank_mask:0xf
  v_mfma_f32_16x16x32_bf16 v[144:147], a[144:147], a[32:35], 0
  ds_read_b128 a[104:107], v7 offset:26624
  v_mfma_f32_16x16x32_bf16 v[144:147], a[148:151], a[36:39], v[144:147]
  v_add_f32_dpp v40, v40, v40 row_bcast:15 row_mask:0xa bank_mask:0xf
  v_add_f32_dpp v41, v41, v41 row_bcast:15 row_mask:0xa bank_mask:0xf
  v_mfma_f32_16x16x32_bf16 v[148:151], a[148:151], a[44:47], 0
  s_add_u32 s68, s68, 131072
  s_add_u32 m0, s42, 16384
  v_mfma_f32_16x16x32_bf16 v[148:151], a[144:147], a[40:43], v[148:151]
  buffer_load_dwordx4 v4, s[12:15], s34 offen offset:0 lds
  v_mul_f32 v40, 0xbfb8aa3b, v40
  v_mul_f32 v41, 0xbfb8aa3b, v41
  v_mfma_f32_16x16x32_bf16 v[152:155], a[144:147], a[48:51], 0
  ds_read_b64_tr_b16 a[134:135], v11 offset:30720
  ds_read_b128 a[108:111], v7 offset:27648
  v_mfma_f32_16x16x32_bf16 v[152:155], a[148:151], a[52:55], v[152:155]
  ds_read_b64_tr_b16 a[136:137], v12 offset:24576
  v_exp_f32 v40, v40
  v_exp_f32 v41, v41
  v_mfma_f32_16x16x32_bf16 v[156:159], a[148:151], a[60:63], 0
  buffer_load_dwordx4 v5, s[12:15], s34 offen offset:1024 lds
  v_mfma_f32_16x16x32_bf16 v[156:159], a[144:147], a[56:59], v[156:159]
  ds_read_b128 a[112:115], v7 offset:28672
  v_add_f32 v40, 1.0, v40
  v_add_f32 v41, 1.0, v41
  v_mfma_f32_16x16x32_bf16 v[96:99], a[152:155], a[0:3], 0
  ds_read_b64_tr_b16 a[138:139], v12 offset:26624
  v_mfma_f32_16x16x32_bf16 v[96:99], a[156:159], a[4:7], v[96:99]
  s_add_u32 s34, s34, 393216
  s_add_u32 m0, s36, 0
  v_rcp_f32 v40, v40
  v_rcp_f32 v41, v41
  v_mfma_f32_16x16x32_bf16 v[100:103], a[156:159], a[12:15], 0
  buffer_load_dwordx4 v3, s[20:23], s30 offen offset:0 sc1 lds
  v_mfma_f32_16x16x32_bf16 v[100:103], a[152:155], a[8:11], v[100:103]
  ds_read_b128 a[116:119], v7 offset:29696
  v_lshrrev_b32 v42, 5, v1
  s_lshr_b32 s6, s52, 3
  v_mfma_f32_16x16x32_bf16 v[104:107], a[152:155], a[16:19], 0
  ds_read_b64_tr_b16 a[140:141], v12 offset:28672
  v_mfma_f32_16x16x32_bf16 v[104:107], a[156:159], a[20:23], v[104:107]
  buffer_load_dwordx4 v252, s[20:23], s30 offen offset:1024 sc1 lds
  v_lshlrev_b32 v42, 4, v42
  s_lshl_b32 s6, s6, 2
  v_mfma_f32_16x16x32_bf16 v[108:111], a[156:159], a[28:31], 0
  ds_read_b128 a[120:123], v7 offset:30720
  v_mfma_f32_16x16x32_bf16 v[108:111], a[152:155], a[24:27], v[108:111]
  ds_read_b64_tr_b16 a[142:143], v12 offset:30720
  s_add_u32 s6, s6, s24
  s_lshl_b32 s6, s6, 5
  v_mfma_f32_16x16x32_bf16 v[160:163], a[152:155], a[32:35], 0
  v_mfma_f32_16x16x32_bf16 v[160:163], a[156:159], a[36:39], v[160:163]
  buffer_load_dwordx4 v253, s[20:23], s30 offen offset:2048 sc1 lds
  s_and_b32 s7, s52, 6
  s_add_u32 s6, s6, s7
  v_mfma_f32_16x16x32_bf16 v[164:167], a[156:159], a[44:47], 0
  ds_read_b128 a[124:127], v7 offset:31744
  v_mfma_f32_16x16x32_bf16 v[164:167], a[152:155], a[40:43], v[164:167]
  s_lshl_b32 s6, s6, 1
  s_add_u32 s6, s6, 39911424
  v_mfma_f32_16x16x32_bf16 v[168:171], a[152:155], a[48:51], 0
  buffer_load_dwordx4 v254, s[20:23], s30 offen offset:3072 sc1 lds
  v_mfma_f32_16x16x32_bf16 v[168:171], a[156:159], a[52:55], v[168:171]
  s_sub_u32 s30, s30, 36864
  s_mov_b32 exec_lo, 0x80000000
  s_mov_b32 exec_hi, 0x80000000
  buffer_store_dword v40, v42, s[20:23], s6 offen sc1
  buffer_store_dword v41, v42, s[20:23], s6 offen offset:32 sc1
  s_mov_b64 exec, -1
  v_mfma_f32_16x16x32_bf16 v[172:175], a[156:159], a[60:63], 0
  v_mfma_f32_16x16x32_bf16 v[172:175], a[152:155], a[56:59], v[172:175]
  s_waitcnt vmcnt(15) lgkmcnt(0)
  s_barrier
  v_mfma_f32_16x16x32_bf16 v[48:51], a[128:131], a[64:67], v[48:51]
  s_add_u32 m0, s42, 155648
  ds_read_b64_tr_b16 a[144:145], v13 offset:0
  v_mfma_f32_16x16x32_bf16 v[48:51], a[132:135], a[68:71], v[48:51]
  buffer_load_dwordx4 v4, s[8:11], s68 offen offset:0 lds
  v_mfma_f32_16x16x32_bf16 v[52:55], a[132:135], a[76:79], v[52:55]
  ds_read_b128 a[0:3], v8 offset:0
  v_mfma_f32_16x16x32_bf16 v[52:55], a[128:131], a[72:75], v[52:55]
  ds_read_b64_tr_b16 a[146:147], v13 offset:2048
  v_mfma_f32_16x16x32_bf16 v[56:59], a[128:131], a[80:83], v[56:59]
  buffer_load_dwordx4 v5, s[8:11], s68 offen offset:1024 lds
  v_mfma_f32_16x16x32_bf16 v[56:59], a[132:135], a[84:87], v[56:59]
  ds_read_b128 a[4:7], v8 offset:1024
  v_mfma_f32_16x16x32_bf16 v[60:63], a[132:135], a[92:95], v[60:63]
  ds_read_b64_tr_b16 a[148:149], v13 offset:4096
  v_mfma_f32_16x16x32_bf16 v[60:63], a[128:131], a[88:91], v[60:63]
  s_add_u32 s68, s68, 131072
  s_add_u32 m0, s42, 40960
  v_mfma_f32_16x16x32_bf16 v[112:115], a[128:131], a[96:99], v[112:115]
  buffer_load_dwordx4 v4, s[12:15], s33 offen offset:0 lds
  v_mfma_f32_16x16x32_bf16 v[112:115], a[132:135], a[100:103], v[112:115]
  ds_read_b128 a[8:11], v8 offset:2048
  v_mfma_f32_16x16x32_bf16 v[116:119], a[132:135], a[108:111], v[116:119]
  ds_read_b64_tr_b16 a[150:151], v13 offset:6144
  v_mfma_f32_16x16x32_bf16 v[116:119], a[128:131], a[104:107], v[116:119]
  ds_read_b128 a[12:15], v8 offset:3072
  v_mfma_f32_16x16x32_bf16 v[120:123], a[128:131], a[112:115], v[120:123]
  buffer_load_dwordx4 v5, s[12:15], s33 offen offset:1024 lds
  v_mfma_f32_16x16x32_bf16 v[120:123], a[132:135], a[116:119], v[120:123]
  ds_read_b64_tr_b16 a[152:153], v14 offset:0
  v_mfma_f32_16x16x32_bf16 v[124:127], a[132:135], a[124:127], v[124:127]
  v_mfma_f32_16x16x32_bf16 v[124:127], a[128:131], a[120:123], v[124:127]
  s_sub_u32 s33, s33, 1179648
  s_add_u32 m0, s36, 24576
  v_mfma_f32_16x16x32_bf16 v[64:67], a[136:139], a[64:67], v[64:67]
  buffer_load_dwordx4 v3, s[20:23], s31 offen offset:0 sc1 lds
  v_mfma_f32_16x16x32_bf16 v[64:67], a[140:143], a[68:71], v[64:67]
  ds_read_b128 a[16:19], v8 offset:4096
  ds_read_b64_tr_b16 a[154:155], v14 offset:2048
  v_mfma_f32_16x16x32_bf16 v[68:71], a[140:143], a[76:79], v[68:71]
  ds_read_b128 a[20:23], v8 offset:5120
  v_mfma_f32_16x16x32_bf16 v[68:71], a[136:139], a[72:75], v[68:71]
  v_mfma_f32_16x16x32_bf16 v[72:75], a[136:139], a[80:83], v[72:75]
  buffer_load_dwordx4 v252, s[20:23], s31 offen offset:1024 sc1 lds
  v_mfma_f32_16x16x32_bf16 v[72:75], a[140:143], a[84:87], v[72:75]
  ds_read_b64_tr_b16 a[156:157], v14 offset:4096
  ds_read_b128 a[24:27], v8 offset:6144
  v_mfma_f32_16x16x32_bf16 v[76:79], a[140:143], a[92:95], v[76:79]
  v_mfma_f32_16x16x32_bf16 v[76:79], a[136:139], a[88:91], v[76:79]
  ds_read_b64_tr_b16 a[158:159], v14 offset:6144
  v_mfma_f32_16x16x32_bf16 v[128:131], a[136:139], a[96:99], v[128:131]
  buffer_load_dwordx4 v253, s[20:23], s31 offen offset:2048 sc1 lds
  v_mfma_f32_16x16x32_bf16 v[128:131], a[140:143], a[100:103], v[128:131]
  ds_read_b128 a[28:31], v8 offset:7168
  v_mfma_f32_16x16x32_bf16 v[132:135], a[140:143], a[108:111], v[132:135]
  v_mfma_f32_16x16x32_bf16 v[132:135], a[136:139], a[104:107], v[132:135]
  v_mfma_f32_16x16x32_bf16 v[136:139], a[136:139], a[112:115], v[136:139]
  buffer_load_dwordx4 v254, s[20:23], s31 offen offset:3072 sc1 lds
  v_mfma_f32_16x16x32_bf16 v[136:139], a[140:143], a[116:119], v[136:139]
  s_sub_u32 s31, s31, 36864
  v_mfma_f32_16x16x32_bf16 v[140:143], a[140:143], a[124:127], v[140:143]
  v_mfma_f32_16x16x32_bf16 v[140:143], a[136:139], a[120:123], v[140:143]
  s_waitcnt vmcnt(16) lgkmcnt(0)
  s_barrier
  v_cmp_ne_u32 vcc, 0x01010101, v23
  s_nop 0
  s_cmp_eq_u64 vcc, 0
  s_cbranch_scc0 L2_h2_slowH
L2_h2_okH:
  v_mfma_f32_16x16x32_bf16 v[80:83], a[144:147], a[64:67], v[80:83]
  s_add_u32 m0, s42, 65536
  ds_read_b64_tr_b16 a[128:129], v13 offset:24576
  v_mfma_f32_16x16x32_bf16 v[80:83], a[148:151], a[68:71], v[80:83]
  buffer_load_dwordx4 v4, s[12:15], s34 offen offset:0 lds
  v_mfma_f32_16x16x32_bf16 v[84:87], a[148:151], a[76:79], v[84:87]
  ds_read_b128 a[32:35], v8 offset:24576
  ds_read_b64_tr_b16 a[160:161], v13 offset:32768
  v_mfma_f32_16x16x32_bf16 v[84:87], a[144:147], a[72:75], v[84:87]
  ds_read_b64_tr_b16 a[130:131], v13 offset:26624
  v_mfma_f32_16x16x32_bf16 v[88:91], a[144:147], a[80:83], v[88:91]
  buffer_load_dwordx4 v5, s[12:15], s34 offen offset:1024 lds
  v_mfma_f32_16x16x32_bf16 v[88:91], a[148:151], a[84:87], v[88:91]
  ds_read_b128 a[36:39], v8 offset:25600
  ds_read_b64_tr_b16 a[162:163], v13 offset:34816
  v_mfma_f32_16x16x32_bf16 v[92:95], a[148:151], a[92:95], v[92:95]
  ds_read_b64_tr_b16 a[132:133], v13 offset:28672
  v_mfma_f32_16x16x32_bf16 v[92:95], a[144:147], a[88:91], v[92:95]
  s_sub_u32 s34, s34, 1179648
  s_add_u32 m0, s36, 49152
  v_mfma_f32_16x16x32_bf16 v[144:147], a[144:147], a[96:99], v[144:147]
  buffer_load_dwordx4 v3, s[20:23], s30 offen offset:0 sc1 lds
  v_mfma_f32_16x16x32_bf16 v[144:147], a[148:151], a[100:103], v[144:147]
  ds_read_b128 a[40:43], v8 offset:26624
  ds_read_b64_tr_b16 a[164:165], v13 offset:36864
  v_mfma_f32_16x16x32_bf16 v[148:151], a[148:151], a[108:111], v[148:151]
  ds_read_b64_tr_b16 a[134:135], v13 offset:30720
  v_mfma_f32_16x16x32_bf16 v[148:151], a[144:147], a[104:107], v[148:151]
  ds_read_b128 a[44:47], v8 offset:27648
  v_mfma_f32_16x16x32_bf16 v[152:155], a[144:147], a[112:115], v[152:155]
  buffer_load_dwordx4 v252, s[20:23], s30 offen offset:1024 sc1 lds
  v_mfma_f32_16x16x32_bf16 v[152:155], a[148:151], a[116:119], v[152:155]
  ds_read_b64_tr_b16 a[166:167], v13 offset:38912
  ds_read_b64_tr_b16 a[136:137], v14 offset:24576
  v_mfma_f32_16x16x32_bf16 v[156:159], a[148:151], a[124:127], v[156:159]
  ds_read_b128 a[48:51], v8 offset:28672
  v_mfma_f32_16x16x32_bf16 v[156:159], a[144:147], a[120:123], v[156:159]
  ds_read_b64_tr_b16 a[168:169], v14 offset:32768
  v_mfma_f32_16x16x32_bf16 v[96:99], a[152:155], a[64:67], v[96:99]
  buffer_load_dwordx4 v253, s[20:23], s30 offen offset:2048 sc1 lds
  v_mfma_f32_16x16x32_bf16 v[96:99], a[156:159], a[68:71], v[96:99]
  ds_read_b64_tr_b16 a[138:139], v14 offset:26624
  v_mfma_f32_16x16x32_bf16 v[100:103], a[156:159], a[76:79], v[100:103]
  ds_read_b128 a[52:55], v8 offset:29696
  v_mfma_f32_16x16x32_bf16 v[100:103], a[152:155], a[72:75], v[100:103]
  ds_read_b64_tr_b16 a[170:171], v14 offset:34816
  v_mfma_f32_16x16x32_bf16 v[104:107], a[152:155], a[80:83], v[104:107]
  buffer_load_dwordx4 v254, s[20:23], s30 offen offset:3072 sc1 lds
  v_mfma_f32_16x16x32_bf16 v[104:107], a[156:159], a[84:87], v[104:107]
  ds_read_b64_tr_b16 a[140:141], v14 offset:28672
  ds_read_b128 a[56:59], v8 offset:30720
  v_mfma_f32_16x16x32_bf16 v[108:111], a[156:159], a[92:95], v[108:111]
  ds_read_b64_tr_b16 a[172:173], v14 offset:36864
  v_mfma_f32_16x16x32_bf16 v[108:111], a[152:155], a[88:91], v[108:111]
  s_add_u32 s30, s30, 12288
  s_add_u32 m0, s42, 90112
  v_mfma_f32_16x16x32_bf16 v[160:163], a[152:155], a[96:99], v[160:163]
  buffer_load_dwordx4 v4, s[12:15], s33 offen offset:0 lds
  v_mfma_f32_16x16x32_bf16 v[160:163], a[156:159], a[100:103], v[160:163]
  ds_read_b64_tr_b16 a[142:143], v14 offset:30720
  ds_read_b128 a[60:63], v8 offset:31744
  v_mfma_f32_16x16x32_bf16 v[164:167], a[156:159], a[108:111], v[164:167]
  ds_read_b64_tr_b16 a[174:175], v14 offset:38912
  v_mfma_f32_16x16x32_bf16 v[164:167], a[152:155], a[104:107], v[164:167]
  v_mfma_f32_16x16x32_bf16 v[168:171], a[152:155], a[112:115], v[168:171]
  buffer_load_dwordx4 v5, s[12:15], s33 offen offset:1024 lds
  v_mfma_f32_16x16x32_bf16 v[168:171], a[156:159], a[116:119], v[168:171]
  s_add_u32 s33, s33, 393216
  v_mfma_f32_16x16x32_bf16 v[172:175], a[156:159], a[124:127], v[172:175]
  v_mfma_f32_16x16x32_bf16 v[172:175], a[152:155], a[120:123], v[172:175]
  s_waitcnt vmcnt(14) lgkmcnt(0)
  s_barrier
  v_mfma_f32_16x16x32_bf16 v[48:51], a[128:131], a[0:3], v[48:51]
  s_add_u32 m0, s42, 147456
  ds_read_b64_tr_b16 a[144:145], v9 offset:0
  v_mfma_f32_16x16x32_bf16 v[48:51], a[132:135], a[4:7], v[48:51]
  s_add_u32 s96, s50, 65536
  s_cmp_eq_u32 s24, 0
  s_cbranch_scc0 L2_nogfH
  s_add_u32 s3, s48, 65536
  s_mov_b64 exec, 1
  buffer_store_dword v15, off, s[20:23], s3 sc1
  s_mov_b64 exec, -1
L2_nogfH:
  buffer_load_dwordx4 v4, s[8:11], s68 offen offset:0 lds
  v_mfma_f32_16x16x32_bf16 v[52:55], a[132:135], a[12:15], v[52:55]
  ds_read_b128 a[64:67], v6 offset:0
  ds_read_b64_tr_b16 a[176:177], v13 offset:40960
  v_mfma_f32_16x16x32_bf16 v[52:55], a[128:131], a[8:11], v[52:55]
  ds_read_b64_tr_b16 a[146:147], v9 offset:2048
  v_mfma_f32_16x16x32_bf16 v[56:59], a[128:131], a[16:19], v[56:59]
  buffer_load_dwordx4 v5, s[8:11], s68 offen offset:1024 lds
  v_mfma_f32_16x16x32_bf16 v[56:59], a[132:135], a[20:23], v[56:59]
  ds_read_b128 a[68:71], v6 offset:1024
  ds_read_b64_tr_b16 a[178:179], v13 offset:43008
  v_mfma_f32_16x16x32_bf16 v[60:63], a[132:135], a[28:31], v[60:63]
  ds_read_b64_tr_b16 a[148:149], v9 offset:4096
  v_mfma_f32_16x16x32_bf16 v[60:63], a[128:131], a[24:27], v[60:63]
  s_add_u32 s68, s68, 131072
  s_add_u32 m0, s36, 73728
  v_mfma_f32_16x16x32_bf16 v[112:115], a[128:131], a[32:35], v[112:115]
  buffer_load_dwordx4 v3, s[20:23], s31 offen offset:0 sc1 lds
  v_mfma_f32_16x16x32_bf16 v[112:115], a[132:135], a[36:39], v[112:115]
  ds_read_b128 a[72:75], v6 offset:2048
  ds_read_b64_tr_b16 a[180:181], v13 offset:45056
  v_mfma_f32_16x16x32_bf16 v[116:119], a[132:135], a[44:47], v[116:119]
  ds_read_b64_tr_b16 a[150:151], v9 offset:6144
  v_mfma_f32_16x16x32_bf16 v[116:119], a[128:131], a[40:43], v[116:119]
  ds_read_b128 a[76:79], v6 offset:3072
  v_mfma_f32_16x16x32_bf16 v[120:123], a[128:131], a[48:51], v[120:123]
  buffer_load_dwordx4 v252, s[20:23], s31 offen offset:1024 sc1 lds
  v_mfma_f32_16x16x32_bf16 v[120:123], a[132:135], a[52:55], v[120:123]
  ds_read_b64_tr_b16 a[182:183], v13 offset:47104
  ds_read_b64_tr_b16 a[152:153], v10 offset:0
  v_mfma_f32_16x16x32_bf16 v[124:127], a[132:135], a[60:63], v[124:127]
  ds_read_b128 a[80:83], v6 offset:4096
  v_mfma_f32_16x16x32_bf16 v[124:127], a[128:131], a[56:59], v[124:127]
  ds_read_b64_tr_b16 a[184:185], v14 offset:40960
  v_mfma_f32_16x16x32_bf16 v[64:67], a[136:139], a[0:3], v[64:67]
  buffer_load_dwordx4 v253, s[20:23], s31 offen offset:2048 sc1 lds
  v_mfma_f32_16x16x32_bf16 v[64:67], a[140:143], a[4:7], v[64:67]
  ds_read_b64_tr_b16 a[154:155], v10 offset:2048
  v_mfma_f32_16x16x32_bf16 v[68:71], a[140:143], a[12:15], v[68:71]
  ds_read_b128 a[84:87], v6 offset:5120
  v_mfma_f32_16x16x32_bf16 v[68:71], a[136:139], a[8:11], v[68:71]
  ds_read_b64_tr_b16 a[186:187], v14 offset:43008
  v_mfma_f32_16x16x32_bf16 v[72:75], a[136:139], a[16:19], v[72:75]
  buffer_load_dwordx4 v254, s[20:23], s31 offen offset:3072 sc1 lds
  v_mfma_f32_16x16x32_bf16 v[72:75], a[140:143], a[20:23], v[72:75]
  ds_read_b64_tr_b16 a[156:157], v10 offset:4096
  ds_read_b128 a[88:91], v6 offset:6144
  v_mfma_f32_16x16x32_bf16 v[76:79], a[140:143], a[28:31], v[76:79]
  ds_read_b64_tr_b16 a[188:189], v14 offset:45056
  v_mfma_f32_16x16x32_bf16 v[76:79], a[136:139], a[24:27], v[76:79]
  s_add_u32 s31, s31, 12288
  s_add_u32 m0, s42, 114688
  v_mfma_f32_16x16x32_bf16 v[128:131], a[136:139], a[32:35], v[128:131]
  buffer_load_dwordx4 v4, s[12:15], s34 offen offset:0 lds
  v_mfma_f32_16x16x32_bf16 v[128:131], a[140:143], a[36:39], v[128:131]
  ds_read_b64_tr_b16 a[158:159], v10 offset:6144
  ds_read_b128 a[92:95], v6 offset:7168
  v_mfma_f32_16x16x32_bf16 v[132:135], a[140:143], a[44:47], v[132:135]
  ds_read_b64_tr_b16 a[190:191], v14 offset:47104
  v_mfma_f32_16x16x32_bf16 v[132:135], a[136:139], a[40:43], v[132:135]
  v_mfma_f32_16x16x32_bf16 v[136:139], a[136:139], a[48:51], v[136:139]
  buffer_load_dwordx4 v5, s[12:15], s34 offen offset:1024 lds
  v_mfma_f32_16x16x32_bf16 v[136:139], a[140:143], a[52:55], v[136:139]
  s_add_u32 s34, s34, 393216
  v_mfma_f32_16x16x32_bf16 v[140:143], a[140:143], a[60:63], v[140:143]
  v_mfma_f32_16x16x32_bf16 v[140:143], a[136:139], a[56:59], v[140:143]
  s_waitcnt vmcnt(16) lgkmcnt(0)
  s_barrier
  v_mfma_f32_16x16x32_bf16 v[80:83], a[144:147], a[0:3], v[80:83]
  ds_read_b64_tr_b16 a[128:129], v9 offset:24576
  v_mfma_f32_16x16x32_bf16 v[80:83], a[148:151], a[4:7], v[80:83]
  s_cmp_eq_u32 s0, 1
  s_cbranch_scc0 LE13a
  buffer_load_dword v23, v22, s[20:23], s51 offen offset:68 nt
LE13b:
  v_mfma_f32_16x16x32_bf16 v[84:87], a[148:151], a[12:15], v[84:87]
  ds_read_b128 a[96:99], v6 offset:24576
  v_mfma_f32_16x16x32_bf16 v[84:87], a[144:147], a[8:11], v[84:87]
  s_add_u32 m0, s42, 155648
  ds_read_b64_tr_b16 a[130:131], v9 offset:26624
  v_mfma_f32_16x16x32_bf16 v[88:91], a[144:147], a[16:19], v[88:91]
  buffer_load_dwordx4 v4, s[8:11], s68 offen offset:0 lds
  v_mfma_f32_16x16x32_bf16 v[88:91], a[148:151], a[20:23], v[88:91]
  ds_read_b128 a[100:103], v6 offset:25600
  v_mfma_f32_16x16x32_bf16 v[92:95], a[148:151], a[28:31], v[92:95]
  ds_read_b64_tr_b16 a[132:133], v9 offset:28672
  v_mfma_f32_16x16x32_bf16 v[92:95], a[144:147], a[24:27], v[92:95]
  buffer_load_dwordx4 v5, s[8:11], s68 offen offset:1024 lds
  v_mfma_f32_16x16x32_bf16 v[144:147], a[144:147], a[32:35], v[144:147]
  ds_read_b128 a[104:107], v6 offset:26624
  v_mfma_f32_16x16x32_bf16 v[144:147], a[148:151], a[36:39], v[144:147]
  v_mfma_f32_16x16x32_bf16 v[148:151], a[148:151], a[44:47], v[148:151]
  s_add_u32 s68, s68, 131072
  s_add_u32 m0, s36, 98304
  v_mfma_f32_16x16x32_bf16 v[148:151], a[144:147], a[40:43], v[148:151]
  buffer_load_dwordx4 v3, s[20:23], s30 offen offset:0 sc1 lds
  v_mfma_f32_16x16x32_bf16 v[152:155], a[144:147], a[48:51], v[152:155]
  ds_read_b64_tr_b16 a[134:135], v9 offset:30720
  ds_read_b128 a[108:111], v6 offset:27648
  v_mfma_f32_16x16x32_bf16 v[152:155], a[148:151], a[52:55], v[152:155]
  ds_read_b64_tr_b16 a[136:137], v10 offset:24576
  v_mfma_f32_16x16x32_bf16 v[156:159], a[148:151], a[60:63], v[156:159]
  buffer_load_dwordx4 v252, s[20:23], s30 offen offset:1024 sc1 lds
  v_mfma_f32_16x16x32_bf16 v[156:159], a[144:147], a[56:59], v[156:159]
  ds_read_b128 a[112:115], v6 offset:28672
  v_mfma_f32_16x16x32_bf16 v[96:99], a[152:155], a[0:3], v[96:99]
  ds_read_b64_tr_b16 a[138:139], v10 offset:26624
  v_mfma_f32_16x16x32_bf16 v[96:99], a[156:159], a[4:7], v[96:99]
  v_mfma_f32_16x16x32_bf16 v[100:103], a[156:159], a[12:15], v[100:103]
  buffer_load_dwordx4 v253, s[20:23], s30 offen offset:2048 sc1 lds
  v_mfma_f32_16x16x32_bf16 v[100:103], a[152:155], a[8:11], v[100:103]
  ds_read_b128 a[116:119], v6 offset:29696
  v_mfma_f32_16x16x32_bf16 v[104:107], a[152:155], a[16:19], v[104:107]
  ds_read_b64_tr_b16 a[140:141], v10 offset:28672
  v_mfma_f32_16x16x32_bf16 v[104:107], a[156:159], a[20:23], v[104:107]
  buffer_load_dwordx4 v254, s[20:23], s30 offen offset:3072 sc1 lds
  v_mfma_f32_16x16x32_bf16 v[108:111], a[156:159], a[28:31], v[108:111]
  ds_read_b128 a[120:123], v6 offset:30720
  v_mfma_f32_16x16x32_bf16 v[108:111], a[152:155], a[24:27], v[108:111]
  ds_read_b64_tr_b16 a[142:143], v10 offset:30720
  v_mfma_f32_16x16x32_bf16 v[160:163], a[152:155], a[32:35], v[160:163]
  s_add_u32 s30, s30, 16384
  s_add_u32 m0, s42, 139264
  v_mfma_f32_16x16x32_bf16 v[160:163], a[156:159], a[36:39], v[160:163]
  buffer_load_dwordx4 v4, s[12:15], s33 offen offset:0 lds
  v_mfma_f32_16x16x32_bf16 v[164:167], a[156:159], a[44:47], v[164:167]
  ds_read_b128 a[124:127], v6 offset:31744
  v_mfma_f32_16x16x32_bf16 v[164:167], a[152:155], a[40:43], v[164:167]
  v_mfma_f32_16x16x32_bf16 v[168:171], a[152:155], a[48:51], v[168:171]
  buffer_load_dwordx4 v5, s[12:15], s33 offen offset:1024 lds
  v_mfma_f32_16x16x32_bf16 v[168:171], a[156:159], a[52:55], v[168:171]
  s_add_u32 s33, s33, 524288
  v_mfma_f32_16x16x32_bf16 v[172:175], a[156:159], a[60:63], v[172:175]
  v_mfma_f32_16x16x32_bf16 v[172:175], a[152:155], a[56:59], v[172:175]
  s_waitcnt vmcnt(15) lgkmcnt(0)
  s_barrier
  v_mfma_f32_16x16x32_bf16 v[48:51], a[128:131], a[64:67], v[48:51]
  s_add_u32 m0, s36, 122880
  ds_read_b64_tr_b16 a[144:145], v11 offset:0
  v_mfma_f32_16x16x32_bf16 v[48:51], a[132:135], a[68:71], v[48:51]
  buffer_load_dwordx4 v3, s[20:23], s31 offen offset:0 sc1 lds
  v_mfma_f32_16x16x32_bf16 v[52:55], a[132:135], a[76:79], v[52:55]
  ds_read_b128 a[0:3], v7 offset:0
  ds_read_b64_tr_b16 a[192:193], v13 offset:32768
  v_mfma_f32_16x16x32_bf16 v[52:55], a[128:131], a[72:75], v[52:55]
  ds_read_b64_tr_b16 a[146:147], v11 offset:2048
  v_mfma_f32_16x16x32_bf16 v[56:59], a[128:131], a[80:83], v[56:59]
  buffer_load_dwordx4 v252, s[20:23], s31 offen offset:1024 sc1 lds
  v_mfma_f32_16x16x32_bf16 v[56:59], a[132:135], a[84:87], v[56:59]
  ds_read_b128 a[4:7], v7 offset:1024
  ds_read_b64_tr_b16 a[194:195], v13 offset:34816
  v_mfma_f32_16x16x32_bf16 v[60:63], a[132:135], a[92:95], v[60:63]
  ds_read_b64_tr_b16 a[148:149], v11 offset:4096
  v_mfma_f32_16x16x32_bf16 v[60:63], a[128:131], a[88:91], v[60:63]
  ds_read_b128 a[8:11], v7 offset:2048
  v_mfma_f32_16x16x32_bf16 v[112:115], a[128:131], a[96:99], v[112:115]
  buffer_load_dwordx4 v253, s[20:23], s31 offen offset:2048 sc1 lds
  v_mfma_f32_16x16x32_bf16 v[112:115], a[132:135], a[100:103], v[112:115]
  ds_read_b64_tr_b16 a[196:197], v13 offset:36864
  v_mfma_f32_16x16x32_bf16 v[116:119], a[132:135], a[108:111], v[116:119]
  ds_read_b64_tr_b16 a[150:151], v11 offset:6144
  v_mfma_f32_16x16x32_bf16 v[116:119], a[128:131], a[104:107], v[116:119]
  ds_read_b128 a[12:15], v7 offset:3072
  v_mfma_f32_16x16x32_bf16 v[120:123], a[128:131], a[112:115], v[120:123]
  buffer_load_dwordx4 v254, s[20:23], s31 offen offset:3072 sc1 lds
  v_mfma_f32_16x16x32_bf16 v[120:123], a[132:135], a[116:119], v[120:123]
  ds_read_b64_tr_b16 a[198:199], v13 offset:38912
  ds_read_b64_tr_b16 a[152:153], v12 offset:0
  v_mfma_f32_16x16x32_bf16 v[124:127], a[132:135], a[124:127], v[124:127]
  ds_read_b128 a[16:19], v7 offset:4096
  v_mfma_f32_16x16x32_bf16 v[124:127], a[128:131], a[120:123], v[124:127]
  s_add_u32 s31, s31, 16384
  s_add_u32 m0, s42, 16384
  v_mfma_f32_16x16x32_bf16 v[64:67], a[136:139], a[64:67], v[64:67]
  buffer_load_dwordx4 v4, s[12:15], s34 offen offset:0 lds
  v_mfma_f32_16x16x32_bf16 v[64:67], a[140:143], a[68:71], v[64:67]
  ds_read_b64_tr_b16 a[200:201], v14 offset:32768
  ds_read_b64_tr_b16 a[154:155], v12 offset:2048
  v_mfma_f32_16x16x32_bf16 v[68:71], a[140:143], a[76:79], v[68:71]
  ds_read_b128 a[20:23], v7 offset:5120
  v_mfma_f32_16x16x32_bf16 v[68:71], a[136:139], a[72:75], v[68:71]
  ds_read_b64_tr_b16 a[202:203], v14 offset:34816
  v_mfma_f32_16x16x32_bf16 v[72:75], a[136:139], a[80:83], v[72:75]
  buffer_load_dwordx4 v5, s[12:15], s34 offen offset:1024 lds
  v_mfma_f32_16x16x32_bf16 v[72:75], a[140:143], a[84:87], v[72:75]
  ds_read_b64_tr_b16 a[156:157], v12 offset:4096
  ds_read_b128 a[24:27], v7 offset:6144
  s_branch L_stubHs4
L_stubH4:
  s_setpc_b64 s[4:5]
L_stubHs4:
  v_mfma_f32_16x16x32_bf16 v[76:79], a[140:143], a[92:95], v[76:79]
  ds_read_b64_tr_b16 a[204:205], v14 offset:36864
  v_mfma_f32_16x16x32_bf16 v[76:79], a[136:139], a[88:91], v[76:79]
  s_add_u32 s34, s34, 524288
  s_add_u32 m0, s36, 0
  v_mfma_f32_16x16x32_bf16 v[128:131], a[136:139], a[96:99], v[128:131]
  buffer_load_dwordx4 v3, s[20:23], s30 offen offset:0 sc1 lds
  v_mfma_f32_16x16x32_bf16 v[128:131], a[140:143], a[100:103], v[128:131]
  ds_read_b64_tr_b16 a[158:159], v12 offset:6144
  ds_read_b128 a[28:31], v7 offset:7168
  v_mfma_f32_16x16x32_bf16 v[132:135], a[140:143], a[108:111], v[132:135]
  ds_read_b64_tr_b16 a[206:207], v14 offset:38912
  v_mfma_f32_16x16x32_bf16 v[132:135], a[136:139], a[104:107], v[132:135]
  v_mfma_f32_16x16x32_bf16 v[136:139], a[136:139], a[112:115], v[136:139]
  buffer_load_dwordx4 v252, s[20:23], s30 offen offset:1024 sc1 lds
  v_mfma_f32_16x16x32_bf16 v[136:139], a[140:143], a[116:119], v[136:139]
  v_mfma_f32_16x16x32_bf16 v[140:143], a[140:143], a[124:127], v[140:143]
  v_mfma_f32_16x16x32_bf16 v[140:143], a[136:139], a[120:123], v[140:143]
  s_waitcnt vmcnt(14) lgkmcnt(0)
  s_barrier
  v_cmp_ne_u32 vcc, 0x01010101, v23
  s_nop 0
  s_cmp_eq_u64 vcc, 0
  s_cbranch_scc0 L2_h3_slowH
L2_h3_okH:
  v_mfma_f32_16x16x32_bf16 v[80:83], a[144:147], a[64:67], v[80:83]
  v_and_b32 v32, 15, v1
  v_lshlrev_b32 v32, 2, v32
  v_mfma_f32_16x16x32_bf16 v[80:83], a[148:151], a[68:71], v[80:83]
  buffer_load_dword v45, v32, s[20:23], s54 offen sc1
  v_mfma_f32_16x16x32_bf16 v[84:87], a[148:151], a[76:79], v[84:87]
  ds_read_b64_tr_b16 a[128:129], v11 offset:24576
  ds_read_b128 a[32:35], v7 offset:24576
  v_mfma_f32_16x16x32_bf16 v[84:87], a[144:147], a[72:75], v[84:87]
  s_add_u32 m0, s42, 147456
  ds_read_b64_tr_b16 a[208:209], v13 offset:40960
  v_mfma_f32_16x16x32_bf16 v[88:91], a[144:147], a[80:83], v[88:91]
  buffer_load_dwordx4 v4, s[8:11], s68 offen offset:0 lds
  v_mfma_f32_16x16x32_bf16 v[88:91], a[148:151], a[84:87], v[88:91]
  ds_read_b64_tr_b16 a[130:131], v11 offset:26624
  ds_read_b128 a[36:39], v7 offset:25600
  v_mfma_f32_16x16x32_bf16 v[92:95], a[148:151], a[92:95], v[92:95]
  ds_read_b64_tr_b16 a[210:211], v13 offset:43008
  ds_read_b64_tr_b16 a[132:133], v11 offset:28672
  v_mfma_f32_16x16x32_bf16 v[92:95], a[144:147], a[88:91], v[92:95]
  buffer_load_dwordx4 v5, s[8:11], s68 offen offset:1024 lds
  v_mfma_f32_16x16x32_bf16 v[144:147], a[144:147], a[96:99], v[144:147]
  ds_read_b128 a[40:43], v7 offset:26624
  v_mfma_f32_16x16x32_bf16 v[144:147], a[148:151], a[100:103], v[144:147]
  ds_read_b64_tr_b16 a[212:213], v13 offset:45056
  v_mfma_f32_16x16x32_bf16 v[148:151], a[148:151], a[108:111], v[148:151]
  s_add_u32 s68, s68, 131072
  s_add_u32 m0, s36, 0
  v_mfma_f32_16x16x32_bf16 v[148:151], a[144:147], a[104:107], v[148:151]
  buffer_load_dwordx4 v253, s[20:23], s30 offen offset:2048 sc1 lds
  v_mfma_f32_16x16x32_bf16 v[152:155], a[144:147], a[112:115], v[152:155]
  ds_read_b64_tr_b16 a[134:135], v11 offset:30720
  ds_read_b128 a[44:47], v7 offset:27648
  v_mfma_f32_16x16x32_bf16 v[152:155], a[148:151], a[116:119], v[152:155]
  ds_read_b64_tr_b16 a[214:215], v13 offset:47104
  ds_read_b64_tr_b16 a[136:137], v12 offset:24576
  v_mfma_f32_16x16x32_bf16 v[156:159], a[148:151], a[124:127], v[156:159]
  buffer_load_dwordx4 v254, s[20:23], s30 offen offset:3072 sc1 lds
  v_mfma_f32_16x16x32_bf16 v[156:159], a[144:147], a[120:123], v[156:159]
  ds_read_b128 a[48:51], v7 offset:28672
  ds_read_b64_tr_b16 a[216:217], v14 offset:40960
  v_mfma_f32_16x16x32_bf16 v[96:99], a[152:155], a[64:67], v[96:99]
  ds_read_b64_tr_b16 a[138:139], v12 offset:26624
  v_mfma_f32_16x16x32_bf16 v[96:99], a[156:159], a[68:71], v[96:99]
  s_add_u32 s30, s30, 12288
  s_add_u32 m0, s42, 40960
  v_mfma_f32_16x16x32_bf16 v[100:103], a[156:159], a[76:79], v[100:103]
  buffer_load_dwordx4 v4, s[12:15], s33 offen offset:0 lds
  v_mfma_f32_16x16x32_bf16 v[100:103], a[152:155], a[72:75], v[100:103]
  ds_read_b128 a[52:55], v7 offset:29696
  ds_read_b64_tr_b16 a[218:219], v14 offset:43008
  v_mfma_f32_16x16x32_bf16 v[104:107], a[152:155], a[80:83], v[104:107]
  ds_read_b64_tr_b16 a[140:141], v12 offset:28672
  v_mfma_f32_16x16x32_bf16 v[104:107], a[156:159], a[84:87], v[104:107]
  buffer_load_dwordx4 v5, s[12:15], s33 offen offset:1024 lds
  v_mfma_f32_16x16x32_bf16 v[108:111], a[156:159], a[92:95], v[108:111]
  ds_read_b128 a[56:59], v7 offset:30720
  ds_read_b64_tr_b16 a[220:221], v14 offset:45056
  v_mfma_f32_16x16x32_bf16 v[108:111], a[152:155], a[88:91], v[108:111]
  ds_read_b64_tr_b16 a[142:143], v12 offset:30720
  v_mfma_f32_16x16x32_bf16 v[160:163], a[152:155], a[96:99], v[160:163]
  s_add_u32 s33, s33, 393216
  s_add_u32 m0, s36, 24576
  v_mfma_f32_16x16x32_bf16 v[160:163], a[156:159], a[100:103], v[160:163]
  buffer_load_dwordx4 v3, s[20:23], s31 offen offset:0 sc1 lds
  v_mfma_f32_16x16x32_bf16 v[164:167], a[156:159], a[108:111], v[164:167]
  ds_read_b128 a[60:63], v7 offset:31744
  ds_read_b64_tr_b16 a[222:223], v14 offset:47104
  v_mfma_f32_16x16x32_bf16 v[164:167], a[152:155], a[104:107], v[164:167]
  v_mfma_f32_16x16x32_bf16 v[168:171], a[152:155], a[112:115], v[168:171]
  buffer_load_dwordx4 v252, s[20:23], s31 offen offset:1024 sc1 lds
  v_mfma_f32_16x16x32_bf16 v[168:171], a[156:159], a[116:119], v[168:171]
  v_mfma_f32_16x16x32_bf16 v[172:175], a[156:159], a[124:127], v[172:175]
  v_mfma_f32_16x16x32_bf16 v[172:175], a[152:155], a[120:123], v[172:175]
  s_waitcnt vmcnt(19) lgkmcnt(0)
  s_barrier
  v_mfma_f32_16x16x32_bf16 v[48:51], a[128:131], a[0:3], v[48:51]
  s_add_u32 m0, s42, 155648
  ds_read_b64_tr_b16 a[144:145], v13 offset:0
  v_mfma_f32_16x16x32_bf16 v[48:51], a[132:135], a[4:7], v[48:51]
  buffer_load_dwordx4 v4, s[8:11], s68 offen offset:0 lds
  v_mfma_f32_16x16x32_bf16 v[52:55], a[132:135], a[12:15], v[52:55]
  ds_read_b128 a[64:67], v8 offset:0
  v_mfma_f32_16x16x32_bf16 v[52:55], a[128:131], a[8:11], v[52:55]
  ds_read_b64_tr_b16 a[146:147], v13 offset:2048
  v_mfma_f32_16x16x32_bf16 v[56:59], a[128:131], a[16:19], v[56:59]
  buffer_load_dwordx4 v5, s[8:11], s68 offen offset:1024 lds
  v_mfma_f32_16x16x32_bf16 v[56:59], a[132:135], a[20:23], v[56:59]
  ds_read_b128 a[68:71], v8 offset:1024
  v_mfma_f32_16x16x32_bf16 v[60:63], a[132:135], a[28:31], v[60:63]
  ds_read_b64_tr_b16 a[148:149], v13 offset:4096
  v_mfma_f32_16x16x32_bf16 v[60:63], a[128:131], a[24:27], v[60:63]
  s_add_u32 s68, s68, 131072
  s_add_u32 m0, s36, 24576
  v_mfma_f32_16x16x32_bf16 v[112:115], a[128:131], a[32:35], v[112:115]
  buffer_load_dwordx4 v253, s[20:23], s31 offen offset:2048 sc1 lds
  v_mfma_f32_16x16x32_bf16 v[112:115], a[132:135], a[36:39], v[112:115]
  ds_read_b128 a[72:75], v8 offset:2048
  v_mfma_f32_16x16x32_bf16 v[116:119], a[132:135], a[44:47], v[116:119]
  ds_read_b64_tr_b16 a[150:151], v13 offset:6144
  v_mfma_f32_16x16x32_bf16 v[116:119], a[128:131], a[40:43], v[116:119]
  ds_read_b128 a[76:79], v8 offset:3072
  v_mfma_f32_16x16x32_bf16 v[120:123], a[128:131], a[48:51], v[120:123]
  buffer_load_dwordx4 v254, s[20:23], s31 offen offset:3072 sc1 lds
  v_mfma_f32_16x16x32_bf16 v[120:123], a[132:135], a[52:55], v[120:123]
  ds_read_b64_tr_b16 a[152:153], v14 offset:0
  v_mfma_f32_16x16x32_bf16 v[124:127], a[132:135], a[60:63], v[124:127]
  v_mfma_f32_16x16x32_bf16 v[124:127], a[128:131], a[56:59], v[124:127]
  s_add_u32 s31, s31, 12288
  s_add_u32 m0, s42, 65536
  v_mfma_f32_16x16x32_bf16 v[64:67], a[136:139], a[0:3], v[64:67]
  buffer_load_dwordx4 v4, s[12:15], s34 offen offset:0 lds
  v_mfma_f32_16x16x32_bf16 v[64:67], a[140:143], a[4:7], v[64:67]
  ds_read_b128 a[80:83], v8 offset:4096
  ds_read_b64_tr_b16 a[154:155], v14 offset:2048
  v_mfma_f32_16x16x32_bf16 v[68:71], a[140:143], a[12:15], v[68:71]
  ds_read_b128 a[84:87], v8 offset:5120
  v_mfma_f32_16x16x32_bf16 v[68:71], a[136:139], a[8:11], v[68:71]
  v_mfma_f32_16x16x32_bf16 v[72:75], a[136:139], a[16:19], v[72:75]
  buffer_load_dwordx4 v5, s[12:15], s34 offen offset:1024 lds
  v_mfma_f32_16x16x32_bf16 v[72:75], a[140:143], a[20:23], v[72:75]
  ds_read_b64_tr_b16 a[156:157], v14 offset:4096
  ds_read_b128 a[88:91], v8 offset:6144
  v_mfma_f32_16x16x32_bf16 v[76:79], a[140:143], a[28:31], v[76:79]
  v_mfma_f32_16x16x32_bf16 v[76:79], a[136:139], a[24:27], v[76:79]
  s_add_u32 s34, s34, 393216
  s_add_u32 m0, s36, 49152
  v_mfma_f32_16x16x32_bf16 v[128:131], a[136:139], a[32:35], v[128:131]
  buffer_load_dwordx4 v3, s[20:23], s30 offen offset:0 sc1 lds
  v_mfma_f32_16x16x32_bf16 v[128:131], a[140:143], a[36:39], v[128:131]
  ds_read_b64_tr_b16 a[158:159], v14 offset:6144
  ds_read_b128 a[92:95], v8 offset:7168
  v_mfma_f32_16x16x32_bf16 v[132:135], a[140:143], a[44:47], v[132:135]
  v_mfma_f32_16x16x32_bf16 v[132:135], a[136:139], a[40:43], v[132:135]
  v_mfma_f32_16x16x32_bf16 v[136:139], a[136:139], a[48:51], v[136:139]
  buffer_load_dwordx4 v252, s[20:23], s30 offen offset:1024 sc1 lds
  v_mfma_f32_16x16x32_bf16 v[136:139], a[140:143], a[52:55], v[136:139]
  v_mfma_f32_16x16x32_bf16 v[140:143], a[140:143], a[60:63], v[140:143]
  v_mfma_f32_16x16x32_bf16 v[140:143], a[136:139], a[56:59], v[140:143]
  s_waitcnt vmcnt(14) lgkmcnt(0)
  s_barrier
  v_cmp_ne_u32 vcc, 1, v45
  s_nop 0
  s_cmp_eq_u64 vcc, 0
  s_cbranch_scc0 L2_k_slowH
L2_k_okH:
  v_mfma_f32_16x16x32_bf16 v[80:83], a[144:147], a[0:3], v[80:83]
  v_and_b32 v33, 3, v1
  v_lshlrev_b32 v33, 2, v33
  s_lshl_b32 s87, s44, 3
  s_add_u32 s87, s87, s25
  s_lshr_b32 s87, s87, 1
  s_lshl_b32 s87, s87, 7
  s_add_u32 s87, s87, 40124416
  v_mfma_f32_16x16x32_bf16 v[80:83], a[148:151], a[4:7], v[80:83]
  buffer_load_dword v46, v33, s[20:23], s87 offen sc1
  v_mfma_f32_16x16x32_bf16 v[84:87], a[148:151], a[12:15], v[84:87]
  ds_read_b64_tr_b16 a[128:129], v13 offset:24576
  ds_read_b128 a[96:99], v8 offset:24576
  v_mfma_f32_16x16x32_bf16 v[84:87], a[144:147], a[8:11], v[84:87]
  buffer_load_dword v47, v34, s[20:23], s96 offen offset:4 sc1
  v_mfma_f32_16x16x32_bf16 v[88:91], a[144:147], a[16:19], v[88:91]
  ds_read_b64_tr_b16 a[224:225], v13 offset:32768
  ds_read_b64_tr_b16 a[130:131], v13 offset:26624
  v_mfma_f32_16x16x32_bf16 v[88:91], a[148:151], a[20:23], v[88:91]
  s_lshl_b32 s94, s44, 10
  s_add_u32 s94, s94, 39845888
  v_mfma_f32_16x16x32_bf16 v[92:95], a[148:151], a[28:31], v[92:95]
  buffer_load_dwordx4 v[36:39], v17, s[20:23], s94 offen sc1
  v_mfma_f32_16x16x32_bf16 v[92:95], a[144:147], a[24:27], v[92:95]
  ds_read_b128 a[100:103], v8 offset:25600
  ds_read_b64_tr_b16 a[226:227], v13 offset:34816
  v_mfma_f32_16x16x32_bf16 v[144:147], a[144:147], a[32:35], v[144:147]
  buffer_load_dwordx4 v[40:43], v17, s[20:23], s94 offen offset:512 sc1
  v_mfma_f32_16x16x32_bf16 v[144:147], a[148:151], a[36:39], v[144:147]
  ds_read_b64_tr_b16 a[132:133], v13 offset:28672
  ds_read_b128 a[104:107], v8 offset:26624
  v_mfma_f32_16x16x32_bf16 v[148:151], a[148:151], a[44:47], v[148:151]
  s_lshl_b32 s94, s44, 16
  s_add_u32 s94, s94, s42
  s_add_u32 s94, s94, 37748736
  v_mfma_f32_16x16x32_bf16 v[148:151], a[144:147], a[40:43], v[148:151]
  buffer_load_dwordx4 v[176:179], v3, s[20:23], s94 offen sc1
  v_mfma_f32_16x16x32_bf16 v[152:155], a[144:147], a[48:51], v[152:155]
  s_add_u32 s94, s94, 8192
  ds_read_b64_tr_b16 a[228:229], v13 offset:36864
  v_mfma_f32_16x16x32_bf16 v[152:155], a[148:151], a[52:55], v[152:155]
  buffer_load_dwordx4 v[180:183], v3, s[20:23], s94 offen sc1
  v_mfma_f32_16x16x32_bf16 v[156:159], a[148:151], a[60:63], v[156:159]
  ds_read_b64_tr_b16 a[134:135], v13 offset:30720
  ds_read_b128 a[108:111], v8 offset:27648
  v_mfma_f32_16x16x32_bf16 v[156:159], a[144:147], a[56:59], v[156:159]
  s_add_u32 s94, s94, 8192
  ds_read_b64_tr_b16 a[230:231], v13 offset:38912
  v_mfma_f32_16x16x32_bf16 v[96:99], a[152:155], a[0:3], v[96:99]
  buffer_load_dwordx4 v[184:187], v3, s[20:23], s94 offen sc1
  v_mfma_f32_16x16x32_bf16 v[96:99], a[156:159], a[4:7], v[96:99]
  ds_read_b64_tr_b16 a[136:137], v14 offset:24576
  ds_read_b128 a[112:115], v8 offset:28672
  v_mfma_f32_16x16x32_bf16 v[100:103], a[156:159], a[12:15], v[100:103]
  ds_read_b64_tr_b16 a[232:233], v14 offset:32768
  ds_read_b64_tr_b16 a[138:139], v14 offset:26624
  v_mfma_f32_16x16x32_bf16 v[100:103], a[152:155], a[8:11], v[100:103]
  buffer_load_dwordx4 v253, s[20:23], s30 offen offset:2048 sc1 lds
  v_mfma_f32_16x16x32_bf16 v[104:107], a[152:155], a[16:19], v[104:107]
  ds_read_b128 a[116:119], v8 offset:29696
  ds_read_b64_tr_b16 a[234:235], v14 offset:34816
  v_mfma_f32_16x16x32_bf16 v[104:107], a[156:159], a[20:23], v[104:107]
  buffer_load_dwordx4 v254, s[20:23], s30 offen offset:3072 sc1 lds
  v_mfma_f32_16x16x32_bf16 v[108:111], a[156:159], a[28:31], v[108:111]
  ds_read_b64_tr_b16 a[140:141], v14 offset:28672
  ds_read_b128 a[120:123], v8 offset:30720
  v_mfma_f32_16x16x32_bf16 v[108:111], a[152:155], a[24:27], v[108:111]
  s_sub_u32 s30, s30, 36864
  s_add_u32 m0, s42, 90112
  v_mfma_f32_16x16x32_bf16 v[160:163], a[152:155], a[32:35], v[160:163]
  buffer_load_dwordx4 v4, s[12:15], s33 offen offset:0 lds
  v_mfma_f32_16x16x32_bf16 v[160:163], a[156:159], a[36:39], v[160:163]
  ds_read_b64_tr_b16 a[236:237], v14 offset:36864
  ds_read_b64_tr_b16 a[142:143], v14 offset:30720
  ds_read_b128 a[124:127], v8 offset:31744
  v_mfma_f32_16x16x32_bf16 v[164:167], a[156:159], a[44:47], v[164:167]
  buffer_load_dwordx4 v5, s[12:15], s33 offen offset:1024 lds
  ds_read_b64_tr_b16 a[238:239], v14 offset:38912
  v_mfma_f32_16x16x32_bf16 v[164:167], a[152:155], a[40:43], v[164:167]
  v_mfma_f32_16x16x32_bf16 v[168:171], a[152:155], a[48:51], v[168:171]
  s_sub_u32 s33, s33, 1179648
  s_add_u32 m0, s36, 73728
  v_mfma_f32_16x16x32_bf16 v[168:171], a[156:159], a[52:55], v[168:171]
  buffer_load_dwordx4 v3, s[20:23], s31 offen offset:0 sc1 lds
  v_mfma_f32_16x16x32_bf16 v[172:175], a[156:159], a[60:63], v[172:175]
  v_mfma_f32_16x16x32_bf16 v[172:175], a[152:155], a[56:59], v[172:175]
  s_waitcnt vmcnt(18) lgkmcnt(0)
  s_barrier
  v_mfma_f32_16x16x32_bf16 v[48:51], a[128:131], a[64:67], v[48:51]
  s_add_u32 s94, s94, 8192
  ds_read_b64_tr_b16 a[144:145], v9 offset:0
  v_mfma_f32_16x16x32_bf16 v[48:51], a[132:135], a[68:71], v[48:51]
  buffer_load_dwordx4 v[188:191], v3, s[20:23], s94 offen sc1
  v_mfma_f32_16x16x32_bf16 v[52:55], a[132:135], a[76:79], v[52:55]
  ds_read_b128 a[0:3], v6 offset:0
  ds_read_b64_tr_b16 a[240:241], v13 offset:40960
  v_mfma_f32_16x16x32_bf16 v[52:55], a[128:131], a[72:75], v[52:55]
  s_add_u32 s94, s94, 8192
  ds_read_b64_tr_b16 a[146:147], v9 offset:2048
  v_mfma_f32_16x16x32_bf16 v[56:59], a[128:131], a[80:83], v[56:59]
  buffer_load_dwordx4 v[192:195], v3, s[20:23], s94 offen sc1
  v_mfma_f32_16x16x32_bf16 v[56:59], a[132:135], a[84:87], v[56:59]
  ds_read_b128 a[4:7], v6 offset:1024
  ds_read_b64_tr_b16 a[242:243], v13 offset:43008
  v_mfma_f32_16x16x32_bf16 v[60:63], a[132:135], a[92:95], v[60:63]
  s_add_u32 s94, s94, 8192
  ds_read_b64_tr_b16 a[148:149], v9 offset:4096
  v_mfma_f32_16x16x32_bf16 v[60:63], a[128:131], a[88:91], v[60:63]
  buffer_load_dwordx4 v[196:199], v3, s[20:23], s94 offen sc1
  v_mfma_f32_16x16x32_bf16 v[112:115], a[128:131], a[96:99], v[112:115]
  ds_read_b128 a[8:11], v6 offset:2048
  v_mfma_f32_16x16x32_bf16 v[112:115], a[132:135], a[100:103], v[112:115]
  s_add_u32 s94, s94, 8192
  ds_read_b64_tr_b16 a[244:245], v13 offset:45056
  v_mfma_f32_16x16x32_bf16 v[116:119], a[132:135], a[108:111], v[116:119]
  buffer_load_dwordx4 v[200:203], v3, s[20:23], s94 offen sc1
  v_mfma_f32_16x16x32_bf16 v[116:119], a[128:131], a[104:107], v[116:119]
  ds_read_b64_tr_b16 a[150:151], v9 offset:6144
  ds_read_b128 a[12:15], v6 offset:3072
  v_mfma_f32_16x16x32_bf16 v[120:123], a[128:131], a[112:115], v[120:123]
  s_add_u32 s94, s94, 8192
  ds_read_b64_tr_b16 a[246:247], v13 offset:47104
  v_mfma_f32_16x16x32_bf16 v[120:123], a[132:135], a[116:119], v[120:123]
  buffer_load_dwordx4 v[204:207], v3, s[20:23], s94 offen sc1
  v_mfma_f32_16x16x32_bf16 v[124:127], a[132:135], a[124:127], v[124:127]
  ds_read_b64_tr_b16 a[152:153], v10 offset:0
  ds_read_b128 a[16:19], v6 offset:4096
  v_mfma_f32_16x16x32_bf16 v[124:127], a[128:131], a[120:123], v[124:127]
  ds_read_b64_tr_b16 a[248:249], v14 offset:40960
  v_mfma_f32_16x16x32_bf16 v[64:67], a[136:139], a[64:67], v[64:67]
  buffer_load_dwordx4 v252, s[20:23], s31 offen offset:1024 sc1 lds
  v_mfma_f32_16x16x32_bf16 v[64:67], a[140:143], a[68:71], v[64:67]
  ds_read_b64_tr_b16 a[154:155], v10 offset:2048
  v_mfma_f32_16x16x32_bf16 v[68:71], a[140:143], a[76:79], v[68:71]
  ds_read_b128 a[20:23], v6 offset:5120
  v_mfma_f32_16x16x32_bf16 v[68:71], a[136:139], a[72:75], v[68:71]
  buffer_load_dwordx4 v253, s[20:23], s31 offen offset:2048 sc1 lds
  v_mfma_f32_16x16x32_bf16 v[72:75], a[136:139], a[80:83], v[72:75]
  ds_read_b64_tr_b16 a[250:251], v14 offset:43008
  ds_read_b64_tr_b16 a[156:157], v10 offset:4096
  v_mfma_f32_16x16x32_bf16 v[72:75], a[140:143], a[84:87], v[72:75]
  ds_read_b128 a[24:27], v6 offset:6144
  v_mfma_f32_16x16x32_bf16 v[76:79], a[140:143], a[92:95], v[76:79]
  buffer_load_dwordx4 v254, s[20:23], s31 offen offset:3072 sc1 lds
  v_mfma_f32_16x16x32_bf16 v[76:79], a[136:139], a[88:91], v[76:79]
  ds_read_b64_tr_b16 a[252:253], v14 offset:45056
  ds_read_b64_tr_b16 a[158:159], v10 offset:6144
  v_mfma_f32_16x16x32_bf16 v[128:131], a[136:139], a[96:99], v[128:131]
  s_sub_u32 s31, s31, 36864
  s_add_u32 m0, s42, 114688
  v_mfma_f32_16x16x32_bf16 v[128:131], a[140:143], a[100:103], v[128:131]
  buffer_load_dwordx4 v4, s[12:15], s34 offen offset:0 lds
  v_mfma_f32_16x16x32_bf16 v[132:135], a[140:143], a[108:111], v[132:135]
  ds_read_b128 a[28:31], v6 offset:7168
  ds_read_b64_tr_b16 a[254:255], v14 offset:47104
  v_mfma_f32_16x16x32_bf16 v[132:135], a[136:139], a[104:107], v[132:135]
  v_mfma_f32_16x16x32_bf16 v[136:139], a[136:139], a[112:115], v[136:139]
  buffer_load_dwordx4 v5, s[12:15], s34 offen offset:1024 lds
  v_mfma_f32_16x16x32_bf16 v[136:139], a[140:143], a[116:119], v[136:139]
  s_sub_u32 s34, s34, 1179648
  v_mfma_f32_16x16x32_bf16 v[140:143], a[140:143], a[124:127], v[140:143]
  v_mfma_f32_16x16x32_bf16 v[140:143], a[136:139], a[120:123], v[140:143]
  s_waitcnt vmcnt(15) lgkmcnt(0)
  s_barrier
  v_cmp_ne_u32 vcc, 1, v46
  s_nop 0
  s_cmp_eq_u64 vcc, 0
  s_cbranch_scc0 L2_q_slowH
L2_q_okH:
  v_cmp_ne_u32 vcc, 1, v47
  s_nop 0
  s_cmp_eq_u64 vcc, 0
  s_cbranch_scc0 L2_g_slowH
L2_g_okH:
  v_mfma_f32_16x16x32_bf16 v[80:83], a[144:147], a[64:67], v[80:83]
  s_lshl_b32 s7, s45, 6
  s_add_u32 s7, s7, 39911424
  v_add_f32_dpp v36, v36, v36 quad_perm:[1,0,3,2] row_mask:0xf bank_mask:0xf
  v_mfma_f32_16x16x32_bf16 v[80:83], a[148:151], a[68:71], v[80:83]
  buffer_load_dwordx4 v[28:31], v18, s[20:23], s7 offen offset:0 sc1
  v_add_f32_dpp v37, v37, v37 quad_perm:[1,0,3,2] row_mask:0xf bank_mask:0xf
  v_mfma_f32_16x16x32_bf16 v[84:87], a[148:151], a[76:79], v[84:87]
  s_mul_i32 s94, s45, 144
  s_add_u32 s94, s94, s44
  s_add_u32 s94, s94, 112
  s_lshl_b32 s94, s94, 11
  s_mov_b32 s95, s94
  v_mfma_f32_16x16x32_bf16 v[84:87], a[144:147], a[72:75], v[84:87]
  buffer_load_dwordx4 v[208:211], v3, s[20:23], s94 offen sc1
  v_add_f32_dpp v38, v38, v38 quad_perm:[1,0,3,2] row_mask:0xf bank_mask:0xf
  v_mfma_f32_16x16x32_bf16 v[88:91], a[144:147], a[80:83], v[88:91]
  ds_read_b64_tr_b16 a[128:129], v9 offset:24576
  ds_read_b128 a[32:35], v6 offset:24576
  v_add_f32_dpp v39, v39, v39 quad_perm:[1,0,3,2] row_mask:0xf bank_mask:0xf
  v_mfma_f32_16x16x32_bf16 v[88:91], a[148:151], a[84:87], v[88:91]
  s_add_u32 s94, s94, 294912
  ds_read_b64_tr_b16 a[130:131], v9 offset:26624
  v_add_f32_dpp v40, v40, v40 quad_perm:[1,0,3,2] row_mask:0xf bank_mask:0xf
  v_mfma_f32_16x16x32_bf16 v[92:95], a[148:151], a[92:95], v[92:95]
  buffer_load_dwordx4 v[212:215], v3, s[20:23], s94 offen sc1
  v_add_f32_dpp v41, v41, v41 quad_perm:[1,0,3,2] row_mask:0xf bank_mask:0xf
  v_mfma_f32_16x16x32_bf16 v[92:95], a[144:147], a[88:91], v[92:95]
  ds_read_b128 a[36:39], v6 offset:25600
  ds_read_b64_tr_b16 a[132:133], v9 offset:28672
  v_add_f32_dpp v42, v42, v42 quad_perm:[1,0,3,2] row_mask:0xf bank_mask:0xf
  v_mfma_f32_16x16x32_bf16 v[144:147], a[144:147], a[96:99], v[144:147]
  s_add_u32 s94, s94, 294912
  ds_read_b128 a[40:43], v6 offset:26624
  v_add_f32_dpp v43, v43, v43 quad_perm:[1,0,3,2] row_mask:0xf bank_mask:0xf
  v_mfma_f32_16x16x32_bf16 v[144:147], a[148:151], a[100:103], v[144:147]
  buffer_load_dwordx4 v[216:219], v3, s[20:23], s94 offen sc1
  v_add_f32_dpp v36, v36, v36 quad_perm:[2,3,0,1] row_mask:0xf bank_mask:0xf
  v_mfma_f32_16x16x32_bf16 v[148:151], a[148:151], a[108:111], v[148:151]
  ds_read_b64_tr_b16 a[134:135], v9 offset:30720
  v_add_f32_dpp v37, v37, v37 quad_perm:[2,3,0,1] row_mask:0xf bank_mask:0xf
  v_add_f32_dpp v38, v38, v38 quad_perm:[2,3,0,1] row_mask:0xf bank_mask:0xf
  v_mfma_f32_16x16x32_bf16 v[148:151], a[144:147], a[104:107], v[148:151]
  s_add_u32 s94, s94, 294912
  ds_read_b128 a[44:47], v6 offset:27648
  v_add_f32_dpp v39, v39, v39 quad_perm:[2,3,0,1] row_mask:0xf bank_mask:0xf
  v_mfma_f32_16x16x32_bf16 v[152:155], a[144:147], a[112:115], v[152:155]
  buffer_load_dwordx4 v[220:223], v3, s[20:23], s94 offen sc1
  v_add_f32_dpp v40, v40, v40 quad_perm:[2,3,0,1] row_mask:0xf bank_mask:0xf
  v_mfma_f32_16x16x32_bf16 v[152:155], a[148:151], a[116:119], v[152:155]
  ds_read_b64_tr_b16 a[136:137], v10 offset:24576
  v_add_f32_dpp v41, v41, v41 quad_perm:[2,3,0,1] row_mask:0xf bank_mask:0xf
  v_add_f32_dpp v42, v42, v42 quad_perm:[2,3,0,1] row_mask:0xf bank_mask:0xf
  v_mfma_f32_16x16x32_bf16 v[156:159], a[148:151], a[124:127], v[156:159]
  s_add_u32 s94, s94, 294912
  v_add_f32_dpp v43, v43, v43 quad_perm:[2,3,0,1] row_mask:0xf bank_mask:0xf
  v_add_f32_dpp v36, v36, v36 row_half_mirror row_mask:0xf bank_mask:0xf
  v_mfma_f32_16x16x32_bf16 v[156:159], a[144:147], a[120:123], v[156:159]
  buffer_load_dwordx4 v[224:227], v3, s[20:23], s94 offen sc1
  v_add_f32_dpp v37, v37, v37 row_half_mirror row_mask:0xf bank_mask:0xf
  v_mfma_f32_16x16x32_bf16 v[96:99], a[152:155], a[64:67], v[96:99]
  s_add_u32 m0, s36, 98304
  ds_read_b128 a[48:51], v6 offset:28672
  v_add_f32_dpp v38, v38, v38 row_half_mirror row_mask:0xf bank_mask:0xf
  v_mfma_f32_16x16x32_bf16 v[96:99], a[156:159], a[68:71], v[96:99]
  buffer_load_dwordx4 v3, s[20:23], s30 offen offset:0 sc1 lds
  v_add_f32_dpp v39, v39, v39 row_half_mirror row_mask:0xf bank_mask:0xf
  v_mfma_f32_16x16x32_bf16 v[100:103], a[156:159], a[76:79], v[100:103]
  ds_read_b64_tr_b16 a[138:139], v10 offset:26624
  ds_read_b128 a[52:55], v6 offset:29696
  v_add_f32_dpp v40, v40, v40 row_half_mirror row_mask:0xf bank_mask:0xf
  v_mfma_f32_16x16x32_bf16 v[100:103], a[152:155], a[72:75], v[100:103]
  v_add_f32_dpp v41, v41, v41 row_half_mirror row_mask:0xf bank_mask:0xf
  v_add_f32_dpp v42, v42, v42 row_half_mirror row_mask:0xf bank_mask:0xf
  v_add_f32_dpp v43, v43, v43 row_half_mirror row_mask:0xf bank_mask:0xf
  v_mfma_f32_16x16x32_bf16 v[104:107], a[152:155], a[80:83], v[104:107]
  buffer_load_dwordx4 v252, s[20:23], s30 offen offset:1024 sc1 lds
  v_cvt_pk_bf16_f32 v36, v36, v37
  v_mfma_f32_16x16x32_bf16 v[104:107], a[156:159], a[84:87], v[104:107]
  ds_read_b64_tr_b16 a[140:141], v10 offset:28672
  ds_read_b128 a[56:59], v6 offset:30720
  v_cvt_pk_bf16_f32 v37, v38, v39
  v_mfma_f32_16x16x32_bf16 v[108:111], a[156:159], a[92:95], v[108:111]
  v_cvt_pk_bf16_f32 v38, v40, v41
  v_cvt_pk_bf16_f32 v39, v42, v43
  s_lshl_b32 s4, s39, 10
  v_mfma_f32_16x16x32_bf16 v[108:111], a[152:155], a[88:91], v[108:111]
  buffer_load_dwordx4 v253, s[20:23], s30 offen offset:2048 sc1 lds
  s_lshl_b32 s5, s38, 3
  v_mfma_f32_16x16x32_bf16 v[160:163], a[152:155], a[96:99], v[160:163]
  ds_read_b64_tr_b16 a[142:143], v10 offset:30720
  s_add_u32 s4, s4, s5
  s_add_u32 s4, s4, 147456
  v_mfma_f32_16x16x32_bf16 v[160:163], a[156:159], a[100:103], v[160:163]
  ds_read_b128 a[60:63], v6 offset:31744
  v_add_u32 v24, s4, v2
  v_add_u32 v25, 147456, v2
  v_mfma_f32_16x16x32_bf16 v[164:167], a[156:159], a[108:111], v[164:167]
  buffer_load_dwordx4 v254, s[20:23], s30 offen offset:3072 sc1 lds
  v_add_f32 v176, v176, v180
  v_mfma_f32_16x16x32_bf16 v[164:167], a[152:155], a[104:107], v[164:167]
  v_add_f32 v177, v177, v181
  v_add_f32 v178, v178, v182
  v_add_f32 v179, v179, v183
  v_add_f32 v176, v176, v184
  v_add_f32 v177, v177, v185
  v_mfma_f32_16x16x32_bf16 v[168:171], a[152:155], a[112:115], v[168:171]
  s_add_u32 s30, s30, 12288
  s_add_u32 m0, s42, 139264
  v_mfma_f32_16x16x32_bf16 v[168:171], a[156:159], a[116:119], v[168:171]
  buffer_load_dwordx4 v4, s[12:15], s33 offen offset:0 lds
  v_mfma_f32_16x16x32_bf16 v[172:175], a[156:159], a[124:127], v[172:175]
  v_mfma_f32_16x16x32_bf16 v[172:175], a[152:155], a[120:123], v[172:175]
  s_waitcnt vmcnt(16) lgkmcnt(0)
  s_barrier
  v_mfma_f32_16x16x32_bf16 v[48:51], a[128:131], a[0:3], v[48:51]
  s_lshl_b32 s7, s45, 6
  s_add_u32 s7, s7, 39911424
  v_add_f32 v178, v178, v186
  v_mfma_f32_16x16x32_bf16 v[48:51], a[132:135], a[4:7], v[48:51]
  buffer_load_dwordx4 v[40:43], v18, s[20:23], s7 offen offset:256 sc1
  v_add_f32 v179, v179, v187
  v_mfma_f32_16x16x32_bf16 v[52:55], a[132:135], a[12:15], v[52:55]
  ds_read_b64_tr_b16 a[144:145], v11 offset:0
  ds_read_b128 a[64:67], v7 offset:0
  v_add_f32 v176, v176, v188
  v_mfma_f32_16x16x32_bf16 v[52:55], a[128:131], a[8:11], v[52:55]
  s_add_u32 s94, s94, 294912
  ds_read_b64_tr_b16 a[146:147], v11 offset:2048
  v_add_f32 v177, v177, v189
  v_mfma_f32_16x16x32_bf16 v[56:59], a[128:131], a[16:19], v[56:59]
  buffer_load_dwordx4 v[228:231], v3, s[20:23], s94 offen sc1
  v_add_f32 v178, v178, v190
  v_mfma_f32_16x16x32_bf16 v[56:59], a[132:135], a[20:23], v[56:59]
  ds_read_b128 a[68:71], v7 offset:1024
  v_add_f32 v179, v179, v191
  v_mfma_f32_16x16x32_bf16 v[60:63], a[132:135], a[28:31], v[60:63]
  s_add_u32 s94, s94, 294912
  ds_read_b64_tr_b16 a[148:149], v11 offset:4096
  v_add_f32 v176, v176, v192
  v_mfma_f32_16x16x32_bf16 v[60:63], a[128:131], a[24:27], v[60:63]
  buffer_load_dwordx4 v[232:235], v3, s[20:23], s94 offen sc1
  v_add_f32 v177, v177, v193
  v_mfma_f32_16x16x32_bf16 v[112:115], a[128:131], a[32:35], v[112:115]
  ds_read_b128 a[72:75], v7 offset:2048
  v_add_f32 v178, v178, v194
  v_mfma_f32_16x16x32_bf16 v[112:115], a[132:135], a[36:39], v[112:115]
  v_mfma_f32_16x16x32_bf16 v[116:119], a[132:135], a[44:47], v[116:119]
  s_add_u32 s94, s94, 294912
  ds_read_b64_tr_b16 a[150:151], v11 offset:6144
  v_add_f32 v179, v179, v195
  v_mfma_f32_16x16x32_bf16 v[116:119], a[128:131], a[40:43], v[116:119]
  buffer_load_dwordx4 v[236:239], v3, s[20:23], s94 offen sc1
  v_add_f32 v176, v176, v196
  v_mfma_f32_16x16x32_bf16 v[120:123], a[128:131], a[48:51], v[120:123]
  ds_read_b128 a[76:79], v7 offset:3072
  v_add_f32 v177, v177, v197
  v_mfma_f32_16x16x32_bf16 v[120:123], a[132:135], a[52:55], v[120:123]
  ds_read_b64_tr_b16 a[152:153], v12 offset:0
  v_add_f32 v178, v178, v198
  v_mfma_f32_16x16x32_bf16 v[124:127], a[132:135], a[60:63], v[124:127]
  buffer_load_dwordx4 v5, s[12:15], s33 offen offset:1024 lds
  v_add_f32 v179, v179, v199
  v_mfma_f32_16x16x32_bf16 v[124:127], a[128:131], a[56:59], v[124:127]
  ds_read_b128 a[80:83], v7 offset:4096
  v_add_f32 v176, v176, v200
  v_mfma_f32_16x16x32_bf16 v[64:67], a[136:139], a[0:3], v[64:67]
  ds_read_b64_tr_b16 a[154:155], v12 offset:2048
  v_add_f32 v177, v177, v201
  v_mfma_f32_16x16x32_bf16 v[64:67], a[140:143], a[4:7], v[64:67]
  s_add_u32 s33, s33, 393216
  s_add_u32 m0, s36, 122880
  v_add_f32 v178, v178, v202
  v_mfma_f32_16x16x32_bf16 v[68:71], a[140:143], a[12:15], v[68:71]
  buffer_load_dwordx4 v3, s[20:23], s31 offen offset:0 sc1 lds
  v_mfma_f32_16x16x32_bf16 v[68:71], a[136:139], a[8:11], v[68:71]
  ds_read_b128 a[84:87], v7 offset:5120
  v_add_f32 v179, v179, v203
  v_mfma_f32_16x16x32_bf16 v[72:75], a[136:139], a[16:19], v[72:75]
  ds_read_b64_tr_b16 a[156:157], v12 offset:4096
  v_add_f32 v176, v176, v204
  v_mfma_f32_16x16x32_bf16 v[72:75], a[140:143], a[20:23], v[72:75]
  buffer_load_dwordx4 v252, s[20:23], s31 offen offset:1024 sc1 lds
  v_add_f32 v177, v177, v205
  v_mfma_f32_16x16x32_bf16 v[76:79], a[140:143], a[28:31], v[76:79]
  ds_read_b128 a[88:91], v7 offset:6144
  v_add_f32 v178, v178, v206
  v_mfma_f32_16x16x32_bf16 v[76:79], a[136:139], a[24:27], v[76:79]
  ds_read_b64_tr_b16 a[158:159], v12 offset:6144
  v_add_f32 v179, v179, v207
  v_mfma_f32_16x16x32_bf16 v[128:131], a[136:139], a[32:35], v[128:131]
  v_cvt_pk_bf16_f32 v176, v176, v177
  v_mfma_f32_16x16x32_bf16 v[128:131], a[140:143], a[36:39], v[128:131]
  buffer_load_dwordx4 v253, s[20:23], s31 offen offset:2048 sc1 lds
  v_cvt_pk_bf16_f32 v177, v178, v179
  v_mfma_f32_16x16x32_bf16 v[132:135], a[140:143], a[44:47], v[132:135]
  ds_read_b128 a[92:95], v7 offset:7168
  ds_write_b64 v24, v[176:177]
  v_mfma_f32_16x16x32_bf16 v[132:135], a[136:139], a[40:43], v[132:135]
  v_mfma_f32_16x16x32_bf16 v[136:139], a[136:139], a[48:51], v[136:139]
  buffer_load_dwordx4 v254, s[20:23], s31 offen offset:3072 sc1 lds
  v_mfma_f32_16x16x32_bf16 v[136:139], a[140:143], a[52:55], v[136:139]
  s_add_u32 s31, s31, 12288
  v_mfma_f32_16x16x32_bf16 v[140:143], a[140:143], a[60:63], v[140:143]
  v_mfma_f32_16x16x32_bf16 v[140:143], a[136:139], a[56:59], v[140:143]
  s_waitcnt vmcnt(14) lgkmcnt(0)
  s_barrier
  v_mfma_f32_16x16x32_bf16 v[80:83], a[144:147], a[0:3], v[80:83]
  ds_read_b128 v[180:183], v25
  ds_read_b128 v[184:187], v25 offset:1024
  s_branch L_stubHs5
L_stubH5:
  s_setpc_b64 s[4:5]
L_stubHs5:
  v_mfma_f32_16x16x32_bf16 v[80:83], a[148:151], a[4:7], v[80:83]
  s_cmp_eq_u32 s0, 1
  s_cbranch_scc0 LE15a
  buffer_load_dword v23, v22, s[20:23], s51 offen offset:64 nt
LE15b:
  v_mfma_f32_16x16x32_bf16 v[84:87], a[148:151], a[12:15], v[84:87]
  ds_read_b64_tr_b16 a[128:129], v11 offset:24576
  ds_read_b128 a[96:99], v7 offset:24576
  v_mfma_f32_16x16x32_bf16 v[84:87], a[144:147], a[8:11], v[84:87]
  ds_read_b64_tr_b16 a[130:131], v11 offset:26624
  v_mfma_f32_16x16x32_bf16 v[88:91], a[144:147], a[16:19], v[88:91]
  v_mfma_f32_16x16x32_bf16 v[88:91], a[148:151], a[20:23], v[88:91]
  s_add_u32 m0, s42, 16384
  ds_read_b128 a[100:103], v7 offset:25600
  v_mfma_f32_16x16x32_bf16 v[92:95], a[148:151], a[28:31], v[92:95]
  buffer_load_dwordx4 v4, s[12:15], s34 offen offset:0 lds
  v_mfma_f32_16x16x32_bf16 v[92:95], a[144:147], a[24:27], v[92:95]
  ds_read_b64_tr_b16 a[132:133], v11 offset:28672
  s_waitcnt lgkmcnt(5)
  v_mfma_f32_16x16x32_bf16 v[144:147], a[144:147], a[32:35], v[144:147]
  ds_read_b128 a[104:107], v7 offset:26624
  v_mfma_f32_16x16x32_bf16 v[240:243], v[36:39], v[208:211], 0
  v_mfma_f32_16x16x32_bf16 v[200:203], v[180:183], v[208:211], 0
  v_mfma_f32_16x16x32_bf16 v[144:147], a[148:151], a[36:39], v[144:147]
  v_mfma_f32_16x16x32_bf16 v[204:207], v[184:187], v[208:211], 0
  v_mfma_f32_16x16x32_bf16 v[188:191], v[36:39], v[212:215], 0
  v_mfma_f32_16x16x32_bf16 v[148:151], a[148:151], a[44:47], v[148:151]
  ds_read_b64_tr_b16 a[134:135], v11 offset:30720
  v_mfma_f32_16x16x32_bf16 v[192:195], v[180:183], v[212:215], 0
  v_mfma_f32_16x16x32_bf16 v[196:199], v[184:187], v[212:215], 0
  v_mfma_f32_16x16x32_bf16 v[148:151], a[144:147], a[40:43], v[148:151]
  buffer_load_dwordx4 v5, s[12:15], s34 offen offset:1024 lds
  v_mfma_f32_16x16x32_bf16 v[152:155], a[144:147], a[48:51], v[152:155]
  ds_read_b128 a[108:111], v7 offset:27648
  v_mfma_f32_16x16x32_bf16 v[152:155], a[148:151], a[52:55], v[152:155]
  ds_read_b64_tr_b16 a[136:137], v12 offset:24576
  v_mfma_f32_16x16x32_bf16 v[156:159], a[148:151], a[60:63], v[156:159]
  v_add_f32 v240, 0x358637bd, v240
  v_rcp_f32 v240, v240
  s_nop 0
  v_mul_f32 v240, v28, v240
  v_mfma_f32_16x16x32_bf16 v[156:159], a[144:147], a[56:59], v[156:159]
  s_add_u32 s34, s34, 393216
  s_add_u32 m0, s36, 0
  v_mul_f32 v200, v240, v200
  v_mul_f32 v201, v240, v201
  v_mul_f32 v202, v240, v202
  v_mfma_f32_16x16x32_bf16 v[96:99], a[152:155], a[0:3], v[96:99]
  buffer_load_dwordx4 v3, s[20:23], s30 offen offset:0 sc1 lds
  v_mul_f32 v203, v240, v203
  v_mul_f32 v204, v240, v204
  v_mul_f32 v205, v240, v205
  v_mfma_f32_16x16x32_bf16 v[96:99], a[156:159], a[4:7], v[96:99]
  ds_read_b128 a[112:115], v7 offset:28672
  ds_read_b64_tr_b16 a[138:139], v12 offset:26624
  v_mul_f32 v206, v240, v206
  v_mul_f32 v207, v240, v207
  v_cvt_pk_bf16_f32 v208, v200, v201
  v_mfma_f32_16x16x32_bf16 v[100:103], a[156:159], a[12:15], v[100:103]
  ds_read_b128 a[116:119], v7 offset:29696
  v_cvt_pk_bf16_f32 v209, v202, v203
  v_cvt_pk_bf16_f32 v210, v204, v205
  v_cvt_pk_bf16_f32 v211, v206, v207
  v_mfma_f32_16x16x32_bf16 v[100:103], a[152:155], a[8:11], v[100:103]
  buffer_store_dwordx4 v[208:211], v3, s[20:23], s95 offen sc1
  s_add_u32 s95, s95, 294912
  v_mfma_f32_16x16x32_bf16 v[240:243], v[36:39], v[216:219], 0
  v_mfma_f32_16x16x32_bf16 v[104:107], a[152:155], a[16:19], v[104:107]
  ds_read_b64_tr_b16 a[140:141], v12 offset:28672
  v_mfma_f32_16x16x32_bf16 v[200:203], v[180:183], v[216:219], 0
  v_mfma_f32_16x16x32_bf16 v[204:207], v[184:187], v[216:219], 0
  v_add_f32 v188, 0x358637bd, v188
  v_rcp_f32 v188, v188
  v_mfma_f32_16x16x32_bf16 v[104:107], a[156:159], a[20:23], v[104:107]
  buffer_load_dwordx4 v252, s[20:23], s30 offen offset:1024 sc1 lds
  s_nop 0
  v_mul_f32 v188, v29, v188
  v_mul_f32 v192, v188, v192
  v_mfma_f32_16x16x32_bf16 v[108:111], a[156:159], a[28:31], v[108:111]
  ds_read_b128 a[120:123], v7 offset:30720
  v_mul_f32 v193, v188, v193
  v_mul_f32 v194, v188, v194
  v_mul_f32 v195, v188, v195
  v_mfma_f32_16x16x32_bf16 v[108:111], a[152:155], a[24:27], v[108:111]
  ds_read_b64_tr_b16 a[142:143], v12 offset:30720
  v_mul_f32 v196, v188, v196
  v_mul_f32 v197, v188, v197
  v_mul_f32 v198, v188, v198
  v_mfma_f32_16x16x32_bf16 v[160:163], a[152:155], a[32:35], v[160:163]
  v_mul_f32 v199, v188, v199
  v_cvt_pk_bf16_f32 v212, v192, v193
  v_cvt_pk_bf16_f32 v213, v194, v195
  v_mfma_f32_16x16x32_bf16 v[160:163], a[156:159], a[36:39], v[160:163]
  ds_read_b128 a[124:127], v7 offset:31744
  v_cvt_pk_bf16_f32 v214, v196, v197
  v_cvt_pk_bf16_f32 v215, v198, v199
  buffer_store_dwordx4 v[212:215], v3, s[20:23], s95 offen sc1
  v_mfma_f32_16x16x32_bf16 v[164:167], a[156:159], a[44:47], v[164:167]
  buffer_load_dwordx4 v253, s[20:23], s30 offen offset:2048 sc1 lds
  s_add_u32 s95, s95, 294912
  v_add_f32 v240, 0x358637bd, v240
  v_rcp_f32 v240, v240
  s_nop 0
  v_mfma_f32_16x16x32_bf16 v[164:167], a[152:155], a[40:43], v[164:167]
  v_mul_f32 v240, v30, v240
  v_mul_f32 v200, v240, v200
  v_mul_f32 v201, v240, v201
  v_mfma_f32_16x16x32_bf16 v[168:171], a[152:155], a[48:51], v[168:171]
  v_mul_f32 v202, v240, v202
  v_mul_f32 v203, v240, v203
  v_mul_f32 v204, v240, v204
  v_mfma_f32_16x16x32_bf16 v[168:171], a[156:159], a[52:55], v[168:171]
  v_mul_f32 v205, v240, v205
  v_mul_f32 v206, v240, v206
  v_mul_f32 v207, v240, v207
  v_mfma_f32_16x16x32_bf16 v[172:175], a[156:159], a[60:63], v[172:175]
  v_cvt_pk_bf16_f32 v216, v200, v201
  v_cvt_pk_bf16_f32 v217, v202, v203
  v_cvt_pk_bf16_f32 v218, v204, v205
  v_mfma_f32_16x16x32_bf16 v[172:175], a[152:155], a[56:59], v[172:175]
  v_cvt_pk_bf16_f32 v219, v206, v207
  buffer_store_dwordx4 v[216:219], v3, s[20:23], s95 offen sc1
  s_add_u32 s95, s95, 294912
  s_waitcnt vmcnt(14) lgkmcnt(0)
  s_barrier
  v_mfma_f32_16x16x32_bf16 v[48:51], a[128:131], a[64:67], v[48:51]
  ds_read_b64_tr_b16 a[144:145], v13 offset:0
  v_mfma_f32_16x16x32_bf16 v[188:191], v[36:39], v[220:223], 0
  v_mfma_f32_16x16x32_bf16 v[192:195], v[180:183], v[220:223], 0
  v_mfma_f32_16x16x32_bf16 v[48:51], a[132:135], a[68:71], v[48:51]
  buffer_load_dwordx4 v254, s[20:23], s30 offen offset:3072 sc1 lds
  v_mfma_f32_16x16x32_bf16 v[196:199], v[184:187], v[220:223], 0
  v_mfma_f32_16x16x32_bf16 v[240:243], v[36:39], v[224:227], 0
  v_mfma_f32_16x16x32_bf16 v[52:55], a[132:135], a[76:79], v[52:55]
  ds_read_b128 a[0:3], v8 offset:0
  v_mfma_f32_16x16x32_bf16 v[200:203], v[180:183], v[224:227], 0
  v_mfma_f32_16x16x32_bf16 v[204:207], v[184:187], v[224:227], 0
  v_mfma_f32_16x16x32_bf16 v[52:55], a[128:131], a[72:75], v[52:55]
  ds_read_b64_tr_b16 a[146:147], v13 offset:2048
  v_mfma_f32_16x16x32_bf16 v[56:59], a[128:131], a[80:83], v[56:59]
  v_mfma_f32_16x16x32_bf16 v[56:59], a[132:135], a[84:87], v[56:59]
  ds_read_b128 a[4:7], v8 offset:1024
  v_mfma_f32_16x16x32_bf16 v[60:63], a[132:135], a[92:95], v[60:63]
  s_add_u32 s30, s30, 16384
  s_add_u32 m0, s42, 40960
  v_add_f32 v188, 0x358637bd, v188
  v_rcp_f32 v188, v188
  s_nop 0
  v_mfma_f32_16x16x32_bf16 v[60:63], a[128:131], a[88:91], v[60:63]
  buffer_load_dwordx4 v4, s[12:15], s33 offen offset:0 lds
  v_mul_f32 v188, v31, v188
  v_mul_f32 v192, v188, v192
  v_mfma_f32_16x16x32_bf16 v[112:115], a[128:131], a[96:99], v[112:115]
  ds_read_b64_tr_b16 a[148:149], v13 offset:4096
  ds_read_b128 a[8:11], v8 offset:2048
  v_mul_f32 v193, v188, v193
  v_mul_f32 v194, v188, v194
  v_mfma_f32_16x16x32_bf16 v[112:115], a[132:135], a[100:103], v[112:115]
  v_mul_f32 v195, v188, v195
  v_mul_f32 v196, v188, v196
  v_mfma_f32_16x16x32_bf16 v[116:119], a[132:135], a[108:111], v[116:119]
  ds_read_b64_tr_b16 a[150:151], v13 offset:6144
  v_mul_f32 v197, v188, v197
  v_mul_f32 v198, v188, v198
  v_mfma_f32_16x16x32_bf16 v[116:119], a[128:131], a[104:107], v[116:119]
  ds_read_b128 a[12:15], v8 offset:3072
  v_mul_f32 v199, v188, v199
  v_cvt_pk_bf16_f32 v220, v192, v193
  v_cvt_pk_bf16_f32 v221, v194, v195
  v_mfma_f32_16x16x32_bf16 v[120:123], a[128:131], a[112:115], v[120:123]
  v_cvt_pk_bf16_f32 v222, v196, v197
  v_cvt_pk_bf16_f32 v223, v198, v199
  v_mfma_f32_16x16x32_bf16 v[120:123], a[132:135], a[116:119], v[120:123]
  buffer_load_dwordx4 v5, s[12:15], s33 offen offset:1024 lds
  buffer_store_dwordx4 v[220:223], v3, s[20:23], s95 offen sc1
  s_add_u32 s95, s95, 294912
  v_mfma_f32_16x16x32_bf16 v[124:127], a[132:135], a[124:127], v[124:127]
  ds_read_b64_tr_b16 a[152:153], v14 offset:0
  v_mfma_f32_16x16x32_bf16 v[188:191], v[36:39], v[228:231], 0
  v_mfma_f32_16x16x32_bf16 v[192:195], v[180:183], v[228:231], 0
  v_mfma_f32_16x16x32_bf16 v[124:127], a[128:131], a[120:123], v[124:127]
  ds_read_b128 a[16:19], v8 offset:4096
  v_mfma_f32_16x16x32_bf16 v[196:199], v[184:187], v[228:231], 0
  v_add_f32 v240, 0x358637bd, v240
  v_mfma_f32_16x16x32_bf16 v[64:67], a[136:139], a[64:67], v[64:67]
  ds_read_b64_tr_b16 a[154:155], v14 offset:2048
  v_rcp_f32 v240, v240
  s_nop 0
  v_mul_f32 v240, v40, v240
  v_mfma_f32_16x16x32_bf16 v[64:67], a[140:143], a[68:71], v[64:67]
  v_mul_f32 v200, v240, v200
  v_mul_f32 v201, v240, v201
  v_mfma_f32_16x16x32_bf16 v[68:71], a[140:143], a[76:79], v[68:71]
  s_add_u32 s33, s33, 524288
  s_add_u32 m0, s36, 24576
  v_mul_f32 v202, v240, v202
  v_mul_f32 v203, v240, v203
  v_mfma_f32_16x16x32_bf16 v[68:71], a[136:139], a[72:75], v[68:71]
  buffer_load_dwordx4 v3, s[20:23], s31 offen offset:0 sc1 lds
  v_mul_f32 v204, v240, v204
  v_mul_f32 v205, v240, v205
  v_mfma_f32_16x16x32_bf16 v[72:75], a[136:139], a[80:83], v[72:75]
  ds_read_b128 a[20:23], v8 offset:5120
  ds_read_b64_tr_b16 a[156:157], v14 offset:4096
  v_mul_f32 v206, v240, v206
  v_mul_f32 v207, v240, v207
  v_mfma_f32_16x16x32_bf16 v[72:75], a[140:143], a[84:87], v[72:75]
  ds_read_b128 a[24:27], v8 offset:6144
  v_cvt_pk_bf16_f32 v224, v200, v201
  v_cvt_pk_bf16_f32 v225, v202, v203
  v_cvt_pk_bf16_f32 v226, v204, v205
  v_mfma_f32_16x16x32_bf16 v[76:79], a[140:143], a[92:95], v[76:79]
  v_cvt_pk_bf16_f32 v227, v206, v207
  buffer_store_dwordx4 v[224:227], v3, s[20:23], s95 offen sc1
  v_mfma_f32_16x16x32_bf16 v[76:79], a[136:139], a[88:91], v[76:79]
  ds_read_b64_tr_b16 a[158:159], v14 offset:6144
  s_add_u32 s95, s95, 294912
  v_add_f32 v188, 0x358637bd, v188
  v_mfma_f32_16x16x32_bf16 v[128:131], a[136:139], a[96:99], v[128:131]
  v_rcp_f32 v188, v188
  s_nop 0
  v_mfma_f32_16x16x32_bf16 v[128:131], a[140:143], a[100:103], v[128:131]
  buffer_load_dwordx4 v252, s[20:23], s31 offen offset:1024 sc1 lds
  v_mul_f32 v188, v41, v188
  v_mul_f32 v192, v188, v192
  v_mfma_f32_16x16x32_bf16 v[132:135], a[140:143], a[108:111], v[132:135]
  ds_read_b128 a[28:31], v8 offset:7168
  v_mul_f32 v193, v188, v193
  v_mul_f32 v194, v188, v194
  v_mul_f32 v195, v188, v195
  v_mfma_f32_16x16x32_bf16 v[132:135], a[136:139], a[104:107], v[132:135]
  v_mul_f32 v196, v188, v196
  v_mul_f32 v197, v188, v197
  v_mfma_f32_16x16x32_bf16 v[136:139], a[136:139], a[112:115], v[136:139]
  v_mul_f32 v198, v188, v198
  v_mul_f32 v199, v188, v199
  v_mfma_f32_16x16x32_bf16 v[136:139], a[140:143], a[116:119], v[136:139]
  v_cvt_pk_bf16_f32 v228, v192, v193
  v_cvt_pk_bf16_f32 v229, v194, v195
  v_mfma_f32_16x16x32_bf16 v[140:143], a[140:143], a[124:127], v[140:143]
  v_cvt_pk_bf16_f32 v230, v196, v197
  v_cvt_pk_bf16_f32 v231, v198, v199
  v_mfma_f32_16x16x32_bf16 v[140:143], a[136:139], a[120:123], v[140:143]
  buffer_store_dwordx4 v[228:231], v3, s[20:23], s95 offen sc1
  s_add_u32 s95, s95, 294912
  s_waitcnt vmcnt(16) lgkmcnt(0)
  s_barrier
  v_cmp_ne_u32 vcc, 0x01010101, v23
  s_nop 0
  s_cmp_eq_u64 vcc, 0
  s_cbranch_scc0 L2_qf_slowH
L2_qf_okH:
  v_mfma_f32_16x16x32_bf16 v[80:83], a[144:147], a[64:67], v[80:83]
  ds_read_b64_tr_b16 a[128:129], v13 offset:24576
  v_mfma_f32_16x16x32_bf16 v[240:243], v[36:39], v[232:235], 0
  v_mfma_f32_16x16x32_bf16 v[80:83], a[148:151], a[68:71], v[80:83]
  buffer_load_dwordx4 v253, s[20:23], s31 offen offset:2048 sc1 lds
  v_mfma_f32_16x16x32_bf16 v[84:87], a[148:151], a[76:79], v[84:87]
  ds_read_b128 a[32:35], v8 offset:24576
  v_mfma_f32_16x16x32_bf16 v[200:203], v[180:183], v[232:235], 0
  v_mfma_f32_16x16x32_bf16 v[84:87], a[144:147], a[72:75], v[84:87]
  ds_read_b64_tr_b16 a[130:131], v13 offset:26624
  v_mfma_f32_16x16x32_bf16 v[204:207], v[184:187], v[232:235], 0
  v_mfma_f32_16x16x32_bf16 v[88:91], a[144:147], a[80:83], v[88:91]
  v_mfma_f32_16x16x32_bf16 v[188:191], v[36:39], v[236:239], 0
  v_mfma_f32_16x16x32_bf16 v[88:91], a[148:151], a[84:87], v[88:91]
  ds_read_b128 a[36:39], v8 offset:25600
  v_mfma_f32_16x16x32_bf16 v[192:195], v[180:183], v[236:239], 0
  v_mfma_f32_16x16x32_bf16 v[92:95], a[148:151], a[92:95], v[92:95]
  ds_read_b64_tr_b16 a[132:133], v13 offset:28672
  v_mfma_f32_16x16x32_bf16 v[196:199], v[184:187], v[236:239], 0
  v_mfma_f32_16x16x32_bf16 v[92:95], a[144:147], a[88:91], v[92:95]
  buffer_load_dwordx4 v254, s[20:23], s31 offen offset:3072 sc1 lds
  v_mfma_f32_16x16x32_bf16 v[144:147], a[144:147], a[96:99], v[144:147]
  ds_read_b128 a[40:43], v8 offset:26624
  v_mfma_f32_16x16x32_bf16 v[144:147], a[148:151], a[100:103], v[144:147]
  v_mfma_f32_16x16x32_bf16 v[148:151], a[148:151], a[108:111], v[148:151]
  ds_read_b64_tr_b16 a[134:135], v13 offset:30720
  v_mfma_f32_16x16x32_bf16 v[148:151], a[144:147], a[104:107], v[148:151]
  ds_read_b128 a[44:47], v8 offset:27648
  v_mfma_f32_16x16x32_bf16 v[152:155], a[144:147], a[112:115], v[152:155]
  s_add_u32 s31, s31, 16384
  s_add_u32 m0, s42, 65536
  v_mfma_f32_16x16x32_bf16 v[152:155], a[148:151], a[116:119], v[152:155]
  buffer_load_dwordx4 v4, s[12:15], s34 offen offset:0 lds
  v_mfma_f32_16x16x32_bf16 v[156:159], a[148:151], a[124:127], v[156:159]
  ds_read_b64_tr_b16 a[136:137], v14 offset:24576
  v_add_f32 v240, 0x358637bd, v240
  v_mfma_f32_16x16x32_bf16 v[156:159], a[144:147], a[120:123], v[156:159]
  ds_read_b128 a[48:51], v8 offset:28672
  v_mfma_f32_16x16x32_bf16 v[96:99], a[152:155], a[64:67], v[96:99]
  ds_read_b64_tr_b16 a[138:139], v14 offset:26624
  v_mfma_f32_16x16x32_bf16 v[96:99], a[156:159], a[68:71], v[96:99]
  v_rcp_f32 v240, v240
  v_mfma_f32_16x16x32_bf16 v[100:103], a[156:159], a[76:79], v[100:103]
  ds_read_b128 a[52:55], v8 offset:29696
  s_nop 0
  v_mfma_f32_16x16x32_bf16 v[100:103], a[152:155], a[72:75], v[100:103]
  buffer_load_dwordx4 v5, s[12:15], s34 offen offset:1024 lds
  v_mfma_f32_16x16x32_bf16 v[104:107], a[152:155], a[80:83], v[104:107]
  ds_read_b64_tr_b16 a[140:141], v14 offset:28672
  v_mul_f32 v240, v42, v240
  v_mfma_f32_16x16x32_bf16 v[104:107], a[156:159], a[84:87], v[104:107]
  ds_read_b128 a[56:59], v8 offset:30720
  v_mul_f32 v200, v240, v200
  v_mfma_f32_16x16x32_bf16 v[108:111], a[156:159], a[92:95], v[108:111]
  v_mul_f32 v201, v240, v201
  v_mul_f32 v202, v240, v202
  v_mfma_f32_16x16x32_bf16 v[108:111], a[152:155], a[88:91], v[108:111]
  ds_read_b64_tr_b16 a[142:143], v14 offset:30720
  v_mul_f32 v203, v240, v203
  v_mfma_f32_16x16x32_bf16 v[160:163], a[152:155], a[96:99], v[160:163]
  s_add_u32 s34, s34, 524288
  s_add_u32 m0, s36, 49152
  v_mfma_f32_16x16x32_bf16 v[160:163], a[156:159], a[100:103], v[160:163]
  buffer_load_dwordx4 v3, s[20:23], s30 offen offset:0 sc1 lds
  v_mfma_f32_16x16x32_bf16 v[164:167], a[156:159], a[108:111], v[164:167]
  ds_read_b128 a[60:63], v8 offset:31744
  v_mul_f32 v204, v240, v204
  v_mfma_f32_16x16x32_bf16 v[164:167], a[152:155], a[104:107], v[164:167]
  v_mul_f32 v205, v240, v205
  v_mul_f32 v206, v240, v206
  v_mfma_f32_16x16x32_bf16 v[168:171], a[152:155], a[112:115], v[168:171]
  v_mul_f32 v207, v240, v207
  v_cvt_pk_bf16_f32 v232, v200, v201
  v_mfma_f32_16x16x32_bf16 v[168:171], a[156:159], a[116:119], v[168:171]
  v_cvt_pk_bf16_f32 v233, v202, v203
  v_cvt_pk_bf16_f32 v234, v204, v205
  v_mfma_f32_16x16x32_bf16 v[172:175], a[156:159], a[124:127], v[172:175]
  v_cvt_pk_bf16_f32 v235, v206, v207
  v_mfma_f32_16x16x32_bf16 v[172:175], a[152:155], a[120:123], v[172:175]
  buffer_store_dwordx4 v[232:235], v3, s[20:23], s95 offen sc1
  s_add_u32 s95, s95, 294912
  v_add_f32 v188, 0x358637bd, v188
  v_rcp_f32 v188, v188
  s_nop 0
  v_mul_f32 v188, v43, v188
  v_mul_f32 v192, v188, v192
  v_mul_f32 v193, v188, v193
  v_mul_f32 v194, v188, v194
  v_mul_f32 v195, v188, v195
  v_mul_f32 v196, v188, v196
  v_mul_f32 v197, v188, v197
  v_mul_f32 v198, v188, v198
  v_mul_f32 v199, v188, v199
  v_cvt_pk_bf16_f32 v236, v192, v193
  v_cvt_pk_bf16_f32 v237, v194, v195
  v_cvt_pk_bf16_f32 v238, v196, v197
  v_cvt_pk_bf16_f32 v239, v198, v199
  buffer_store_dwordx4 v[236:239], v3, s[20:23], s95 offen sc1
  s_waitcnt vmcnt(14) lgkmcnt(0)
  s_barrier
  v_mfma_f32_16x16x32_bf16 v[48:51], a[128:131], a[0:3], v[48:51]
  ds_read_b64_tr_b16 a[144:145], v9 offset:0
  v_mfma_f32_16x16x32_bf16 v[48:51], a[132:135], a[4:7], v[48:51]
  buffer_load_dwordx4 v252, s[20:23], s30 offen offset:1024 sc1 lds
  v_mfma_f32_16x16x32_bf16 v[52:55], a[132:135], a[12:15], v[52:55]
  ds_read_b128 a[64:67], v6 offset:0
  v_mfma_f32_16x16x32_bf16 v[52:55], a[128:131], a[8:11], v[52:55]
  ds_read_b64_tr_b16 a[146:147], v9 offset:2048
  v_mfma_f32_16x16x32_bf16 v[56:59], a[128:131], a[16:19], v[56:59]
  buffer_load_dwordx4 v253, s[20:23], s30 offen offset:2048 sc1 lds
  v_mfma_f32_16x16x32_bf16 v[56:59], a[132:135], a[20:23], v[56:59]
  ds_read_b128 a[68:71], v6 offset:1024
  v_mfma_f32_16x16x32_bf16 v[60:63], a[132:135], a[28:31], v[60:63]
  ds_read_b64_tr_b16 a[148:149], v9 offset:4096
  v_mfma_f32_16x16x32_bf16 v[60:63], a[128:131], a[24:27], v[60:63]
  v_mfma_f32_16x16x32_bf16 v[112:115], a[128:131], a[32:35], v[112:115]
  buffer_load_dwordx4 v254, s[20:23], s30 offen offset:3072 sc1 lds
  v_mfma_f32_16x16x32_bf16 v[112:115], a[132:135], a[36:39], v[112:115]
  ds_read_b128 a[72:75], v6 offset:2048
  v_mfma_f32_16x16x32_bf16 v[116:119], a[132:135], a[44:47], v[116:119]
  ds_read_b64_tr_b16 a[150:151], v9 offset:6144
  v_mfma_f32_16x16x32_bf16 v[116:119], a[128:131], a[40:43], v[116:119]
  s_add_u32 s30, s30, 12288
  s_add_u32 m0, s42, 90112
  v_mfma_f32_16x16x32_bf16 v[120:123], a[128:131], a[48:51], v[120:123]
  buffer_load_dwordx4 v4, s[12:15], s33 offen offset:0 lds
  v_mfma_f32_16x16x32_bf16 v[120:123], a[132:135], a[52:55], v[120:123]
  ds_read_b128 a[76:79], v6 offset:3072
  ds_read_b64_tr_b16 a[152:153], v10 offset:0
  v_mfma_f32_16x16x32_bf16 v[124:127], a[132:135], a[60:63], v[124:127]
  v_mfma_f32_16x16x32_bf16 v[124:127], a[128:131], a[56:59], v[124:127]
  ds_read_b128 a[80:83], v6 offset:4096
  v_mfma_f32_16x16x32_bf16 v[64:67], a[136:139], a[0:3], v[64:67]
  buffer_load_dwordx4 v5, s[12:15], s33 offen offset:1024 lds
  v_mfma_f32_16x16x32_bf16 v[64:67], a[140:143], a[4:7], v[64:67]
  ds_read_b64_tr_b16 a[154:155], v10 offset:2048
  v_mfma_f32_16x16x32_bf16 v[68:71], a[140:143], a[12:15], v[68:71]
  ds_read_b128 a[84:87], v6 offset:5120
  v_mfma_f32_16x16x32_bf16 v[68:71], a[136:139], a[8:11], v[68:71]
  s_add_u32 s33, s33, 393216
  s_add_u32 m0, s36, 73728
  v_mfma_f32_16x16x32_bf16 v[72:75], a[136:139], a[16:19], v[72:75]
  buffer_load_dwordx4 v3, s[20:23], s31 offen offset:0 sc1 lds
  v_mfma_f32_16x16x32_bf16 v[72:75], a[140:143], a[20:23], v[72:75]
  ds_read_b64_tr_b16 a[156:157], v10 offset:4096
  ds_read_b128 a[88:91], v6 offset:6144
  v_mfma_f32_16x16x32_bf16 v[76:79], a[140:143], a[28:31], v[76:79]
  v_mfma_f32_16x16x32_bf16 v[76:79], a[136:139], a[24:27], v[76:79]
  ds_read_b64_tr_b16 a[158:159], v10 offset:6144
  v_mfma_f32_16x16x32_bf16 v[128:131], a[136:139], a[32:35], v[128:131]
  buffer_load_dwordx4 v252, s[20:23], s31 offen offset:1024 sc1 lds
  v_mfma_f32_16x16x32_bf16 v[128:131], a[140:143], a[36:39], v[128:131]
  ds_read_b128 a[92:95], v6 offset:7168
  v_mfma_f32_16x16x32_bf16 v[132:135], a[140:143], a[44:47], v[132:135]
  v_mfma_f32_16x16x32_bf16 v[132:135], a[136:139], a[40:43], v[132:135]
  v_mfma_f32_16x16x32_bf16 v[136:139], a[136:139], a[48:51], v[136:139]
  buffer_load_dwordx4 v253, s[20:23], s31 offen offset:2048 sc1 lds
  v_mfma_f32_16x16x32_bf16 v[136:139], a[140:143], a[52:55], v[136:139]
  v_mfma_f32_16x16x32_bf16 v[140:143], a[140:143], a[60:63], v[140:143]
  v_mfma_f32_16x16x32_bf16 v[140:143], a[136:139], a[56:59], v[140:143]
  s_waitcnt vmcnt(8) lgkmcnt(0)
  s_barrier
  v_mfma_f32_16x16x32_bf16 v[80:83], a[144:147], a[0:3], v[80:83]
  ds_read_b64_tr_b16 a[128:129], v9 offset:24576
  v_mfma_f32_16x16x32_bf16 v[80:83], a[148:151], a[4:7], v[80:83]
  buffer_load_dwordx4 v254, s[20:23], s31 offen offset:3072 sc1 lds
  s_cmp_eq_u32 s24, 0
  s_cbranch_scc0 L2_nosigH
  s_mov_b64 exec, 1
  buffer_store_dword v15, off, s[20:23], s48 sc1
  s_mov_b64 exec, -1
L2_nosigH:
  v_mfma_f32_16x16x32_bf16 v[84:87], a[148:151], a[12:15], v[84:87]
  ds_read_b128 a[96:99], v6 offset:24576
  v_mfma_f32_16x16x32_bf16 v[84:87], a[144:147], a[8:11], v[84:87]
  s_add_u32 s31, s31, 12288
  s_add_u32 m0, s42, 114688
  v_mfma_f32_16x16x32_bf16 v[88:91], a[144:147], a[16:19], v[88:91]
  buffer_load_dwordx4 v4, s[12:15], s34 offen offset:0 lds
  v_mfma_f32_16x16x32_bf16 v[88:91], a[148:151], a[20:23], v[88:91]
  ds_read_b64_tr_b16 a[130:131], v9 offset:26624
  ds_read_b128 a[100:103], v6 offset:25600
  v_mfma_f32_16x16x32_bf16 v[92:95], a[148:151], a[28:31], v[92:95]
  ds_read_b64_tr_b16 a[132:133], v9 offset:28672
  v_mfma_f32_16x16x32_bf16 v[92:95], a[144:147], a[24:27], v[92:95]
  v_mfma_f32_16x16x32_bf16 v[144:147], a[144:147], a[32:35], v[144:147]
  buffer_load_dwordx4 v5, s[12:15], s34 offen offset:1024 lds
  v_mfma_f32_16x16x32_bf16 v[144:147], a[148:151], a[36:39], v[144:147]
  ds_read_b128 a[104:107], v6 offset:26624
  v_mfma_f32_16x16x32_bf16 v[148:151], a[148:151], a[44:47], v[148:151]
  ds_read_b64_tr_b16 a[134:135], v9 offset:30720
  v_mfma_f32_16x16x32_bf16 v[148:151], a[144:147], a[40:43], v[148:151]
  s_add_u32 s34, s34, 393216
  s_add_u32 m0, s36, 98304
  v_mfma_f32_16x16x32_bf16 v[152:155], a[144:147], a[48:51], v[152:155]
  buffer_load_dwordx4 v3, s[20:23], s30 offen offset:0 sc1 lds
  v_mfma_f32_16x16x32_bf16 v[152:155], a[148:151], a[52:55], v[152:155]
  ds_read_b128 a[108:111], v6 offset:27648
  ds_read_b64_tr_b16 a[136:137], v10 offset:24576
  v_mfma_f32_16x16x32_bf16 v[156:159], a[148:151], a[60:63], v[156:159]
  v_mfma_f32_16x16x32_bf16 v[156:159], a[144:147], a[56:59], v[156:159]
  ds_read_b128 a[112:115], v6 offset:28672
  v_mfma_f32_16x16x32_bf16 v[96:99], a[152:155], a[0:3], v[96:99]
  buffer_load_dwordx4 v252, s[20:23], s30 offen offset:1024 sc1 lds
  v_mfma_f32_16x16x32_bf16 v[96:99], a[156:159], a[4:7], v[96:99]
  ds_read_b64_tr_b16 a[138:139], v10 offset:26624
  v_mfma_f32_16x16x32_bf16 v[100:103], a[156:159], a[12:15], v[100:103]
  ds_read_b128 a[116:119], v6 offset:29696
  v_mfma_f32_16x16x32_bf16 v[100:103], a[152:155], a[8:11], v[100:103]
  v_mfma_f32_16x16x32_bf16 v[104:107], a[152:155], a[16:19], v[104:107]
  buffer_load_dwordx4 v253, s[20:23], s30 offen offset:2048 sc1 lds
  v_mfma_f32_16x16x32_bf16 v[104:107], a[156:159], a[20:23], v[104:107]
  ds_read_b64_tr_b16 a[140:141], v10 offset:28672
  ds_read_b128 a[120:123], v6 offset:30720
  v_mfma_f32_16x16x32_bf16 v[108:111], a[156:159], a[28:31], v[108:111]
  v_mfma_f32_16x16x32_bf16 v[108:111], a[152:155], a[24:27], v[108:111]
  ds_read_b64_tr_b16 a[142:143], v10 offset:30720
  v_mfma_f32_16x16x32_bf16 v[160:163], a[152:155], a[32:35], v[160:163]
  buffer_load_dwordx4 v254, s[20:23], s30 offen offset:3072 sc1 lds
  v_mfma_f32_16x16x32_bf16 v[160:163], a[156:159], a[36:39], v[160:163]
  ds_read_b128 a[124:127], v6 offset:31744
  v_mfma_f32_16x16x32_bf16 v[164:167], a[156:159], a[44:47], v[164:167]
  v_mfma_f32_16x16x32_bf16 v[164:167], a[152:155], a[40:43], v[164:167]
  s_sub_u32 s30, s30, 24576
  s_add_u32 m0, s42, 139264
  v_mfma_f32_16x16x32_bf16 v[168:171], a[152:155], a[48:51], v[168:171]
  buffer_load_dwordx4 v4, s[12:15], s33 offen offset:0 lds
  v_mfma_f32_16x16x32_bf16 v[168:171], a[156:159], a[52:55], v[168:171]
  v_mfma_f32_16x16x32_bf16 v[172:175], a[156:159], a[60:63], v[172:175]
  v_mfma_f32_16x16x32_bf16 v[172:175], a[152:155], a[56:59], v[172:175]
  s_waitcnt vmcnt(13) lgkmcnt(0)
  s_barrier
  v_mfma_f32_16x16x32_bf16 v[48:51], a[128:131], a[64:67], v[48:51]
  ds_read_b64_tr_b16 a[144:145], v11 offset:0
  v_mfma_f32_16x16x32_bf16 v[48:51], a[132:135], a[68:71], v[48:51]
  buffer_load_dwordx4 v5, s[12:15], s33 offen offset:1024 lds
  v_mfma_f32_16x16x32_bf16 v[52:55], a[132:135], a[76:79], v[52:55]
  ds_read_b128 a[0:3], v7 offset:0
  v_mfma_f32_16x16x32_bf16 v[52:55], a[128:131], a[72:75], v[52:55]
  s_sub_u32 s33, s33, 786432
  s_add_u32 m0, s36, 122880
  v_mfma_f32_16x16x32_bf16 v[56:59], a[128:131], a[80:83], v[56:59]
  buffer_load_dwordx4 v3, s[20:23], s31 offen offset:0 sc1 lds
  v_mfma_f32_16x16x32_bf16 v[56:59], a[132:135], a[84:87], v[56:59]
  ds_read_b64_tr_b16 a[146:147], v11 offset:2048
  ds_read_b128 a[4:7], v7 offset:1024
  v_mfma_f32_16x16x32_bf16 v[60:63], a[132:135], a[92:95], v[60:63]
  ds_read_b64_tr_b16 a[148:149], v11 offset:4096
  v_mfma_f32_16x16x32_bf16 v[60:63], a[128:131], a[88:91], v[60:63]
  v_mfma_f32_16x16x32_bf16 v[112:115], a[128:131], a[96:99], v[112:115]
  buffer_load_dwordx4 v252, s[20:23], s31 offen offset:1024 sc1 lds
  v_mfma_f32_16x16x32_bf16 v[112:115], a[132:135], a[100:103], v[112:115]
  ds_read_b128 a[8:11], v7 offset:2048
  v_mfma_f32_16x16x32_bf16 v[116:119], a[132:135], a[108:111], v[116:119]
  ds_read_b64_tr_b16 a[150:151], v11 offset:6144
  v_mfma_f32_16x16x32_bf16 v[116:119], a[128:131], a[104:107], v[116:119]
  ds_read_b128 a[12:15], v7 offset:3072
  v_mfma_f32_16x16x32_bf16 v[120:123], a[128:131], a[112:115], v[120:123]
  buffer_load_dwordx4 v253, s[20:23], s31 offen offset:2048 sc1 lds
  v_mfma_f32_16x16x32_bf16 v[120:123], a[132:135], a[116:119], v[120:123]
  ds_read_b64_tr_b16 a[152:153], v12 offset:0
  v_mfma_f32_16x16x32_bf16 v[124:127], a[132:135], a[124:127], v[124:127]
  v_mfma_f32_16x16x32_bf16 v[124:127], a[128:131], a[120:123], v[124:127]
  ds_read_b128 a[16:19], v7 offset:4096
  v_mfma_f32_16x16x32_bf16 v[64:67], a[136:139], a[64:67], v[64:67]
  buffer_load_dwordx4 v254, s[20:23], s31 offen offset:3072 sc1 lds
  v_mfma_f32_16x16x32_bf16 v[64:67], a[140:143], a[68:71], v[64:67]
  ds_read_b64_tr_b16 a[154:155], v12 offset:2048
  v_mfma_f32_16x16x32_bf16 v[68:71], a[140:143], a[76:79], v[68:71]
  ds_read_b128 a[20:23], v7 offset:5120
  v_mfma_f32_16x16x32_bf16 v[68:71], a[136:139], a[72:75], v[68:71]
  s_sub_u32 s31, s31, 24576
  s_add_u32 m0, s42, 16384
  v_mfma_f32_16x16x32_bf16 v[72:75], a[136:139], a[80:83], v[72:75]
  buffer_load_dwordx4 v4, s[12:15], s34 offen offset:0 lds
  v_mfma_f32_16x16x32_bf16 v[72:75], a[140:143], a[84:87], v[72:75]
  ds_read_b64_tr_b16 a[156:157], v12 offset:4096
  ds_read_b128 a[24:27], v7 offset:6144
  v_mfma_f32_16x16x32_bf16 v[76:79], a[140:143], a[92:95], v[76:79]
  v_mfma_f32_16x16x32_bf16 v[76:79], a[136:139], a[88:91], v[76:79]
  ds_read_b64_tr_b16 a[158:159], v12 offset:6144
  v_mfma_f32_16x16x32_bf16 v[128:131], a[136:139], a[96:99], v[128:131]
  buffer_load_dwordx4 v5, s[12:15], s34 offen offset:1024 lds
  v_mfma_f32_16x16x32_bf16 v[128:131], a[140:143], a[100:103], v[128:131]
  ds_read_b128 a[28:31], v7 offset:7168
  v_mfma_f32_16x16x32_bf16 v[132:135], a[140:143], a[108:111], v[132:135]
  v_mfma_f32_16x16x32_bf16 v[132:135], a[136:139], a[104:107], v[132:135]
  s_sub_u32 s34, s34, 786432
  s_add_u32 m0, s36, 0
  v_mfma_f32_16x16x32_bf16 v[136:139], a[136:139], a[112:115], v[136:139]
  buffer_load_dwordx4 v3, s[20:23], s30 offen offset:0 sc1 lds
  v_mfma_f32_16x16x32_bf16 v[136:139], a[140:143], a[116:119], v[136:139]
  v_mfma_f32_16x16x32_bf16 v[140:143], a[140:143], a[124:127], v[140:143]
  v_mfma_f32_16x16x32_bf16 v[140:143], a[136:139], a[120:123], v[140:143]
  s_waitcnt vmcnt(15) lgkmcnt(0)
  s_barrier
  v_mfma_f32_16x16x32_bf16 v[80:83], a[144:147], a[64:67], v[80:83]
  ds_read_b64_tr_b16 a[128:129], v11 offset:24576
  v_mfma_f32_16x16x32_bf16 v[80:83], a[148:151], a[68:71], v[80:83]
  buffer_load_dwordx4 v252, s[20:23], s30 offen offset:1024 sc1 lds
  v_mfma_f32_16x16x32_bf16 v[84:87], a[148:151], a[76:79], v[84:87]
  ds_read_b128 a[32:35], v7 offset:24576
  v_mfma_f32_16x16x32_bf16 v[84:87], a[144:147], a[72:75], v[84:87]
  ds_read_b64_tr_b16 a[130:131], v11 offset:26624
  v_mfma_f32_16x16x32_bf16 v[88:91], a[144:147], a[80:83], v[88:91]
  buffer_load_dwordx4 v253, s[20:23], s30 offen offset:2048 sc1 lds
  v_mfma_f32_16x16x32_bf16 v[88:91], a[148:151], a[84:87], v[88:91]
  ds_read_b128 a[36:39], v7 offset:25600
  v_mfma_f32_16x16x32_bf16 v[92:95], a[148:151], a[92:95], v[92:95]
  ds_read_b64_tr_b16 a[132:133], v11 offset:28672
  v_mfma_f32_16x16x32_bf16 v[92:95], a[144:147], a[88:91], v[92:95]
  v_mfma_f32_16x16x32_bf16 v[144:147], a[144:147], a[96:99], v[144:147]
  buffer_load_dwordx4 v254, s[20:23], s30 offen offset:3072 sc1 lds
  v_mfma_f32_16x16x32_bf16 v[144:147], a[148:151], a[100:103], v[144:147]
  ds_read_b128 a[40:43], v7 offset:26624
  v_mfma_f32_16x16x32_bf16 v[148:151], a[148:151], a[108:111], v[148:151]
  ds_read_b64_tr_b16 a[134:135], v11 offset:30720
  v_mfma_f32_16x16x32_bf16 v[148:151], a[144:147], a[104:107], v[148:151]
  s_branch L_stubHs6
L_stubH6:
  s_setpc_b64 s[4:5]
L_stubHs6:
  s_add_u32 s30, s30, 28672
  s_add_u32 m0, s42, 40960
  v_mfma_f32_16x16x32_bf16 v[152:155], a[144:147], a[112:115], v[152:155]
  buffer_load_dwordx4 v4, s[12:15], s33 offen offset:0 lds
  v_mfma_f32_16x16x32_bf16 v[152:155], a[148:151], a[116:119], v[152:155]
  ds_read_b128 a[44:47], v7 offset:27648
  ds_read_b64_tr_b16 a[136:137], v12 offset:24576
  v_mfma_f32_16x16x32_bf16 v[156:159], a[148:151], a[124:127], v[156:159]
  v_mfma_f32_16x16x32_bf16 v[156:159], a[144:147], a[120:123], v[156:159]
  ds_read_b128 a[48:51], v7 offset:28672
  v_mfma_f32_16x16x32_bf16 v[96:99], a[152:155], a[64:67], v[96:99]
  buffer_load_dwordx4 v5, s[12:15], s33 offen offset:1024 lds
  v_mfma_f32_16x16x32_bf16 v[96:99], a[156:159], a[68:71], v[96:99]
  ds_read_b64_tr_b16 a[138:139], v12 offset:26624
  v_mfma_f32_16x16x32_bf16 v[100:103], a[156:159], a[76:79], v[100:103]
  ds_read_b128 a[52:55], v7 offset:29696
  v_mfma_f32_16x16x32_bf16 v[100:103], a[152:155], a[72:75], v[100:103]
  s_add_u32 s33, s33, 917504
  s_add_u32 m0, s36, 24576
  v_mfma_f32_16x16x32_bf16 v[104:107], a[152:155], a[80:83], v[104:107]
  buffer_load_dwordx4 v3, s[20:23], s31 offen offset:0 sc1 lds
  v_mfma_f32_16x16x32_bf16 v[104:107], a[156:159], a[84:87], v[104:107]
  ds_read_b64_tr_b16 a[140:141], v12 offset:28672
  ds_read_b128 a[56:59], v7 offset:30720
  v_mfma_f32_16x16x32_bf16 v[108:111], a[156:159], a[92:95], v[108:111]
  v_mfma_f32_16x16x32_bf16 v[108:111], a[152:155], a[88:91], v[108:111]
  ds_read_b64_tr_b16 a[142:143], v12 offset:30720
  v_mfma_f32_16x16x32_bf16 v[160:163], a[152:155], a[96:99], v[160:163]
  buffer_load_dwordx4 v252, s[20:23], s31 offen offset:1024 sc1 lds
  v_mfma_f32_16x16x32_bf16 v[160:163], a[156:159], a[100:103], v[160:163]
  ds_read_b128 a[60:63], v7 offset:31744
  v_mfma_f32_16x16x32_bf16 v[164:167], a[156:159], a[108:111], v[164:167]
  v_mfma_f32_16x16x32_bf16 v[164:167], a[152:155], a[104:107], v[164:167]
  v_mfma_f32_16x16x32_bf16 v[168:171], a[152:155], a[112:115], v[168:171]
  buffer_load_dwordx4 v253, s[20:23], s31 offen offset:2048 sc1 lds
  v_mfma_f32_16x16x32_bf16 v[168:171], a[156:159], a[116:119], v[168:171]
  v_mfma_f32_16x16x32_bf16 v[172:175], a[156:159], a[124:127], v[172:175]
  v_mfma_f32_16x16x32_bf16 v[172:175], a[152:155], a[120:123], v[172:175]
  s_waitcnt vmcnt(17) lgkmcnt(0)
  s_barrier
  v_mfma_f32_16x16x32_bf16 v[48:51], a[128:131], a[0:3], v[48:51]
  ds_read_b64_tr_b16 a[144:145], v13 offset:0
  v_mfma_f32_16x16x32_bf16 v[48:51], a[132:135], a[4:7], v[48:51]
  buffer_load_dwordx4 v254, s[20:23], s31 offen offset:3072 sc1 lds
  v_mfma_f32_16x16x32_bf16 v[52:55], a[132:135], a[12:15], v[52:55]
  ds_read_b128 a[64:67], v8 offset:0
  v_mfma_f32_16x16x32_bf16 v[52:55], a[128:131], a[8:11], v[52:55]
  s_add_u32 s31, s31, 28672
  s_add_u32 m0, s42, 65536
  v_mfma_f32_16x16x32_bf16 v[56:59], a[128:131], a[16:19], v[56:59]
  buffer_load_dwordx4 v4, s[12:15], s34 offen offset:0 lds
  v_mfma_f32_16x16x32_bf16 v[56:59], a[132:135], a[20:23], v[56:59]
  ds_read_b64_tr_b16 a[146:147], v13 offset:2048
  ds_read_b128 a[68:71], v8 offset:1024
  v_mfma_f32_16x16x32_bf16 v[60:63], a[132:135], a[28:31], v[60:63]
  ds_read_b64_tr_b16 a[148:149], v13 offset:4096
  v_mfma_f32_16x16x32_bf16 v[60:63], a[128:131], a[24:27], v[60:63]
  v_mfma_f32_16x16x32_bf16 v[112:115], a[128:131], a[32:35], v[112:115]
  buffer_load_dwordx4 v5, s[12:15], s34 offen offset:1024 lds
  v_mfma_f32_16x16x32_bf16 v[112:115], a[132:135], a[36:39], v[112:115]
  ds_read_b128 a[72:75], v8 offset:2048
  v_mfma_f32_16x16x32_bf16 v[116:119], a[132:135], a[44:47], v[116:119]
  ds_read_b64_tr_b16 a[150:151], v13 offset:6144
  v_mfma_f32_16x16x32_bf16 v[116:119], a[128:131], a[40:43], v[116:119]
  s_add_u32 s34, s34, 917504
  s_add_u32 m0, s36, 49152
  v_mfma_f32_16x16x32_bf16 v[120:123], a[128:131], a[48:51], v[120:123]
  buffer_load_dwordx4 v3, s[20:23], s30 offen offset:0 sc1 lds
  v_mfma_f32_16x16x32_bf16 v[120:123], a[132:135], a[52:55], v[120:123]
  ds_read_b128 a[76:79], v8 offset:3072
  ds_read_b64_tr_b16 a[152:153], v14 offset:0
  v_mfma_f32_16x16x32_bf16 v[124:127], a[132:135], a[60:63], v[124:127]
  v_mfma_f32_16x16x32_bf16 v[124:127], a[128:131], a[56:59], v[124:127]
  ds_read_b128 a[80:83], v8 offset:4096
  v_mfma_f32_16x16x32_bf16 v[64:67], a[136:139], a[0:3], v[64:67]
  buffer_load_dwordx4 v252, s[20:23], s30 offen offset:1024 sc1 lds
  v_mfma_f32_16x16x32_bf16 v[64:67], a[140:143], a[4:7], v[64:67]
  ds_read_b64_tr_b16 a[154:155], v14 offset:2048
  v_mfma_f32_16x16x32_bf16 v[68:71], a[140:143], a[12:15], v[68:71]
  ds_read_b128 a[84:87], v8 offset:5120
  v_mfma_f32_16x16x32_bf16 v[68:71], a[136:139], a[8:11], v[68:71]
  v_mfma_f32_16x16x32_bf16 v[72:75], a[136:139], a[16:19], v[72:75]
  buffer_load_dwordx4 v253, s[20:23], s30 offen offset:2048 sc1 lds
  v_mfma_f32_16x16x32_bf16 v[72:75], a[140:143], a[20:23], v[72:75]
  ds_read_b64_tr_b16 a[156:157], v14 offset:4096
  ds_read_b128 a[88:91], v8 offset:6144
  v_mfma_f32_16x16x32_bf16 v[76:79], a[140:143], a[28:31], v[76:79]
  v_mfma_f32_16x16x32_bf16 v[76:79], a[136:139], a[24:27], v[76:79]
  ds_read_b64_tr_b16 a[158:159], v14 offset:6144
  v_mfma_f32_16x16x32_bf16 v[128:131], a[136:139], a[32:35], v[128:131]
  buffer_load_dwordx4 v254, s[20:23], s30 offen offset:3072 sc1 lds
  v_mfma_f32_16x16x32_bf16 v[128:131], a[140:143], a[36:39], v[128:131]
  ds_read_b128 a[92:95], v8 offset:7168
  v_mfma_f32_16x16x32_bf16 v[132:135], a[140:143], a[44:47], v[132:135]
  v_mfma_f32_16x16x32_bf16 v[132:135], a[136:139], a[40:43], v[132:135]
  s_add_u32 m0, s42, 90112
  v_mfma_f32_16x16x32_bf16 v[136:139], a[136:139], a[48:51], v[136:139]
  buffer_load_dwordx4 v4, s[12:15], s33 offen offset:0 lds
  v_mfma_f32_16x16x32_bf16 v[136:139], a[140:143], a[52:55], v[136:139]
  v_mfma_f32_16x16x32_bf16 v[140:143], a[140:143], a[60:63], v[140:143]
  v_mfma_f32_16x16x32_bf16 v[140:143], a[136:139], a[56:59], v[140:143]
  s_waitcnt vmcnt(19) lgkmcnt(0)
  s_barrier
  v_mfma_f32_16x16x32_bf16 v[80:83], a[144:147], a[0:3], v[80:83]
  ds_read_b64_tr_b16 a[128:129], v13 offset:24576
  v_mfma_f32_16x16x32_bf16 v[80:83], a[148:151], a[4:7], v[80:83]
  buffer_load_dword v45, v34, s[20:23], s50 offen offset:4 sc1
  v_mfma_f32_16x16x32_bf16 v[84:87], a[148:151], a[12:15], v[84:87]
  ds_read_b128 a[96:99], v8 offset:24576
  v_mfma_f32_16x16x32_bf16 v[84:87], a[144:147], a[8:11], v[84:87]
  ds_read_b64_tr_b16 a[130:131], v13 offset:26624
  v_mfma_f32_16x16x32_bf16 v[88:91], a[144:147], a[16:19], v[88:91]
  buffer_load_dwordx4 v5, s[12:15], s33 offen offset:1024 lds
  v_mfma_f32_16x16x32_bf16 v[88:91], a[148:151], a[20:23], v[88:91]
  ds_read_b128 a[100:103], v8 offset:25600
  v_mfma_f32_16x16x32_bf16 v[92:95], a[148:151], a[28:31], v[92:95]
  ds_read_b64_tr_b16 a[132:133], v13 offset:28672
  v_mfma_f32_16x16x32_bf16 v[92:95], a[144:147], a[24:27], v[92:95]
  s_add_u32 m0, s36, 73728
  v_mfma_f32_16x16x32_bf16 v[144:147], a[144:147], a[32:35], v[144:147]
  buffer_load_dwordx4 v3, s[20:23], s31 offen offset:0 sc1 lds
  v_mfma_f32_16x16x32_bf16 v[144:147], a[148:151], a[36:39], v[144:147]
  ds_read_b128 a[104:107], v8 offset:26624
  v_mfma_f32_16x16x32_bf16 v[148:151], a[148:151], a[44:47], v[148:151]
  ds_read_b64_tr_b16 a[134:135], v13 offset:30720
  v_mfma_f32_16x16x32_bf16 v[148:151], a[144:147], a[40:43], v[148:151]
  ds_read_b128 a[108:111], v8 offset:27648
  v_mfma_f32_16x16x32_bf16 v[152:155], a[144:147], a[48:51], v[152:155]
  buffer_load_dwordx4 v252, s[20:23], s31 offen offset:1024 sc1 lds
  v_mfma_f32_16x16x32_bf16 v[152:155], a[148:151], a[52:55], v[152:155]
  ds_read_b64_tr_b16 a[136:137], v14 offset:24576
  v_mfma_f32_16x16x32_bf16 v[156:159], a[148:151], a[60:63], v[156:159]
  v_mfma_f32_16x16x32_bf16 v[156:159], a[144:147], a[56:59], v[156:159]
  ds_read_b128 a[112:115], v8 offset:28672
  v_mfma_f32_16x16x32_bf16 v[96:99], a[152:155], a[0:3], v[96:99]
  buffer_load_dwordx4 v253, s[20:23], s31 offen offset:2048 sc1 lds
  v_mfma_f32_16x16x32_bf16 v[96:99], a[156:159], a[4:7], v[96:99]
  ds_read_b64_tr_b16 a[138:139], v14 offset:26624
  v_mfma_f32_16x16x32_bf16 v[100:103], a[156:159], a[12:15], v[100:103]
  ds_read_b128 a[116:119], v8 offset:29696
  v_mfma_f32_16x16x32_bf16 v[100:103], a[152:155], a[8:11], v[100:103]
  v_mfma_f32_16x16x32_bf16 v[104:107], a[152:155], a[16:19], v[104:107]
  buffer_load_dwordx4 v254, s[20:23], s31 offen offset:3072 sc1 lds
  v_mfma_f32_16x16x32_bf16 v[104:107], a[156:159], a[20:23], v[104:107]
  ds_read_b64_tr_b16 a[140:141], v14 offset:28672
  ds_read_b128 a[120:123], v8 offset:30720
  v_mfma_f32_16x16x32_bf16 v[108:111], a[156:159], a[28:31], v[108:111]
  v_mfma_f32_16x16x32_bf16 v[108:111], a[152:155], a[24:27], v[108:111]
  s_add_u32 m0, s42, 114688
  ds_read_b64_tr_b16 a[142:143], v14 offset:30720
  v_mfma_f32_16x16x32_bf16 v[160:163], a[152:155], a[32:35], v[160:163]
  buffer_load_dwordx4 v4, s[12:15], s34 offen offset:0 lds
  v_mfma_f32_16x16x32_bf16 v[160:163], a[156:159], a[36:39], v[160:163]
  ds_read_b128 a[124:127], v8 offset:31744
  v_mfma_f32_16x16x32_bf16 v[164:167], a[156:159], a[44:47], v[164:167]
  v_mfma_f32_16x16x32_bf16 v[164:167], a[152:155], a[40:43], v[164:167]
  v_mfma_f32_16x16x32_bf16 v[168:171], a[152:155], a[48:51], v[168:171]
  buffer_load_dwordx4 v5, s[12:15], s34 offen offset:1024 lds
  v_mfma_f32_16x16x32_bf16 v[168:171], a[156:159], a[52:55], v[168:171]
  v_mfma_f32_16x16x32_bf16 v[172:175], a[156:159], a[60:63], v[172:175]
  v_mfma_f32_16x16x32_bf16 v[172:175], a[152:155], a[56:59], v[172:175]
  s_waitcnt vmcnt(21) lgkmcnt(0)
  s_barrier
  v_mfma_f32_16x16x32_bf16 v[48:51], a[128:131], a[64:67], v[48:51]
  ds_read_b64_tr_b16 a[144:145], v9 offset:0
  v_mfma_f32_16x16x32_bf16 v[48:51], a[132:135], a[68:71], v[48:51]
  ds_read_b128 a[0:3], v6 offset:0
  v_mfma_f32_16x16x32_bf16 v[52:55], a[132:135], a[76:79], v[52:55]
  v_mfma_f32_16x16x32_bf16 v[52:55], a[128:131], a[72:75], v[52:55]
  ds_read_b64_tr_b16 a[146:147], v9 offset:2048
  v_mfma_f32_16x16x32_bf16 v[56:59], a[128:131], a[80:83], v[56:59]
  v_mfma_f32_16x16x32_bf16 v[56:59], a[132:135], a[84:87], v[56:59]
  ds_read_b128 a[4:7], v6 offset:1024
  v_mfma_f32_16x16x32_bf16 v[60:63], a[132:135], a[92:95], v[60:63]
  ds_read_b64_tr_b16 a[148:149], v9 offset:4096
  v_mfma_f32_16x16x32_bf16 v[60:63], a[128:131], a[88:91], v[60:63]
  v_mfma_f32_16x16x32_bf16 v[112:115], a[128:131], a[96:99], v[112:115]
  ds_read_b128 a[8:11], v6 offset:2048
  v_mfma_f32_16x16x32_bf16 v[112:115], a[132:135], a[100:103], v[112:115]
  v_mfma_f32_16x16x32_bf16 v[116:119], a[132:135], a[108:111], v[116:119]
  ds_read_b64_tr_b16 a[150:151], v9 offset:6144
  v_mfma_f32_16x16x32_bf16 v[116:119], a[128:131], a[104:107], v[116:119]
  ds_read_b128 a[12:15], v6 offset:3072
  v_mfma_f32_16x16x32_bf16 v[120:123], a[128:131], a[112:115], v[120:123]
  v_mfma_f32_16x16x32_bf16 v[120:123], a[132:135], a[116:119], v[120:123]
  ds_read_b64_tr_b16 a[152:153], v10 offset:0
  v_mfma_f32_16x16x32_bf16 v[124:127], a[132:135], a[124:127], v[124:127]
  v_mfma_f32_16x16x32_bf16 v[124:127], a[128:131], a[120:123], v[124:127]
  ds_read_b128 a[16:19], v6 offset:4096
  v_mfma_f32_16x16x32_bf16 v[64:67], a[136:139], a[64:67], v[64:67]
  ds_read_b64_tr_b16 a[154:155], v10 offset:2048
  v_mfma_f32_16x16x32_bf16 v[64:67], a[140:143], a[68:71], v[64:67]
  v_mfma_f32_16x16x32_bf16 v[68:71], a[140:143], a[76:79], v[68:71]
  ds_read_b128 a[20:23], v6 offset:5120
  v_mfma_f32_16x16x32_bf16 v[68:71], a[136:139], a[72:75], v[68:71]
  v_mfma_f32_16x16x32_bf16 v[72:75], a[136:139], a[80:83], v[72:75]
  ds_read_b64_tr_b16 a[156:157], v10 offset:4096
  v_mfma_f32_16x16x32_bf16 v[72:75], a[140:143], a[84:87], v[72:75]
  ds_read_b128 a[24:27], v6 offset:6144
  v_mfma_f32_16x16x32_bf16 v[76:79], a[140:143], a[92:95], v[76:79]
  v_mfma_f32_16x16x32_bf16 v[76:79], a[136:139], a[88:91], v[76:79]
  ds_read_b64_tr_b16 a[158:159], v10 offset:6144
  v_mfma_f32_16x16x32_bf16 v[128:131], a[136:139], a[96:99], v[128:131]
  v_mfma_f32_16x16x32_bf16 v[128:131], a[140:143], a[100:103], v[128:131]
  ds_read_b128 a[28:31], v6 offset:7168
  v_mfma_f32_16x16x32_bf16 v[132:135], a[140:143], a[108:111], v[132:135]
  v_mfma_f32_16x16x32_bf16 v[132:135], a[136:139], a[104:107], v[132:135]
  v_mfma_f32_16x16x32_bf16 v[136:139], a[136:139], a[112:115], v[136:139]
  v_mfma_f32_16x16x32_bf16 v[136:139], a[140:143], a[116:119], v[136:139]
  v_mfma_f32_16x16x32_bf16 v[140:143], a[140:143], a[124:127], v[140:143]
  v_mfma_f32_16x16x32_bf16 v[140:143], a[136:139], a[120:123], v[140:143]
  s_waitcnt vmcnt(7) lgkmcnt(0)
  s_barrier
  v_cmp_ne_u32 vcc, 1, v45
  s_nop 0
  s_cmp_eq_u64 vcc, 0
  s_cbranch_scc0 L2_o_slowH
L2_o_okH:
  v_mfma_f32_16x16x32_bf16 v[80:83], a[144:147], a[64:67], v[80:83]
  s_lshl_b32 s4, s25, 2
  s_and_b32 s5, s41, 2
  s_add_u32 s4, s4, s5
  s_add_u32 s4, s4, s38
  s_lshl_b32 s4, s4, 8
  s_add_u32 s94, s4, 39911424
  v_mfma_f32_16x16x32_bf16 v[80:83], a[148:151], a[68:71], v[80:83]
  buffer_load_dwordx4 v[20:23], v18, s[20:23], s94 offen sc1
  v_mfma_f32_16x16x32_bf16 v[84:87], a[148:151], a[76:79], v[84:87]
  ds_read_b64_tr_b16 a[128:129], v9 offset:24576
  ds_read_b128 a[32:35], v6 offset:24576
  v_mfma_f32_16x16x32_bf16 v[84:87], a[144:147], a[72:75], v[84:87]
  s_add_u32 m0, s42, 139264
  ds_read_b64_tr_b16 a[130:131], v9 offset:26624
  v_mfma_f32_16x16x32_bf16 v[88:91], a[144:147], a[80:83], v[88:91]
  buffer_load_dwordx4 v4, s[8:11], s35 offen offset:0 lds
  v_mfma_f32_16x16x32_bf16 v[88:91], a[148:151], a[84:87], v[88:91]
  ds_read_b128 a[36:39], v6 offset:25600
  v_mfma_f32_16x16x32_bf16 v[92:95], a[148:151], a[92:95], v[92:95]
  ds_read_b64_tr_b16 a[132:133], v9 offset:28672
  v_mfma_f32_16x16x32_bf16 v[92:95], a[144:147], a[88:91], v[92:95]
  buffer_load_dwordx4 v5, s[8:11], s35 offen offset:1024 lds
  v_mfma_f32_16x16x32_bf16 v[144:147], a[144:147], a[96:99], v[144:147]
  ds_read_b128 a[40:43], v6 offset:26624
  v_mfma_f32_16x16x32_bf16 v[144:147], a[148:151], a[100:103], v[144:147]
  v_mfma_f32_16x16x32_bf16 v[148:151], a[148:151], a[108:111], v[148:151]
  s_add_u32 s35, s35, 131072
  s_add_u32 m0, s36, 122880
  v_mfma_f32_16x16x32_bf16 v[148:151], a[144:147], a[104:107], v[148:151]
  buffer_load_dwordx4 v3, s[20:23], s32 offen offset:0 sc1 lds
  v_mfma_f32_16x16x32_bf16 v[152:155], a[144:147], a[112:115], v[152:155]
  ds_read_b64_tr_b16 a[134:135], v9 offset:30720
  ds_read_b128 a[44:47], v6 offset:27648
  v_mfma_f32_16x16x32_bf16 v[152:155], a[148:151], a[116:119], v[152:155]
  ds_read_b64_tr_b16 a[136:137], v10 offset:24576
  v_mfma_f32_16x16x32_bf16 v[156:159], a[148:151], a[124:127], v[156:159]
  buffer_load_dwordx4 v252, s[20:23], s32 offen offset:1024 sc1 lds
  v_mfma_f32_16x16x32_bf16 v[156:159], a[144:147], a[120:123], v[156:159]
  ds_read_b128 a[48:51], v6 offset:28672
  v_mfma_f32_16x16x32_bf16 v[96:99], a[152:155], a[64:67], v[96:99]
  ds_read_b64_tr_b16 a[138:139], v10 offset:26624
  v_mfma_f32_16x16x32_bf16 v[96:99], a[156:159], a[68:71], v[96:99]
  v_mfma_f32_16x16x32_bf16 v[100:103], a[156:159], a[76:79], v[100:103]
  buffer_load_dwordx4 v253, s[20:23], s32 offen offset:2048 sc1 lds
  v_mfma_f32_16x16x32_bf16 v[100:103], a[152:155], a[72:75], v[100:103]
  ds_read_b128 a[52:55], v6 offset:29696
  v_mfma_f32_16x16x32_bf16 v[104:107], a[152:155], a[80:83], v[104:107]
  ds_read_b64_tr_b16 a[140:141], v10 offset:28672
  v_mfma_f32_16x16x32_bf16 v[104:107], a[156:159], a[84:87], v[104:107]
  buffer_load_dwordx4 v254, s[20:23], s32 offen offset:3072 sc1 lds
  v_mfma_f32_16x16x32_bf16 v[108:111], a[156:159], a[92:95], v[108:111]
  ds_read_b128 a[56:59], v6 offset:30720
  v_mfma_f32_16x16x32_bf16 v[108:111], a[152:155], a[88:91], v[108:111]
  ds_read_b64_tr_b16 a[142:143], v10 offset:30720
  v_mfma_f32_16x16x32_bf16 v[160:163], a[152:155], a[96:99], v[160:163]
  s_add_u32 s32, s32, 4096
  s_add_u32 m0, s42, 16384
  v_mfma_f32_16x16x32_bf16 v[160:163], a[156:159], a[100:103], v[160:163]
  buffer_load_dwordx4 v4, s[8:11], s35 offen offset:0 lds
  v_mfma_f32_16x16x32_bf16 v[164:167], a[156:159], a[108:111], v[164:167]
  ds_read_b128 a[60:63], v6 offset:31744
  v_mfma_f32_16x16x32_bf16 v[164:167], a[152:155], a[104:107], v[164:167]
  v_mfma_f32_16x16x32_bf16 v[168:171], a[152:155], a[112:115], v[168:171]
  buffer_load_dwordx4 v5, s[8:11], s35 offen offset:1024 lds
  v_mfma_f32_16x16x32_bf16 v[168:171], a[156:159], a[116:119], v[168:171]
  s_add_u32 s35, s35, 131072
  v_mfma_f32_16x16x32_bf16 v[172:175], a[156:159], a[124:127], v[172:175]
  v_mfma_f32_16x16x32_bf16 v[172:175], a[152:155], a[120:123], v[172:175]
  s_waitcnt vmcnt(16) lgkmcnt(0)
  s_barrier
  v_mfma_f32_16x16x32_bf16 v[48:51], a[128:131], a[0:3], v[48:51]
  s_add_u32 m0, s36, 0
  ds_read_b64_tr_b16 a[144:145], v11 offset:0
  v_mfma_f32_16x16x32_bf16 v[48:51], a[132:135], a[4:7], v[48:51]
  buffer_load_dwordx4 v3, s[20:23], s32 offen offset:0 sc1 lds
  v_mfma_f32_16x16x32_bf16 v[52:55], a[132:135], a[12:15], v[52:55]
  ds_read_b128 a[64:67], v7 offset:0
  v_mfma_f32_16x16x32_bf16 v[52:55], a[128:131], a[8:11], v[52:55]
  ds_read_b64_tr_b16 a[146:147], v11 offset:2048
  v_mfma_f32_16x16x32_bf16 v[56:59], a[128:131], a[16:19], v[56:59]
  buffer_load_dwordx4 v252, s[20:23], s32 offen offset:1024 sc1 lds
  v_mfma_f32_16x16x32_bf16 v[56:59], a[132:135], a[20:23], v[56:59]
  ds_read_b128 a[68:71], v7 offset:1024
  v_mfma_f32_16x16x32_bf16 v[60:63], a[132:135], a[28:31], v[60:63]
  ds_read_b64_tr_b16 a[148:149], v11 offset:4096
  v_mfma_f32_16x16x32_bf16 v[60:63], a[128:131], a[24:27], v[60:63]
  v_mfma_f32_16x16x32_bf16 v[112:115], a[128:131], a[32:35], v[112:115]
  buffer_load_dwordx4 v253, s[20:23], s32 offen offset:2048 sc1 lds
  v_mfma_f32_16x16x32_bf16 v[112:115], a[132:135], a[36:39], v[112:115]
  ds_read_b128 a[72:75], v7 offset:2048
  v_mfma_f32_16x16x32_bf16 v[116:119], a[132:135], a[44:47], v[116:119]
  ds_read_b64_tr_b16 a[150:151], v11 offset:6144
  v_mfma_f32_16x16x32_bf16 v[116:119], a[128:131], a[40:43], v[116:119]
  ds_read_b128 a[76:79], v7 offset:3072
  v_mfma_f32_16x16x32_bf16 v[120:123], a[128:131], a[48:51], v[120:123]
  buffer_load_dwordx4 v254, s[20:23], s32 offen offset:3072 sc1 lds
  v_mfma_f32_16x16x32_bf16 v[120:123], a[132:135], a[52:55], v[120:123]
  ds_read_b64_tr_b16 a[152:153], v12 offset:0
  v_mfma_f32_16x16x32_bf16 v[124:127], a[132:135], a[60:63], v[124:127]
  v_mfma_f32_16x16x32_bf16 v[124:127], a[128:131], a[56:59], v[124:127]
  s_add_u32 s32, s32, 4096
  s_add_u32 m0, s42, 40960
  v_mfma_f32_16x16x32_bf16 v[64:67], a[136:139], a[0:3], v[64:67]
  buffer_load_dwordx4 v4, s[8:11], s35 offen offset:0 lds
  v_mfma_f32_16x16x32_bf16 v[64:67], a[140:143], a[4:7], v[64:67]
  ds_read_b128 a[80:83], v7 offset:4096
  ds_read_b64_tr_b16 a[154:155], v12 offset:2048
  v_mfma_f32_16x16x32_bf16 v[68:71], a[140:143], a[12:15], v[68:71]
  ds_read_b128 a[84:87], v7 offset:5120
  v_mfma_f32_16x16x32_bf16 v[68:71], a[136:139], a[8:11], v[68:71]
  v_mfma_f32_16x16x32_bf16 v[72:75], a[136:139], a[16:19], v[72:75]
  buffer_load_dwordx4 v5, s[8:11], s35 offen offset:1024 lds
  v_mfma_f32_16x16x32_bf16 v[72:75], a[140:143], a[20:23], v[72:75]
  ds_read_b64_tr_b16 a[156:157], v12 offset:4096
  ds_read_b128 a[88:91], v7 offset:6144
  v_mfma_f32_16x16x32_bf16 v[76:79], a[140:143], a[28:31], v[76:79]
  v_mfma_f32_16x16x32_bf16 v[76:79], a[136:139], a[24:27], v[76:79]
  s_add_u32 s35, s35, 131072
  s_add_u32 m0, s36, 24576
  v_mfma_f32_16x16x32_bf16 v[128:131], a[136:139], a[32:35], v[128:131]
  buffer_load_dwordx4 v3, s[20:23], s32 offen offset:0 sc1 lds
  v_mfma_f32_16x16x32_bf16 v[128:131], a[140:143], a[36:39], v[128:131]
  ds_read_b64_tr_b16 a[158:159], v12 offset:6144
  ds_read_b128 a[92:95], v7 offset:7168
  v_mfma_f32_16x16x32_bf16 v[132:135], a[140:143], a[44:47], v[132:135]
  v_mfma_f32_16x16x32_bf16 v[132:135], a[136:139], a[40:43], v[132:135]
  v_mfma_f32_16x16x32_bf16 v[136:139], a[136:139], a[48:51], v[136:139]
  buffer_load_dwordx4 v252, s[20:23], s32 offen offset:1024 sc1 lds
  v_mfma_f32_16x16x32_bf16 v[136:139], a[140:143], a[52:55], v[136:139]
  v_mfma_f32_16x16x32_bf16 v[140:143], a[140:143], a[60:63], v[140:143]
  v_mfma_f32_16x16x32_bf16 v[140:143], a[136:139], a[56:59], v[140:143]
  s_waitcnt vmcnt(19) lgkmcnt(0)
  s_barrier
  v_mfma_f32_16x16x32_bf16 v[80:83], a[144:147], a[0:3], v[80:83]
  ds_read_b64_tr_b16 a[128:129], v11 offset:24576
  v_mfma_f32_16x16x32_bf16 v[80:83], a[148:151], a[4:7], v[80:83]
  buffer_load_dwordx4 v253, s[20:23], s32 offen offset:2048 sc1 lds
  v_mfma_f32_16x16x32_bf16 v[84:87], a[148:151], a[12:15], v[84:87]
  ds_read_b128 a[96:99], v7 offset:24576
  v_mfma_f32_16x16x32_bf16 v[84:87], a[144:147], a[8:11], v[84:87]
  ds_read_b64_tr_b16 a[130:131], v11 offset:26624
  v_mfma_f32_16x16x32_bf16 v[88:91], a[144:147], a[16:19], v[88:91]
  buffer_load_dwordx4 v254, s[20:23], s32 offen offset:3072 sc1 lds
  v_mfma_f32_16x16x32_bf16 v[88:91], a[148:151], a[20:23], v[88:91]
  ds_read_b128 a[100:103], v7 offset:25600
  v_mfma_f32_16x16x32_bf16 v[92:95], a[148:151], a[28:31], v[92:95]
  ds_read_b64_tr_b16 a[132:133], v11 offset:28672
  v_mfma_f32_16x16x32_bf16 v[92:95], a[144:147], a[24:27], v[92:95]
  s_add_u32 s32, s32, 4096
  s_add_u32 m0, s42, 65536
  v_mfma_f32_16x16x32_bf16 v[144:147], a[144:147], a[32:35], v[144:147]
  buffer_load_dwordx4 v4, s[8:11], s35 offen offset:0 lds
  v_mfma_f32_16x16x32_bf16 v[144:147], a[148:151], a[36:39], v[144:147]
  ds_read_b128 a[104:107], v7 offset:26624
  v_mfma_f32_16x16x32_bf16 v[148:151], a[148:151], a[44:47], v[148:151]
  ds_read_b64_tr_b16 a[134:135], v11 offset:30720
  v_mfma_f32_16x16x32_bf16 v[148:151], a[144:147], a[40:43], v[148:151]
  ds_read_b128 a[108:111], v7 offset:27648
  v_mfma_f32_16x16x32_bf16 v[152:155], a[144:147], a[48:51], v[152:155]
  buffer_load_dwordx4 v5, s[8:11], s35 offen offset:1024 lds
  v_mfma_f32_16x16x32_bf16 v[152:155], a[148:151], a[52:55], v[152:155]
  ds_read_b64_tr_b16 a[136:137], v12 offset:24576
  v_mfma_f32_16x16x32_bf16 v[156:159], a[148:151], a[60:63], v[156:159]
  v_mfma_f32_16x16x32_bf16 v[156:159], a[144:147], a[56:59], v[156:159]
  s_add_u32 s35, s35, 131072
  s_add_u32 m0, s36, 49152
  v_mfma_f32_16x16x32_bf16 v[96:99], a[152:155], a[0:3], v[96:99]
  buffer_load_dwordx4 v3, s[20:23], s32 offen offset:0 sc1 lds
  v_mfma_f32_16x16x32_bf16 v[96:99], a[156:159], a[4:7], v[96:99]
  ds_read_b128 a[112:115], v7 offset:28672
  ds_read_b64_tr_b16 a[138:139], v12 offset:26624
  v_mfma_f32_16x16x32_bf16 v[100:103], a[156:159], a[12:15], v[100:103]
  ds_read_b128 a[116:119], v7 offset:29696
  v_mfma_f32_16x16x32_bf16 v[100:103], a[152:155], a[8:11], v[100:103]
  v_mfma_f32_16x16x32_bf16 v[104:107], a[152:155], a[16:19], v[104:107]
  buffer_load_dwordx4 v252, s[20:23], s32 offen offset:1024 sc1 lds
  v_mfma_f32_16x16x32_bf16 v[104:107], a[156:159], a[20:23], v[104:107]
  ds_read_b64_tr_b16 a[140:141], v12 offset:28672
  ds_read_b128 a[120:123], v7 offset:30720
  v_mfma_f32_16x16x32_bf16 v[108:111], a[156:159], a[28:31], v[108:111]
  v_mfma_f32_16x16x32_bf16 v[108:111], a[152:155], a[24:27], v[108:111]
  ds_read_b64_tr_b16 a[142:143], v12 offset:30720
  v_mfma_f32_16x16x32_bf16 v[160:163], a[152:155], a[32:35], v[160:163]
  buffer_load_dwordx4 v253, s[20:23], s32 offen offset:2048 sc1 lds
  v_mfma_f32_16x16x32_bf16 v[160:163], a[156:159], a[36:39], v[160:163]
  ds_read_b128 a[124:127], v7 offset:31744
  v_mfma_f32_16x16x32_bf16 v[164:167], a[156:159], a[44:47], v[164:167]
  v_mfma_f32_16x16x32_bf16 v[164:167], a[152:155], a[40:43], v[164:167]
  v_mfma_f32_16x16x32_bf16 v[168:171], a[152:155], a[48:51], v[168:171]
  buffer_load_dwordx4 v254, s[20:23], s32 offen offset:3072 sc1 lds
  v_mfma_f32_16x16x32_bf16 v[168:171], a[156:159], a[52:55], v[168:171]
  s_add_u32 s32, s32, 4096
  v_mfma_f32_16x16x32_bf16 v[172:175], a[156:159], a[60:63], v[172:175]
  v_mfma_f32_16x16x32_bf16 v[172:175], a[152:155], a[56:59], v[172:175]
  s_waitcnt vmcnt(24) lgkmcnt(0)
  s_barrier
  v_mfma_f32_16x16x32_bf16 v[48:51], a[128:131], a[64:67], v[48:51]
  s_add_u32 m0, s42, 90112
  ds_read_b64_tr_b16 a[144:145], v13 offset:0
  v_mfma_f32_16x16x32_bf16 v[48:51], a[132:135], a[68:71], v[48:51]
  buffer_load_dwordx4 v4, s[8:11], s35 offen offset:0 lds
  v_mfma_f32_16x16x32_bf16 v[52:55], a[132:135], a[76:79], v[52:55]
  v_mfma_f32_16x16x32_bf16 v[52:55], a[128:131], a[72:75], v[52:55]
  ds_read_b64_tr_b16 a[146:147], v13 offset:2048
  v_mfma_f32_16x16x32_bf16 v[56:59], a[128:131], a[80:83], v[56:59]
  v_mfma_f32_16x16x32_bf16 v[56:59], a[132:135], a[84:87], v[56:59]
  v_mfma_f32_16x16x32_bf16 v[60:63], a[132:135], a[92:95], v[60:63]
  buffer_load_dwordx4 v5, s[8:11], s35 offen offset:1024 lds
  v_mfma_f32_16x16x32_bf16 v[60:63], a[128:131], a[88:91], v[60:63]
  ds_read_b64_tr_b16 a[148:149], v13 offset:4096
  v_mfma_f32_16x16x32_bf16 v[112:115], a[128:131], a[96:99], v[112:115]
  v_mfma_f32_16x16x32_bf16 v[112:115], a[132:135], a[100:103], v[112:115]
  v_mfma_f32_16x16x32_bf16 v[116:119], a[132:135], a[108:111], v[116:119]
  s_add_u32 s35, s35, 131072
  s_add_u32 m0, s36, 73728
  v_mfma_f32_16x16x32_bf16 v[116:119], a[128:131], a[104:107], v[116:119]
  buffer_load_dwordx4 v3, s[20:23], s32 offen offset:0 sc1 lds
  v_mfma_f32_16x16x32_bf16 v[120:123], a[128:131], a[112:115], v[120:123]
  ds_read_b64_tr_b16 a[150:151], v13 offset:6144
  v_mfma_f32_16x16x32_bf16 v[120:123], a[132:135], a[116:119], v[120:123]
  ds_read_b64_tr_b16 a[152:153], v14 offset:0
  v_mfma_f32_16x16x32_bf16 v[124:127], a[132:135], a[124:127], v[124:127]
  v_mfma_f32_16x16x32_bf16 v[124:127], a[128:131], a[120:123], v[124:127]
  v_mfma_f32_16x16x32_bf16 v[64:67], a[136:139], a[64:67], v[64:67]
  buffer_load_dwordx4 v252, s[20:23], s32 offen offset:1024 sc1 lds
  v_mfma_f32_16x16x32_bf16 v[64:67], a[140:143], a[68:71], v[64:67]
  ds_read_b64_tr_b16 a[154:155], v14 offset:2048
  v_mfma_f32_16x16x32_bf16 v[68:71], a[140:143], a[76:79], v[68:71]
  v_mfma_f32_16x16x32_bf16 v[68:71], a[136:139], a[72:75], v[68:71]
  v_mfma_f32_16x16x32_bf16 v[72:75], a[136:139], a[80:83], v[72:75]
  ds_read_b64_tr_b16 a[156:157], v14 offset:4096
  v_mfma_f32_16x16x32_bf16 v[72:75], a[140:143], a[84:87], v[72:75]
  buffer_load_dwordx4 v253, s[20:23], s32 offen offset:2048 sc1 lds
  v_mfma_f32_16x16x32_bf16 v[76:79], a[140:143], a[92:95], v[76:79]
  v_mfma_f32_16x16x32_bf16 v[76:79], a[136:139], a[88:91], v[76:79]
  ds_read_b64_tr_b16 a[158:159], v14 offset:6144
  v_mfma_f32_16x16x32_bf16 v[128:131], a[136:139], a[96:99], v[128:131]
  v_mfma_f32_16x16x32_bf16 v[128:131], a[140:143], a[100:103], v[128:131]
  v_mfma_f32_16x16x32_bf16 v[132:135], a[140:143], a[108:111], v[132:135]
  buffer_load_dwordx4 v254, s[20:23], s32 offen offset:3072 sc1 lds
  v_mfma_f32_16x16x32_bf16 v[132:135], a[136:139], a[104:107], v[132:135]
  s_add_u32 s32, s32, 4096
  v_mfma_f32_16x16x32_bf16 v[136:139], a[136:139], a[112:115], v[136:139]
  v_mfma_f32_16x16x32_bf16 v[136:139], a[140:143], a[116:119], v[136:139]
  v_mfma_f32_16x16x32_bf16 v[140:143], a[140:143], a[124:127], v[140:143]
  v_mfma_f32_16x16x32_bf16 v[140:143], a[136:139], a[120:123], v[140:143]
  s_waitcnt vmcnt(24) lgkmcnt(0)
  s_barrier
  v_mfma_f32_16x16x32_bf16 v[144:147], a[144:147], a[96:99], v[144:147]
  ds_read_b64_tr_b16 a[128:129], v13 offset:24576
  v_mfma_f32_16x16x32_bf16 v[144:147], a[148:151], a[100:103], v[144:147]
  ds_read_b128 a[0:3], v8 offset:24576
  v_mfma_f32_16x16x32_bf16 v[148:151], a[148:151], a[108:111], v[148:151]
  v_mfma_f32_16x16x32_bf16 v[148:151], a[144:147], a[104:107], v[148:151]
  ds_read_b64_tr_b16 a[130:131], v13 offset:26624
  v_mfma_f32_16x16x32_bf16 v[152:155], a[144:147], a[112:115], v[152:155]
  v_mfma_f32_16x16x32_bf16 v[152:155], a[148:151], a[116:119], v[152:155]
  ds_read_b128 a[4:7], v8 offset:25600
  v_mfma_f32_16x16x32_bf16 v[156:159], a[148:151], a[124:127], v[156:159]
  ds_read_b64_tr_b16 a[132:133], v13 offset:28672
  s_add_u32 s95, s49, 32768
  v_cvt_pk_bf16_f32 v24, v48, v49
  v_mfma_f32_16x16x32_bf16 v[156:159], a[144:147], a[120:123], v[156:159]
  v_cvt_pk_bf16_f32 v25, v50, v51
  v_cvt_pk_bf16_f32 v26, v64, v65
  v_mfma_f32_16x16x32_bf16 v[160:163], a[152:155], a[96:99], v[160:163]
  ds_read_b128 a[8:11], v8 offset:26624
  v_cvt_pk_bf16_f32 v27, v66, v67
  v_mfma_f32_16x16x32_bf16 v[160:163], a[156:159], a[100:103], v[160:163]
  buffer_store_dwordx4 v[24:27], v3, s[20:23], s95 offen offset:0 sc1
  v_cvt_pk_bf16_f32 v28, v52, v53
  v_mfma_f32_16x16x32_bf16 v[164:167], a[156:159], a[108:111], v[164:167]
  ds_read_b64_tr_b16 a[134:135], v13 offset:30720
  v_cvt_pk_bf16_f32 v29, v54, v55
  v_cvt_pk_bf16_f32 v30, v68, v69
  v_mfma_f32_16x16x32_bf16 v[164:167], a[152:155], a[104:107], v[164:167]
  ds_read_b128 a[12:15], v8 offset:27648
  v_cvt_pk_bf16_f32 v31, v70, v71
  v_mfma_f32_16x16x32_bf16 v[168:171], a[152:155], a[112:115], v[168:171]
  buffer_store_dwordx4 v[28:31], v3, s[20:23], s95 offen offset:2048 sc1
  v_cvt_pk_bf16_f32 v32, v56, v57
  v_mfma_f32_16x16x32_bf16 v[168:171], a[156:159], a[116:119], v[168:171]
  ds_read_b64_tr_b16 a[136:137], v14 offset:24576
  v_cvt_pk_bf16_f32 v33, v58, v59
  v_mfma_f32_16x16x32_bf16 v[172:175], a[156:159], a[124:127], v[172:175]
  v_cvt_pk_bf16_f32 v34, v72, v73
  v_cvt_pk_bf16_f32 v35, v74, v75
  v_mfma_f32_16x16x32_bf16 v[172:175], a[152:155], a[120:123], v[172:175]
  ds_read_b128 a[16:19], v8 offset:28672
  buffer_store_dwordx4 v[32:35], v255, s[20:23], s95 offen offset:0 sc1
  v_mfma_f32_16x16x32_bf16 v[80:83], a[144:147], a[64:67], v[80:83]
  ds_read_b64_tr_b16 a[138:139], v14 offset:26624
  v_cvt_pk_bf16_f32 v36, v60, v61
  v_cvt_pk_bf16_f32 v37, v62, v63
  v_mfma_f32_16x16x32_bf16 v[80:83], a[148:151], a[68:71], v[80:83]
  v_cvt_pk_bf16_f32 v38, v76, v77
  v_cvt_pk_bf16_f32 v39, v78, v79
  v_mfma_f32_16x16x32_bf16 v[84:87], a[148:151], a[76:79], v[84:87]
  ds_read_b128 a[20:23], v8 offset:29696
  buffer_store_dwordx4 v[36:39], v255, s[20:23], s95 offen offset:2048 sc1
  v_mfma_f32_16x16x32_bf16 v[84:87], a[144:147], a[72:75], v[84:87]
  s_add_u32 s95, s49, 98304
  v_cvt_pk_bf16_f32 v24, v112, v113
  v_mfma_f32_16x16x32_bf16 v[88:91], a[144:147], a[80:83], v[88:91]
  ds_read_b64_tr_b16 a[140:141], v14 offset:28672
  v_cvt_pk_bf16_f32 v25, v114, v115
  s_branch L_stubHs7
L_stubH7:
  s_setpc_b64 s[4:5]
L_stubHs7:
  v_cvt_pk_bf16_f32 v26, v128, v129
  v_mfma_f32_16x16x32_bf16 v[88:91], a[148:151], a[84:87], v[88:91]
  ds_read_b128 a[24:27], v8 offset:30720
  v_cvt_pk_bf16_f32 v27, v130, v131
  v_mfma_f32_16x16x32_bf16 v[92:95], a[148:151], a[92:95], v[92:95]
  buffer_store_dwordx4 v[24:27], v3, s[20:23], s95 offen offset:0 sc1
  v_cvt_pk_bf16_f32 v28, v116, v117
  v_mfma_f32_16x16x32_bf16 v[92:95], a[144:147], a[88:91], v[92:95]
  ds_read_b64_tr_b16 a[142:143], v14 offset:30720
  v_cvt_pk_bf16_f32 v29, v118, v119
  v_cvt_pk_bf16_f32 v30, v132, v133
  v_mfma_f32_16x16x32_bf16 v[96:99], a[152:155], a[64:67], v[96:99]
  v_cvt_pk_bf16_f32 v31, v134, v135
  v_mfma_f32_16x16x32_bf16 v[96:99], a[156:159], a[68:71], v[96:99]
  ds_read_b128 a[28:31], v8 offset:31744
  buffer_store_dwordx4 v[28:31], v3, s[20:23], s95 offen offset:2048 sc1
  v_mfma_f32_16x16x32_bf16 v[100:103], a[156:159], a[76:79], v[100:103]
  v_cvt_pk_bf16_f32 v32, v120, v121
  v_cvt_pk_bf16_f32 v33, v122, v123
  v_mfma_f32_16x16x32_bf16 v[100:103], a[152:155], a[72:75], v[100:103]
  v_cvt_pk_bf16_f32 v34, v136, v137
  v_cvt_pk_bf16_f32 v35, v138, v139
  v_mfma_f32_16x16x32_bf16 v[104:107], a[152:155], a[80:83], v[104:107]
  buffer_store_dwordx4 v[32:35], v255, s[20:23], s95 offen offset:0 sc1
  v_cvt_pk_bf16_f32 v36, v124, v125
  v_mfma_f32_16x16x32_bf16 v[104:107], a[156:159], a[84:87], v[104:107]
  v_cvt_pk_bf16_f32 v37, v126, v127
  v_mfma_f32_16x16x32_bf16 v[108:111], a[156:159], a[92:95], v[108:111]
  v_cvt_pk_bf16_f32 v38, v140, v141
  v_cvt_pk_bf16_f32 v39, v142, v143
  v_mfma_f32_16x16x32_bf16 v[108:111], a[152:155], a[88:91], v[108:111]
  buffer_store_dwordx4 v[36:39], v255, s[20:23], s95 offen offset:2048 sc1
  s_waitcnt vmcnt(26) lgkmcnt(0)
  s_barrier
  v_mfma_f32_16x16x32_bf16 v[176:179], a[128:131], a[0:3], 0
  ds_read_b64_tr_b16 a[144:145], v9 offset:0
  ds_read_b128 a[64:67], v6 offset:0
  s_add_u32 s95, s49, 65536
  v_mfma_f32_16x16x32_bf16 v[176:179], a[132:135], a[4:7], v[176:179]
  ds_read_b64_tr_b16 a[146:147], v9 offset:2048
  v_cvt_pk_bf16_f32 v24, v144, v145
  v_cvt_pk_bf16_f32 v25, v146, v147
  v_mfma_f32_16x16x32_bf16 v[180:183], a[132:135], a[12:15], 0
  ds_read_b128 a[68:71], v6 offset:1024
  v_cvt_pk_bf16_f32 v26, v160, v161
  v_mfma_f32_16x16x32_bf16 v[180:183], a[128:131], a[8:11], v[180:183]
  ds_read_b64_tr_b16 a[148:149], v9 offset:4096
  v_cvt_pk_bf16_f32 v27, v162, v163
  v_mfma_f32_16x16x32_bf16 v[184:187], a[128:131], a[16:19], 0
  ds_read_b128 a[72:75], v6 offset:2048
  buffer_store_dwordx4 v[24:27], v3, s[20:23], s95 offen offset:0 sc1
  v_mfma_f32_16x16x32_bf16 v[184:187], a[132:135], a[20:23], v[184:187]
  ds_read_b64_tr_b16 a[150:151], v9 offset:6144
  v_cvt_pk_bf16_f32 v28, v148, v149
  v_cvt_pk_bf16_f32 v29, v150, v151
  v_mfma_f32_16x16x32_bf16 v[188:191], a[132:135], a[28:31], 0
  ds_read_b128 a[76:79], v6 offset:3072
  v_cvt_pk_bf16_f32 v30, v164, v165
  v_cvt_pk_bf16_f32 v31, v166, v167
  v_mfma_f32_16x16x32_bf16 v[188:191], a[128:131], a[24:27], v[188:191]
  ds_read_b64_tr_b16 a[152:153], v10 offset:0
  ds_read_b128 a[80:83], v6 offset:4096
  v_mfma_f32_16x16x32_bf16 v[192:195], a[136:139], a[0:3], 0
  ds_read_b64_tr_b16 a[154:155], v10 offset:2048
  buffer_store_dwordx4 v[28:31], v3, s[20:23], s95 offen offset:2048 sc1
  v_mfma_f32_16x16x32_bf16 v[192:195], a[140:143], a[4:7], v[192:195]
  ds_read_b128 a[84:87], v6 offset:5120
  v_cvt_pk_bf16_f32 v32, v152, v153
  v_cvt_pk_bf16_f32 v33, v154, v155
  v_mfma_f32_16x16x32_bf16 v[196:199], a[140:143], a[12:15], 0
  ds_read_b64_tr_b16 a[156:157], v10 offset:4096
  v_cvt_pk_bf16_f32 v34, v168, v169
  v_cvt_pk_bf16_f32 v35, v170, v171
  v_mfma_f32_16x16x32_bf16 v[196:199], a[136:139], a[8:11], v[196:199]
  ds_read_b128 a[88:91], v6 offset:6144
  buffer_store_dwordx4 v[32:35], v255, s[20:23], s95 offen offset:0 sc1
  v_mfma_f32_16x16x32_bf16 v[200:203], a[136:139], a[16:19], 0
  ds_read_b64_tr_b16 a[158:159], v10 offset:6144
  v_cvt_pk_bf16_f32 v36, v156, v157
  v_cvt_pk_bf16_f32 v37, v158, v159
  v_mfma_f32_16x16x32_bf16 v[200:203], a[140:143], a[20:23], v[200:203]
  ds_read_b128 a[92:95], v6 offset:7168
  v_cvt_pk_bf16_f32 v38, v172, v173
  v_mfma_f32_16x16x32_bf16 v[204:207], a[140:143], a[28:31], 0
  v_cvt_pk_bf16_f32 v39, v174, v175
  v_mfma_f32_16x16x32_bf16 v[204:207], a[136:139], a[24:27], v[204:207]
  buffer_store_dwordx4 v[36:39], v255, s[20:23], s95 offen offset:2048 sc1
  s_waitcnt vmcnt(24) lgkmcnt(0)
  s_barrier
  v_mfma_f32_16x16x32_bf16 v[176:179], a[144:147], a[64:67], v[176:179]
  s_add_u32 m0, s42, 114688
  ds_read_b64_tr_b16 a[128:129], v9 offset:24576
  v_mfma_f32_16x16x32_bf16 v[176:179], a[148:151], a[68:71], v[176:179]
  buffer_load_dwordx4 v4, s[8:11], s35 offen offset:0 lds
  v_mfma_f32_16x16x32_bf16 v[180:183], a[148:151], a[76:79], v[180:183]
  ds_read_b128 a[0:3], v6 offset:24576
  ds_read_b64_tr_b16 a[130:131], v9 offset:26624
  v_mfma_f32_16x16x32_bf16 v[180:183], a[144:147], a[72:75], v[180:183]
  buffer_load_dwordx4 v5, s[8:11], s35 offen offset:1024 lds
  v_mfma_f32_16x16x32_bf16 v[184:187], a[144:147], a[80:83], v[184:187]
  ds_read_b128 a[4:7], v6 offset:25600
  ds_read_b64_tr_b16 a[132:133], v9 offset:28672
  v_mfma_f32_16x16x32_bf16 v[184:187], a[148:151], a[84:87], v[184:187]
  s_add_u32 s35, s35, 131072
  s_add_u32 m0, s36, 98304
  v_mfma_f32_16x16x32_bf16 v[188:191], a[148:151], a[92:95], v[188:191]
  buffer_load_dwordx4 v3, s[20:23], s32 offen offset:0 sc1 lds
  v_mfma_f32_16x16x32_bf16 v[188:191], a[144:147], a[88:91], v[188:191]
  ds_read_b128 a[8:11], v6 offset:26624
  ds_read_b64_tr_b16 a[134:135], v9 offset:30720
  v_mfma_f32_16x16x32_bf16 v[192:195], a[152:155], a[64:67], v[192:195]
  buffer_load_dwordx4 v252, s[20:23], s32 offen offset:1024 sc1 lds
  v_mfma_f32_16x16x32_bf16 v[192:195], a[156:159], a[68:71], v[192:195]
  ds_read_b128 a[12:15], v6 offset:27648
  ds_read_b64_tr_b16 a[136:137], v10 offset:24576
  v_mfma_f32_16x16x32_bf16 v[196:199], a[156:159], a[76:79], v[196:199]
  ds_read_b128 a[16:19], v6 offset:28672
  ds_read_b64_tr_b16 a[138:139], v10 offset:26624
  v_mfma_f32_16x16x32_bf16 v[196:199], a[152:155], a[72:75], v[196:199]
  buffer_load_dwordx4 v253, s[20:23], s32 offen offset:2048 sc1 lds
  v_mfma_f32_16x16x32_bf16 v[200:203], a[152:155], a[80:83], v[200:203]
  ds_read_b128 a[20:23], v6 offset:29696
  ds_read_b64_tr_b16 a[140:141], v10 offset:28672
  ds_read_b128 a[24:27], v6 offset:30720
  v_mfma_f32_16x16x32_bf16 v[200:203], a[156:159], a[84:87], v[200:203]
  buffer_load_dwordx4 v254, s[20:23], s32 offen offset:3072 sc1 lds
  ds_read_b64_tr_b16 a[142:143], v10 offset:30720
  ds_read_b128 a[28:31], v6 offset:31744
  v_mfma_f32_16x16x32_bf16 v[204:207], a[156:159], a[92:95], v[204:207]
  s_add_u32 s32, s32, 4096
  v_mfma_f32_16x16x32_bf16 v[204:207], a[152:155], a[88:91], v[204:207]
  s_waitcnt vmcnt(24) lgkmcnt(0)
  s_barrier
  v_mfma_f32_16x16x32_bf16 v[176:179], a[128:131], a[0:3], v[176:179]
  s_add_u32 m0, s42, 139264
  ds_read_b64_tr_b16 a[144:145], v11 offset:0
  v_mfma_f32_16x16x32_bf16 v[176:179], a[132:135], a[4:7], v[176:179]
  buffer_load_dwordx4 v4, s[8:11], s35 offen offset:0 lds
  v_mfma_f32_16x16x32_bf16 v[180:183], a[132:135], a[12:15], v[180:183]
  ds_read_b128 a[64:67], v7 offset:0
  ds_read_b64_tr_b16 a[146:147], v11 offset:2048
  v_mfma_f32_16x16x32_bf16 v[180:183], a[128:131], a[8:11], v[180:183]
  buffer_load_dwordx4 v5, s[8:11], s35 offen offset:1024 lds
  v_mfma_f32_16x16x32_bf16 v[184:187], a[128:131], a[16:19], v[184:187]
  ds_read_b128 a[68:71], v7 offset:1024
  ds_read_b64_tr_b16 a[148:149], v11 offset:4096
  v_mfma_f32_16x16x32_bf16 v[184:187], a[132:135], a[20:23], v[184:187]
  s_add_u32 s35, s35, 131072
  s_add_u32 m0, s36, 122880
  v_mfma_f32_16x16x32_bf16 v[188:191], a[132:135], a[28:31], v[188:191]
  buffer_load_dwordx4 v3, s[20:23], s32 offen offset:0 sc1 lds
  v_mfma_f32_16x16x32_bf16 v[188:191], a[128:131], a[24:27], v[188:191]
  ds_read_b128 a[72:75], v7 offset:2048
  ds_read_b64_tr_b16 a[150:151], v11 offset:6144
  v_mfma_f32_16x16x32_bf16 v[192:195], a[136:139], a[0:3], v[192:195]
  buffer_load_dwordx4 v252, s[20:23], s32 offen offset:1024 sc1 lds
  v_mfma_f32_16x16x32_bf16 v[192:195], a[140:143], a[4:7], v[192:195]
  ds_read_b128 a[76:79], v7 offset:3072
  ds_read_b64_tr_b16 a[152:153], v12 offset:0
  v_mfma_f32_16x16x32_bf16 v[196:199], a[140:143], a[12:15], v[196:199]
  ds_read_b128 a[80:83], v7 offset:4096
  ds_read_b64_tr_b16 a[154:155], v12 offset:2048
  v_mfma_f32_16x16x32_bf16 v[196:199], a[136:139], a[8:11], v[196:199]
  buffer_load_dwordx4 v253, s[20:23], s32 offen offset:2048 sc1 lds
  v_mfma_f32_16x16x32_bf16 v[200:203], a[136:139], a[16:19], v[200:203]
  ds_read_b128 a[84:87], v7 offset:5120
  ds_read_b64_tr_b16 a[156:157], v12 offset:4096
  ds_read_b128 a[88:91], v7 offset:6144
  v_mfma_f32_16x16x32_bf16 v[200:203], a[140:143], a[20:23], v[200:203]
  buffer_load_dwordx4 v254, s[20:23], s32 offen offset:3072 sc1 lds
  ds_read_b64_tr_b16 a[158:159], v12 offset:6144
  ds_read_b128 a[92:95], v7 offset:7168
  v_mfma_f32_16x16x32_bf16 v[204:207], a[140:143], a[28:31], v[204:207]
  s_add_u32 s32, s32, 4096
  v_mfma_f32_16x16x32_bf16 v[204:207], a[136:139], a[24:27], v[204:207]
  s_waitcnt vmcnt(12) lgkmcnt(0)
  s_barrier
  v_mfma_f32_16x16x32_bf16 v[176:179], a[144:147], a[64:67], v[176:179]
  ds_read_b64_tr_b16 a[128:129], v11 offset:24576
  ds_read_b128 a[0:3], v7 offset:24576
  v_and_b32 v40, 15, v1
  v_bfe_u32 v41, v1, 4, 1
  v_mfma_f32_16x16x32_bf16 v[176:179], a[148:151], a[68:71], v[176:179]
  s_mov_b64 exec, 14
  buffer_store_dword v15, v16, s[20:23], s63 offen sc1
  s_mov_b64 exec, -1
  v_mfma_f32_16x16x32_bf16 v[180:183], a[148:151], a[76:79], v[180:183]
  s_add_u32 m0, s42, 16384
  ds_read_b64_tr_b16 a[130:131], v11 offset:26624
  v_lshrrev_b32 v42, 5, v1
  v_lshlrev_b32 v40, 11, v40
  v_mfma_f32_16x16x32_bf16 v[180:183], a[144:147], a[72:75], v[180:183]
  buffer_load_dwordx4 v4, s[8:11], s35 offen offset:0 lds
  v_lshl_add_u32 v40, v41, 5, v40
  v_mfma_f32_16x16x32_bf16 v[184:187], a[144:147], a[80:83], v[184:187]
  ds_read_b128 a[4:7], v7 offset:25600
  ds_read_b64_tr_b16 a[132:133], v11 offset:28672
  v_lshl_add_u32 v40, v42, 4, v40
  v_mfma_f32_16x16x32_bf16 v[184:187], a[148:151], a[84:87], v[184:187]
  buffer_load_dwordx4 v5, s[8:11], s35 offen offset:1024 lds
  s_lshl_b32 s4, s25, 19
  s_lshl_b32 s5, s41, 17
  v_mfma_f32_16x16x32_bf16 v[188:191], a[148:151], a[92:95], v[188:191]
  s_add_u32 s35, s35, 131072
  s_add_u32 m0, s36, 0
  s_and_b32 s5, s5, 262144
  v_mfma_f32_16x16x32_bf16 v[188:191], a[144:147], a[88:91], v[188:191]
  buffer_load_dwordx4 v3, s[20:23], s32 offen offset:0 sc1 lds
  s_add_u32 s4, s4, s5
  v_mfma_f32_16x16x32_bf16 v[192:195], a[152:155], a[64:67], v[192:195]
  ds_read_b128 a[8:11], v7 offset:26624
  ds_read_b64_tr_b16 a[134:135], v11 offset:30720
  s_lshl_b32 s5, s38, 17
  v_mfma_f32_16x16x32_bf16 v[192:195], a[156:159], a[68:71], v[192:195]
  buffer_load_dwordx4 v252, s[20:23], s32 offen offset:1024 sc1 lds
  s_add_u32 s4, s4, s5
  v_mfma_f32_16x16x32_bf16 v[196:199], a[156:159], a[76:79], v[196:199]
  ds_read_b128 a[12:15], v7 offset:27648
  ds_read_b64_tr_b16 a[136:137], v12 offset:24576
  s_lshl_b32 s5, s39, 6
  s_add_u32 s4, s4, s5
  v_mfma_f32_16x16x32_bf16 v[196:199], a[152:155], a[72:75], v[196:199]
  buffer_load_dwordx4 v253, s[20:23], s32 offen offset:2048 sc1 lds
  s_add_u32 s97, s4, s43
  v_mfma_f32_16x16x32_bf16 v[200:203], a[152:155], a[80:83], v[200:203]
  ds_read_b128 a[16:19], v7 offset:28672
  ds_read_b64_tr_b16 a[138:139], v12 offset:26624
  ds_read_b128 a[20:23], v7 offset:29696
  v_sub_f32 v32, 1.0, v20
  v_mfma_f32_16x16x32_bf16 v[200:203], a[156:159], a[84:87], v[200:203]
  buffer_load_dwordx4 v254, s[20:23], s32 offen offset:3072 sc1 lds
  ds_read_b64_tr_b16 a[140:141], v12 offset:28672
  ds_read_b128 a[24:27], v7 offset:30720
  ds_read_b64_tr_b16 a[142:143], v12 offset:30720
  ds_read_b128 a[28:31], v7 offset:31744
  v_mfma_f32_16x16x32_bf16 v[204:207], a[156:159], a[92:95], v[204:207]
  s_add_u32 s32, s32, 4096
  v_sub_f32 v34, 1.0, v21
  v_sub_f32 v36, 1.0, v22
  v_mfma_f32_16x16x32_bf16 v[204:207], a[152:155], a[88:91], v[204:207]
  v_sub_f32 v38, 1.0, v23
  s_waitcnt vmcnt(13) lgkmcnt(0)
  s_barrier
  v_mfma_f32_16x16x32_bf16 v[176:179], a[128:131], a[0:3], v[176:179]
  s_add_u32 m0, s42, 40960
  ds_read_b64_tr_b16 a[144:145], v13 offset:0
  v_mfma_f32_16x16x32_bf16 v[176:179], a[132:135], a[4:7], v[176:179]
  buffer_load_dwordx4 v4, s[8:11], s35 offen offset:0 lds
  v_mfma_f32_16x16x32_bf16 v[180:183], a[132:135], a[12:15], v[180:183]
  ds_read_b128 a[64:67], v8 offset:0
  ds_read_b64_tr_b16 a[146:147], v13 offset:2048
  v_mfma_f32_16x16x32_bf16 v[180:183], a[128:131], a[8:11], v[180:183]
  buffer_load_dwordx4 v5, s[8:11], s35 offen offset:1024 lds
  v_mfma_f32_16x16x32_bf16 v[184:187], a[128:131], a[16:19], v[184:187]
  ds_read_b128 a[68:71], v8 offset:1024
  ds_read_b64_tr_b16 a[148:149], v13 offset:4096
  v_mfma_f32_16x16x32_bf16 v[184:187], a[132:135], a[20:23], v[184:187]
  s_add_u32 s35, s35, 131072
  s_add_u32 m0, s36, 24576
  v_mfma_f32_16x16x32_bf16 v[188:191], a[132:135], a[28:31], v[188:191]
  buffer_load_dwordx4 v3, s[20:23], s32 offen offset:0 sc1 lds
  v_mfma_f32_16x16x32_bf16 v[188:191], a[128:131], a[24:27], v[188:191]
  ds_read_b128 a[72:75], v8 offset:2048
  ds_read_b64_tr_b16 a[150:151], v13 offset:6144
  v_mfma_f32_16x16x32_bf16 v[192:195], a[136:139], a[0:3], v[192:195]
  buffer_load_dwordx4 v252, s[20:23], s32 offen offset:1024 sc1 lds
  v_mfma_f32_16x16x32_bf16 v[192:195], a[140:143], a[4:7], v[192:195]
  ds_read_b128 a[76:79], v8 offset:3072
  ds_read_b64_tr_b16 a[152:153], v14 offset:0
  v_mfma_f32_16x16x32_bf16 v[196:199], a[140:143], a[12:15], v[196:199]
  ds_read_b128 a[80:83], v8 offset:4096
  ds_read_b64_tr_b16 a[154:155], v14 offset:2048
  v_mfma_f32_16x16x32_bf16 v[196:199], a[136:139], a[8:11], v[196:199]
  buffer_load_dwordx4 v253, s[20:23], s32 offen offset:2048 sc1 lds
  v_mfma_f32_16x16x32_bf16 v[200:203], a[136:139], a[16:19], v[200:203]
  ds_read_b128 a[84:87], v8 offset:5120
  ds_read_b64_tr_b16 a[156:157], v14 offset:4096
  ds_read_b128 a[88:91], v8 offset:6144
  v_mfma_f32_16x16x32_bf16 v[200:203], a[140:143], a[20:23], v[200:203]
  buffer_load_dwordx4 v254, s[20:23], s32 offen offset:3072 sc1 lds
  ds_read_b64_tr_b16 a[158:159], v14 offset:6144
  ds_read_b128 a[92:95], v8 offset:7168
  v_mfma_f32_16x16x32_bf16 v[204:207], a[140:143], a[28:31], v[204:207]
  s_add_u32 s32, s32, 4096
  v_mfma_f32_16x16x32_bf16 v[204:207], a[136:139], a[24:27], v[204:207]
  s_waitcnt vmcnt(13) lgkmcnt(0)
  s_barrier
  v_mfma_f32_16x16x32_bf16 v[176:179], a[144:147], a[64:67], v[176:179]
  s_lshl_b32 s94, s1, 7
  s_add_u32 s94, s94, s63
  v_mfma_f32_16x16x32_bf16 v[176:179], a[148:151], a[68:71], v[176:179]
  buffer_load_dwordx4 v[44:47], off, s[20:23], s94 sc1
  v_mfma_f32_16x16x32_bf16 v[180:183], a[148:151], a[76:79], v[180:183]
  s_add_u32 m0, s42, 65536
  ds_read_b64_tr_b16 a[128:129], v13 offset:24576
  v_mfma_f32_16x16x32_bf16 v[180:183], a[144:147], a[72:75], v[180:183]
  buffer_load_dwordx4 v4, s[8:11], s35 offen offset:0 lds
  v_mfma_f32_16x16x32_bf16 v[184:187], a[144:147], a[80:83], v[184:187]
  ds_read_b128 a[0:3], v8 offset:24576
  ds_read_b64_tr_b16 a[130:131], v13 offset:26624
  v_mfma_f32_16x16x32_bf16 v[184:187], a[148:151], a[84:87], v[184:187]
  buffer_load_dwordx4 v5, s[8:11], s35 offen offset:1024 lds
  v_mfma_f32_16x16x32_bf16 v[188:191], a[148:151], a[92:95], v[188:191]
  s_add_u32 s35, s35, 131072
  s_add_u32 m0, s36, 49152
  v_mfma_f32_16x16x32_bf16 v[188:191], a[144:147], a[88:91], v[188:191]
  buffer_load_dwordx4 v3, s[20:23], s32 offen offset:0 sc1 lds
  v_mfma_f32_16x16x32_bf16 v[192:195], a[152:155], a[64:67], v[192:195]
  ds_read_b128 a[4:7], v8 offset:25600
  ds_read_b64_tr_b16 a[132:133], v13 offset:28672
  v_mfma_f32_16x16x32_bf16 v[192:195], a[156:159], a[68:71], v[192:195]
  buffer_load_dwordx4 v252, s[20:23], s32 offen offset:1024 sc1 lds
  v_mfma_f32_16x16x32_bf16 v[196:199], a[156:159], a[76:79], v[196:199]
  ds_read_b128 a[8:11], v8 offset:26624
  ds_read_b64_tr_b16 a[134:135], v13 offset:30720
  v_mfma_f32_16x16x32_bf16 v[196:199], a[152:155], a[72:75], v[196:199]
  buffer_load_dwordx4 v253, s[20:23], s32 offen offset:2048 sc1 lds
  v_mfma_f32_16x16x32_bf16 v[200:203], a[152:155], a[80:83], v[200:203]
  ds_read_b128 a[12:15], v8 offset:27648
  ds_read_b64_tr_b16 a[136:137], v14 offset:24576
  ds_read_b128 a[16:19], v8 offset:28672
  v_mfma_f32_16x16x32_bf16 v[200:203], a[156:159], a[84:87], v[200:203]
  buffer_load_dwordx4 v254, s[20:23], s32 offen offset:3072 sc1 lds
  ds_read_b64_tr_b16 a[138:139], v14 offset:26624
  ds_read_b128 a[20:23], v8 offset:29696
  ds_read_b64_tr_b16 a[140:141], v14 offset:28672
  ds_read_b128 a[24:27], v8 offset:30720
  ds_read_b64_tr_b16 a[142:143], v14 offset:30720
  ds_read_b128 a[28:31], v8 offset:31744
  v_mfma_f32_16x16x32_bf16 v[204:207], a[156:159], a[92:95], v[204:207]
  s_add_u32 s32, s32, 4096
  v_mfma_f32_16x16x32_bf16 v[204:207], a[152:155], a[88:91], v[204:207]
  s_waitcnt vmcnt(13) lgkmcnt(0)
  s_barrier
  v_mfma_f32_16x16x32_bf16 v[176:179], a[128:131], a[0:3], v[176:179]
  s_add_u32 m0, s36, 73728
  ds_read_b64_tr_b16 a[144:145], v9 offset:0
  v_mfma_f32_16x16x32_bf16 v[176:179], a[132:135], a[4:7], v[176:179]
  buffer_load_dwordx4 v3, s[20:23], s32 offen offset:0 sc1 lds
  v_mfma_f32_16x16x32_bf16 v[180:183], a[132:135], a[12:15], v[180:183]
  ds_read_b128 a[64:67], v6 offset:0
  ds_read_b64_tr_b16 a[146:147], v9 offset:2048
  v_mfma_f32_16x16x32_bf16 v[180:183], a[128:131], a[8:11], v[180:183]
  ds_read_b128 a[68:71], v6 offset:1024
  ds_read_b64_tr_b16 a[148:149], v9 offset:4096
  v_mfma_f32_16x16x32_bf16 v[184:187], a[128:131], a[16:19], v[184:187]
  buffer_load_dwordx4 v252, s[20:23], s32 offen offset:1024 sc1 lds
  v_mfma_f32_16x16x32_bf16 v[184:187], a[132:135], a[20:23], v[184:187]
  ds_read_b128 a[72:75], v6 offset:2048
  ds_read_b64_tr_b16 a[150:151], v9 offset:6144
  v_mfma_f32_16x16x32_bf16 v[188:191], a[132:135], a[28:31], v[188:191]
  ds_read_b128 a[76:79], v6 offset:3072
  v_mfma_f32_16x16x32_bf16 v[188:191], a[128:131], a[24:27], v[188:191]
  ds_read_b64_tr_b16 a[152:153], v10 offset:0
  ds_read_b128 a[80:83], v6 offset:4096
  v_mfma_f32_16x16x32_bf16 v[192:195], a[136:139], a[0:3], v[192:195]
  buffer_load_dwordx4 v253, s[20:23], s32 offen offset:2048 sc1 lds
  v_mfma_f32_16x16x32_bf16 v[192:195], a[140:143], a[4:7], v[192:195]
  ds_read_b64_tr_b16 a[154:155], v10 offset:2048
  ds_read_b128 a[84:87], v6 offset:5120
  v_mfma_f32_16x16x32_bf16 v[196:199], a[140:143], a[12:15], v[196:199]
  ds_read_b64_tr_b16 a[156:157], v10 offset:4096
  v_mfma_f32_16x16x32_bf16 v[196:199], a[136:139], a[8:11], v[196:199]
  ds_read_b128 a[88:91], v6 offset:6144
  v_mfma_f32_16x16x32_bf16 v[200:203], a[136:139], a[16:19], v[200:203]
  buffer_load_dwordx4 v254, s[20:23], s32 offen offset:3072 sc1 lds
  v_mfma_f32_16x16x32_bf16 v[200:203], a[140:143], a[20:23], v[200:203]
  s_add_u32 s32, s32, 4096
  ds_read_b64_tr_b16 a[158:159], v10 offset:6144
  ds_read_b128 a[92:95], v6 offset:7168
  v_mfma_f32_16x16x32_bf16 v[204:207], a[140:143], a[28:31], v[204:207]
  v_mfma_f32_16x16x32_bf16 v[204:207], a[136:139], a[24:27], v[204:207]
  s_waitcnt vmcnt(10) lgkmcnt(0)
  s_barrier
  v_and_b32 v44, v45, v46
  v_and_b32 v44, v44, v47
  s_nop 0
  v_readfirstlane_b32 s4, v44
  s_nop 0
  s_cmp_eq_u32 s4, 1
  s_cbranch_scc0 L2_p_slowH
L2_p_okH:
  v_mfma_f32_16x16x32_bf16 v[176:179], a[144:147], a[64:67], v[176:179]
  ds_read_b64_tr_b16 a[128:129], v9 offset:24576
  ds_read_b128 a[0:3], v6 offset:24576
  v_mfma_f32_16x16x32_bf16 v[176:179], a[148:151], a[68:71], v[176:179]
  buffer_load_dwordx4 v[112:115], v3, s[20:23], s60 offen offset:0 sc1
  v_mfma_f32_16x16x32_bf16 v[180:183], a[148:151], a[76:79], v[180:183]
  buffer_load_dwordx4 v[116:119], v3, s[20:23], s60 offen offset:2048 sc1
  v_mfma_f32_16x16x32_bf16 v[180:183], a[144:147], a[72:75], v[180:183]
  ds_read_b64_tr_b16 a[130:131], v9 offset:26624
  ds_read_b128 a[4:7], v6 offset:25600
  v_mfma_f32_16x16x32_bf16 v[184:187], a[144:147], a[80:83], v[184:187]
  buffer_load_dwordx4 v[120:123], v255, s[20:23], s60 offen offset:0 sc1
  v_mfma_f32_16x16x32_bf16 v[184:187], a[148:151], a[84:87], v[184:187]
  ds_read_b64_tr_b16 a[132:133], v9 offset:28672
  ds_read_b128 a[8:11], v6 offset:26624
  v_mfma_f32_16x16x32_bf16 v[188:191], a[148:151], a[92:95], v[188:191]
  buffer_load_dwordx4 v[124:127], v255, s[20:23], s60 offen offset:2048 sc1
  v_mfma_f32_16x16x32_bf16 v[188:191], a[144:147], a[88:91], v[188:191]
  s_add_u32 m0, s36, 98304
  ds_read_b64_tr_b16 a[134:135], v9 offset:30720
  v_mfma_f32_16x16x32_bf16 v[192:195], a[152:155], a[64:67], v[192:195]
  buffer_load_dwordx4 v3, s[20:23], s32 offen offset:0 sc1 lds
  v_mfma_f32_16x16x32_bf16 v[192:195], a[156:159], a[68:71], v[192:195]
  ds_read_b128 a[12:15], v6 offset:27648
  ds_read_b64_tr_b16 a[136:137], v10 offset:24576
  v_mfma_f32_16x16x32_bf16 v[196:199], a[156:159], a[76:79], v[196:199]
  buffer_load_dwordx4 v252, s[20:23], s32 offen offset:1024 sc1 lds
  v_mfma_f32_16x16x32_bf16 v[196:199], a[152:155], a[72:75], v[196:199]
  ds_read_b128 a[16:19], v6 offset:28672
  ds_read_b64_tr_b16 a[138:139], v10 offset:26624
  v_mfma_f32_16x16x32_bf16 v[200:203], a[152:155], a[80:83], v[200:203]
  buffer_load_dwordx4 v253, s[20:23], s32 offen offset:2048 sc1 lds
  v_mfma_f32_16x16x32_bf16 v[200:203], a[156:159], a[84:87], v[200:203]
  ds_read_b128 a[20:23], v6 offset:29696
  ds_read_b64_tr_b16 a[140:141], v10 offset:28672
  ds_read_b128 a[24:27], v6 offset:30720
  ds_read_b64_tr_b16 a[142:143], v10 offset:30720
  ds_read_b128 a[28:31], v6 offset:31744
  v_mfma_f32_16x16x32_bf16 v[204:207], a[156:159], a[92:95], v[204:207]
  buffer_load_dwordx4 v254, s[20:23], s32 offen offset:3072 sc1 lds
  v_mfma_f32_16x16x32_bf16 v[204:207], a[152:155], a[88:91], v[204:207]
  s_add_u32 s32, s32, 4096
  s_waitcnt vmcnt(12) lgkmcnt(0)
  s_barrier
  v_mfma_f32_16x16x32_bf16 v[176:179], a[128:131], a[0:3], v[176:179]
  ds_read_b64_tr_b16 a[144:145], v11 offset:0
  ds_read_b128 a[64:67], v7 offset:0
  v_mfma_f32_16x16x32_bf16 v[176:179], a[132:135], a[4:7], v[176:179]
  buffer_load_dwordx4 v[128:131], v3, s[20:23], s61 offen offset:0 sc1
  v_mfma_f32_16x16x32_bf16 v[180:183], a[132:135], a[12:15], v[180:183]
  buffer_load_dwordx4 v[132:135], v3, s[20:23], s61 offen offset:2048 sc1
  v_mfma_f32_16x16x32_bf16 v[180:183], a[128:131], a[8:11], v[180:183]
  ds_read_b64_tr_b16 a[146:147], v11 offset:2048
  ds_read_b128 a[68:71], v7 offset:1024
  v_mfma_f32_16x16x32_bf16 v[184:187], a[128:131], a[16:19], v[184:187]
  buffer_load_dwordx4 v[136:139], v255, s[20:23], s61 offen offset:0 sc1
  v_mfma_f32_16x16x32_bf16 v[184:187], a[132:135], a[20:23], v[184:187]
  ds_read_b64_tr_b16 a[148:149], v11 offset:4096
  ds_read_b128 a[72:75], v7 offset:2048
  v_mfma_f32_16x16x32_bf16 v[188:191], a[132:135], a[28:31], v[188:191]
  buffer_load_dwordx4 v[140:143], v255, s[20:23], s61 offen offset:2048 sc1
  v_mfma_f32_16x16x32_bf16 v[188:191], a[128:131], a[24:27], v[188:191]
  s_add_u32 m0, s36, 122880
  ds_read_b64_tr_b16 a[150:151], v11 offset:6144
  v_mfma_f32_16x16x32_bf16 v[192:195], a[136:139], a[0:3], v[192:195]
  buffer_load_dwordx4 v3, s[20:23], s32 offen offset:0 sc1 lds
  v_mfma_f32_16x16x32_bf16 v[192:195], a[140:143], a[4:7], v[192:195]
  ds_read_b128 a[76:79], v7 offset:3072
  ds_read_b64_tr_b16 a[152:153], v12 offset:0
  v_mfma_f32_16x16x32_bf16 v[196:199], a[140:143], a[12:15], v[196:199]
  buffer_load_dwordx4 v252, s[20:23], s32 offen offset:1024 sc1 lds
  v_mfma_f32_16x16x32_bf16 v[196:199], a[136:139], a[8:11], v[196:199]
  ds_read_b128 a[80:83], v7 offset:4096
  ds_read_b64_tr_b16 a[154:155], v12 offset:2048
  v_mfma_f32_16x16x32_bf16 v[200:203], a[136:139], a[16:19], v[200:203]
  buffer_load_dwordx4 v253, s[20:23], s32 offen offset:2048 sc1 lds
  v_mfma_f32_16x16x32_bf16 v[200:203], a[140:143], a[20:23], v[200:203]
  ds_read_b128 a[84:87], v7 offset:5120
  ds_read_b64_tr_b16 a[156:157], v12 offset:4096
  ds_read_b128 a[88:91], v7 offset:6144
  ds_read_b64_tr_b16 a[158:159], v12 offset:6144
  ds_read_b128 a[92:95], v7 offset:7168
  v_mfma_f32_16x16x32_bf16 v[204:207], a[140:143], a[28:31], v[204:207]
  buffer_load_dwordx4 v254, s[20:23], s32 offen offset:3072 sc1 lds
  v_mfma_f32_16x16x32_bf16 v[204:207], a[136:139], a[24:27], v[204:207]
  s_add_u32 s32, s32, 4096
  s_waitcnt vmcnt(16) lgkmcnt(0)
  s_barrier
  v_mfma_f32_16x16x32_bf16 v[176:179], a[144:147], a[64:67], v[176:179]
  ds_read_b128 a[0:3], v7 offset:24576
  v_mfma_f32_16x16x32_bf16 v[176:179], a[148:151], a[68:71], v[176:179]
  buffer_load_dwordx4 v[144:147], v3, s[20:23], s62 offen offset:0 sc1
  v_mfma_f32_16x16x32_bf16 v[180:183], a[148:151], a[76:79], v[180:183]
  buffer_load_dwordx4 v[148:151], v3, s[20:23], s62 offen offset:2048 sc1
  v_mfma_f32_16x16x32_bf16 v[180:183], a[144:147], a[72:75], v[180:183]
  ds_read_b128 a[4:7], v7 offset:25600
  ds_read_b128 a[8:11], v7 offset:26624
  v_mfma_f32_16x16x32_bf16 v[184:187], a[144:147], a[80:83], v[184:187]
  buffer_load_dwordx4 v[152:155], v255, s[20:23], s62 offen offset:0 sc1
  v_mfma_f32_16x16x32_bf16 v[184:187], a[148:151], a[84:87], v[184:187]
  ds_read_b128 a[12:15], v7 offset:27648
  v_mfma_f32_16x16x32_bf16 v[188:191], a[148:151], a[92:95], v[188:191]
  buffer_load_dwordx4 v[156:159], v255, s[20:23], s62 offen offset:2048 sc1
  v_mfma_f32_16x16x32_bf16 v[188:191], a[144:147], a[88:91], v[188:191]
  s_add_u32 m0, s36, 0
  ds_read_b128 a[16:19], v7 offset:28672
  v_mfma_f32_16x16x32_bf16 v[192:195], a[152:155], a[64:67], v[192:195]
  buffer_load_dwordx4 v3, s[20:23], s32 offen offset:0 sc1 lds
  v_mfma_f32_16x16x32_bf16 v[192:195], a[156:159], a[68:71], v[192:195]
  ds_read_b128 a[20:23], v7 offset:29696
  v_mfma_f32_16x16x32_bf16 v[196:199], a[156:159], a[76:79], v[196:199]
  buffer_load_dwordx4 v252, s[20:23], s32 offen offset:1024 sc1 lds
  v_mfma_f32_16x16x32_bf16 v[196:199], a[152:155], a[72:75], v[196:199]
  ds_read_b128 a[24:27], v7 offset:30720
  v_mfma_f32_16x16x32_bf16 v[200:203], a[152:155], a[80:83], v[200:203]
  buffer_load_dwordx4 v253, s[20:23], s32 offen offset:2048 sc1 lds
  v_mfma_f32_16x16x32_bf16 v[200:203], a[156:159], a[84:87], v[200:203]
  ds_read_b128 a[28:31], v7 offset:31744
  v_mfma_f32_16x16x32_bf16 v[204:207], a[156:159], a[92:95], v[204:207]
  buffer_load_dwordx4 v254, s[20:23], s32 offen offset:3072 sc1 lds
  v_mfma_f32_16x16x32_bf16 v[204:207], a[152:155], a[88:91], v[204:207]
  s_add_u32 s32, s32, 4096
  s_waitcnt vmcnt(16) lgkmcnt(0)
  s_barrier
  v_mfma_f32_16x16x32_bf16 v[176:179], a[160:163], a[0:3], v[176:179]
  s_add_u32 m0, s36, 24576
  ds_read_b128 a[64:67], v8 offset:0
  v_mfma_f32_16x16x32_bf16 v[80:83], v[246:249], v[112:115], v[80:83]
  v_mfma_f32_16x16x32_bf16 v[176:179], a[164:167], a[4:7], v[176:179]
  buffer_load_dwordx4 v3, s[20:23], s32 offen offset:0 sc1 lds
  v_mfma_f32_16x16x32_bf16 v[96:99], v[244:247], v[112:115], v[96:99]
  v_mfma_f32_16x16x32_bf16 v[180:183], a[164:167], a[12:15], v[180:183]
  ds_read_b128 a[68:71], v8 offset:1024
  v_mfma_f32_16x16x32_bf16 v[84:87], v[246:249], v[116:119], v[84:87]
  v_mfma_f32_16x16x32_bf16 v[180:183], a[160:163], a[8:11], v[180:183]
  ds_read_b128 a[72:75], v8 offset:2048
  v_mfma_f32_16x16x32_bf16 v[100:103], v[244:247], v[116:119], v[100:103]
  v_mfma_f32_16x16x32_bf16 v[184:187], a[160:163], a[16:19], v[184:187]
  buffer_load_dwordx4 v252, s[20:23], s32 offen offset:1024 sc1 lds
  v_mfma_f32_16x16x32_bf16 v[184:187], a[164:167], a[20:23], v[184:187]
  ds_read_b128 a[76:79], v8 offset:3072
  v_mfma_f32_16x16x32_bf16 v[88:91], v[246:249], v[120:123], v[88:91]
  v_mfma_f32_16x16x32_bf16 v[188:191], a[164:167], a[28:31], v[188:191]
  v_mfma_f32_16x16x32_bf16 v[104:107], v[244:247], v[120:123], v[104:107]
  v_mfma_f32_16x16x32_bf16 v[188:191], a[160:163], a[24:27], v[188:191]
  ds_read_b128 a[80:83], v8 offset:4096
  v_mfma_f32_16x16x32_bf16 v[92:95], v[246:249], v[124:127], v[92:95]
  v_mfma_f32_16x16x32_bf16 v[192:195], a[168:171], a[0:3], v[192:195]
  buffer_load_dwordx4 v253, s[20:23], s32 offen offset:2048 sc1 lds
  v_mfma_f32_16x16x32_bf16 v[108:111], v[244:247], v[124:127], v[108:111]
  v_mfma_f32_16x16x32_bf16 v[192:195], a[172:175], a[4:7], v[192:195]
  ds_read_b128 a[84:87], v8 offset:5120
  v_mfma_f32_16x16x32_bf16 v[196:199], a[172:175], a[12:15], v[196:199]
  ds_read_b128 a[88:91], v8 offset:6144
  v_mfma_f32_16x16x32_bf16 v[196:199], a[168:171], a[8:11], v[196:199]
  s_branch L_stubHs8
L_stubH8:
  s_setpc_b64 s[4:5]
L_stubHs8:
  v_mfma_f32_16x16x32_bf16 v[200:203], a[168:171], a[16:19], v[200:203]
  buffer_load_dwordx4 v254, s[20:23], s32 offen offset:3072 sc1 lds
  v_mfma_f32_16x16x32_bf16 v[200:203], a[172:175], a[20:23], v[200:203]
  s_add_u32 s32, s32, 4096
  ds_read_b128 a[92:95], v8 offset:7168
  v_mfma_f32_16x16x32_bf16 v[204:207], a[172:175], a[28:31], v[204:207]
  v_mfma_f32_16x16x32_bf16 v[204:207], a[168:171], a[24:27], v[204:207]
  s_waitcnt vmcnt(12) lgkmcnt(0)
  s_barrier
  v_mfma_f32_16x16x32_bf16 v[176:179], a[176:179], a[64:67], v[176:179]
  s_add_u32 m0, s36, 49152
  ds_read_b128 a[0:3], v8 offset:24576
  v_mfma_f32_16x16x32_bf16 v[80:83], v[246:249], v[128:131], v[80:83]
  v_mfma_f32_16x16x32_bf16 v[176:179], a[180:183], a[68:71], v[176:179]
  buffer_load_dwordx4 v3, s[20:23], s32 offen offset:0 sc1 lds
  v_mfma_f32_16x16x32_bf16 v[96:99], v[244:247], v[128:131], v[96:99]
  v_mfma_f32_16x16x32_bf16 v[180:183], a[180:183], a[76:79], v[180:183]
  ds_read_b128 a[4:7], v8 offset:25600
  v_mfma_f32_16x16x32_bf16 v[84:87], v[246:249], v[132:135], v[84:87]
  v_mfma_f32_16x16x32_bf16 v[180:183], a[176:179], a[72:75], v[180:183]
  ds_read_b128 a[8:11], v8 offset:26624
  v_mfma_f32_16x16x32_bf16 v[100:103], v[244:247], v[132:135], v[100:103]
  v_mfma_f32_16x16x32_bf16 v[184:187], a[176:179], a[80:83], v[184:187]
  buffer_load_dwordx4 v252, s[20:23], s32 offen offset:1024 sc1 lds
  v_mfma_f32_16x16x32_bf16 v[184:187], a[180:183], a[84:87], v[184:187]
  ds_read_b128 a[12:15], v8 offset:27648
  v_mfma_f32_16x16x32_bf16 v[88:91], v[246:249], v[136:139], v[88:91]
  v_mfma_f32_16x16x32_bf16 v[188:191], a[180:183], a[92:95], v[188:191]
  v_mfma_f32_16x16x32_bf16 v[104:107], v[244:247], v[136:139], v[104:107]
  v_mfma_f32_16x16x32_bf16 v[188:191], a[176:179], a[88:91], v[188:191]
  ds_read_b128 a[16:19], v8 offset:28672
  v_mfma_f32_16x16x32_bf16 v[92:95], v[246:249], v[140:143], v[92:95]
  v_mfma_f32_16x16x32_bf16 v[192:195], a[184:187], a[64:67], v[192:195]
  buffer_load_dwordx4 v253, s[20:23], s32 offen offset:2048 sc1 lds
  v_mfma_f32_16x16x32_bf16 v[108:111], v[244:247], v[140:143], v[108:111]
  v_mfma_f32_16x16x32_bf16 v[192:195], a[188:191], a[68:71], v[192:195]
  ds_read_b128 a[20:23], v8 offset:29696
  v_mfma_f32_16x16x32_bf16 v[196:199], a[188:191], a[76:79], v[196:199]
  ds_read_b128 a[24:27], v8 offset:30720
  v_mfma_f32_16x16x32_bf16 v[196:199], a[184:187], a[72:75], v[196:199]
  v_mfma_f32_16x16x32_bf16 v[200:203], a[184:187], a[80:83], v[200:203]
  buffer_load_dwordx4 v254, s[20:23], s32 offen offset:3072 sc1 lds
  v_mfma_f32_16x16x32_bf16 v[200:203], a[188:191], a[84:87], v[200:203]
  s_add_u32 s32, s32, 4096
  ds_read_b128 a[28:31], v8 offset:31744
  v_mfma_f32_16x16x32_bf16 v[204:207], a[188:191], a[92:95], v[204:207]
  v_mfma_f32_16x16x32_bf16 v[204:207], a[184:187], a[88:91], v[204:207]
  s_waitcnt vmcnt(8) lgkmcnt(0)
  s_barrier
  v_mfma_f32_16x16x32_bf16 v[176:179], a[192:195], a[0:3], v[176:179]
  ds_read_b128 a[64:67], v6 offset:0
  v_mfma_f32_16x16x32_bf16 v[80:83], v[246:249], v[144:147], v[80:83]
  v_mfma_f32_16x16x32_bf16 v[176:179], a[196:199], a[4:7], v[176:179]
  ds_read_b128 a[68:71], v6 offset:1024
  v_mfma_f32_16x16x32_bf16 v[96:99], v[244:247], v[144:147], v[96:99]
  v_mfma_f32_16x16x32_bf16 v[180:183], a[196:199], a[12:15], v[180:183]
  v_mfma_f32_16x16x32_bf16 v[84:87], v[246:249], v[148:151], v[84:87]
  v_mfma_f32_16x16x32_bf16 v[180:183], a[192:195], a[8:11], v[180:183]
  ds_read_b128 a[72:75], v6 offset:2048
  v_mfma_f32_16x16x32_bf16 v[100:103], v[244:247], v[148:151], v[100:103]
  v_mfma_f32_16x16x32_bf16 v[184:187], a[192:195], a[16:19], v[184:187]
  v_mfma_f32_16x16x32_bf16 v[184:187], a[196:199], a[20:23], v[184:187]
  ds_read_b128 a[76:79], v6 offset:3072
  v_mfma_f32_16x16x32_bf16 v[88:91], v[246:249], v[152:155], v[88:91]
  v_mfma_f32_16x16x32_bf16 v[188:191], a[196:199], a[28:31], v[188:191]
  v_mfma_f32_16x16x32_bf16 v[104:107], v[244:247], v[152:155], v[104:107]
  v_mfma_f32_16x16x32_bf16 v[188:191], a[192:195], a[24:27], v[188:191]
  ds_read_b128 a[80:83], v6 offset:4096
  v_mfma_f32_16x16x32_bf16 v[92:95], v[246:249], v[156:159], v[92:95]
  v_mfma_f32_16x16x32_bf16 v[192:195], a[200:203], a[0:3], v[192:195]
  ds_read_b128 a[84:87], v6 offset:5120
  v_mfma_f32_16x16x32_bf16 v[108:111], v[244:247], v[156:159], v[108:111]
  v_mfma_f32_16x16x32_bf16 v[192:195], a[204:207], a[4:7], v[192:195]
  v_mfma_f32_16x16x32_bf16 v[196:199], a[204:207], a[12:15], v[196:199]
  ds_read_b128 a[88:91], v6 offset:6144
  v_mfma_f32_16x16x32_bf16 v[196:199], a[200:203], a[8:11], v[196:199]
  v_mfma_f32_16x16x32_bf16 v[200:203], a[200:203], a[16:19], v[200:203]
  ds_read_b128 a[92:95], v6 offset:7168
  v_mfma_f32_16x16x32_bf16 v[200:203], a[204:207], a[20:23], v[200:203]
  v_mfma_f32_16x16x32_bf16 v[204:207], a[204:207], a[28:31], v[204:207]
  v_mfma_f32_16x16x32_bf16 v[204:207], a[200:203], a[24:27], v[204:207]
  s_waitcnt vmcnt(4) lgkmcnt(0)
  s_barrier
  v_mfma_f32_16x16x32_bf16 v[176:179], a[208:211], a[64:67], v[176:179]
  ds_read_b128 a[0:3], v6 offset:24576
  v_mfma_f32_16x16x32_bf16 v[176:179], a[212:215], a[68:71], v[176:179]
  ds_read_b128 a[4:7], v6 offset:25600
  v_mfma_f32_16x16x32_bf16 v[180:183], a[212:215], a[76:79], v[180:183]
  v_mfma_f32_16x16x32_bf16 v[180:183], a[208:211], a[72:75], v[180:183]
  ds_read_b128 a[8:11], v6 offset:26624
  v_mfma_f32_16x16x32_bf16 v[184:187], a[208:211], a[80:83], v[184:187]
  v_mfma_f32_16x16x32_bf16 v[184:187], a[212:215], a[84:87], v[184:187]
  ds_read_b128 a[12:15], v6 offset:27648
  v_mfma_f32_16x16x32_bf16 v[188:191], a[212:215], a[92:95], v[188:191]
  v_mfma_f32_16x16x32_bf16 v[188:191], a[208:211], a[88:91], v[188:191]
  ds_read_b128 a[16:19], v6 offset:28672
  v_mfma_f32_16x16x32_bf16 v[192:195], a[216:219], a[64:67], v[192:195]
  ds_read_b128 a[20:23], v6 offset:29696
  v_mfma_f32_16x16x32_bf16 v[192:195], a[220:223], a[68:71], v[192:195]
  v_mfma_f32_16x16x32_bf16 v[196:199], a[220:223], a[76:79], v[196:199]
  ds_read_b128 a[24:27], v6 offset:30720
  v_mfma_f32_16x16x32_bf16 v[196:199], a[216:219], a[72:75], v[196:199]
  v_mfma_f32_16x16x32_bf16 v[200:203], a[216:219], a[80:83], v[200:203]
  ds_read_b128 a[28:31], v6 offset:31744
  v_mfma_f32_16x16x32_bf16 v[200:203], a[220:223], a[84:87], v[200:203]
  v_mfma_f32_16x16x32_bf16 v[204:207], a[220:223], a[92:95], v[204:207]
  v_mfma_f32_16x16x32_bf16 v[204:207], a[216:219], a[88:91], v[204:207]
  s_waitcnt vmcnt(0) lgkmcnt(0)
  s_barrier
  v_mfma_f32_16x16x32_bf16 v[176:179], a[224:227], a[0:3], v[176:179]
  ds_read_b128 a[64:67], v7 offset:0
  v_mfma_f32_16x16x32_bf16 v[176:179], a[228:231], a[4:7], v[176:179]
  ds_read_b128 a[68:71], v7 offset:1024
  v_mfma_f32_16x16x32_bf16 v[180:183], a[228:231], a[12:15], v[180:183]
  v_mfma_f32_16x16x32_bf16 v[180:183], a[224:227], a[8:11], v[180:183]
  ds_read_b128 a[72:75], v7 offset:2048
  v_mfma_f32_16x16x32_bf16 v[184:187], a[224:227], a[16:19], v[184:187]
  v_mfma_f32_16x16x32_bf16 v[184:187], a[228:231], a[20:23], v[184:187]
  ds_read_b128 a[76:79], v7 offset:3072
  v_mfma_f32_16x16x32_bf16 v[188:191], a[228:231], a[28:31], v[188:191]
  v_mfma_f32_16x16x32_bf16 v[188:191], a[224:227], a[24:27], v[188:191]
  ds_read_b128 a[80:83], v7 offset:4096
  v_mfma_f32_16x16x32_bf16 v[192:195], a[232:235], a[0:3], v[192:195]
  ds_read_b128 a[84:87], v7 offset:5120
  v_mfma_f32_16x16x32_bf16 v[192:195], a[236:239], a[4:7], v[192:195]
  v_mfma_f32_16x16x32_bf16 v[196:199], a[236:239], a[12:15], v[196:199]
  ds_read_b128 a[88:91], v7 offset:6144
  v_mfma_f32_16x16x32_bf16 v[196:199], a[232:235], a[8:11], v[196:199]
  v_mfma_f32_16x16x32_bf16 v[200:203], a[232:235], a[16:19], v[200:203]
  ds_read_b128 a[92:95], v7 offset:7168
  v_mfma_f32_16x16x32_bf16 v[200:203], a[236:239], a[20:23], v[200:203]
  v_mfma_f32_16x16x32_bf16 v[204:207], a[236:239], a[28:31], v[204:207]
  v_mfma_f32_16x16x32_bf16 v[204:207], a[232:235], a[24:27], v[204:207]
  s_waitcnt vmcnt(0) lgkmcnt(0)
  v_mfma_f32_16x16x32_bf16 v[176:179], a[240:243], a[64:67], v[176:179]
  v_mfma_f32_16x16x32_bf16 v[176:179], a[244:247], a[68:71], v[176:179]
  v_mfma_f32_16x16x32_bf16 v[192:195], a[248:251], a[64:67], v[192:195]
  v_mfma_f32_16x16x32_bf16 v[192:195], a[252:255], a[68:71], v[192:195]
  v_mfma_f32_16x16x32_bf16 v[180:183], a[244:247], a[76:79], v[180:183]
  v_mfma_f32_16x16x32_bf16 v[180:183], a[240:243], a[72:75], v[180:183]
  v_mfma_f32_16x16x32_bf16 v[196:199], a[252:255], a[76:79], v[196:199]
  v_mfma_f32_16x16x32_bf16 v[196:199], a[248:251], a[72:75], v[196:199]
  v_mfma_f32_16x16x32_bf16 v[184:187], a[240:243], a[80:83], v[184:187]
  v_mfma_f32_16x16x32_bf16 v[184:187], a[244:247], a[84:87], v[184:187]
  v_mfma_f32_16x16x32_bf16 v[200:203], a[248:251], a[80:83], v[200:203]
  v_fma_f32 v80, v80, v32, v176
  v_fma_f32 v81, v81, v32, v177
  v_fma_f32 v82, v82, v32, v178
  v_mfma_f32_16x16x32_bf16 v[200:203], a[252:255], a[84:87], v[200:203]
  v_fma_f32 v83, v83, v32, v179
  v_fma_f32 v96, v96, v32, v192
  v_fma_f32 v97, v97, v32, v193
  v_mfma_f32_16x16x32_bf16 v[188:191], a[244:247], a[92:95], v[188:191]
  v_fma_f32 v98, v98, v32, v194
  v_fma_f32 v99, v99, v32, v195
  v_cvt_pk_bf16_f32 v48, v80, v81
  v_mfma_f32_16x16x32_bf16 v[188:191], a[240:243], a[88:91], v[188:191]
  v_cvt_pk_bf16_f32 v49, v82, v83
  v_cvt_pk_bf16_f32 v50, v96, v97
  v_cvt_pk_bf16_f32 v51, v98, v99
  v_mfma_f32_16x16x32_bf16 v[204:207], a[252:255], a[92:95], v[204:207]
  s_nop 1
  v_permlane16_swap_b32 v48, v50
  v_permlane16_swap_b32 v49, v51
  v_mfma_f32_16x16x32_bf16 v[204:207], a[248:251], a[88:91], v[204:207]
  buffer_store_dwordx4 v[48:51], v40, s[16:19], s97 offen sc1
  s_add_u32 s97, s97, 32768
  s_nop 1
  v_pk_fma_f32 v[84:85], v[84:85], v[34:35], v[180:181] op_sel_hi:[1,0,1]
  v_pk_fma_f32 v[86:87], v[86:87], v[34:35], v[182:183] op_sel_hi:[1,0,1]
  v_pk_fma_f32 v[100:101], v[100:101], v[34:35], v[196:197] op_sel_hi:[1,0,1]
  v_pk_fma_f32 v[102:103], v[102:103], v[34:35], v[198:199] op_sel_hi:[1,0,1]
  v_cvt_pk_bf16_f32 v52, v84, v85
  v_cvt_pk_bf16_f32 v53, v86, v87
  v_cvt_pk_bf16_f32 v54, v100, v101
  v_cvt_pk_bf16_f32 v55, v102, v103
  s_nop 1
  v_permlane16_swap_b32 v52, v54
  v_permlane16_swap_b32 v53, v55
  buffer_store_dwordx4 v[52:55], v40, s[16:19], s97 offen sc1
  s_add_u32 s97, s97, 32768
  v_pk_fma_f32 v[88:89], v[88:89], v[36:37], v[184:185] op_sel_hi:[1,0,1]
  v_pk_fma_f32 v[90:91], v[90:91], v[36:37], v[186:187] op_sel_hi:[1,0,1]
  v_pk_fma_f32 v[104:105], v[104:105], v[36:37], v[200:201] op_sel_hi:[1,0,1]
  v_pk_fma_f32 v[106:107], v[106:107], v[36:37], v[202:203] op_sel_hi:[1,0,1]
  v_cvt_pk_bf16_f32 v56, v88, v89
  v_cvt_pk_bf16_f32 v57, v90, v91
  v_cvt_pk_bf16_f32 v58, v104, v105
  v_cvt_pk_bf16_f32 v59, v106, v107
  s_nop 1
  v_permlane16_swap_b32 v56, v58
  v_permlane16_swap_b32 v57, v59
  buffer_store_dwordx4 v[56:59], v40, s[16:19], s97 offen sc1
  s_add_u32 s97, s97, 32768
  v_pk_fma_f32 v[92:93], v[92:93], v[38:39], v[188:189] op_sel_hi:[1,0,1]
  v_pk_fma_f32 v[94:95], v[94:95], v[38:39], v[190:191] op_sel_hi:[1,0,1]
  v_pk_fma_f32 v[108:109], v[108:109], v[38:39], v[204:205] op_sel_hi:[1,0,1]
  v_pk_fma_f32 v[110:111], v[110:111], v[38:39], v[206:207] op_sel_hi:[1,0,1]
  v_cvt_pk_bf16_f32 v60, v92, v93
  v_cvt_pk_bf16_f32 v61, v94, v95
  v_cvt_pk_bf16_f32 v62, v108, v109
  v_cvt_pk_bf16_f32 v63, v110, v111
  s_nop 1
  v_permlane16_swap_b32 v60, v62
  v_permlane16_swap_b32 v61, v63
  buffer_store_dwordx4 v[60:63], v40, s[16:19], s97 offen sc1
L_end:
  s_endpgm
L2_oolH:
L_stubH9:
L_stubH10:
L_stubH11:
  s_setpc_b64 s[4:5]
L1_loopH_is:
  s_mov_b32 s0, 0
L1_loopH_il:
  s_add_u32 s0, s0, 1
  s_cmp_gt_u32 s0, 262144
  s_cbranch_scc1 L1_loopH_ir
  s_sleep 8
  buffer_load_dword v47, v46, s[20:23], s69 offen sc1
  s_waitcnt vmcnt(0)
  v_cmp_eq_u32 vcc, 0, v47
  v_cmp_ne_u32 s[6:7], s53, v47
  s_nop 1
  s_cmp_lg_u64 vcc, 0
  s_cbranch_scc1 L1_loopH_il
  s_branch L1_loopH_ir
LE6a:
  buffer_store_byte v15, off, s[20:23], s55 offset:0 sc1
  s_branch LE6b
LE7a:
  buffer_load_dword v23, v22, s[20:23], s51 offen offset:4 sc1
  s_branch LE7b
LE8a:
  buffer_store_byte v15, off, s[20:23], s55 offset:32 sc1
  s_branch LE8b
LE9a:
  buffer_store_byte v15, off, s[20:23], s55 offset:64 sc1
  s_branch LE9b
LE10a:
  buffer_load_dword v23, v22, s[20:23], s51 offen offset:4 sc1
  s_branch LE10b
L2_h_slowH:
  s_mov_b32 s3, 0
L2_h_spinH:
  s_add_u32 s3, s3, 1
  s_cmp_gt_u32 s3, 262144
  s_cbranch_scc1 L2_h_okH
  s_cmp_eq_u32 s0, 1
  s_cbranch_scc0 LE10a
  buffer_load_dword v23, v22, s[20:23], s51 offen offset:4 nt
LE10b:
  s_waitcnt vmcnt(0)
  v_cmp_ne_u32 vcc, 0x01010101, v23
  s_nop 0
  s_cmp_eq_u64 vcc, 0
  s_cbranch_scc0 L2_h_spinH
  s_branch L2_h_okH
LE11a:
  buffer_load_dword v23, v22, s[20:23], s51 offen offset:36 sc1
  s_branch LE11b
LE12a:
  buffer_load_dword v23, v22, s[20:23], s51 offen offset:36 sc1
  s_branch LE12b
L2_h2_slowH:
  s_mov_b32 s3, 0
L2_h2_spinH:
  s_add_u32 s3, s3, 1
  s_cmp_gt_u32 s3, 262144
  s_cbranch_scc1 L2_h2_okH
  s_sleep 4
  s_cmp_eq_u32 s0, 1
  s_cbranch_scc0 LE12a
  buffer_load_dword v23, v22, s[20:23], s51 offen offset:36 nt
LE12b:
  s_waitcnt vmcnt(0)
  v_cmp_ne_u32 vcc, 0x01010101, v23
  s_nop 0
  s_cmp_eq_u64 vcc, 0
  s_cbranch_scc0 L2_h2_spinH
  s_branch L2_h2_okH
LE13a:
  buffer_load_dword v23, v22, s[20:23], s51 offen offset:68 sc1
  s_branch LE13b
LE14a:
  buffer_load_dword v23, v22, s[20:23], s51 offen offset:68 sc1
  s_branch LE14b
L2_h3_slowH:
  s_mov_b32 s3, 0
L2_h3_spinH:
  s_add_u32 s3, s3, 1
  s_cmp_gt_u32 s3, 262144
  s_cbranch_scc1 L2_h3_okH
  s_sleep 4
  s_cmp_eq_u32 s0, 1
  s_cbranch_scc0 LE14a
  buffer_load_dword v23, v22, s[20:23], s51 offen offset:68 nt
LE14b:
  s_waitcnt vmcnt(0)
  v_cmp_ne_u32 vcc, 0x01010101, v23
  s_nop 0
  s_cmp_eq_u64 vcc, 0
  s_cbranch_scc0 L2_h3_spinH
  s_branch L2_h3_okH
L2_k_slowH:
  s_mov_b32 s3, 0
L2_k_spinH:
  s_add_u32 s3, s3, 1
  s_cmp_gt_u32 s3, 262144
  s_cbranch_scc1 L2_k_okH
  s_sleep 4
  buffer_load_dword v45, v32, s[20:23], s54 offen sc1
  s_waitcnt vmcnt(0)
  v_cmp_ne_u32 vcc, 1, v45
  s_nop 0
  s_cmp_eq_u64 vcc, 0
  s_cbranch_scc0 L2_k_spinH
  s_branch L2_k_okH
L2_q_slowH:
  s_mov_b32 s3, 0
L2_q_spinH:
  s_add_u32 s3, s3, 1
  s_cmp_gt_u32 s3, 262144
  s_cbranch_scc1 L2_q_okH
  s_sleep 4
  buffer_load_dword v46, v33, s[20:23], s87 offen sc1
  s_waitcnt vmcnt(0)
  v_cmp_ne_u32 vcc, 1, v46
  s_nop 0
  s_cmp_eq_u64 vcc, 0
  s_cbranch_scc0 L2_q_spinH
  s_branch L2_q_okH
L2_g_slowH:
  s_mov_b32 s3, 0
L2_g_spinH:
  s_add_u32 s3, s3, 1
  s_cmp_gt_u32 s3, 262144
  s_cbranch_scc1 L2_g_okH
  s_sleep 4
  buffer_load_dword v47, v34, s[20:23], s96 offen offset:4 sc1
  s_waitcnt vmcnt(0)
  v_cmp_ne_u32 vcc, 1, v47
  s_nop 0
  s_cmp_eq_u64 vcc, 0
  s_cbranch_scc0 L2_g_spinH
  s_branch L2_g_okH
LE15a:
  buffer_load_dword v23, v22, s[20:23], s51 offen offset:64 sc1
  s_branch LE15b
LE16a:
  buffer_load_dword v23, v22, s[20:23], s51 offen offset:64 sc1
  s_branch LE16b
L2_qf_slowH:
  s_mov_b32 s3, 0
L2_qf_spinH:
  s_add_u32 s3, s3, 1
  s_cmp_gt_u32 s3, 262144
  s_cbranch_scc1 L2_qf_okH
  s_sleep 4
  s_cmp_eq_u32 s0, 1
  s_cbranch_scc0 LE16a
  buffer_load_dword v23, v22, s[20:23], s51 offen offset:64 nt
LE16b:
  s_waitcnt vmcnt(0)
  v_cmp_ne_u32 vcc, 0x01010101, v23
  s_nop 0
  s_cmp_eq_u64 vcc, 0
  s_cbranch_scc0 L2_qf_spinH
  s_branch L2_qf_okH
L2_o_slowH:
  s_mov_b32 s3, 0
L2_o_spinH:
  s_add_u32 s3, s3, 1
  s_cmp_gt_u32 s3, 262144
  s_cbranch_scc1 L2_o_okH
  s_sleep 4
  buffer_load_dword v45, v34, s[20:23], s50 offen offset:4 sc1
  s_waitcnt vmcnt(0)
  v_cmp_ne_u32 vcc, 1, v45
  s_nop 0
  s_cmp_eq_u64 vcc, 0
  s_cbranch_scc0 L2_o_spinH
  s_branch L2_o_okH
L2_p_slowH:
  s_mov_b32 s3, 0
L2_p_spinH:
  s_add_u32 s3, s3, 1
  s_cmp_gt_u32 s3, 262144
  s_cbranch_scc1 L2_p_okH
  s_sleep 4
  buffer_load_dwordx4 v[44:47], off, s[20:23], s94 sc1
  s_waitcnt vmcnt(0)
  v_and_b32 v44, v45, v46
  v_and_b32 v44, v44, v47
  s_nop 0
  v_readfirstlane_b32 s4, v44
  s_nop 0
  s_cmp_eq_u32 s4, 1
  s_cbranch_scc0 L2_p_spinH
  s_branch L2_p_okH
L2_endH:
gm_text_end:
.section .rodata,"a"
.p2align 6
.amdhsa_kernel gated_mix__linear_attn_block__dense_activation_relu__prompt_kernel
  .amdhsa_next_free_vgpr 512
  .amdhsa_next_free_sgpr 102
  .amdhsa_accum_offset 256
  .amdhsa_group_segment_fixed_size 0
  .amdhsa_kernarg_size 80
  .amdhsa_user_sgpr_count 2
  .amdhsa_user_sgpr_kernarg_segment_ptr 1
  .amdhsa_system_sgpr_workgroup_id_x 1
  .amdhsa_float_denorm_mode_32 3
.end_amdhsa_kernel
```
